```python
import torch

def _softmax(x, axis=-1):
    return torch.softmax(x, dim=axis)
def _gelu(x):
    return torch.nn.functional.gelu(x, approximate="tanh")
def _silu(x):
    return torch.nn.functional.silu(x)
def _sigmoid(x):
    return torch.sigmoid(x)
def _layernorm(x, axis=-1, eps=1e-5):
    m = x.mean(dim=axis, keepdim=True)
    v = x.var(dim=axis, keepdim=True, unbiased=False)
    return (x - m) / torch.sqrt(v + eps)
def _scatter_add(tgt, idx, src, axis=0):
    return tgt.clone().index_add_(axis, idx, src)
def _segment_sum(src, seg, n):
    out = torch.zeros((n,) + src.shape[1:], dtype=src.dtype)
    return out.index_add_(0, seg, src)
def _pad(x, pw):
    flat = tuple(v for pair in reversed(pw) for v in pair)
    return torch.nn.functional.pad(x, flat)

kernel_name = 'concat_heads__mha_block_cached__gqa_block_cached__near_ridge'

def setup_inputs():

    _w = (lambda a: (lambda t: t.to(torch.bfloat16) if t.is_floating_point() else t)(torch.as_tensor(a)))
    def _A_setup():
        B, Sq, D = 8, 240, 1024
        H, Sk, Dh = 32, 1024, 128
        return {
            "x": _w((lambda *s: torch.randn(*s, dtype=torch.bfloat16) * 0.8)(B, Sq, D)),
            "k_cache": _w((lambda *s: torch.randn(*s, dtype=torch.bfloat16) * 0.8)(B, H, Sk, Dh)),
            "v_cache": _w((lambda *s: torch.randn(*s, dtype=torch.bfloat16) * 0.05)(B, H, Sk, Dh)),
            "wq": _w((lambda *s: torch.randn(*s, dtype=torch.bfloat16) * 0.8)(D, H * Dh) * (D ** -0.5)),
            "wo": _w((lambda *s: torch.randn(*s, dtype=torch.bfloat16) * 0.05)(H * Dh, D) * ((H * Dh) ** -0.5)),
        }
    _A_in = _A_setup()

    def _B_setup():
        B, Sq, D = 8, 240, 1024
        Hq, Hkv, Sk, Dh = 32, 32, 1024, 128
        assert Hq % Hkv == 0, (Hq, Hkv)
        return {
            "x": _w((lambda *s: torch.randn(*s, dtype=torch.bfloat16) * 0.8)(B, Sq, D)),
            "k_cache": _w((lambda *s: torch.randn(*s, dtype=torch.bfloat16) * 0.8)(B, Hkv, Sk, Dh)),
            "v_cache": _w((lambda *s: torch.randn(*s, dtype=torch.bfloat16) * 0.05)(B, Hkv, Sk, Dh)),
            "wq": _w((lambda *s: torch.randn(*s, dtype=torch.bfloat16) * 0.8)(D, Hq * Dh) * (D ** -0.5)),
            "wo": _w((lambda *s: torch.randn(*s, dtype=torch.bfloat16) * 0.05)(Hq * Dh, D) * ((Hq * Dh) ** -0.5)),
        }
    _B_in = _B_setup()

    return {
        "A_x": _A_in["x"],
        "A_k_cache": _A_in["k_cache"],
        "A_v_cache": _A_in["v_cache"],
        "A_wq": _A_in["wq"],
        "A_wo": _A_in["wo"],
        "B_x": _B_in["x"],
        "B_k_cache": _B_in["k_cache"],
        "B_v_cache": _B_in["v_cache"],
        "B_wq": _B_in["wq"],
        "B_wo": _B_in["wo"],
    }

def reference(A_x, A_k_cache, A_v_cache, A_wq, A_wo, B_x, B_k_cache, B_v_cache, B_wq, B_wo):
    def _A_ref(x, k_cache, v_cache, wq, wo):
        B, Sq, D = x.shape
        H, Dh = 32, 128
        q = (lambda x, *d: x.permute(*d))((x @ wq).reshape(B, Sq, H, Dh), 0, 2, 1, 3)
        scores = torch.einsum("bhqd,bhkd->bhqk", q, k_cache) * (Dh ** -0.5)
        p = _softmax(scores, axis=-1)
        o = torch.einsum("bhqk,bhkd->bhqd", p, v_cache)
        return (lambda x, *d: x.permute(*d))(o, 0, 2, 1, 3).reshape(B, Sq, H * Dh) @ wo

    def _B_ref(x, k_cache, v_cache, wq, wo):
        B, Sq, D = x.shape
        Hq, Dh = 32, 128
        Hkv = k_cache.shape[1]
        rep = Hq // Hkv
        q = (lambda x, *d: x.permute(*d))((x @ wq).reshape(B, Sq, Hq, Dh), 0, 2, 1, 3)
        k = (lambda x, n, axis: torch.repeat_interleave(x, n, dim=axis))(k_cache, rep, axis=1)
        v = (lambda x, n, axis: torch.repeat_interleave(x, n, dim=axis))(v_cache, rep, axis=1)
        scores = torch.einsum("bhqd,bhkd->bhqk", q, k) * (Dh ** -0.5)
        p = _softmax(scores, axis=-1)
        o = torch.einsum("bhqk,bhkd->bhqd", p, v)
        return (lambda x, *d: x.permute(*d))(o, 0, 2, 1, 3).reshape(B, Sq, Hq * Dh) @ wo

    a = _A_ref(A_x, A_k_cache, A_v_cache, A_wq, A_wo)
    b = _B_ref(B_x, B_k_cache, B_v_cache, B_wq, B_wo)
    return torch.concatenate([a, b], axis=-1)
```

```asm
; @launch grid=(256,1,1) block=(256,1,1) lds=163840
.amdgcn_target "amdgcn-amd-amdhsa--gfx950"
.text
.macro Mvvv d,a,b
v_mfma_f32_16x16x32_bf16 v[\d:\d+3], v[\a:\a+3], v[\b:\b+3], v[\d:\d+3]
.endm
.macro Zvvv d,a,b
v_mfma_f32_16x16x32_bf16 v[\d:\d+3], v[\a:\a+3], v[\b:\b+3], 0
.endm
.macro Mvva d,a,b
v_mfma_f32_16x16x32_bf16 v[\d:\d+3], v[\a:\a+3], a[\b:\b+3], v[\d:\d+3]
.endm
.macro Zvva d,a,b
v_mfma_f32_16x16x32_bf16 v[\d:\d+3], v[\a:\a+3], a[\b:\b+3], 0
.endm
.macro Mvav d,a,b
v_mfma_f32_16x16x32_bf16 v[\d:\d+3], a[\a:\a+3], v[\b:\b+3], v[\d:\d+3]
.endm
.macro Zvav d,a,b
v_mfma_f32_16x16x32_bf16 v[\d:\d+3], a[\a:\a+3], v[\b:\b+3], 0
.endm
.macro Mvaa d,a,b
v_mfma_f32_16x16x32_bf16 v[\d:\d+3], a[\a:\a+3], a[\b:\b+3], v[\d:\d+3]
.endm
.macro Zvaa d,a,b
v_mfma_f32_16x16x32_bf16 v[\d:\d+3], a[\a:\a+3], a[\b:\b+3], 0
.endm
.macro Mavv d,a,b
v_mfma_f32_16x16x32_bf16 a[\d:\d+3], v[\a:\a+3], v[\b:\b+3], a[\d:\d+3]
.endm
.macro Zavv d,a,b
v_mfma_f32_16x16x32_bf16 a[\d:\d+3], v[\a:\a+3], v[\b:\b+3], 0
.endm
.macro Mava d,a,b
v_mfma_f32_16x16x32_bf16 a[\d:\d+3], v[\a:\a+3], a[\b:\b+3], a[\d:\d+3]
.endm
.macro Zava d,a,b
v_mfma_f32_16x16x32_bf16 a[\d:\d+3], v[\a:\a+3], a[\b:\b+3], 0
.endm
.macro Maav d,a,b
v_mfma_f32_16x16x32_bf16 a[\d:\d+3], a[\a:\a+3], v[\b:\b+3], a[\d:\d+3]
.endm
.macro Zaav d,a,b
v_mfma_f32_16x16x32_bf16 a[\d:\d+3], a[\a:\a+3], v[\b:\b+3], 0
.endm
.macro Maaa d,a,b
v_mfma_f32_16x16x32_bf16 a[\d:\d+3], a[\a:\a+3], a[\b:\b+3], a[\d:\d+3]
.endm
.macro Zaaa d,a,b
v_mfma_f32_16x16x32_bf16 a[\d:\d+3], a[\a:\a+3], a[\b:\b+3], 0
.endm
.macro Tv d,a,o
ds_read_b64_tr_b16 v[\d:\d+1], v\a offset:\o
.endm
.macro Rv d,a,o
ds_read_b128 v[\d:\d+3], v\a offset:\o
.endm
.macro Lv d,v,r,s,o
buffer_load_dwordx4 v[\d:\d+3], v\v, s[\r:\r+3], s\s offen offset:\o sc1
.endm
.macro Ta d,a,o
ds_read_b64_tr_b16 a[\d:\d+1], v\a offset:\o
.endm
.macro Ra d,a,o
ds_read_b128 a[\d:\d+3], v\a offset:\o
.endm
.macro La d,v,r,s,o
buffer_load_dwordx4 a[\d:\d+3], v\v, s[\r:\r+3], s\s offen offset:\o sc1
.endm
.macro Pv d,v,r,s,o
buffer_load_dwordx4 v[\d:\d+3], v\v, s[\r:\r+3], s\s offen offset:\o
.endm
.macro Pa d,v,r,s,o
buffer_load_dwordx4 a[\d:\d+3], v\v, s[\r:\r+3], s\s offen offset:\o
.endm
.macro EX d
v_exp_f32_e32 v\d, v\d
.endm
.macro AD d,s
v_add_f32_e32 v\d, v\d, v\s
.endm
.macro CV d,s
v_cvt_pk_bf16_f32 v\d, v\s, v[\s+1]
.endm
.macro DN v,r,s,o
buffer_load_dwordx4 v\v, s[\r:\r+3], s\s offen offset:\o nt lds
.endm
.macro DD v,r,s,o
buffer_load_dwordx4 v\v, s[\r:\r+3], s\s offen offset:\o lds
.endm
.macro AR d,s
v_accvgpr_read_b32 v\d, a\s
.endm
.macro AW d,s
v_accvgpr_write_b32 a\d, v\s
.endm
.macro AM d,s
v_accvgpr_mov_b32 a\d, a\s
.endm
.globl concat_heads__mha_block_cached__gqa_block_cached__near_ridge_kernel
.p2align 8
.type concat_heads__mha_block_cached__gqa_block_cached__near_ridge_kernel,@function
concat_heads__mha_block_cached__gqa_block_cached__near_ridge_kernel:
s_cmp_ge_u32 s2, 256
s_cbranch_scc0 L1_go
s_endpgm
L1_go:
s_and_b32 s3, s2, 7
s_lshr_b32 s5, s3, 2
s_mul_i32 s30, s5, 40
s_add_u32 s96, s0, s30
s_addc_u32 s97, s1, 0
s_load_dwordx2 s[8:9], s[96:97], 0
s_load_dwordx2 s[12:13], s[96:97], 24
s_load_dwordx2 s[16:17], s[96:97], 8
s_load_dwordx2 s[20:21], s[96:97], 16
s_load_dwordx2 s[52:53], s[96:97], 32
s_load_dwordx2 s[42:43], s[0:1], 96
s_load_dwordx2 s[64:65], s[0:1], 80
s_load_dwordx2 s[68:69], s[0:1], 88
v_lshrrev_b32 v3, 6, v0
v_and_b32 v2, 63, v0
v_readfirstlane_b32 s28, v3
v_lshlrev_b32 v1, 4, v2
s_lshr_b32 s4, s2, 3
s_lshr_b32 s6, s3, 1
s_and_b32 s6, s6, 1
s_lshl_b32 s6, s6, 2
s_lshr_b32 s7, s4, 3
s_add_u32 s6, s6, s7
s_and_b32 s72, s4, 7
s_and_b32 s7, s3, 1
s_lshl_b32 s31, s7, 7
s_xor_b32 s31, s31, 0x80
s_lshl_b32 s7, s7, 3
s_add_u32 s7, s7, s72
v_and_b32 v40, 15, v2
v_lshrrev_b32 v41, 4, v2
v_add_u32 v45, 0, v41
v_lshlrev_b32 v45, 1, v45
v_xor_b32 v45, v45, v40
v_lshlrev_b32 v45, 4, v45
v_lshl_add_u32 v30, v41, 8, v45
v_lshl_add_u32 v32, v41, 13, v45
v_add_u32 v33, 31744, v32
v_add_u32 v45, 4, v41
v_lshlrev_b32 v45, 1, v45
v_xor_b32 v45, v45, v40
v_lshlrev_b32 v45, 4, v45
v_lshl_add_u32 v31, v41, 8, v45
v_lshl_add_u32 v34, v41, 13, v45
v_add_u32 v34, 63488, v34
v_add_u32 v35, 31744, v34
v_lshrrev_b32 v46, 3, v2
v_and_b32 v47, 7, v2
v_lshrrev_b32 v43, 1, v46
v_xor_b32 v45, v43, v47
v_lshlrev_b32 v45, 4, v45
v_lshl_add_u32 v36, v46, 11, v45
v_add_u32 v38, 30720, v36
v_add_u32 v43, 4, v43
v_xor_b32 v45, v43, v47
v_lshlrev_b32 v45, 4, v45
v_lshl_add_u32 v37, v46, 11, v45
v_add_u32 v37, 15360, v37
v_add_u32 v39, 30720, v37
s_mul_i32 s34, s6, 491520
s_lshl_b32 s35, s7, 9
s_mov_b32 s10, 491520
s_mov_b32 s11, 0x20000
s_sub_u32 s14, 0x800000, s35
s_mov_b32 s15, 0x20000
s_lshl_b32 s36, s28, 12
s_lshl_b32 s37, s28, 17
s_waitcnt lgkmcnt(0)
s_add_u32 s8, s8, s34
s_addc_u32 s9, s9, 0
s_add_u32 s12, s12, s35
s_addc_u32 s13, s13, 0
s_lshl_b32 s38, s36, 1
s_mov_b32 m0, s36
s_add_u32 s39, s38, 0x11000
DD 32,12,37,0
DD 33,12,37,1024
DD 34,12,37,2048
DD 35,12,37,3072
s_add_u32 m0, s38, 0x10000
s_add_u32 s3, s37, 0x10000
DD 36,8,37,0
DD 37,8,37,1024
DD 38,8,37,2048
DD 39,8,37,3072
s_mov_b32 m0, s39
s_nop 0
DD 36,8,3,0
DD 37,8,3,1024
s_cmp_eq_u32 s28, 3
s_cbranch_scc1 L1_x7skip
DD 38,8,3,2048
DD 39,8,3,3072
L1_x7skip:
s_add_u32 m0, s36, 0x4000
s_add_u32 s3, s37, 256
DD 32,12,3,0
DD 33,12,3,1024
DD 34,12,3,2048
DD 35,12,3,3072
v_mov_b64 v[48:49], 0
v_mov_b64 v[50:51], 0
v_lshrrev_b32 v43, 2, v40
v_and_b32 v42, 1, v41
v_lshl_add_u32 v42, v42, 2, v43
v_and_b32 v44, 3, v40
v_lshlrev_b32 v44, 3, v44
s_lshl_b32 s3, s28, 13
s_add_u32 s3, s3, 0x10000
v_mfma_f32_32x32x16_bf16 v[128:143], v[48:51], v[48:51], 0
v_lshl_add_u32 v46, v41, 3, v43
v_lshl_add_u32 v46, v46, 8, v44
v_lshlrev_b32 v45, 10, v41
s_lshl_b32 s34, s6, 4
s_add_u32 s34, s34, s7
s_lshl_b32 s34, s34, 19
s_add_u32 s16, s16, s34
v_mfma_f32_32x32x16_bf16 a[128:143], v[48:51], v[48:51], 0
v_sub_u32 v45, 0x10000, v45
v_xor_b32 v47, 0, v42
v_lshl_add_u32 v16, v47, 5, v46
v_add_u32 v8, v45, v16
s_addc_u32 s17, s17, 0
s_mov_b32 s18, 0x80000
s_mov_b32 s19, 0x20000
s_add_u32 s20, s20, s34
v_mfma_f32_32x32x16_bf16 v[144:159], v[48:51], v[48:51], 0
v_xor_b32 v47, 1, v42
v_lshl_add_u32 v17, v47, 5, v46
v_add_u32 v9, v45, v17
v_xor_b32 v47, 2, v42
s_addc_u32 s21, s21, 0
s_mov_b32 s22, 0x80000
s_mov_b32 s23, 0x20000
s_mul_i32 s34, s5, 15728640
v_mfma_f32_32x32x16_bf16 a[144:159], v[48:51], v[48:51], 0
v_lshl_add_u32 v18, v47, 5, v46
v_add_u32 v10, v45, v18
v_xor_b32 v47, 3, v42
s_mul_i32 s35, s6, 1966080
s_add_u32 s34, s34, s35
s_lshl_b32 s35, s7, 13
s_add_u32 s38, s34, s35
s_sub_u32 s26, 1966080, s35
v_mfma_f32_32x32x16_bf16 v[160:175], v[48:51], v[48:51], 0
v_lshl_add_u32 v19, v47, 5, v46
v_add_u32 v11, v45, v19
v_xor_b32 v47, 4, v42
v_lshl_add_u32 v20, v47, 5, v46
s_add_u32 s24, s42, s38
s_addc_u32 s25, s43, 0
s_mov_b32 s27, 0x20000
s_lshr_b32 s39, s7, 3
v_mfma_f32_32x32x16_bf16 a[160:175], v[48:51], v[48:51], 0
v_add_u32 v12, v45, v20
v_xor_b32 v47, 5, v42
v_lshl_add_u32 v21, v47, 5, v46
v_add_u32 v13, v45, v21
s_lshl_b32 s35, s39, 16
s_add_u32 s38, s34, s35
s_sub_u32 s58, 1966080, s35
s_add_u32 s56, s42, s38
v_mfma_f32_32x32x16_bf16 v[176:191], v[48:51], v[48:51], 0
v_xor_b32 v47, 6, v42
v_lshl_add_u32 v22, v47, 5, v46
v_add_u32 v14, v45, v22
s_addc_u32 s57, s43, 0
s_mov_b32 s59, 0x20000
s_lshl_b32 s34, s39, 22
s_lshl_b32 s35, s72, 8
v_mfma_f32_32x32x16_bf16 a[176:191], v[48:51], v[48:51], 0
v_xor_b32 v47, 7, v42
v_lshl_add_u32 v23, v47, 5, v46
v_add_u32 v15, v45, v23
v_lshrrev_b32 v47, 1, v40
s_add_u32 s34, s34, s35
s_sub_u32 s38, 0x400000, s35
s_add_u32 s52, s52, s34
s_addc_u32 s53, s53, 0
s_mov_b32 s54, s38
v_mfma_f32_32x32x16_bf16 v[192:207], v[48:51], v[48:51], 0
v_add_u32 v45, 0, v41
v_xor_b32 v45, v45, v47
v_lshlrev_b32 v45, 4, v45
v_lshl_add_u32 v45, v40, 7, v45
s_mov_b32 s55, 0x20000
s_lshl_b32 s34, s5, 3
s_add_u32 s34, s34, s6
s_lshl_b32 s34, s34, 19
v_mfma_f32_32x32x16_bf16 a[192:207], v[48:51], v[48:51], 0
v_add_u32 v24, s3, v45
v_add_u32 v45, 4, v41
v_xor_b32 v45, v45, v47
s_add_u32 s34, s34, 0x2000000
s_mov_b32 s62, 0x80000
s_add_u32 s60, s42, s34
s_addc_u32 s61, s43, 0
v_mfma_f32_32x32x16_bf16 v[208:223], v[48:51], v[48:51], 0
v_lshlrev_b32 v45, 4, v45
v_lshl_add_u32 v45, v40, 7, v45
v_add_u32 v25, s3, v45
v_add_u32 v45, 0, v41
s_mov_b32 s63, 0x20000
s_lshl_b32 s34, s28, 13
s_lshl_b32 s38, s7, 15
s_add_u32 s75, s38, s34
v_mfma_f32_32x32x16_bf16 a[208:223], v[48:51], v[48:51], 0
v_xor_b32 v45, v45, v40
v_lshlrev_b32 v45, 4, v45
v_lshl_add_u32 v4, v40, 8, v45
v_lshl_add_u32 v26, v41, 8, v45
s_xor_b32 s51, s75, 0x40000
s_mul_i32 s34, s6, 983040
s_lshl_b32 s38, s5, 11
s_add_u32 s38, s38, s35
s_lshl_b32 s35, s39, 7
v_mfma_f32_32x32x16_bf16 v[224:239], v[48:51], v[48:51], 0
v_add_u32 v45, 4, v41
v_xor_b32 v45, v45, v40
v_lshlrev_b32 v45, 4, v45
s_add_u32 s38, s38, s35
s_add_u32 s34, s34, s38
s_sub_u32 s38, 983040, s38
s_add_u32 s64, s64, s34
v_mfma_f32_32x32x16_bf16 a[224:239], v[48:51], v[48:51], 0
v_lshl_add_u32 v5, v40, 8, v45
v_lshl_add_u32 v27, v41, 8, v45
v_add_u32 v45, 8, v41
v_xor_b32 v45, v45, v40
s_addc_u32 s65, s65, 0
s_mov_b32 s66, s38
s_mov_b32 s67, 0x20000
s_mov_b32 s70, 256
v_mfma_f32_32x32x16_bf16 v[240:255], v[48:51], v[48:51], 0
v_lshlrev_b32 v45, 4, v45
v_lshl_add_u32 v6, v40, 8, v45
v_lshl_add_u32 v28, v41, 8, v45
v_add_u32 v45, 12, v41
s_mov_b32 s71, 0x20000
s_lshl_b32 s34, s5, 7
s_lshl_b32 s35, s6, 3
s_add_u32 s74, s34, s35
v_mfma_f32_32x32x16_bf16 a[240:255], v[48:51], v[48:51], 0
v_xor_b32 v45, v45, v40
v_lshlrev_b32 v45, 4, v45
v_lshl_add_u32 v7, v40, 8, v45
v_lshl_add_u32 v29, v41, 8, v45
s_lshl_b32 s35, s39, 2
s_add_u32 s73, s74, s35
s_lshl_b32 s48, s28, 19
s_mov_b32 s40, 0x3e0293ee
s_mov_b32 s41, 0x3e0293ee

s_cmp_lg_u32 s28, 1
s_cbranch_scc1 L1_noct
s_getpc_b64 s[96:97]
L1_pc0:
s_sub_u32 s96, s96, L1_pc0-concat_heads__mha_block_cached__gqa_block_cached__near_ridge_kernel
s_subb_u32 s97, s97, 0
s_lshr_b32 s92, s2, 3
s_lshl_b32 s92, s92, 13
v_lshlrev_b32 v40, 3, v1
v_add_u32 v40, s92, v40
s_mov_b32 s92, L1_codeend-concat_heads__mha_block_cached__gqa_block_cached__near_ridge_kernel-4
v_min_u32 v40, s92, v40
v_mov_b32 v41, s97
v_add_co_u32 v40, vcc, s96, v40
v_addc_co_u32 v41, vcc, 0, v41, vcc
global_load_dword v3, v[40:41], off
L1_noct:
s_cmp_eq_u32 s28, 3
s_cbranch_scc1 L1b_start
s_lshl_b32 s49, s28, 12
s_mov_b32 s47, s49
s_lshr_b32 s33, s2, 4
s_xor_b32 s33, s33, s2
s_and_b32 s33, s33, 15
s_lshl_b32 s33, s33, 14
s_add_u32 s47, s47, s33
s_mov_b32 s33, s47
s_mov_b32 s32, 0
s_and_b32 s33, s33, 0x3c000
s_mov_b32 s32, 0xffffc000
s_mul_i32 s90, s28, 32768
s_add_u32 s32, s32, 16384
s_add_u32 s47, s32, s33
s_and_b32 s50, s47, 0x20000
s_lshr_b32 s47, s47, 3
s_and_b32 s47, s47, 0x3800
s_or_b32 s47, s47, s50
s_and_b32 s50, s32, 0x40000
s_or_b32 s47, s47, s50
s_add_u32 s47, s47, s90
v_add_u32 v28, 14336, v28
v_add_u32 v29, 14336, v29
s_sub_u32 s86, s47, s90
s_mov_b32 s87, s28
s_add_u32 s32, s32, 16384
s_add_u32 s47, s32, s33
s_and_b32 s50, s47, 0x20000
s_lshr_b32 s47, s47, 3
s_and_b32 s47, s47, 0x3800
s_or_b32 s47, s47, s50
s_and_b32 s50, s32, 0x40000
s_or_b32 s47, s47, s50
s_add_u32 s47, s47, s90
s_mov_b64 s[94:95], 0
v_mov_b64 v[48:49], -1
v_mov_b64 v[50:51], -1
s_mul_i32 s38, s28, 1024
s_add_u32 s38, s38, s75
s_waitcnt vmcnt(4)
s_barrier
Ta 64,16,0
Ta 66,16,1024
Ta 68,16,8192
Ta 70,16,9216
Ta 72,17,0
Ta 74,17,1024
Ta 76,17,8192
Ta 78,17,9216
Ta 80,18,0
Ta 82,18,1024
Ta 84,18,8192
Ta 86,18,9216
Ra 0,24,0
Ra 4,25,0
Ra 8,24,2048
Ra 12,25,2048
Ra 16,24,4096
Ra 20,25,4096
Ra 24,24,6144
Ra 28,25,6144
s_waitcnt lgkmcnt(0)
Mvaa 128,64,0
s_add_u32 m0, s36, 0x18000
s_lshl_b32 s3, s28, 16
s_add_u32 s3, s3, 128
Ta 88,19,0
Ta 90,19,1024
Mvaa 128,68,4
Ta 92,19,8192
Ta 94,19,9216
DD 36,8,3,0
Mvaa 160,68,12
DD 37,8,3,1024
Mvaa 160,64,8
DD 38,8,3,2048
Mvaa 192,64,16
DD 39,8,3,3072
Mvaa 192,68,20
s_add_u32 m0, s36, 0x8000
s_add_u32 s3, s37, 524288
Mvaa 224,68,28
DD 32,12,3,0
Mvaa 224,64,24
DD 33,12,3,1024
Mvaa 228,72,24
Ta 64,20,0
Ta 66,20,1024
DD 34,12,3,2048
Mvaa 228,76,28
Ta 68,20,8192
Ta 70,20,9216
DD 35,12,3,3072
Mvaa 196,76,20
Mvaa 196,72,16
s_cmp_lg_u32 s28, 0
s_cbranch_scc1 L1_q0x
s_mov_b32 m0, 0x1b000
s_mov_b32 s3, 196736
DD 36,8,3,0
DD 37,8,3,1024
DD 38,8,3,2048
DD 39,8,3,3072
L1_q0x:
s_cmp_lg_u32 s28, 1
s_cbranch_scc1 L1_q0w
s_mov_b32 m0, 0xb000
s_mov_b32 s3, 917504
DD 32,12,3,0
DD 33,12,3,1024
DD 34,12,3,2048
DD 35,12,3,3072
L1_q0w:
Mvaa 164,72,8
Mvaa 164,76,12
Mvaa 132,76,4
Mvaa 132,72,0
Mvaa 136,80,0
Ta 72,21,0
Ta 74,21,1024
Mvaa 136,84,4
Ta 76,21,8192
Ta 78,21,9216
Mvaa 168,84,12
Mvaa 168,80,8
Mvaa 200,80,16
Mvaa 200,84,20
Mvaa 232,84,28
Mvaa 232,80,24
s_waitcnt lgkmcnt(8)
Mvaa 236,88,24
Ta 80,22,0
Ta 82,22,1024
Mvaa 236,92,28
Ta 84,22,8192
Ta 86,22,9216
Mvaa 204,92,20
Mvaa 204,88,16
Mvaa 172,88,8
Mvaa 172,92,12
Mvaa 140,92,4
Mvaa 140,88,0
s_waitcnt lgkmcnt(8)
Mvaa 144,64,0
Ta 88,23,0
Ta 90,23,1024
Mvaa 144,68,4
Ta 92,23,8192
Ta 94,23,9216
Mvaa 176,68,12
Mvaa 176,64,8
Mvaa 208,64,16
Mvaa 208,68,20
Mvaa 240,68,28
Mvaa 240,64,24
s_mov_b32 s30, 7
L1a_qloop:
s_cmp_lg_u32 s30, 7
s_cbranch_scc1 L1_qw1
s_waitcnt vmcnt(8)
L1_qw1:
s_waitcnt lgkmcnt(0)
s_barrier
Mvaa 244,72,24
Ta 64,16,16384
Ta 66,16,17408
Mvaa 244,76,28
Ta 68,16,24576
Ta 70,16,25600
Mvaa 212,76,20
Mvaa 212,72,16
Mvaa 180,72,8
Mvaa 180,76,12
Mvaa 148,76,4
Mvaa 148,72,0
Mvaa 152,80,0
Ta 72,17,16384
Ta 74,17,17408
Mvaa 152,84,4
Ta 76,17,24576
Ta 78,17,25600
Mvaa 184,84,12
Mvaa 184,80,8
Mvaa 216,80,16
Mvaa 216,84,20
Mvaa 248,84,28
Mvaa 248,80,24
Mvaa 252,88,24
Ta 80,18,16384
Ta 82,18,17408
Mvaa 252,92,28
Ta 84,18,24576
Ta 86,18,25600
Mvaa 220,92,20
Mvaa 220,88,16
Mvaa 188,88,8
Mvaa 188,92,12
Mvaa 156,92,4
Mvaa 156,88,0
s_waitcnt lgkmcnt(8)
Maaa 128,64,0
Ta 88,19,16384
Ta 90,19,17408
Maaa 128,68,4
Ta 92,19,24576
Ta 94,19,25600
Maaa 160,68,12
Maaa 160,64,8
Maaa 192,64,16
Maaa 192,68,20
Maaa 224,68,28
Maaa 224,64,24
s_waitcnt lgkmcnt(8)
Maaa 228,72,24
Ta 64,20,16384
Ta 66,20,17408
Maaa 228,76,28
Ta 68,20,24576
Ta 70,20,25600
Maaa 196,76,20
Maaa 196,72,16
Maaa 164,72,8
Maaa 164,76,12
Maaa 132,76,4
Maaa 132,72,0
s_waitcnt lgkmcnt(8)
Maaa 136,80,0
Ta 72,21,16384
Ta 74,21,17408
Maaa 136,84,4
Ta 76,21,24576
Ta 78,21,25600
Maaa 168,84,12
Maaa 168,80,8
Maaa 200,80,16
Maaa 200,84,20
Maaa 232,84,28
Maaa 232,80,24
s_waitcnt lgkmcnt(8)
Maaa 236,88,24
Ta 80,22,16384
Ta 82,22,17408
Maaa 236,92,28
Ta 84,22,24576
Ta 86,22,25600
Maaa 204,92,20
Maaa 204,88,16
Maaa 172,88,8
Maaa 172,92,12
Maaa 140,92,4
Maaa 140,88,0
s_waitcnt lgkmcnt(8)
Maaa 144,64,0
Ta 88,23,16384
Ta 90,23,17408
Maaa 144,68,4
Ta 92,23,24576
Ta 94,23,25600
Maaa 176,68,12
s_mov_b32 s91, 0
s_cmp_gt_u32 s30, 3
s_cbranch_scc1 L1_flx0
s_cmp_gt_u32 s87, 7
s_cbranch_scc1 L1_flx0
s_lshl_b32 s3, s87, 12
s_add_u32 m0, s3, 0x20000
s_and_b32 s3, s87, 3
s_mul_i32 s3, s3, 32768
s_add_u32 s3, s3, s86
s_cmp_gt_u32 s87, 3
s_cselect_b32 s91, 2, 1
s_add_u32 s87, s87, 3
L1_flx0:
s_cmp_eq_u32 s91, 1
s_cbranch_scc0 L1_flv0
DN 26,16,3,0
L1_flv0:
s_cmp_eq_u32 s91, 2
s_cbranch_scc0 L1_fld0
DN 30,20,3,0
L1_fld0:
Maaa 176,64,8
Maaa 208,64,16
Maaa 208,68,20
Maaa 240,68,28
Maaa 240,64,24
s_cmp_lg_u32 s30, 7
s_cbranch_scc1 L1_qw2
s_waitcnt vmcnt(0)
L1_qw2:
s_waitcnt lgkmcnt(0)
s_barrier
Maaa 244,72,24
Ta 64,16,32768
Ta 66,16,33792
Maaa 244,76,28
Ta 68,16,40960
Ta 70,16,41984
Maaa 212,76,20
Ra 96,24,32768
Maaa 212,72,16
Ra 100,25,32768
Maaa 180,72,8
Ra 104,24,34816
Maaa 180,76,12
Maaa 148,76,4
Maaa 148,72,0
Maaa 152,80,0
Ta 72,17,32768
Ta 74,17,33792
Maaa 152,84,4
Ta 76,17,40960
Ta 78,17,41984
Maaa 184,84,12
Ra 108,25,34816
Maaa 184,80,8
Ra 112,24,36864
Maaa 216,80,16
Ra 116,25,36864
buffer_store_dwordx4 v[48:51], v1, s[60:63], s38 offen sc1
Maaa 216,84,20
Maaa 248,84,28
Maaa 248,80,24
Maaa 252,88,24
Ta 80,18,32768
Ta 82,18,33792
Maaa 252,92,28
Ta 84,18,40960
Ta 86,18,41984
Maaa 220,92,20
Ra 120,24,38912
Maaa 220,88,16
Ra 124,25,38912
Maaa 188,88,8
Maaa 188,92,12
Maaa 156,92,4
Maaa 156,88,0
s_waitcnt lgkmcnt(13)
Mvaa 128,64,96
Ta 88,19,32768
Ta 90,19,33792
Mvaa 128,68,100
s_waitcnt lgkmcnt(8)
Ta 92,19,40960
Ta 94,19,41984
Mvaa 160,68,108
Mvaa 160,64,104
Mvaa 192,64,112
buffer_store_dwordx4 v[48:51], v1, s[60:63], s38 offen offset:1024 sc1
Mvaa 192,68,116
s_waitcnt lgkmcnt(4)
s_add_u32 s38, s38, 2048
Mvaa 224,68,124
Mvaa 224,64,120
Mvaa 228,72,120
Ta 64,20,32768
Ta 66,20,33792
Mvaa 228,76,124
Ta 68,20,40960
Ta 70,20,41984
Mvaa 196,76,116
Mvaa 196,72,112
Mvaa 164,72,104
Mvaa 164,76,108
Mvaa 132,76,100
Mvaa 132,72,96
Mvaa 136,80,96
Ta 72,21,32768
Ta 74,21,33792
Mvaa 136,84,100
Ta 76,21,40960
Ta 78,21,41984
Mvaa 168,84,108
Mvaa 168,80,104
Mvaa 200,80,112
Mvaa 200,84,116
Mvaa 232,84,124
Mvaa 232,80,120
s_waitcnt lgkmcnt(8)
Mvaa 236,88,120
Ta 80,22,32768
Ta 82,22,33792
Mvaa 236,92,124
Ta 84,22,40960
Ta 86,22,41984
Mvaa 204,92,116
Mvaa 204,88,112
Mvaa 172,88,104
Mvaa 172,92,108
Mvaa 140,92,100
Mvaa 140,88,96
s_waitcnt lgkmcnt(8)
Mvaa 144,64,96
Ta 88,23,32768
Ta 90,23,33792
Mvaa 144,68,100
Ta 92,23,40960
Ta 94,23,41984
Mvaa 176,68,108
s_cmp_eq_u32 s91, 1
s_cbranch_scc0 L1_flv1
DN 27,16,3,1024
L1_flv1:
s_cmp_eq_u32 s91, 2
s_cbranch_scc0 L1_fld1
DN 31,20,3,1024
L1_fld1:
Mvaa 176,64,104
Mvaa 208,64,112
Mvaa 208,68,116
Mvaa 240,68,124
Mvaa 240,64,120
s_waitcnt lgkmcnt(0)
s_barrier
Mvaa 244,72,120
Ta 64,16,49152
Ta 66,16,50176
Mvaa 244,76,124
Ta 68,16,57344
Ta 70,16,58368
Mvaa 212,76,116
Mvaa 212,72,112
Mvaa 180,72,104
Mvaa 180,76,108
Mvaa 148,76,100
Mvaa 148,72,96
Mvaa 152,80,96
Ta 72,17,49152
Ta 74,17,50176
Mvaa 152,84,100
Ta 76,17,57344
Ta 78,17,58368
Mvaa 184,84,108
Mvaa 184,80,104
Mvaa 216,80,112
Mvaa 216,84,116
Mvaa 248,84,124
Mvaa 248,80,120
Mvaa 252,88,120
Ta 80,18,49152
Ta 82,18,50176
Mvaa 252,92,124
Ta 84,18,57344
Ta 86,18,58368
Mvaa 220,92,116
Mvaa 220,88,112
Mvaa 188,88,104
Mvaa 188,92,108
Mvaa 156,92,100
Mvaa 156,88,96
s_waitcnt lgkmcnt(8)
Maaa 128,64,96
Ta 88,19,49152
Ta 90,19,50176
Maaa 128,68,100
Ta 92,19,57344
Ta 94,19,58368
Maaa 160,68,108
Maaa 160,64,104
Maaa 192,64,112
Maaa 192,68,116
Maaa 224,68,124
Maaa 224,64,120
s_waitcnt lgkmcnt(8)
Maaa 228,72,120
Ta 64,20,49152
Ta 66,20,50176
Maaa 228,76,124
Ta 68,20,57344
Ta 70,20,58368
Maaa 196,76,116
Maaa 196,72,112
Maaa 164,72,104
Maaa 164,76,108
Maaa 132,76,100
Maaa 132,72,96
s_waitcnt lgkmcnt(8)
Maaa 136,80,96
Ta 72,21,49152
Ta 74,21,50176
Maaa 136,84,100
Ta 76,21,57344
Ta 78,21,58368
Maaa 168,84,108
Maaa 168,80,104
Maaa 200,80,112
Maaa 200,84,116
Maaa 232,84,124
Maaa 232,80,120
s_waitcnt lgkmcnt(8)
Maaa 236,88,120
Ta 80,22,49152
Ta 82,22,50176
Maaa 236,92,124
Ta 84,22,57344
Ta 86,22,58368
Maaa 204,92,116
Maaa 204,88,112
Maaa 172,88,104
Maaa 172,92,108
Maaa 140,92,100
Maaa 140,88,96
s_waitcnt lgkmcnt(8)
Maaa 144,64,96
Ta 88,23,49152
Ta 90,23,50176
Maaa 144,68,100
Ta 92,23,57344
Ta 94,23,58368
Maaa 176,68,108
s_cmp_eq_u32 s91, 1
s_cbranch_scc0 L1_flv2
DN 28,16,3,2048
L1_flv2:
s_cmp_eq_u32 s91, 2
s_cbranch_scc0 L1_fld2
s_add_u32 s3, s3, 14336
DN 30,20,3,2048
L1_fld2:
Maaa 176,64,104
Maaa 208,64,112
Maaa 208,68,116
Maaa 240,68,124
Maaa 240,64,120
s_waitcnt lgkmcnt(0)
s_barrier
Maaa 244,72,120
Ta 64,16,0
Ta 66,16,1024
Maaa 244,76,124
Ta 68,16,8192
Ta 70,16,9216
Maaa 212,76,116
Ra 0,24,0
Maaa 212,72,112
Ra 4,25,0
Maaa 180,72,104
Ra 8,24,2048
Maaa 180,76,108
Maaa 148,76,100
Maaa 148,72,96
Maaa 152,80,96
Ta 72,17,0
Ta 74,17,1024
Maaa 152,84,100
Ta 76,17,8192
Ta 78,17,9216
Maaa 184,84,108
Ra 12,25,2048
Maaa 184,80,104
Ra 16,24,4096
Maaa 216,80,112
Ra 20,25,4096
Maaa 216,84,116
Maaa 248,84,124
Maaa 248,80,120
Maaa 252,88,120
Ta 80,18,0
Ta 82,18,1024
Maaa 252,92,124
Ta 84,18,8192
Ta 86,18,9216
Maaa 220,92,116
Ra 24,24,6144
Maaa 220,88,112
Ra 28,25,6144
Maaa 188,88,104
Maaa 188,92,108
Maaa 156,92,100
Maaa 156,88,96
s_waitcnt lgkmcnt(13)
Mvaa 128,64,0
Ta 88,19,0
Ta 90,19,1024
Mvaa 128,68,4
s_waitcnt lgkmcnt(8)
Ta 92,19,8192
Ta 94,19,9216
Mvaa 160,68,12
Mvaa 160,64,8
Mvaa 192,64,16
Mvaa 192,68,20
s_waitcnt lgkmcnt(4)
Mvaa 224,68,28
Mvaa 224,64,24
Mvaa 228,72,24
Ta 64,20,0
Ta 66,20,1024
Mvaa 228,76,28
Ta 68,20,8192
Ta 70,20,9216
Mvaa 196,76,20
Mvaa 196,72,16
Mvaa 164,72,8
Mvaa 164,76,12
Mvaa 132,76,4
Mvaa 132,72,0
Mvaa 136,80,0
Ta 72,21,0
Ta 74,21,1024
Mvaa 136,84,4
Ta 76,21,8192
Ta 78,21,9216
Mvaa 168,84,12
Mvaa 168,80,8
Mvaa 200,80,16
Mvaa 200,84,20
Mvaa 232,84,28
Mvaa 232,80,24
s_waitcnt lgkmcnt(8)
Mvaa 236,88,24
Ta 80,22,0
Ta 82,22,1024
Mvaa 236,92,28
Ta 84,22,8192
Ta 86,22,9216
Mvaa 204,92,20
Mvaa 204,88,16
Mvaa 172,88,8
Mvaa 172,92,12
Mvaa 140,92,4
Mvaa 140,88,0
s_waitcnt lgkmcnt(8)
Mvaa 144,64,0
Ta 88,23,0
Ta 90,23,1024
Mvaa 144,68,4
Ta 92,23,8192
Ta 94,23,9216
Mvaa 176,68,12
s_cmp_eq_u32 s91, 1
s_cbranch_scc0 L1_flv3
DN 29,16,3,3072
L1_flv3:
s_cmp_eq_u32 s91, 2
s_cbranch_scc0 L1_fld3
DN 31,20,3,3072
L1_fld3:
Mvaa 176,64,8
Mvaa 208,64,16
Mvaa 208,68,20
Mvaa 240,68,28
Mvaa 240,64,24
s_sub_u32 s30, s30, 1
s_cmp_lg_u32 s30, 0
s_cbranch_scc1 L1a_qloop
s_waitcnt lgkmcnt(0)
s_barrier
Mvaa 244,72,24
Ta 64,16,16384
Ta 66,16,17408
Mvaa 244,76,28
Ta 68,16,24576
Ta 70,16,25600
Mvaa 212,76,20
v_lshrrev_b32 v40, 4, v1
Mvaa 212,72,16
v_and_b32 v41, 15, v40
Mvaa 180,72,8
v_lshrrev_b32 v40, 4, v40
Mvaa 180,76,12
v_add_u32 v32, 0, v40
Mvaa 148,76,4
v_lshlrev_b32 v32, 1, v32
Mvaa 148,72,0
v_xor_b32 v32, v32, v41
Mvaa 152,80,0
Ta 72,17,16384
Ta 74,17,17408
Mvaa 152,84,4
Ta 76,17,24576
Ta 78,17,25600
Mvaa 184,84,12
v_lshlrev_b32 v32, 4, v32
Mvaa 184,80,8
v_xor_b32 v32, s31, v32
Mvaa 216,80,16
v_lshl_add_u32 v32, v40, 11, v32
Mvaa 216,84,20
v_add_u32 v33, 4, v40
Mvaa 248,84,28
v_lshlrev_b32 v33, 1, v33
Mvaa 248,80,24
v_xor_b32 v33, v33, v41
Mvaa 252,88,24
Ta 80,18,16384
Ta 82,18,17408
Mvaa 252,92,28
Ta 84,18,24576
Ta 86,18,25600
Mvaa 220,92,20
v_lshlrev_b32 v33, 4, v33
Mvaa 220,88,16
v_xor_b32 v33, s31, v33
Mvaa 188,88,8
v_lshl_add_u32 v33, v40, 11, v33
Mvaa 188,92,12
v_add_u32 v33, 7168, v33
Mvaa 156,92,4
v_add_u32 v34, 0, v40
Mvaa 156,88,0
s_waitcnt lgkmcnt(8)
v_lshlrev_b32 v34, 1, v34
Maaa 128,64,0
Ta 88,19,16384
Ta 90,19,17408
Maaa 128,68,4
Ta 92,19,24576
Ta 94,19,25600
Maaa 160,68,12
v_xor_b32 v34, v34, v41
Maaa 160,64,8
v_lshlrev_b32 v34, 4, v34
Maaa 192,64,16
v_xor_b32 v34, s31, v34
Maaa 192,68,20
v_lshl_add_u32 v34, v40, 11, v34
Maaa 224,68,28
v_add_u32 v34, 14336, v34
Maaa 224,64,24
s_waitcnt lgkmcnt(8)
v_add_u32 v35, 4, v40
Maaa 228,72,24
Ta 64,20,16384
Ta 66,20,17408
Maaa 228,76,28
Ta 68,20,24576
Ta 70,20,25600
Maaa 196,76,20
v_lshlrev_b32 v35, 1, v35
Maaa 196,72,16
v_xor_b32 v35, v35, v41
Maaa 164,72,8
v_lshlrev_b32 v35, 4, v35
Maaa 164,76,12
v_xor_b32 v35, s31, v35
Maaa 132,76,4
v_lshl_add_u32 v35, v40, 11, v35
Maaa 132,72,0
s_waitcnt lgkmcnt(8)
v_add_u32 v35, 21504, v35
Maaa 136,80,0
Ta 72,21,16384
Ta 74,21,17408
Maaa 136,84,4
Ta 76,21,24576
Ta 78,21,25600
Maaa 168,84,12
s_lshl_b32 s39, s28, 15
Maaa 168,80,8
Maaa 200,80,16
Maaa 200,84,20
Maaa 232,84,28
Maaa 232,80,24
s_waitcnt lgkmcnt(8)
Maaa 236,88,24
Ta 80,22,16384
Ta 82,22,17408
Maaa 236,92,28
Ta 84,22,24576
Ta 86,22,25600
Maaa 204,92,20
Maaa 204,88,16
Maaa 172,88,8
Maaa 172,92,12
Maaa 140,92,4
Maaa 140,88,0
s_waitcnt lgkmcnt(8)
Maaa 144,64,0
Ta 88,23,16384
Ta 90,23,17408
Maaa 144,68,4
Ta 92,23,24576
Ta 94,23,25600
Maaa 176,68,12
Maaa 176,64,8
Maaa 208,64,16
Maaa 208,68,20
Maaa 240,68,28
Maaa 240,64,24
s_waitcnt lgkmcnt(0)
s_barrier
Maaa 244,72,24
Ta 64,16,32768
Ta 66,16,33792
Maaa 244,76,28
Ta 68,16,40960
Ta 70,16,41984
Maaa 212,76,20
s_add_u32 m0, s49, 0x4000
Ra 96,24,32768
Maaa 212,72,16
Ra 100,25,32768
DN 26,16,47,0
Maaa 180,72,8
Ra 104,24,34816
Maaa 180,76,12
Maaa 148,76,4
Maaa 148,72,0
Maaa 152,80,0
Ta 72,17,32768
Ta 74,17,33792
Maaa 152,84,4
Ta 76,17,40960
Ta 78,17,41984
Maaa 184,84,12
Ra 108,25,34816
Maaa 184,80,8
Ra 112,24,36864
Maaa 216,80,16
Ra 116,25,36864
Maaa 216,84,20
Maaa 248,84,28
Maaa 248,80,24
Maaa 252,88,24
Ta 80,18,32768
Ta 82,18,33792
Maaa 252,92,28
Ta 84,18,40960
Ta 86,18,41984
Maaa 220,92,20
Ra 120,24,38912
Maaa 220,88,16
Ra 124,25,38912
DN 27,16,47,1024
Maaa 188,88,8
Maaa 188,92,12
Maaa 156,92,4
Maaa 156,88,0
s_waitcnt lgkmcnt(13)
Mvaa 128,64,96
Ta 88,19,32768
Ta 90,19,33792
Mvaa 128,68,100
s_waitcnt lgkmcnt(8)
Ta 92,19,40960
Ta 94,19,41984
Mvaa 160,68,108
Mvaa 160,64,104
Mvaa 192,64,112
Mvaa 192,68,116
s_waitcnt lgkmcnt(4)
Mvaa 224,68,124
Mvaa 224,64,120
Mvaa 228,72,120
Ta 64,20,32768
Ta 66,20,33792
Mvaa 228,76,124
Ta 68,20,40960
Ta 70,20,41984
Mvaa 196,76,116
Mvaa 196,72,112
DN 28,16,47,2048
Mvaa 164,72,104
Mvaa 164,76,108
Mvaa 132,76,100
Mvaa 132,72,96
Mvaa 136,80,96
Ta 72,21,32768
Ta 74,21,33792
Mvaa 136,84,100
Ta 76,21,40960
Ta 78,21,41984
Mvaa 168,84,108
Mvaa 168,80,104
v_mul_f32 v40, s40, v128
v_mul_f32 v41, s40, v129
Mvaa 200,80,112
v_mul_f32 v42, s40, v130
v_mul_f32 v43, s40, v131
Mvaa 200,84,116
v_mul_f32 v44, s40, v132
v_mul_f32 v45, s40, v133
Mvaa 232,84,124
v_mul_f32 v46, s40, v134
v_mul_f32 v47, s40, v135
Mvaa 232,80,120
s_waitcnt lgkmcnt(8)
CV 48,40
CV 49,42
Mvaa 236,88,120
Ta 80,22,32768
Ta 82,22,33792
Mvaa 236,92,124
Ta 84,22,40960
Ta 86,22,41984
Mvaa 204,92,116
CV 50,44
CV 51,46
Mvaa 204,88,112
DN 29,16,47,3072
v_permlane32_swap_b32 v48, v50
Mvaa 172,88,104
s_add_u32 s32, s32, 16384
s_add_u32 s47, s32, s33
s_and_b32 s50, s47, 0x20000
s_lshr_b32 s47, s47, 3
s_and_b32 s47, s47, 0x3800
s_or_b32 s47, s47, s50
s_and_b32 s50, s32, 0x40000
s_or_b32 s47, s47, s50
s_add_u32 s47, s47, s90
v_permlane32_swap_b32 v49, v51
Mvaa 172,92,108
v_permlane16_swap_b32 v48, v50
Mvaa 140,92,100
v_permlane16_swap_b32 v49, v51
Mvaa 140,88,96
s_waitcnt lgkmcnt(8)
v_mul_f32 v52, s40, v160
v_mul_f32 v53, s40, v161
Mvaa 144,64,96
Ta 88,23,32768
Ta 90,23,33792
Mvaa 144,68,100
Ta 92,23,40960
Ta 94,23,41984
Mvaa 176,68,108
v_mul_f32 v54, s40, v162
v_mul_f32 v55, s40, v163
Mvaa 176,64,104
v_mul_f32 v56, s40, v164
v_mul_f32 v57, s40, v165
Mvaa 208,64,112
v_mul_f32 v58, s40, v166
v_mul_f32 v59, s40, v167
Mvaa 208,68,116
CV 60,52
CV 61,54
Mvaa 240,68,124
CV 62,56
CV 63,58
Mvaa 240,64,120
AW 0,48
AW 1,49
s_waitcnt lgkmcnt(0)
s_barrier
Mvaa 244,72,120
Ta 64,16,49152
Ta 66,16,50176
AW 2,50
Mvaa 244,76,124
Ta 68,16,57344
Ta 70,16,58368
AW 3,51
Mvaa 212,76,116
s_add_u32 m0, s49, 0x8000
v_permlane32_swap_b32 v60, v62
Mvaa 212,72,112
DN 26,16,47,0
v_permlane32_swap_b32 v61, v63
Mvaa 180,72,104
v_permlane16_swap_b32 v60, v62
Mvaa 180,76,108
v_permlane16_swap_b32 v61, v63
v_mul_f32 v40, s40, v192
Mvaa 148,76,100
v_mul_f32 v41, s40, v193
v_mul_f32 v42, s40, v194
v_mul_f32 v43, s40, v195
Mvaa 148,72,96
v_mul_f32 v44, s40, v196
v_mul_f32 v45, s40, v197
v_mul_f32 v46, s40, v198
Mvaa 152,80,96
Ta 72,17,49152
Ta 74,17,50176
v_mul_f32 v47, s40, v199
Mvaa 152,84,100
Ta 76,17,57344
Ta 78,17,58368
CV 48,40
Mvaa 184,84,108
CV 49,42
CV 50,44
CV 51,46
Mvaa 184,80,104
AW 16,60
AW 17,61
AW 18,62
Mvaa 216,80,112
AW 19,63
v_permlane32_swap_b32 v48, v50
Mvaa 216,84,116
v_permlane32_swap_b32 v49, v51
Mvaa 248,84,124
v_permlane16_swap_b32 v48, v50
Mvaa 248,80,120
v_permlane16_swap_b32 v49, v51
v_mul_f32 v52, s40, v224
Mvaa 252,88,120
Ta 80,18,49152
Ta 82,18,50176
v_mul_f32 v53, s40, v225
Mvaa 252,92,124
Ta 84,18,57344
Ta 86,18,58368
v_mul_f32 v54, s40, v226
Mvaa 220,92,116
v_mul_f32 v55, s40, v227
v_mul_f32 v56, s40, v228
v_mul_f32 v57, s40, v229
Mvaa 220,88,112
DN 27,16,47,1024
v_mul_f32 v58, s40, v230
v_mul_f32 v59, s40, v231
CV 60,52
Mvaa 188,88,104
CV 61,54
CV 62,56
CV 63,58
Mvaa 188,92,108
AW 32,48
AW 33,49
AW 34,50
Mvaa 156,92,100
AW 35,51
v_permlane32_swap_b32 v60, v62
Mvaa 156,88,96
s_waitcnt lgkmcnt(8)
v_permlane32_swap_b32 v61, v63
Maaa 128,64,96
Ta 88,19,49152
Ta 90,19,50176
Maaa 128,68,100
Ta 92,19,57344
Ta 94,19,58368
Maaa 160,68,108
v_permlane16_swap_b32 v60, v62
Maaa 160,64,104
v_permlane16_swap_b32 v61, v63
v_mul_f32 v40, s40, v136
Maaa 192,64,112
v_mul_f32 v41, s40, v137
v_mul_f32 v42, s40, v138
v_mul_f32 v43, s40, v139
Maaa 192,68,116
v_mul_f32 v44, s40, v140
v_mul_f32 v45, s40, v141
v_mul_f32 v46, s40, v142
Maaa 224,68,124
v_mul_f32 v47, s40, v143
CV 48,40
CV 49,42
Maaa 224,64,120
s_waitcnt lgkmcnt(8)
CV 50,44
CV 51,46
AW 48,60
Maaa 228,72,120
Ta 64,20,49152
Ta 66,20,50176
AW 49,61
Maaa 228,76,124
Ta 68,20,57344
Ta 70,20,58368
AW 50,62
Maaa 196,76,116
AW 51,63
v_permlane32_swap_b32 v48, v50
Maaa 196,72,112
DN 28,16,47,2048
v_permlane32_swap_b32 v49, v51
Maaa 164,72,104
v_permlane16_swap_b32 v48, v50
Maaa 164,76,108
v_permlane16_swap_b32 v49, v51
v_mul_f32 v52, s40, v168
Maaa 132,76,100
v_mul_f32 v53, s40, v169
v_mul_f32 v54, s40, v170
v_mul_f32 v55, s40, v171
Maaa 132,72,96
s_waitcnt lgkmcnt(8)
v_mul_f32 v56, s40, v172
v_mul_f32 v57, s40, v173
v_mul_f32 v58, s40, v174
Maaa 136,80,96
Ta 72,21,49152
Ta 74,21,50176
v_mul_f32 v59, s40, v175
Maaa 136,84,100
Ta 76,21,57344
Ta 78,21,58368
CV 60,52
Maaa 168,84,108
CV 61,54
CV 62,56
CV 63,58
Maaa 168,80,104
AW 4,48
AW 5,49
AW 6,50
Maaa 200,80,112
AW 7,51
v_permlane32_swap_b32 v60, v62
Maaa 200,84,116
v_permlane32_swap_b32 v61, v63
Maaa 232,84,124
v_permlane16_swap_b32 v60, v62
Maaa 232,80,120
s_waitcnt lgkmcnt(8)
v_permlane16_swap_b32 v61, v63
v_mul_f32 v40, s40, v200
Maaa 236,88,120
Ta 80,22,49152
Ta 82,22,50176
v_mul_f32 v41, s40, v201
Maaa 236,92,124
Ta 84,22,57344
Ta 86,22,58368
v_mul_f32 v42, s40, v202
Maaa 204,92,116
v_mul_f32 v43, s40, v203
v_mul_f32 v44, s40, v204
v_mul_f32 v45, s40, v205
Maaa 204,88,112
DN 29,16,47,3072
v_mul_f32 v46, s40, v206
v_mul_f32 v47, s40, v207
CV 48,40
Maaa 172,88,104
s_add_u32 s32, s32, 16384
s_add_u32 s47, s32, s33
s_and_b32 s50, s47, 0x20000
s_lshr_b32 s47, s47, 3
s_and_b32 s47, s47, 0x3800
s_or_b32 s47, s47, s50
s_and_b32 s50, s32, 0x40000
s_or_b32 s47, s47, s50
s_add_u32 s47, s47, s90
CV 49,42
CV 50,44
CV 51,46
Maaa 172,92,108
AW 20,60
AW 21,61
AW 22,62
Maaa 140,92,100
AW 23,63
v_permlane32_swap_b32 v48, v50
Maaa 140,88,96
s_waitcnt lgkmcnt(8)
v_permlane32_swap_b32 v49, v51
Maaa 144,64,96
Ta 88,23,49152
Ta 90,23,50176
Maaa 144,68,100
Ta 92,23,57344
Ta 94,23,58368
Maaa 176,68,108
v_permlane16_swap_b32 v48, v50
Maaa 176,64,104
v_permlane16_swap_b32 v49, v51
v_mul_f32 v52, s40, v232
Maaa 208,64,112
v_mul_f32 v53, s40, v233
v_mul_f32 v54, s40, v234
v_mul_f32 v55, s40, v235
Maaa 208,68,116
v_mul_f32 v56, s40, v236
v_mul_f32 v57, s40, v237
v_mul_f32 v58, s40, v238
Maaa 240,68,124
v_mul_f32 v59, s40, v239
CV 60,52
CV 61,54
Maaa 240,64,120
CV 62,56
CV 63,58
AW 36,48
s_waitcnt vmcnt(8)
s_waitcnt lgkmcnt(0)
s_barrier
Maaa 244,72,120
AW 37,49
AW 38,50
AW 39,51
Maaa 244,76,124
v_permlane32_swap_b32 v60, v62
Maaa 212,76,116
s_add_u32 m0, s49, 0xc000
v_permlane32_swap_b32 v61, v63
Maaa 212,72,112
DN 26,16,47,0
v_permlane16_swap_b32 v60, v62
Maaa 180,72,104
v_permlane16_swap_b32 v61, v63
v_mul_f32 v40, s40, v144
Maaa 180,76,108
v_mul_f32 v41, s40, v145
v_mul_f32 v42, s40, v146
v_mul_f32 v43, s40, v147
Maaa 148,76,100
v_mul_f32 v44, s40, v148
v_mul_f32 v45, s40, v149
v_mul_f32 v46, s40, v150
Maaa 148,72,96
v_mul_f32 v47, s40, v151
CV 48,40
CV 49,42
Maaa 152,80,96
CV 50,44
CV 51,46
AW 52,60
Maaa 152,84,100
DN 27,16,47,1024
AW 53,61
AW 54,62
AW 55,63
Maaa 184,84,108
v_permlane32_swap_b32 v48, v50
Maaa 184,80,104
v_permlane32_swap_b32 v49, v51
Maaa 216,80,112
v_permlane16_swap_b32 v48, v50
Maaa 216,84,116
v_permlane16_swap_b32 v49, v51
v_mul_f32 v52, s40, v176
Maaa 248,84,124
v_mul_f32 v53, s40, v177
v_mul_f32 v54, s40, v178
v_mul_f32 v55, s40, v179
Maaa 248,80,120
DN 28,16,47,2048
v_mul_f32 v56, s40, v180
v_mul_f32 v57, s40, v181
v_mul_f32 v58, s40, v182
Maaa 252,88,120
v_mul_f32 v59, s40, v183
CV 60,52
CV 61,54
Maaa 252,92,124
CV 62,56
CV 63,58
AW 8,48
Maaa 220,92,116
AW 9,49
AW 10,50
AW 11,51
Maaa 220,88,112
v_permlane32_swap_b32 v60, v62
Maaa 188,88,104
v_permlane32_swap_b32 v61, v63
Maaa 188,92,108
DN 29,16,47,3072
v_permlane16_swap_b32 v60, v62
Maaa 156,92,100
s_add_u32 s32, s32, 16384
s_add_u32 s47, s32, s33
s_and_b32 s50, s47, 0x20000
s_lshr_b32 s47, s47, 3
s_and_b32 s47, s47, 0x3800
s_or_b32 s47, s47, s50
s_and_b32 s50, s32, 0x40000
s_or_b32 s47, s47, s50
s_add_u32 s47, s47, s90
v_permlane16_swap_b32 v61, v63
v_mul_f32 v40, s40, v208
Maaa 156,88,96
v_mul_f32 v41, s40, v209
v_mul_f32 v42, s40, v210
v_mul_f32 v43, s40, v211
v_mul_f32 v44, s40, v212
v_mul_f32 v45, s40, v213
v_mul_f32 v46, s40, v214
v_mul_f32 v47, s40, v215
CV 48,40
CV 49,42
CV 50,44
CV 51,46
AW 24,60
AW 25,61
AW 26,62
AW 27,63
v_permlane32_swap_b32 v48, v50
v_permlane32_swap_b32 v49, v51
s_nop 0
v_permlane16_swap_b32 v48, v50
v_permlane16_swap_b32 v49, v51
v_mul_f32 v52, s40, v240
v_mul_f32 v53, s40, v241
v_mul_f32 v54, s40, v242
v_mul_f32 v55, s40, v243
v_mul_f32 v56, s40, v244
v_mul_f32 v57, s40, v245
v_mul_f32 v58, s40, v246
v_mul_f32 v59, s40, v247
CV 60,52
CV 61,54
CV 62,56
CV 63,58
AW 40,48
AW 41,49
AW 42,50
AW 43,51
v_permlane32_swap_b32 v60, v62
v_permlane32_swap_b32 v61, v63
s_nop 0
v_permlane16_swap_b32 v60, v62
v_permlane16_swap_b32 v61, v63
v_mul_f32 v40, s40, v152
v_mul_f32 v41, s40, v153
v_mul_f32 v42, s40, v154
v_mul_f32 v43, s40, v155
v_mul_f32 v44, s40, v156
v_mul_f32 v45, s40, v157
v_mul_f32 v46, s40, v158
v_mul_f32 v47, s40, v159
CV 48,40
CV 49,42
CV 50,44
CV 51,46
AW 56,60
AW 57,61
AW 58,62
AW 59,63
v_permlane32_swap_b32 v48, v50
v_permlane32_swap_b32 v49, v51
s_nop 0
v_permlane16_swap_b32 v48, v50
v_permlane16_swap_b32 v49, v51
v_pk_mul_f32 v[52:53], v[184:185], s[40:41]
v_pk_mul_f32 v[54:55], v[186:187], s[40:41]
v_pk_mul_f32 v[56:57], v[188:189], s[40:41]
v_pk_mul_f32 v[58:59], v[190:191], s[40:41]
CV 60,52
CV 61,54
CV 62,56
CV 63,58
AW 12,48
AW 13,49
AW 14,50
AW 15,51
v_permlane32_swap_b32 v60, v62
v_permlane32_swap_b32 v61, v63
s_nop 0
v_permlane16_swap_b32 v60, v62
v_permlane16_swap_b32 v61, v63
v_pk_mul_f32 v[40:41], v[216:217], s[40:41]
v_pk_mul_f32 v[42:43], v[218:219], s[40:41]
v_pk_mul_f32 v[44:45], v[220:221], s[40:41]
v_pk_mul_f32 v[46:47], v[222:223], s[40:41]
CV 48,40
CV 49,42
CV 50,44
CV 51,46
AW 28,60
AW 29,61
AW 30,62
AW 31,63
v_permlane32_swap_b32 v48, v50
v_permlane32_swap_b32 v49, v51
s_nop 0
v_permlane16_swap_b32 v48, v50
v_permlane16_swap_b32 v49, v51
v_pk_mul_f32 v[52:53], v[248:249], s[40:41]
v_pk_mul_f32 v[54:55], v[250:251], s[40:41]
v_pk_mul_f32 v[56:57], v[252:253], s[40:41]
v_pk_mul_f32 v[58:59], v[254:255], s[40:41]
CV 60,52
CV 61,54
CV 62,56
CV 63,58
AW 44,48
AW 45,49
AW 46,50
AW 47,51
v_permlane32_swap_b32 v60, v62
v_permlane32_swap_b32 v61, v63
s_nop 0
v_permlane16_swap_b32 v60, v62
v_permlane16_swap_b32 v61, v63
AW 60,60
AW 61,61
AW 62,62
AW 63,63
v_mov_b64 v[96:97], 0
v_mov_b64 v[98:99], 0
AR 40,128
AR 41,129
AR 42,130
AR 43,131
AR 44,132
AR 45,133
AR 46,134
AR 47,135
v_pk_mul_f32 v[40:41], v[40:41], s[40:41]
v_pk_mul_f32 v[42:43], v[42:43], s[40:41]
v_pk_mul_f32 v[44:45], v[44:45], s[40:41]
v_pk_mul_f32 v[46:47], v[46:47], s[40:41]
v_mfma_f32_32x32x16_bf16 v[128:143], v[96:99], v[96:99], 0
CV 48,40
CV 49,42
CV 50,44
CV 51,46
s_nop 1
v_permlane32_swap_b32 v48, v50
v_permlane32_swap_b32 v49, v51
s_nop 0
v_permlane16_swap_b32 v48, v50
v_permlane16_swap_b32 v49, v51
AR 52,136
AR 53,137
AR 54,138
AR 55,139
AR 56,140
AR 57,141
AR 58,142
AR 59,143
v_pk_mul_f32 v[52:53], v[52:53], s[40:41]
v_pk_mul_f32 v[54:55], v[54:55], s[40:41]
v_pk_mul_f32 v[56:57], v[56:57], s[40:41]
v_pk_mul_f32 v[58:59], v[58:59], s[40:41]
v_mfma_f32_32x32x16_bf16 v[144:159], v[96:99], v[96:99], 0
CV 60,52
CV 61,54
CV 62,56
CV 63,58
AW 64,48
AW 65,49
AW 66,50
AW 67,51
v_permlane32_swap_b32 v60, v62
v_permlane32_swap_b32 v61, v63
s_nop 0
v_permlane16_swap_b32 v60, v62
v_permlane16_swap_b32 v61, v63
AR 40,144
AR 41,145
AR 42,146
AR 43,147
AR 44,148
AR 45,149
AR 46,150
AR 47,151
v_pk_mul_f32 v[40:41], v[40:41], s[40:41]
v_pk_mul_f32 v[42:43], v[42:43], s[40:41]
v_pk_mul_f32 v[44:45], v[44:45], s[40:41]
v_pk_mul_f32 v[46:47], v[46:47], s[40:41]
v_mfma_f32_32x32x16_bf16 v[160:175], v[96:99], v[96:99], 0
CV 48,40
CV 49,42
CV 50,44
CV 51,46
AW 68,60
AW 69,61
AW 70,62
AW 71,63
v_permlane32_swap_b32 v48, v50
v_permlane32_swap_b32 v49, v51
s_nop 0
v_permlane16_swap_b32 v48, v50
v_permlane16_swap_b32 v49, v51
AR 52,152
AR 53,153
AR 54,154
AR 55,155
AR 56,156
AR 57,157
AR 58,158
AR 59,159
v_pk_mul_f32 v[52:53], v[52:53], s[40:41]
v_pk_mul_f32 v[54:55], v[54:55], s[40:41]
v_pk_mul_f32 v[56:57], v[56:57], s[40:41]
v_pk_mul_f32 v[58:59], v[58:59], s[40:41]
v_mfma_f32_32x32x16_bf16 v[176:191], v[96:99], v[96:99], 0
CV 60,52
CV 61,54
CV 62,56
CV 63,58
AW 72,48
AW 73,49
AW 74,50
AW 75,51
v_permlane32_swap_b32 v60, v62
v_permlane32_swap_b32 v61, v63
s_nop 0
v_permlane16_swap_b32 v60, v62
v_permlane16_swap_b32 v61, v63
AR 40,160
AR 41,161
AR 42,162
AR 43,163
AR 44,164
AR 45,165
AR 46,166
AR 47,167
v_pk_mul_f32 v[40:41], v[40:41], s[40:41]
v_pk_mul_f32 v[42:43], v[42:43], s[40:41]
v_pk_mul_f32 v[44:45], v[44:45], s[40:41]
v_pk_mul_f32 v[46:47], v[46:47], s[40:41]
v_mfma_f32_32x32x16_bf16 v[192:207], v[96:99], v[96:99], 0
CV 48,40
CV 49,42
CV 50,44
CV 51,46
AW 76,60
AW 77,61
AW 78,62
AW 79,63
v_permlane32_swap_b32 v48, v50
v_permlane32_swap_b32 v49, v51
s_nop 0
v_permlane16_swap_b32 v48, v50
v_permlane16_swap_b32 v49, v51
AR 52,168
AR 53,169
AR 54,170
AR 55,171
AR 56,172
AR 57,173
AR 58,174
AR 59,175
v_pk_mul_f32 v[52:53], v[52:53], s[40:41]
v_pk_mul_f32 v[54:55], v[54:55], s[40:41]
v_pk_mul_f32 v[56:57], v[56:57], s[40:41]
v_pk_mul_f32 v[58:59], v[58:59], s[40:41]
v_mfma_f32_32x32x16_bf16 v[208:223], v[96:99], v[96:99], 0
CV 60,52
CV 61,54
CV 62,56
CV 63,58
AW 80,48
AW 81,49
AW 82,50
AW 83,51
v_permlane32_swap_b32 v60, v62
v_permlane32_swap_b32 v61, v63
s_nop 0
v_permlane16_swap_b32 v60, v62
v_permlane16_swap_b32 v61, v63
AR 40,176
AR 41,177
AR 42,178
AR 43,179
AR 44,180
AR 45,181
AR 46,182
AR 47,183
v_pk_mul_f32 v[40:41], v[40:41], s[40:41]
v_pk_mul_f32 v[42:43], v[42:43], s[40:41]
v_pk_mul_f32 v[44:45], v[44:45], s[40:41]
v_pk_mul_f32 v[46:47], v[46:47], s[40:41]
v_mfma_f32_32x32x16_bf16 v[224:239], v[96:99], v[96:99], 0
CV 48,40
CV 49,42
CV 50,44
CV 51,46
AW 84,60
AW 85,61
AW 86,62
AW 87,63
v_permlane32_swap_b32 v48, v50
v_permlane32_swap_b32 v49, v51
s_nop 0
v_permlane16_swap_b32 v48, v50
v_permlane16_swap_b32 v49, v51
AR 52,184
AR 53,185
AR 54,186
AR 55,187
AR 56,188
AR 57,189
AR 58,190
AR 59,191
v_add_u32 v16, 0x20000, v4
v_add_u32 v17, 0x20000, v5
v_add_u32 v18, 0x20000, v6
v_add_u32 v19, 0x20000, v7
v_pk_mul_f32 v[52:53], v[52:53], s[40:41]
v_pk_mul_f32 v[54:55], v[54:55], s[40:41]
v_pk_mul_f32 v[56:57], v[56:57], s[40:41]
Ra 128,16,0
v_pk_mul_f32 v[58:59], v[58:59], s[40:41]
v_mfma_f32_32x32x16_bf16 v[240:255], v[96:99], v[96:99], 0
CV 60,52
CV 61,54
Ra 132,17,0
CV 62,56
CV 63,58
AW 88,48
Ra 136,18,0
AW 89,49
AW 90,50
AW 91,51
v_permlane32_swap_b32 v60, v62
v_permlane32_swap_b32 v61, v63
s_nop 0
v_permlane16_swap_b32 v60, v62
v_permlane16_swap_b32 v61, v63
AR 40,192
Ra 140,19,0
Ra 144,16,4096
AR 41,193
AR 42,194
Ra 148,17,4096
AR 43,195
AR 44,196
AR 45,197
Ra 152,18,4096
AR 46,198
AR 47,199
v_pk_mul_f32 v[40:41], v[40:41], s[40:41]
v_pk_mul_f32 v[42:43], v[42:43], s[40:41]
Ra 156,19,4096
v_pk_mul_f32 v[44:45], v[44:45], s[40:41]
v_pk_mul_f32 v[46:47], v[46:47], s[40:41]
CV 48,40
Ra 160,16,8192
CV 49,42
CV 50,44
CV 51,46
AW 92,60
Ra 164,17,8192
AW 93,61
AW 94,62
AW 95,63
v_permlane32_swap_b32 v48, v50
v_permlane32_swap_b32 v49, v51
s_nop 0
v_permlane16_swap_b32 v48, v50
v_permlane16_swap_b32 v49, v51
AR 52,200
Ra 168,18,8192
Ra 172,19,8192
AR 53,201
Ra 176,16,12288
AR 54,202
AR 55,203
AR 56,204
AR 57,205
Ra 180,17,12288
AR 58,206
AR 59,207
v_pk_mul_f32 v[52:53], v[52:53], s[40:41]
Ra 184,18,12288
v_pk_mul_f32 v[54:55], v[54:55], s[40:41]
v_pk_mul_f32 v[56:57], v[56:57], s[40:41]
v_pk_mul_f32 v[58:59], v[58:59], s[40:41]
CV 60,52
Ra 188,19,12288
CV 61,54
CV 62,56
CV 63,58
AW 96,48
AW 97,49
AW 98,50
AW 99,51
v_permlane32_swap_b32 v60, v62
v_permlane32_swap_b32 v61, v63
s_nop 0
v_permlane16_swap_b32 v60, v62
v_permlane16_swap_b32 v61, v63
AR 40,208
AR 41,209
AR 42,210
AR 43,211
AR 44,212
AR 45,213
AR 46,214
AR 47,215
v_pk_mul_f32 v[40:41], v[40:41], s[40:41]
v_pk_mul_f32 v[42:43], v[42:43], s[40:41]
v_pk_mul_f32 v[44:45], v[44:45], s[40:41]
v_pk_mul_f32 v[46:47], v[46:47], s[40:41]
CV 48,40
CV 49,42
CV 50,44
CV 51,46
AW 100,60
AW 101,61
AW 102,62
AW 103,63
v_permlane32_swap_b32 v48, v50
v_permlane32_swap_b32 v49, v51
s_nop 0
v_permlane16_swap_b32 v48, v50
v_permlane16_swap_b32 v49, v51
AR 52,216
AR 53,217
AR 54,218
AR 55,219
AR 56,220
AR 57,221
AR 58,222
AR 59,223
v_pk_mul_f32 v[52:53], v[52:53], s[40:41]
v_pk_mul_f32 v[54:55], v[54:55], s[40:41]
v_pk_mul_f32 v[56:57], v[56:57], s[40:41]
v_pk_mul_f32 v[58:59], v[58:59], s[40:41]
CV 60,52
CV 61,54
CV 62,56
CV 63,58
AW 104,48
AW 105,49
AW 106,50
AW 107,51
v_permlane32_swap_b32 v60, v62
v_permlane32_swap_b32 v61, v63
s_nop 0
v_permlane16_swap_b32 v60, v62
v_permlane16_swap_b32 v61, v63
AR 40,224
AR 41,225
AR 42,226
AR 43,227
AR 44,228
AR 45,229
AR 46,230
AR 47,231
v_pk_mul_f32 v[40:41], v[40:41], s[40:41]
v_pk_mul_f32 v[42:43], v[42:43], s[40:41]
v_pk_mul_f32 v[44:45], v[44:45], s[40:41]
v_pk_mul_f32 v[46:47], v[46:47], s[40:41]
CV 48,40
CV 49,42
CV 50,44
CV 51,46
AW 108,60
AW 109,61
AW 110,62
AW 111,63
v_permlane32_swap_b32 v48, v50
v_permlane32_swap_b32 v49, v51
s_nop 0
v_permlane16_swap_b32 v48, v50
v_permlane16_swap_b32 v49, v51
AR 52,232
AR 53,233
AR 54,234
AR 55,235
AR 56,236
AR 57,237
AR 58,238
AR 59,239
v_pk_mul_f32 v[52:53], v[52:53], s[40:41]
v_pk_mul_f32 v[54:55], v[54:55], s[40:41]
v_pk_mul_f32 v[56:57], v[56:57], s[40:41]
v_pk_mul_f32 v[58:59], v[58:59], s[40:41]
CV 60,52
CV 61,54
CV 62,56
CV 63,58
AW 112,48
AW 113,49
AW 114,50
AW 115,51
v_permlane32_swap_b32 v60, v62
v_permlane32_swap_b32 v61, v63
s_nop 0
v_permlane16_swap_b32 v60, v62
v_permlane16_swap_b32 v61, v63
AR 40,240
AR 41,241
AR 42,242
AR 43,243
AR 44,244
AR 45,245
AR 46,246
AR 47,247
v_pk_mul_f32 v[40:41], v[40:41], s[40:41]
v_pk_mul_f32 v[42:43], v[42:43], s[40:41]
v_pk_mul_f32 v[44:45], v[44:45], s[40:41]
v_pk_mul_f32 v[46:47], v[46:47], s[40:41]
CV 48,40
CV 49,42
CV 50,44
CV 51,46
AW 116,60
AW 117,61
AW 118,62
AW 119,63
v_permlane32_swap_b32 v48, v50
v_permlane32_swap_b32 v49, v51
s_nop 0
v_permlane16_swap_b32 v48, v50
v_permlane16_swap_b32 v49, v51
AR 52,248
AR 53,249
AR 54,250
AR 55,251
AR 56,252
AR 57,253
AR 58,254
AR 59,255
v_pk_mul_f32 v[52:53], v[52:53], s[40:41]
v_pk_mul_f32 v[54:55], v[54:55], s[40:41]
v_pk_mul_f32 v[56:57], v[56:57], s[40:41]
v_pk_mul_f32 v[58:59], v[58:59], s[40:41]
CV 60,52
CV 61,54
CV 62,56
CV 63,58
AW 120,48
AW 121,49
AW 122,50
AW 123,51
v_permlane32_swap_b32 v60, v62
v_permlane32_swap_b32 v61, v63
s_nop 0
v_permlane16_swap_b32 v60, v62
v_permlane16_swap_b32 v61, v63
AW 124,60
AW 125,61
AW 126,62
AW 127,63
v_mov_b32 v112, 0
v_mov_b32 v113, 0
v_mov_b32 v114, 0
v_mov_b32 v115, 0
s_mov_b32 s29, 0
s_nop 1
s_waitcnt lgkmcnt(12)
Zvaa 64,128,0
v_add_u32 v16, 0x14000, v8
v_add_u32 v17, 0x14000, v9
v_add_u32 v18, 0x14000, v10
v_add_u32 v19, 0x14000, v11
Mvaa 64,132,4
v_add_u32 v20, 0x14000, v12
v_add_u32 v21, 0x14000, v13
v_add_u32 v22, 0x14000, v14
v_add_u32 v23, 0x14000, v15
Mvaa 64,136,8
s_add_u32 m0, s49, 0x0
Ta 192,16,0
Ta 194,16,4096
Mvaa 64,140,12
s_waitcnt lgkmcnt(10)
Ta 196,16,8192
DN 26,16,47,0
Zvaa 68,156,12
Ta 198,16,12288
DN 27,16,47,1024
Mvaa 68,152,8
Ta 200,17,0
DN 28,16,47,2048
Mvaa 68,148,4
Ta 202,17,4096
DN 29,16,47,3072
Mvaa 68,144,0
s_waitcnt lgkmcnt(10)
Ta 204,17,8192
Zvaa 72,160,0
Ta 206,17,12288
EX 64
Mvaa 72,164,4
Ta 208,18,0
AD 112,64
EX 65
Mvaa 72,168,8
Ta 210,18,4096
AD 112,65
CV 96,64
Mvaa 72,172,12
s_waitcnt lgkmcnt(10)
Ta 212,18,8192
EX 66
Zvaa 76,188,12
Ta 214,18,12288
AD 112,66
EX 67
Mvaa 76,184,8
Ta 216,19,0
AD 112,67
CV 97,66
Mvaa 76,180,4
Ta 218,19,4096
EX 68
Mvaa 76,176,0
Ta 220,19,8192
AD 112,68
EX 69
Zvaa 80,128,16
Ta 222,19,12288
AD 112,69
CV 98,68
Mvaa 80,132,20
Ta 224,20,0
Ta 226,20,4096
EX 70
Mvaa 80,136,24
Ta 228,20,8192
AD 112,70
EX 71
Mvaa 80,140,28
Ta 230,20,12288
AD 112,71
CV 99,70
Zvaa 84,156,28
Ta 232,21,0
EX 72
Mvaa 84,152,24
Ta 234,21,4096
AD 112,72
EX 73
Mvaa 84,148,20
Ta 236,21,8192
AD 112,73
CV 100,72
Mvaa 84,144,16
Ta 238,21,12288
EX 74
Zvaa 88,160,16
Ta 240,22,0
AD 112,74
EX 75
Mvaa 88,164,20
Ta 242,22,4096
AD 112,75
CV 101,74
Mvaa 88,168,24
Ta 244,22,8192
EX 76
Mvaa 88,172,28
Ta 246,22,12288
AD 112,76
EX 77
Zvaa 92,188,28
Ta 248,23,0
AD 112,77
CV 102,76
Mvaa 92,184,24
Ta 250,23,4096
EX 78
Mvaa 92,180,20
Ta 252,23,8192
AD 112,78
EX 79
Mvaa 92,176,16
Ta 254,23,12288
AD 112,79
CV 103,78
Zvaa 64,128,32
EX 80
Mvaa 64,132,36
AD 113,80
Mvaa 64,136,40
EX 81
Mvaa 64,140,44
AD 113,81
CV 104,80
Zvaa 68,156,44
EX 82
Mvaa 68,152,40
AD 113,82
Mvaa 68,148,36
EX 83
Mvaa 68,144,32
AD 113,83
CV 105,82
Zvaa 72,160,32
EX 84
Mvaa 72,164,36
AD 113,84
Mvaa 72,168,40
EX 85
Mvaa 72,172,44
AD 113,85
CV 106,84
Zvaa 76,188,44
EX 86
Mvaa 76,184,40
AD 113,86
Mvaa 76,180,36
EX 87
Mvaa 76,176,32
s_waitcnt lgkmcnt(15)
AD 113,87
CV 107,86
Mvav 128,192,96
EX 88
Mvav 128,196,100
s_waitcnt lgkmcnt(15)
AD 113,88
Mvav 132,204,100
EX 89
Mvav 132,200,96
s_waitcnt lgkmcnt(15)
AD 113,89
CV 108,88
Mvav 136,208,96
EX 90
Mvav 136,212,100
s_waitcnt lgkmcnt(15)
AD 113,90
Mvav 140,220,100
EX 91
Mvav 140,216,96
s_waitcnt lgkmcnt(12)
AD 113,91
CV 109,90
Mvav 144,224,96
EX 92
Mvav 144,228,100
s_waitcnt lgkmcnt(8)
AD 113,92
Mvav 148,236,100
EX 93
Mvav 148,232,96
s_waitcnt lgkmcnt(4)
AD 113,93
CV 110,92
Mvav 152,240,96
EX 94
Mvav 152,244,100
s_waitcnt lgkmcnt(0)
AD 113,94
Mvav 156,252,100
EX 95
Mvav 156,248,96
AD 113,95
CV 111,94
L1a_aloop:
s_waitcnt vmcnt(8)
s_barrier
Zvaa 80,128,48
s_add_u32 m0, s49, 0x0
EX 64
Mvaa 80,132,52
Ra 128,4,16384
AD 114,64
Mvaa 80,136,56
s_mov_b64 exec, s[94:95]
DN 26,16,47,0
s_mov_b64 exec, -1
EX 65
Mvaa 80,140,60
AD 114,65
CV 96,64
Zvaa 84,156,60
EX 66
Mvaa 84,152,56
Ra 132,5,16384
AD 114,66
Mvaa 84,148,52
EX 67
Mvaa 84,144,48
AD 114,67
CV 97,66
Zvaa 88,160,48
EX 68
Mvaa 88,164,52
Ra 136,6,16384
AD 114,68
Mvaa 88,168,56
EX 69
Mvaa 88,172,60
AD 114,69
CV 98,68
Zvaa 92,188,60
EX 70
Mvaa 92,184,56
Ra 140,7,16384
AD 114,70
Mvaa 92,180,52
EX 71
Mvaa 92,176,48
AD 114,71
CV 99,70
Mvav 160,192,104
EX 72
Mvav 160,196,108
Ra 144,4,20480
AD 114,72
Mvav 164,204,108
EX 73
Mvav 164,200,104
AD 114,73
CV 100,72
Mvav 168,208,104
EX 74
Mvav 168,212,108
Ra 148,5,20480
AD 114,74
Mvav 172,220,108
EX 75
Mvav 172,216,104
AD 114,75
CV 101,74
Mvav 176,224,104
EX 76
Mvav 176,228,108
Ra 152,6,20480
AD 114,76
Mvav 180,236,108
EX 77
Mvav 180,232,104
AD 114,77
CV 102,76
Mvav 184,240,104
EX 78
Mvav 184,244,108
Ra 156,7,20480
AD 114,78
Mvav 188,252,108
EX 79
Mvav 188,248,104
s_waitcnt lgkmcnt(4)
AD 114,79
CV 103,78
Zvaa 64,128,0
Ra 160,4,24576
Ra 164,5,24576
Mvaa 64,132,4
Ra 168,6,24576
Ra 172,7,24576
Mvaa 64,136,8
Ra 176,4,28672
Ra 180,5,28672
s_mov_b64 exec, s[94:95]
DN 27,16,47,1024
s_mov_b64 exec, -1
Mvaa 64,140,12
s_waitcnt lgkmcnt(6)
Ra 184,6,28672
Ra 188,7,28672
Zvaa 68,156,12
EX 80
Mvaa 68,152,8
EX 81
Mvaa 68,148,4
AD 115,80
AD 115,81
Mvaa 68,144,0
s_waitcnt lgkmcnt(4)
EX 82
Zvaa 72,160,0
EX 83
Mvaa 72,164,4
CV 104,80
AD 115,82
Mvaa 72,168,8
AD 115,83
CV 105,82
Mvaa 72,172,12
s_waitcnt lgkmcnt(0)
EX 84
Zvaa 76,188,12
EX 85
Mvaa 76,184,8
AD 115,84
AD 115,85
Mvaa 76,180,4
EX 86
Mvaa 76,176,0
EX 87
Mvav 192,192,96
CV 106,84
AD 115,86
Mvav 192,196,100
AD 115,87
CV 107,86
Mvav 196,204,100
EX 88
Mvav 196,200,96
EX 89
Mvav 200,208,96
AD 115,88
AD 115,89
Mvav 200,212,100
EX 90
Mvav 204,220,100
EX 91
Mvav 204,216,96
CV 108,88
AD 115,90
Mvav 208,224,96
AD 115,91
CV 109,90
Mvav 208,228,100
EX 92
Mvav 212,236,100
EX 93
Mvav 212,232,96
AD 115,92
AD 115,93
Mvav 216,240,96
EX 94
Mvav 216,244,100
EX 95
Mvav 220,252,100
CV 110,92
AD 115,94
Mvav 220,248,96
AD 115,95
CV 111,94
Zvaa 80,128,16
EX 64
Mvaa 80,132,20
EX 65
Mvaa 80,136,24
s_mov_b64 exec, s[94:95]
DN 28,16,47,2048
s_mov_b64 exec, -1
AD 112,64
AD 112,65
Mvaa 80,140,28
EX 66
Zvaa 84,156,28
EX 67
Mvaa 84,152,24
CV 96,64
AD 112,66
Mvaa 84,148,20
AD 112,67
CV 97,66
Mvaa 84,144,16
EX 68
Zvaa 88,160,16
EX 69
Mvaa 88,164,20
AD 112,68
AD 112,69
Mvaa 88,168,24
EX 70
Mvaa 88,172,28
EX 71
Zvaa 92,188,28
CV 98,68
AD 112,70
Mvaa 92,184,24
AD 112,71
CV 99,70
Mvaa 92,180,20
EX 72
Mvaa 92,176,16
EX 73
Mvav 224,192,104
AD 112,72
AD 112,73
Mvav 224,196,108
EX 74
Mvav 228,204,108
EX 75
Mvav 228,200,104
CV 100,72
AD 112,74
Mvav 232,208,104
AD 112,75
CV 101,74
Mvav 232,212,108
EX 76
Mvav 236,220,108
EX 77
Mvav 236,216,104
AD 112,76
AD 112,77
Mvav 240,224,104
EX 78
Mvav 240,228,108
EX 79
Mvav 244,236,108
CV 102,76
AD 112,78
Mvav 244,232,104
AD 112,79
CV 103,78
Mvav 248,240,104
Ta 192,8,16384
Ta 194,8,20480
Mvav 248,244,108
Ta 196,8,24576
Ta 198,8,28672
Mvav 252,252,108
Ta 200,9,16384
Ta 202,9,20480
Mvav 252,248,104
Ta 204,9,24576
Ta 206,9,28672
Zvaa 64,128,32
Ta 208,10,16384
Ta 210,10,20480
Mvaa 64,132,36
Ta 212,10,24576
Ta 214,10,28672
Mvaa 64,136,40
Ta 216,11,16384
Ta 218,11,20480
s_mov_b64 exec, s[94:95]
DN 29,16,47,3072
s_mov_b64 exec, -1
Mvaa 64,140,44
Ta 220,11,24576
Ta 222,11,28672
Zvaa 68,156,44
Ta 224,12,16384
Ta 226,12,20480
Mvaa 68,152,40
Ta 228,12,24576
Ta 230,12,28672
Mvaa 68,148,36
Ta 232,13,16384
Ta 234,13,20480
Mvaa 68,144,32
Ta 236,13,24576
Ta 238,13,28672
Zvaa 72,160,32
Ta 240,14,16384
Ta 242,14,20480
Mvaa 72,164,36
Ta 244,14,24576
Ta 246,14,28672
Mvaa 72,168,40
Ta 248,15,16384
Ta 250,15,20480
Mvaa 72,172,44
Ta 252,15,24576
Ta 254,15,28672
Zvaa 76,188,44
EX 80
Mvaa 76,184,40
AD 113,80
EX 81
Mvaa 76,180,36
AD 113,81
EX 82
Mvaa 76,176,32
s_waitcnt lgkmcnt(15)
AD 113,82
EX 83
Mvav 128,192,96
CV 104,80
CV 105,82
AD 113,83
Mvav 128,196,100
s_waitcnt lgkmcnt(15)
EX 84
Mvav 132,204,100
AD 113,84
EX 85
Mvav 132,200,96
s_waitcnt lgkmcnt(15)
AD 113,85
EX 86
Mvav 136,208,96
AD 113,86
EX 87
Mvav 136,212,100
s_waitcnt lgkmcnt(15)
CV 106,84
CV 107,86
AD 113,87
Mvav 140,220,100
EX 88
Mvav 140,216,96
s_waitcnt lgkmcnt(12)
AD 113,88
EX 89
Mvav 144,224,96
AD 113,89
EX 90
Mvav 144,228,100
s_waitcnt lgkmcnt(8)
AD 113,90
EX 91
Mvav 148,236,100
CV 108,88
CV 109,90
AD 113,91
Mvav 148,232,96
s_waitcnt lgkmcnt(4)
EX 92
Mvav 152,240,96
AD 113,92
EX 93
Mvav 152,244,100
s_waitcnt lgkmcnt(0)
AD 113,93
EX 94
Mvav 156,252,100
AD 113,94
EX 95
Mvav 156,248,96
s_add_u32 s32, s32, 16384
s_add_u32 s47, s32, s33
s_and_b32 s50, s47, 0x20000
s_lshr_b32 s47, s47, 3
s_and_b32 s47, s47, 0x3800
s_or_b32 s47, s47, s50
s_and_b32 s50, s32, 0x40000
s_or_b32 s47, s47, s50
s_add_u32 s47, s47, s90
s_mov_b64 s[94:95], -1
CV 110,92
CV 111,94
AD 113,95
s_add_u32 s29, s29, 1
s_waitcnt vmcnt(8)
s_barrier
Zvaa 80,128,48
s_add_u32 m0, s49, 0x4000
EX 64
Mvaa 80,132,52
Ra 128,4,32768
AD 114,64
Mvaa 80,136,56
DN 26,16,47,0
EX 65
Mvaa 80,140,60
AD 114,65
CV 96,64
Zvaa 84,156,60
EX 66
Mvaa 84,152,56
Ra 132,5,32768
AD 114,66
Mvaa 84,148,52
EX 67
Mvaa 84,144,48
AD 114,67
CV 97,66
Zvaa 88,160,48
EX 68
Mvaa 88,164,52
Ra 136,6,32768
AD 114,68
Mvaa 88,168,56
EX 69
Mvaa 88,172,60
AD 114,69
CV 98,68
Zvaa 92,188,60
EX 70
Mvaa 92,184,56
Ra 140,7,32768
AD 114,70
Mvaa 92,180,52
EX 71
Mvaa 92,176,48
AD 114,71
CV 99,70
Mvav 160,192,104
EX 72
Mvav 160,196,108
Ra 144,4,36864
AD 114,72
Mvav 164,204,108
EX 73
Mvav 164,200,104
AD 114,73
CV 100,72
Mvav 168,208,104
EX 74
Mvav 168,212,108
Ra 148,5,36864
AD 114,74
Mvav 172,220,108
EX 75
Mvav 172,216,104
AD 114,75
CV 101,74
Mvav 176,224,104
EX 76
Mvav 176,228,108
Ra 152,6,36864
AD 114,76
Mvav 180,236,108
EX 77
Mvav 180,232,104
AD 114,77
CV 102,76
Mvav 184,240,104
EX 78
Mvav 184,244,108
Ra 156,7,36864
AD 114,78
Mvav 188,252,108
EX 79
Mvav 188,248,104
s_waitcnt lgkmcnt(4)
AD 114,79
CV 103,78
Zvaa 64,128,0
Ra 160,4,40960
Ra 164,5,40960
Mvaa 64,132,4
Ra 168,6,40960
Ra 172,7,40960
Mvaa 64,136,8
Ra 176,4,45056
Ra 180,5,45056
DN 27,16,47,1024
Mvaa 64,140,12
s_waitcnt lgkmcnt(6)
Ra 184,6,45056
Ra 188,7,45056
Zvaa 68,156,12
EX 80
Mvaa 68,152,8
EX 81
Mvaa 68,148,4
AD 115,80
AD 115,81
Mvaa 68,144,0
s_waitcnt lgkmcnt(4)
EX 82
Zvaa 72,160,0
EX 83
Mvaa 72,164,4
CV 104,80
AD 115,82
Mvaa 72,168,8
AD 115,83
CV 105,82
Mvaa 72,172,12
s_waitcnt lgkmcnt(0)
EX 84
Zvaa 76,188,12
EX 85
Mvaa 76,184,8
AD 115,84
AD 115,85
Mvaa 76,180,4
EX 86
Mvaa 76,176,0
EX 87
Mvav 192,192,96
CV 106,84
AD 115,86
Mvav 192,196,100
AD 115,87
CV 107,86
Mvav 196,204,100
EX 88
Mvav 196,200,96
EX 89
Mvav 200,208,96
AD 115,88
AD 115,89
Mvav 200,212,100
EX 90
Mvav 204,220,100
EX 91
Mvav 204,216,96
CV 108,88
AD 115,90
Mvav 208,224,96
AD 115,91
CV 109,90
Mvav 208,228,100
EX 92
Mvav 212,236,100
EX 93
Mvav 212,232,96
AD 115,92
AD 115,93
Mvav 216,240,96
EX 94
Mvav 216,244,100
EX 95
Mvav 220,252,100
CV 110,92
AD 115,94
Mvav 220,248,96
AD 115,95
CV 111,94
Zvaa 80,128,16
EX 64
Mvaa 80,132,20
EX 65
Mvaa 80,136,24
DN 28,16,47,2048
AD 112,64
AD 112,65
Mvaa 80,140,28
EX 66
Zvaa 84,156,28
EX 67
Mvaa 84,152,24
CV 96,64
AD 112,66
Mvaa 84,148,20
AD 112,67
CV 97,66
Mvaa 84,144,16
EX 68
Zvaa 88,160,16
EX 69
Mvaa 88,164,20
AD 112,68
AD 112,69
Mvaa 88,168,24
EX 70
Mvaa 88,172,28
EX 71
Zvaa 92,188,28
CV 98,68
AD 112,70
Mvaa 92,184,24
AD 112,71
CV 99,70
Mvaa 92,180,20
EX 72
Mvaa 92,176,16
EX 73
Mvav 224,192,104
AD 112,72
AD 112,73
Mvav 224,196,108
EX 74
Mvav 228,204,108
EX 75
Mvav 228,200,104
CV 100,72
AD 112,74
Mvav 232,208,104
AD 112,75
CV 101,74
Mvav 232,212,108
EX 76
Mvav 236,220,108
EX 77
Mvav 236,216,104
AD 112,76
AD 112,77
Mvav 240,224,104
EX 78
Mvav 240,228,108
EX 79
Mvav 244,236,108
CV 102,76
AD 112,78
Mvav 244,232,104
AD 112,79
CV 103,78
Mvav 248,240,104
Ta 192,8,32768
Ta 194,8,36864
Mvav 248,244,108
Ta 196,8,40960
Ta 198,8,45056
Mvav 252,252,108
Ta 200,9,32768
Ta 202,9,36864
Mvav 252,248,104
Ta 204,9,40960
Ta 206,9,45056
Zvaa 64,128,32
Ta 208,10,32768
Ta 210,10,36864
Mvaa 64,132,36
Ta 212,10,40960
Ta 214,10,45056
Mvaa 64,136,40
Ta 216,11,32768
Ta 218,11,36864
DN 29,16,47,3072
Mvaa 64,140,44
Ta 220,11,40960
Ta 222,11,45056
Zvaa 68,156,44
Ta 224,12,32768
Ta 226,12,36864
Mvaa 68,152,40
Ta 228,12,40960
Ta 230,12,45056
Mvaa 68,148,36
Ta 232,13,32768
Ta 234,13,36864
Mvaa 68,144,32
Ta 236,13,40960
Ta 238,13,45056
Zvaa 72,160,32
Ta 240,14,32768
Ta 242,14,36864
Mvaa 72,164,36
Ta 244,14,40960
Ta 246,14,45056
Mvaa 72,168,40
Ta 248,15,32768
Ta 250,15,36864
Mvaa 72,172,44
Ta 252,15,40960
Ta 254,15,45056
Zvaa 76,188,44
EX 80
Mvaa 76,184,40
AD 113,80
EX 81
Mvaa 76,180,36
AD 113,81
EX 82
Mvaa 76,176,32
s_waitcnt lgkmcnt(15)
AD 113,82
EX 83
Mvav 128,192,96
CV 104,80
CV 105,82
AD 113,83
Mvav 128,196,100
s_waitcnt lgkmcnt(15)
EX 84
Mvav 132,204,100
AD 113,84
EX 85
Mvav 132,200,96
s_waitcnt lgkmcnt(15)
AD 113,85
EX 86
Mvav 136,208,96
AD 113,86
EX 87
Mvav 136,212,100
s_waitcnt lgkmcnt(15)
CV 106,84
CV 107,86
AD 113,87
Mvav 140,220,100
EX 88
Mvav 140,216,96
s_waitcnt lgkmcnt(12)
AD 113,88
EX 89
Mvav 144,224,96
AD 113,89
EX 90
Mvav 144,228,100
s_waitcnt lgkmcnt(8)
AD 113,90
EX 91
Mvav 148,236,100
CV 108,88
CV 109,90
AD 113,91
Mvav 148,232,96
s_waitcnt lgkmcnt(4)
EX 92
Mvav 152,240,96
AD 113,92
EX 93
Mvav 152,244,100
s_waitcnt lgkmcnt(0)
AD 113,93
EX 94
Mvav 156,252,100
AD 113,94
EX 95
Mvav 156,248,96
s_add_u32 s32, s32, 16384
s_add_u32 s47, s32, s33
s_and_b32 s50, s47, 0x20000
s_lshr_b32 s47, s47, 3
s_and_b32 s47, s47, 0x3800
s_or_b32 s47, s47, s50
s_and_b32 s50, s32, 0x40000
s_or_b32 s47, s47, s50
s_add_u32 s47, s47, s90
CV 110,92
CV 111,94
AD 113,95
s_add_u32 s29, s29, 1
s_waitcnt vmcnt(8)
s_barrier
Zvaa 80,128,48
s_add_u32 m0, s49, 0x8000
EX 64
Mvaa 80,132,52
Ra 128,4,49152
AD 114,64
Mvaa 80,136,56
DN 26,16,47,0
EX 65
Mvaa 80,140,60
AD 114,65
CV 96,64
Zvaa 84,156,60
EX 66
Mvaa 84,152,56
Ra 132,5,49152
AD 114,66
Mvaa 84,148,52
EX 67
Mvaa 84,144,48
AD 114,67
CV 97,66
Zvaa 88,160,48
EX 68
Mvaa 88,164,52
Ra 136,6,49152
AD 114,68
Mvaa 88,168,56
EX 69
Mvaa 88,172,60
AD 114,69
CV 98,68
Zvaa 92,188,60
EX 70
Mvaa 92,184,56
Ra 140,7,49152
AD 114,70
Mvaa 92,180,52
EX 71
Mvaa 92,176,48
AD 114,71
CV 99,70
Mvav 160,192,104
EX 72
Mvav 160,196,108
Ra 144,4,53248
AD 114,72
Mvav 164,204,108
EX 73
Mvav 164,200,104
AD 114,73
CV 100,72
Mvav 168,208,104
EX 74
Mvav 168,212,108
Ra 148,5,53248
AD 114,74
Mvav 172,220,108
EX 75
Mvav 172,216,104
AD 114,75
CV 101,74
Mvav 176,224,104
EX 76
Mvav 176,228,108
Ra 152,6,53248
AD 114,76
Mvav 180,236,108
EX 77
Mvav 180,232,104
AD 114,77
CV 102,76
Mvav 184,240,104
EX 78
Mvav 184,244,108
Ra 156,7,53248
AD 114,78
Mvav 188,252,108
EX 79
Mvav 188,248,104
s_waitcnt lgkmcnt(4)
AD 114,79
CV 103,78
Zvaa 64,128,0
Ra 160,4,57344
Ra 164,5,57344
Mvaa 64,132,4
Ra 168,6,57344
Ra 172,7,57344
Mvaa 64,136,8
Ra 176,4,61440
Ra 180,5,61440
DN 27,16,47,1024
Mvaa 64,140,12
s_waitcnt lgkmcnt(6)
Ra 184,6,61440
Ra 188,7,61440
Zvaa 68,156,12
EX 80
Mvaa 68,152,8
EX 81
Mvaa 68,148,4
AD 115,80
AD 115,81
Mvaa 68,144,0
s_waitcnt lgkmcnt(4)
EX 82
Zvaa 72,160,0
EX 83
Mvaa 72,164,4
CV 104,80
AD 115,82
Mvaa 72,168,8
AD 115,83
CV 105,82
Mvaa 72,172,12
s_waitcnt lgkmcnt(0)
EX 84
Zvaa 76,188,12
EX 85
Mvaa 76,184,8
AD 115,84
AD 115,85
Mvaa 76,180,4
EX 86
Mvaa 76,176,0
EX 87
Mvav 192,192,96
CV 106,84
AD 115,86
Mvav 192,196,100
AD 115,87
CV 107,86
Mvav 196,204,100
EX 88
Mvav 196,200,96
EX 89
Mvav 200,208,96
AD 115,88
AD 115,89
Mvav 200,212,100
EX 90
Mvav 204,220,100
EX 91
Mvav 204,216,96
CV 108,88
AD 115,90
Mvav 208,224,96
AD 115,91
CV 109,90
Mvav 208,228,100
EX 92
Mvav 212,236,100
EX 93
Mvav 212,232,96
AD 115,92
AD 115,93
Mvav 216,240,96
EX 94
Mvav 216,244,100
EX 95
Mvav 220,252,100
CV 110,92
AD 115,94
Mvav 220,248,96
AD 115,95
CV 111,94
Zvaa 80,128,16
EX 64
Mvaa 80,132,20
EX 65
Mvaa 80,136,24
DN 28,16,47,2048
AD 112,64
AD 112,65
Mvaa 80,140,28
EX 66
Zvaa 84,156,28
EX 67
Mvaa 84,152,24
CV 96,64
AD 112,66
Mvaa 84,148,20
AD 112,67
CV 97,66
Mvaa 84,144,16
EX 68
Zvaa 88,160,16
EX 69
Mvaa 88,164,20
AD 112,68
AD 112,69
Mvaa 88,168,24
EX 70
Mvaa 88,172,28
EX 71
Zvaa 92,188,28
CV 98,68
AD 112,70
Mvaa 92,184,24
AD 112,71
CV 99,70
Mvaa 92,180,20
EX 72
Mvaa 92,176,16
EX 73
Mvav 224,192,104
AD 112,72
AD 112,73
Mvav 224,196,108
EX 74
Mvav 228,204,108
EX 75
Mvav 228,200,104
CV 100,72
AD 112,74
Mvav 232,208,104
AD 112,75
CV 101,74
Mvav 232,212,108
EX 76
Mvav 236,220,108
EX 77
Mvav 236,216,104
AD 112,76
AD 112,77
Mvav 240,224,104
EX 78
Mvav 240,228,108
EX 79
Mvav 244,236,108
CV 102,76
AD 112,78
Mvav 244,232,104
AD 112,79
CV 103,78
Mvav 248,240,104
Ta 192,8,49152
Ta 194,8,53248
Mvav 248,244,108
Ta 196,8,57344
Ta 198,8,61440
Mvav 252,252,108
Ta 200,9,49152
Ta 202,9,53248
Mvav 252,248,104
Ta 204,9,57344
Ta 206,9,61440
Zvaa 64,128,32
Ta 208,10,49152
Ta 210,10,53248
Mvaa 64,132,36
Ta 212,10,57344
Ta 214,10,61440
Mvaa 64,136,40
Ta 216,11,49152
Ta 218,11,53248
DN 29,16,47,3072
Mvaa 64,140,44
Ta 220,11,57344
Ta 222,11,61440
Zvaa 68,156,44
Ta 224,12,49152
Ta 226,12,53248
Mvaa 68,152,40
Ta 228,12,57344
Ta 230,12,61440
Mvaa 68,148,36
Ta 232,13,49152
Ta 234,13,53248
Mvaa 68,144,32
Ta 236,13,57344
Ta 238,13,61440
Zvaa 72,160,32
Ta 240,14,49152
Ta 242,14,53248
Mvaa 72,164,36
Ta 244,14,57344
Ta 246,14,61440
Mvaa 72,168,40
Ta 248,15,49152
Ta 250,15,53248
Mvaa 72,172,44
Ta 252,15,57344
Ta 254,15,61440
Zvaa 76,188,44
EX 80
Mvaa 76,184,40
AD 113,80
EX 81
Mvaa 76,180,36
AD 113,81
EX 82
Mvaa 76,176,32
s_waitcnt lgkmcnt(15)
AD 113,82
EX 83
Mvav 128,192,96
CV 104,80
CV 105,82
AD 113,83
Mvav 128,196,100
s_waitcnt lgkmcnt(15)
EX 84
Mvav 132,204,100
AD 113,84
EX 85
Mvav 132,200,96
s_waitcnt lgkmcnt(15)
AD 113,85
EX 86
Mvav 136,208,96
AD 113,86
EX 87
Mvav 136,212,100
s_waitcnt lgkmcnt(15)
CV 106,84
CV 107,86
AD 113,87
Mvav 140,220,100
EX 88
Mvav 140,216,96
s_waitcnt lgkmcnt(12)
AD 113,88
EX 89
Mvav 144,224,96
AD 113,89
EX 90
Mvav 144,228,100
s_waitcnt lgkmcnt(8)
AD 113,90
EX 91
Mvav 148,236,100
CV 108,88
CV 109,90
AD 113,91
Mvav 148,232,96
s_waitcnt lgkmcnt(4)
EX 92
Mvav 152,240,96
AD 113,92
EX 93
Mvav 152,244,100
s_waitcnt lgkmcnt(0)
AD 113,93
EX 94
Mvav 156,252,100
AD 113,94
EX 95
Mvav 156,248,96
s_add_u32 s32, s32, 16384
s_add_u32 s47, s32, s33
s_and_b32 s50, s47, 0x20000
s_lshr_b32 s47, s47, 3
s_and_b32 s47, s47, 0x3800
s_or_b32 s47, s47, s50
s_and_b32 s50, s32, 0x40000
s_or_b32 s47, s47, s50
s_add_u32 s47, s47, s90
CV 110,92
CV 111,94
AD 113,95
s_add_u32 s29, s29, 1
s_waitcnt vmcnt(8)
s_barrier
s_cmp_eq_u32 s29, 15
s_cbranch_scc1 L1a_flush0
L1a_flush0_back:
Zvaa 80,128,48
s_add_u32 m0, s49, 0xc000
EX 64
Mvaa 80,132,52
Ra 128,4,0
AD 114,64
Mvaa 80,136,56
DN 26,16,47,0
EX 65
Mvaa 80,140,60
AD 114,65
CV 96,64
Zvaa 84,156,60
EX 66
Mvaa 84,152,56
Ra 132,5,0
AD 114,66
Mvaa 84,148,52
EX 67
Mvaa 84,144,48
AD 114,67
CV 97,66
Zvaa 88,160,48
EX 68
Mvaa 88,164,52
Ra 136,6,0
AD 114,68
Mvaa 88,168,56
EX 69
Mvaa 88,172,60
AD 114,69
CV 98,68
Zvaa 92,188,60
EX 70
Mvaa 92,184,56
Ra 140,7,0
AD 114,70
Mvaa 92,180,52
EX 71
Mvaa 92,176,48
AD 114,71
CV 99,70
Mvav 160,192,104
EX 72
Mvav 160,196,108
Ra 144,4,4096
AD 114,72
Mvav 164,204,108
EX 73
Mvav 164,200,104
AD 114,73
CV 100,72
Mvav 168,208,104
EX 74
Mvav 168,212,108
Ra 148,5,4096
AD 114,74
Mvav 172,220,108
EX 75
Mvav 172,216,104
AD 114,75
CV 101,74
Mvav 176,224,104
EX 76
Mvav 176,228,108
Ra 152,6,4096
AD 114,76
Mvav 180,236,108
EX 77
Mvav 180,232,104
AD 114,77
CV 102,76
Mvav 184,240,104
EX 78
Mvav 184,244,108
Ra 156,7,4096
AD 114,78
Mvav 188,252,108
EX 79
Mvav 188,248,104
s_cmp_eq_u32 s29, 15
s_cbranch_scc1 L1a_flush1
L1a_flush1_back:
AD 114,79
CV 103,78
s_waitcnt lgkmcnt(4)
Zvaa 64,128,0
Ra 160,4,8192
Ra 164,5,8192
Mvaa 64,132,4
Ra 168,6,8192
Ra 172,7,8192
Mvaa 64,136,8
Ra 176,4,12288
Ra 180,5,12288
DN 27,16,47,1024
Mvaa 64,140,12
s_waitcnt lgkmcnt(6)
Ra 184,6,12288
Ra 188,7,12288
Zvaa 68,156,12
EX 80
Mvaa 68,152,8
EX 81
Mvaa 68,148,4
AD 115,80
AD 115,81
Mvaa 68,144,0
s_waitcnt lgkmcnt(4)
EX 82
Zvaa 72,160,0
EX 83
Mvaa 72,164,4
CV 104,80
AD 115,82
Mvaa 72,168,8
AD 115,83
CV 105,82
Mvaa 72,172,12
s_waitcnt lgkmcnt(0)
EX 84
Zvaa 76,188,12
EX 85
Mvaa 76,184,8
AD 115,84
AD 115,85
Mvaa 76,180,4
EX 86
Mvaa 76,176,0
EX 87
Mvav 192,192,96
CV 106,84
AD 115,86
Mvav 192,196,100
AD 115,87
CV 107,86
Mvav 196,204,100
EX 88
Mvav 196,200,96
EX 89
Mvav 200,208,96
AD 115,88
AD 115,89
Mvav 200,212,100
EX 90
Mvav 204,220,100
EX 91
Mvav 204,216,96
CV 108,88
AD 115,90
Mvav 208,224,96
AD 115,91
CV 109,90
Mvav 208,228,100
EX 92
Mvav 212,236,100
EX 93
Mvav 212,232,96
AD 115,92
AD 115,93
Mvav 216,240,96
EX 94
Mvav 216,244,100
EX 95
Mvav 220,252,100
CV 110,92
AD 115,94
Mvav 220,248,96
s_cmp_eq_u32 s29, 15
s_cbranch_scc1 L1a_flush2
L1a_flush2_back:
AD 115,95
CV 111,94
Zvaa 80,128,16
EX 64
Mvaa 80,132,20
EX 65
Mvaa 80,136,24
DN 28,16,47,2048
AD 112,64
AD 112,65
Mvaa 80,140,28
EX 66
Zvaa 84,156,28
EX 67
Mvaa 84,152,24
CV 96,64
AD 112,66
Mvaa 84,148,20
AD 112,67
CV 97,66
Mvaa 84,144,16
EX 68
Zvaa 88,160,16
EX 69
Mvaa 88,164,20
AD 112,68
AD 112,69
Mvaa 88,168,24
EX 70
Mvaa 88,172,28
EX 71
Zvaa 92,188,28
CV 98,68
AD 112,70
Mvaa 92,184,24
AD 112,71
CV 99,70
Mvaa 92,180,20
EX 72
Mvaa 92,176,16
EX 73
Mvav 224,192,104
AD 112,72
AD 112,73
Mvav 224,196,108
EX 74
Mvav 228,204,108
EX 75
Mvav 228,200,104
CV 100,72
AD 112,74
Mvav 232,208,104
AD 112,75
CV 101,74
Mvav 232,212,108
EX 76
Mvav 236,220,108
EX 77
Mvav 236,216,104
AD 112,76
AD 112,77
Mvav 240,224,104
EX 78
Mvav 240,228,108
EX 79
Mvav 244,236,108
CV 102,76
AD 112,78
Mvav 244,232,104
AD 112,79
CV 103,78
Mvav 248,240,104
Ta 192,8,0
Ta 194,8,4096
Mvav 248,244,108
Ta 196,8,8192
Ta 198,8,12288
Mvav 252,252,108
Ta 200,9,0
Ta 202,9,4096
Mvav 252,248,104
s_cmp_eq_u32 s29, 15
s_cbranch_scc1 L1a_flush3
L1a_flush3_back:
Ta 204,9,8192
Ta 206,9,12288
Zvaa 64,128,32
Ta 208,10,0
Ta 210,10,4096
Mvaa 64,132,36
Ta 212,10,8192
Ta 214,10,12288
Mvaa 64,136,40
Ta 216,11,0
Ta 218,11,4096
DN 29,16,47,3072
Mvaa 64,140,44
Ta 220,11,8192
Ta 222,11,12288
Zvaa 68,156,44
Ta 224,12,0
Ta 226,12,4096
Mvaa 68,152,40
Ta 228,12,8192
Ta 230,12,12288
Mvaa 68,148,36
Ta 232,13,0
Ta 234,13,4096
Mvaa 68,144,32
Ta 236,13,8192
Ta 238,13,12288
Zvaa 72,160,32
Ta 240,14,0
Ta 242,14,4096
Mvaa 72,164,36
Ta 244,14,8192
Ta 246,14,12288
Mvaa 72,168,40
Ta 248,15,0
Ta 250,15,4096
Mvaa 72,172,44
Ta 252,15,8192
Ta 254,15,12288
Zvaa 76,188,44
EX 80
Mvaa 76,184,40
AD 113,80
EX 81
Mvaa 76,180,36
AD 113,81
EX 82
Mvaa 76,176,32
s_waitcnt lgkmcnt(15)
AD 113,82
EX 83
Mvav 128,192,96
CV 104,80
CV 105,82
AD 113,83
Mvav 128,196,100
s_waitcnt lgkmcnt(15)
EX 84
Mvav 132,204,100
AD 113,84
EX 85
Mvav 132,200,96
s_waitcnt lgkmcnt(15)
AD 113,85
EX 86
Mvav 136,208,96
AD 113,86
EX 87
Mvav 136,212,100
s_waitcnt lgkmcnt(15)
CV 106,84
CV 107,86
AD 113,87
Mvav 140,220,100
EX 88
Mvav 140,216,96
s_waitcnt lgkmcnt(12)
AD 113,88
EX 89
Mvav 144,224,96
AD 113,89
EX 90
Mvav 144,228,100
s_waitcnt lgkmcnt(8)
AD 113,90
EX 91
Mvav 148,236,100
CV 108,88
CV 109,90
AD 113,91
Mvav 148,232,96
s_waitcnt lgkmcnt(4)
EX 92
Mvav 152,240,96
AD 113,92
EX 93
Mvav 152,244,100
s_waitcnt lgkmcnt(0)
AD 113,93
EX 94
Mvav 156,252,100
AD 113,94
EX 95
Mvav 156,248,96
s_add_u32 s32, s32, 16384
s_add_u32 s47, s32, s33
s_and_b32 s50, s47, 0x20000
s_lshr_b32 s47, s47, 3
s_and_b32 s47, s47, 0x3800
s_or_b32 s47, s47, s50
s_and_b32 s50, s32, 0x40000
s_or_b32 s47, s47, s50
s_add_u32 s47, s47, s90
CV 110,92
CV 111,94
AD 113,95
s_add_u32 s29, s29, 1
s_cmp_lg_u32 s29, 28
s_cbranch_scc1 L1a_aloop
s_waitcnt vmcnt(8)
s_barrier
Zvaa 80,128,48
s_lshl_b32 s44, s72, 19
s_add_u32 s44, s44, 0x40000
s_add_u32 s44, s44, s39
s_add_u32 m0, s49, 0x20000
EX 64
Mvaa 80,132,52
Ra 128,4,16384
AD 114,64
Mvaa 80,136,56
DD 32,52,44,0
EX 65
Mvaa 80,140,60
AD 114,65
CV 96,64
Zvaa 84,156,60
EX 66
Mvaa 84,152,56
Ra 132,5,16384
AD 114,66
Mvaa 84,148,52
DD 33,52,44,1024
EX 67
Mvaa 84,144,48
AD 114,67
CV 97,66
Zvaa 88,160,48
EX 68
Mvaa 88,164,52
Ra 136,6,16384
AD 114,68
Mvaa 88,168,56
DD 34,52,44,2048
EX 69
Mvaa 88,172,60
AD 114,69
CV 98,68
Zvaa 92,188,60
EX 70
Mvaa 92,184,56
Ra 140,7,16384
AD 114,70
Mvaa 92,180,52
DD 35,52,44,3072
EX 71
Mvaa 92,176,48
AD 114,71
CV 99,70
Mvav 160,192,104
EX 72
Mvav 160,196,108
Ra 144,4,20480
AD 114,72
Mvav 164,204,108
EX 73
Mvav 164,200,104
AD 114,73
CV 100,72
Mvav 168,208,104
EX 74
Mvav 168,212,108
Ra 148,5,20480
AD 114,74
Mvav 172,220,108
EX 75
Mvav 172,216,104
AD 114,75
CV 101,74
Mvav 176,224,104
EX 76
Mvav 176,228,108
Ra 152,6,20480
AD 114,76
Mvav 180,236,108
EX 77
Mvav 180,232,104
AD 114,77
CV 102,76
Mvav 184,240,104
EX 78
Mvav 184,244,108
Ra 156,7,20480
AD 114,78
Mvav 188,252,108
EX 79
Mvav 188,248,104
s_waitcnt lgkmcnt(4)
AD 114,79
CV 103,78
Zvaa 64,128,0
Ra 160,4,24576
Ra 164,5,24576
Mvaa 64,132,4
Ra 168,6,24576
Ra 172,7,24576
Mvaa 64,136,8
Ra 176,4,28672
Ra 180,5,28672
Mvaa 64,140,12
s_waitcnt lgkmcnt(6)
Ra 184,6,28672
Ra 188,7,28672
Zvaa 68,156,12
EX 80
Mvaa 68,152,8
EX 81
Mvaa 68,148,4
AD 115,80
AD 115,81
Mvaa 68,144,0
s_waitcnt lgkmcnt(4)
EX 82
Zvaa 72,160,0
EX 83
Mvaa 72,164,4
CV 104,80
AD 115,82
Mvaa 72,168,8
AD 115,83
CV 105,82
Mvaa 72,172,12
s_waitcnt lgkmcnt(0)
EX 84
Zvaa 76,188,12
EX 85
Mvaa 76,184,8
AD 115,84
AD 115,85
Mvaa 76,180,4
EX 86
Mvaa 76,176,0
EX 87
Mvav 192,192,96
CV 106,84
AD 115,86
Mvav 192,196,100
AD 115,87
CV 107,86
Mvav 196,204,100
EX 88
Mvav 196,200,96
EX 89
Mvav 200,208,96
AD 115,88
AD 115,89
Mvav 200,212,100
EX 90
Mvav 204,220,100
EX 91
Mvav 204,216,96
CV 108,88
AD 115,90
Mvav 208,224,96
AD 115,91
CV 109,90
Mvav 208,228,100
EX 92
Mvav 212,236,100
EX 93
Mvav 212,232,96
AD 115,92
AD 115,93
Mvav 216,240,96
EX 94
Mvav 216,244,100
EX 95
Mvav 220,252,100
CV 110,92
AD 115,94
Mvav 220,248,96
AD 115,95
CV 111,94
Zvaa 80,128,16
EX 64
Mvaa 80,132,20
EX 65
Mvaa 80,136,24
AD 112,64
AD 112,65
Mvaa 80,140,28
EX 66
Zvaa 84,156,28
EX 67
Mvaa 84,152,24
CV 96,64
AD 112,66
Mvaa 84,148,20
AD 112,67
CV 97,66
Mvaa 84,144,16
EX 68
Zvaa 88,160,16
EX 69
Mvaa 88,164,20
AD 112,68
AD 112,69
Mvaa 88,168,24
EX 70
Mvaa 88,172,28
EX 71
Zvaa 92,188,28
CV 98,68
AD 112,70
Mvaa 92,184,24
AD 112,71
CV 99,70
Mvaa 92,180,20
EX 72
Mvaa 92,176,16
EX 73
Mvav 224,192,104
AD 112,72
AD 112,73
Mvav 224,196,108
EX 74
Mvav 228,204,108
EX 75
Mvav 228,200,104
CV 100,72
AD 112,74
Mvav 232,208,104
AD 112,75
CV 101,74
Mvav 232,212,108
EX 76
Mvav 236,220,108
EX 77
Mvav 236,216,104
AD 112,76
AD 112,77
Mvav 240,224,104
EX 78
Mvav 240,228,108
EX 79
Mvav 244,236,108
CV 102,76
AD 112,78
Mvav 244,232,104
AD 112,79
CV 103,78
Mvav 248,240,104
Ta 192,8,16384
Ta 194,8,20480
Mvav 248,244,108
Ta 196,8,24576
Ta 198,8,28672
Mvav 252,252,108
Ta 200,9,16384
Ta 202,9,20480
Mvav 252,248,104
Ta 204,9,24576
Ta 206,9,28672
Zvaa 64,128,32
Ta 208,10,16384
Ta 210,10,20480
Mvaa 64,132,36
Ta 212,10,24576
Ta 214,10,28672
Mvaa 64,136,40
Ta 216,11,16384
Ta 218,11,20480
Mvaa 64,140,44
Ta 220,11,24576
Ta 222,11,28672
Zvaa 68,156,44
Ta 224,12,16384
Ta 226,12,20480
Mvaa 68,152,40
Ta 228,12,24576
Ta 230,12,28672
Mvaa 68,148,36
Ta 232,13,16384
Ta 234,13,20480
Mvaa 68,144,32
Ta 236,13,24576
Ta 238,13,28672
Zvaa 72,160,32
Ta 240,14,16384
Ta 242,14,20480
Mvaa 72,164,36
Ta 244,14,24576
Ta 246,14,28672
Mvaa 72,168,40
Ta 248,15,16384
Ta 250,15,20480
Mvaa 72,172,44
Ta 252,15,24576
Ta 254,15,28672
Zvaa 76,188,44
EX 80
Mvaa 76,184,40
AD 113,80
EX 81
Mvaa 76,180,36
AD 113,81
EX 82
Mvaa 76,176,32
s_waitcnt lgkmcnt(15)
AD 113,82
EX 83
Mvav 128,192,96
CV 104,80
CV 105,82
AD 113,83
Mvav 128,196,100
s_waitcnt lgkmcnt(15)
EX 84
Mvav 132,204,100
AD 113,84
EX 85
Mvav 132,200,96
s_waitcnt lgkmcnt(15)
AD 113,85
EX 86
Mvav 136,208,96
AD 113,86
EX 87
Mvav 136,212,100
s_waitcnt lgkmcnt(15)
CV 106,84
CV 107,86
AD 113,87
Mvav 140,220,100
EX 88
Mvav 140,216,96
s_waitcnt lgkmcnt(12)
AD 113,88
EX 89
Mvav 144,224,96
AD 113,89
EX 90
Mvav 144,228,100
s_waitcnt lgkmcnt(8)
AD 113,90
EX 91
Mvav 148,236,100
CV 108,88
CV 109,90
AD 113,91
Mvav 148,232,96
s_waitcnt lgkmcnt(4)
EX 92
Mvav 152,240,96
AD 113,92
EX 93
Mvav 152,244,100
s_waitcnt lgkmcnt(0)
AD 113,93
EX 94
Mvav 156,252,100
AD 113,94
EX 95
Mvav 156,248,96
CV 110,92
CV 111,94
AD 113,95
s_add_u32 s29, s29, 1
s_waitcnt vmcnt(8)
s_barrier
Zvaa 80,128,48
s_lshl_b32 s44, s72, 19
s_add_u32 s44, s44, s39
s_add_u32 m0, s49, 0x0
EX 64
Mvaa 80,132,52
Ra 128,4,32768
AD 114,64
Mvaa 80,136,56
DD 32,52,44,0
EX 65
Mvaa 80,140,60
AD 114,65
CV 96,64
Zvaa 84,156,60
EX 66
Mvaa 84,152,56
Ra 132,5,32768
AD 114,66
Mvaa 84,148,52
DD 33,52,44,1024
EX 67
Mvaa 84,144,48
AD 114,67
CV 97,66
Zvaa 88,160,48
EX 68
Mvaa 88,164,52
Ra 136,6,32768
AD 114,68
Mvaa 88,168,56
DD 34,52,44,2048
EX 69
Mvaa 88,172,60
AD 114,69
CV 98,68
Zvaa 92,188,60
EX 70
Mvaa 92,184,56
Ra 140,7,32768
AD 114,70
Mvaa 92,180,52
DD 35,52,44,3072
EX 71
Mvaa 92,176,48
AD 114,71
CV 99,70
Mvav 160,192,104
EX 72
Mvav 160,196,108
Ra 144,4,36864
AD 114,72
Mvav 164,204,108
EX 73
Mvav 164,200,104
AD 114,73
CV 100,72
Mvav 168,208,104
EX 74
Mvav 168,212,108
Ra 148,5,36864
AD 114,74
Mvav 172,220,108
EX 75
Mvav 172,216,104
AD 114,75
CV 101,74
Mvav 176,224,104
EX 76
Mvav 176,228,108
Ra 152,6,36864
AD 114,76
Mvav 180,236,108
EX 77
Mvav 180,232,104
AD 114,77
CV 102,76
Mvav 184,240,104
EX 78
Mvav 184,244,108
Ra 156,7,36864
AD 114,78
Mvav 188,252,108
EX 79
Mvav 188,248,104
s_waitcnt lgkmcnt(4)
AD 114,79
CV 103,78
Zvaa 64,128,0
Ra 160,4,40960
Ra 164,5,40960
Mvaa 64,132,4
Ra 168,6,40960
Ra 172,7,40960
Mvaa 64,136,8
Ra 176,4,45056
Ra 180,5,45056
Mvaa 64,140,12
s_waitcnt lgkmcnt(6)
Ra 184,6,45056
Ra 188,7,45056
Zvaa 68,156,12
EX 80
Mvaa 68,152,8
EX 81
Mvaa 68,148,4
AD 115,80
AD 115,81
Mvaa 68,144,0
s_waitcnt lgkmcnt(4)
EX 82
Zvaa 72,160,0
EX 83
Mvaa 72,164,4
CV 104,80
AD 115,82
Mvaa 72,168,8
AD 115,83
CV 105,82
Mvaa 72,172,12
s_waitcnt lgkmcnt(0)
EX 84
Zvaa 76,188,12
EX 85
Mvaa 76,184,8
AD 115,84
AD 115,85
Mvaa 76,180,4
EX 86
Mvaa 76,176,0
EX 87
Mvav 192,192,96
CV 106,84
AD 115,86
Mvav 192,196,100
AD 115,87
CV 107,86
Mvav 196,204,100
EX 88
Mvav 196,200,96
EX 89
Mvav 200,208,96
AD 115,88
AD 115,89
Mvav 200,212,100
EX 90
Mvav 204,220,100
EX 91
Mvav 204,216,96
CV 108,88
AD 115,90
Mvav 208,224,96
AD 115,91
CV 109,90
Mvav 208,228,100
EX 92
Mvav 212,236,100
EX 93
Mvav 212,232,96
AD 115,92
AD 115,93
Mvav 216,240,96
EX 94
Mvav 216,244,100
EX 95
Mvav 220,252,100
CV 110,92
AD 115,94
Mvav 220,248,96
AD 115,95
CV 111,94
Zvaa 80,128,16
EX 64
Mvaa 80,132,20
EX 65
Mvaa 80,136,24
AD 112,64
AD 112,65
Mvaa 80,140,28
EX 66
Zvaa 84,156,28
EX 67
Mvaa 84,152,24
CV 96,64
AD 112,66
Mvaa 84,148,20
AD 112,67
CV 97,66
Mvaa 84,144,16
EX 68
Zvaa 88,160,16
EX 69
Mvaa 88,164,20
AD 112,68
AD 112,69
Mvaa 88,168,24
EX 70
Mvaa 88,172,28
EX 71
Zvaa 92,188,28
CV 98,68
AD 112,70
Mvaa 92,184,24
AD 112,71
CV 99,70
Mvaa 92,180,20
EX 72
Mvaa 92,176,16
EX 73
Mvav 224,192,104
AD 112,72
AD 112,73
Mvav 224,196,108
EX 74
Mvav 228,204,108
EX 75
Mvav 228,200,104
CV 100,72
AD 112,74
Mvav 232,208,104
AD 112,75
CV 101,74
Mvav 232,212,108
EX 76
Mvav 236,220,108
EX 77
Mvav 236,216,104
AD 112,76
AD 112,77
Mvav 240,224,104
EX 78
Mvav 240,228,108
EX 79
Mvav 244,236,108
CV 102,76
AD 112,78
Mvav 244,232,104
AD 112,79
CV 103,78
Mvav 248,240,104
Ta 192,8,32768
Ta 194,8,36864
Mvav 248,244,108
Ta 196,8,40960
Ta 198,8,45056
Mvav 252,252,108
Ta 200,9,32768
Ta 202,9,36864
Mvav 252,248,104
Ta 204,9,40960
Ta 206,9,45056
Zvaa 64,128,32
Ta 208,10,32768
Ta 210,10,36864
Mvaa 64,132,36
Ta 212,10,40960
Ta 214,10,45056
Mvaa 64,136,40
Ta 216,11,32768
Ta 218,11,36864
Mvaa 64,140,44
Ta 220,11,40960
Ta 222,11,45056
Zvaa 68,156,44
Ta 224,12,32768
Ta 226,12,36864
Mvaa 68,152,40
Ta 228,12,40960
Ta 230,12,45056
Mvaa 68,148,36
Ta 232,13,32768
Ta 234,13,36864
Mvaa 68,144,32
Ta 236,13,40960
Ta 238,13,45056
Zvaa 72,160,32
Ta 240,14,32768
Ta 242,14,36864
Mvaa 72,164,36
Ta 244,14,40960
Ta 246,14,45056
Mvaa 72,168,40
Ta 248,15,32768
Ta 250,15,36864
Mvaa 72,172,44
Ta 252,15,40960
Ta 254,15,45056
Zvaa 76,188,44
EX 80
Mvaa 76,184,40
AD 113,80
EX 81
Mvaa 76,180,36
AD 113,81
EX 82
Mvaa 76,176,32
s_waitcnt lgkmcnt(15)
AD 113,82
EX 83
Mvav 128,192,96
CV 104,80
CV 105,82
AD 113,83
Mvav 128,196,100
s_waitcnt lgkmcnt(15)
EX 84
Mvav 132,204,100
AD 113,84
EX 85
Mvav 132,200,96
s_waitcnt lgkmcnt(15)
AD 113,85
EX 86
Mvav 136,208,96
AD 113,86
EX 87
Mvav 136,212,100
s_waitcnt lgkmcnt(15)
CV 106,84
CV 107,86
AD 113,87
Mvav 140,220,100
EX 88
Mvav 140,216,96
s_waitcnt lgkmcnt(12)
AD 113,88
EX 89
Mvav 144,224,96
AD 113,89
EX 90
Mvav 144,228,100
s_waitcnt lgkmcnt(8)
AD 113,90
EX 91
Mvav 148,236,100
CV 108,88
CV 109,90
AD 113,91
Mvav 148,232,96
s_waitcnt lgkmcnt(4)
EX 92
Mvav 152,240,96
AD 113,92
EX 93
Mvav 152,244,100
s_waitcnt lgkmcnt(0)
AD 113,93
EX 94
Mvav 156,252,100
AD 113,94
EX 95
Mvav 156,248,96
CV 110,92
CV 111,94
AD 113,95
s_add_u32 s29, s29, 1
s_waitcnt vmcnt(8)
s_barrier
Zvaa 80,128,48
s_cmp_le_u32 s72, 0
s_addc_u32 s44, 0, 0
s_lshl_b32 s44, s44, 19
s_add_u32 s44, s44, s39
s_add_u32 m0, s49, 0x4000
EX 64
Mvaa 80,132,52
Ra 128,4,49152
AD 114,64
Mvaa 80,136,56
DD 32,52,44,0
EX 65
Mvaa 80,140,60
AD 114,65
CV 96,64
Zvaa 84,156,60
EX 66
Mvaa 84,152,56
Ra 132,5,49152
AD 114,66
Mvaa 84,148,52
DD 33,52,44,1024
EX 67
Mvaa 84,144,48
AD 114,67
CV 97,66
Zvaa 88,160,48
EX 68
Mvaa 88,164,52
Ra 136,6,49152
AD 114,68
Mvaa 88,168,56
DD 34,52,44,2048
EX 69
Mvaa 88,172,60
AD 114,69
CV 98,68
Zvaa 92,188,60
EX 70
Mvaa 92,184,56
Ra 140,7,49152
AD 114,70
Mvaa 92,180,52
DD 35,52,44,3072
EX 71
Mvaa 92,176,48
AD 114,71
CV 99,70
Mvav 160,192,104
EX 72
Mvav 160,196,108
Ra 144,4,53248
AD 114,72
Mvav 164,204,108
EX 73
Mvav 164,200,104
AD 114,73
CV 100,72
Mvav 168,208,104
EX 74
Mvav 168,212,108
Ra 148,5,53248
AD 114,74
Mvav 172,220,108
EX 75
Mvav 172,216,104
AD 114,75
CV 101,74
Mvav 176,224,104
EX 76
Mvav 176,228,108
Ra 152,6,53248
AD 114,76
Mvav 180,236,108
EX 77
Mvav 180,232,104
AD 114,77
CV 102,76
Mvav 184,240,104
EX 78
Mvav 184,244,108
Ra 156,7,53248
AD 114,78
Mvav 188,252,108
EX 79
Mvav 188,248,104
s_waitcnt lgkmcnt(4)
AD 114,79
CV 103,78
Zvaa 64,128,0
Ra 160,4,57344
Ra 164,5,57344
Mvaa 64,132,4
Ra 168,6,57344
Ra 172,7,57344
Mvaa 64,136,8
Ra 176,4,61440
Ra 180,5,61440
Mvaa 64,140,12
s_waitcnt lgkmcnt(6)
Ra 184,6,61440
Ra 188,7,61440
Zvaa 68,156,12
EX 80
Mvaa 68,152,8
EX 81
Mvaa 68,148,4
AD 115,80
AD 115,81
Mvaa 68,144,0
s_waitcnt lgkmcnt(4)
EX 82
Zvaa 72,160,0
EX 83
Mvaa 72,164,4
CV 104,80
AD 115,82
Mvaa 72,168,8
AD 115,83
CV 105,82
Mvaa 72,172,12
s_waitcnt lgkmcnt(0)
EX 84
Zvaa 76,188,12
EX 85
Mvaa 76,184,8
AD 115,84
AD 115,85
Mvaa 76,180,4
EX 86
Mvaa 76,176,0
EX 87
Mvav 192,192,96
CV 106,84
AD 115,86
Mvav 192,196,100
AD 115,87
CV 107,86
Mvav 196,204,100
EX 88
Mvav 196,200,96
EX 89
Mvav 200,208,96
AD 115,88
AD 115,89
Mvav 200,212,100
EX 90
Mvav 204,220,100
EX 91
Mvav 204,216,96
CV 108,88
AD 115,90
Mvav 208,224,96
AD 115,91
CV 109,90
Mvav 208,228,100
EX 92
Mvav 212,236,100
EX 93
Mvav 212,232,96
AD 115,92
AD 115,93
Mvav 216,240,96
EX 94
Mvav 216,244,100
EX 95
Mvav 220,252,100
CV 110,92
AD 115,94
Mvav 220,248,96
AD 115,95
CV 111,94
Zvaa 80,128,16
EX 64
Mvaa 80,132,20
EX 65
Mvaa 80,136,24
AD 112,64
AD 112,65
Mvaa 80,140,28
EX 66
Zvaa 84,156,28
EX 67
Mvaa 84,152,24
CV 96,64
AD 112,66
Mvaa 84,148,20
AD 112,67
CV 97,66
Mvaa 84,144,16
EX 68
Zvaa 88,160,16
EX 69
Mvaa 88,164,20
AD 112,68
AD 112,69
Mvaa 88,168,24
EX 70
Mvaa 88,172,28
EX 71
Zvaa 92,188,28
CV 98,68
AD 112,70
Mvaa 92,184,24
AD 112,71
CV 99,70
Mvaa 92,180,20
EX 72
Mvaa 92,176,16
EX 73
Mvav 224,192,104
AD 112,72
AD 112,73
Mvav 224,196,108
EX 74
Mvav 228,204,108
EX 75
Mvav 228,200,104
CV 100,72
AD 112,74
Mvav 232,208,104
AD 112,75
CV 101,74
Mvav 232,212,108
EX 76
Mvav 236,220,108
EX 77
Mvav 236,216,104
AD 112,76
AD 112,77
Mvav 240,224,104
EX 78
Mvav 240,228,108
EX 79
Mvav 244,236,108
CV 102,76
AD 112,78
Mvav 244,232,104
AD 112,79
CV 103,78
Mvav 248,240,104
Ta 192,8,49152
Ta 194,8,53248
Mvav 248,244,108
Ta 196,8,57344
Ta 198,8,61440
Mvav 252,252,108
Ta 200,9,49152
Ta 202,9,53248
Mvav 252,248,104
Ta 204,9,57344
Ta 206,9,61440
Zvaa 64,128,32
Ta 208,10,49152
Ta 210,10,53248
Mvaa 64,132,36
Ta 212,10,57344
Ta 214,10,61440
Mvaa 64,136,40
Ta 216,11,49152
Ta 218,11,53248
Mvaa 64,140,44
Ta 220,11,57344
Ta 222,11,61440
Zvaa 68,156,44
Ta 224,12,49152
Ta 226,12,53248
Mvaa 68,152,40
Ta 228,12,57344
Ta 230,12,61440
Mvaa 68,148,36
Ta 232,13,49152
Ta 234,13,53248
Mvaa 68,144,32
Ta 236,13,57344
Ta 238,13,61440
Zvaa 72,160,32
Ta 240,14,49152
Ta 242,14,53248
Mvaa 72,164,36
Ta 244,14,57344
Ta 246,14,61440
Mvaa 72,168,40
Ta 248,15,49152
Ta 250,15,53248
Mvaa 72,172,44
Ta 252,15,57344
Ta 254,15,61440
Zvaa 76,188,44
EX 80
Mvaa 76,184,40
AD 113,80
EX 81
Mvaa 76,180,36
AD 113,81
EX 82
Mvaa 76,176,32
s_waitcnt lgkmcnt(15)
AD 113,82
EX 83
Mvav 128,192,96
CV 104,80
CV 105,82
AD 113,83
Mvav 128,196,100
s_waitcnt lgkmcnt(15)
EX 84
Mvav 132,204,100
AD 113,84
EX 85
Mvav 132,200,96
s_waitcnt lgkmcnt(15)
AD 113,85
EX 86
Mvav 136,208,96
AD 113,86
EX 87
Mvav 136,212,100
s_waitcnt lgkmcnt(15)
CV 106,84
CV 107,86
AD 113,87
Mvav 140,220,100
EX 88
Mvav 140,216,96
s_waitcnt lgkmcnt(12)
AD 113,88
EX 89
Mvav 144,224,96
AD 113,89
EX 90
Mvav 144,228,100
s_waitcnt lgkmcnt(8)
AD 113,90
EX 91
Mvav 148,236,100
CV 108,88
CV 109,90
AD 113,91
Mvav 148,232,96
s_waitcnt lgkmcnt(4)
EX 92
Mvav 152,240,96
AD 113,92
EX 93
Mvav 152,244,100
s_waitcnt lgkmcnt(0)
AD 113,93
EX 94
Mvav 156,252,100
AD 113,94
EX 95
Mvav 156,248,96
CV 110,92
CV 111,94
AD 113,95
s_add_u32 s29, s29, 1
v_mov_b32 v40, v112
s_nop 1
v_permlane32_swap_b32 v112, v40
AD 112,40
v_mov_b32 v40, v112
s_nop 1
v_permlane16_swap_b32 v112, v40
AD 112,40
v_subrev_u32 v40, 0x30800000, v112
v_cmp_lt_u32 vcc, 0x1b000000, v40
s_nop 1
s_cbranch_vccnz L1a_ffin0_slow
L1a_ffin0_rcp:
v_rcp_f32 v112, v112
s_add_u32 s50, s48, 4096
v_pk_mul_f32 v[40:41], v[128:129], v[112:113] op_sel_hi:[1,0]
v_pk_mul_f32 v[42:43], v[130:131], v[112:113] op_sel_hi:[1,0]
v_pk_mul_f32 v[44:45], v[132:133], v[112:113] op_sel_hi:[1,0]
v_pk_mul_f32 v[46:47], v[134:135], v[112:113] op_sel_hi:[1,0]
CV 128,40
CV 129,42
CV 130,44
CV 131,46
buffer_store_dwordx4 v[128:131], v1, s[24:27], s50 offen sc1
v_pk_mul_f32 v[40:41], v[136:137], v[112:113] op_sel_hi:[1,0]
v_pk_mul_f32 v[42:43], v[138:139], v[112:113] op_sel_hi:[1,0]
v_pk_mul_f32 v[44:45], v[140:141], v[112:113] op_sel_hi:[1,0]
v_pk_mul_f32 v[46:47], v[142:143], v[112:113] op_sel_hi:[1,0]
CV 132,40
CV 133,42
CV 134,44
CV 135,46
buffer_store_dwordx4 v[132:135], v1, s[24:27], s50 offen offset:1024 sc1
v_pk_mul_f32 v[40:41], v[144:145], v[112:113] op_sel_hi:[1,0]
v_pk_mul_f32 v[42:43], v[146:147], v[112:113] op_sel_hi:[1,0]
v_pk_mul_f32 v[44:45], v[148:149], v[112:113] op_sel_hi:[1,0]
v_pk_mul_f32 v[46:47], v[150:151], v[112:113] op_sel_hi:[1,0]
CV 136,40
CV 137,42
CV 138,44
CV 139,46
buffer_store_dwordx4 v[136:139], v1, s[24:27], s50 offen offset:2048 sc1
v_pk_mul_f32 v[40:41], v[152:153], v[112:113] op_sel_hi:[1,0]
v_pk_mul_f32 v[42:43], v[154:155], v[112:113] op_sel_hi:[1,0]
v_pk_mul_f32 v[44:45], v[156:157], v[112:113] op_sel_hi:[1,0]
v_pk_mul_f32 v[46:47], v[158:159], v[112:113] op_sel_hi:[1,0]
CV 140,40
CV 141,42
CV 142,44
CV 143,46
buffer_store_dwordx4 v[140:143], v1, s[24:27], s50 offen offset:3072 sc1
L1a_ffin0_done:
Zvaa 80,128,48
s_cmp_le_u32 s72, 1
s_addc_u32 s44, 1, 0
s_lshl_b32 s44, s44, 19
s_add_u32 s44, s44, s39
s_add_u32 m0, s49, 0x8000
EX 64
Mvaa 80,132,52
AD 114,64
Mvaa 80,136,56
DD 32,52,44,0
EX 65
Mvaa 80,140,60
AD 114,65
CV 96,64
Zvaa 84,156,60
EX 66
Mvaa 84,152,56
AD 114,66
Mvaa 84,148,52
DD 33,52,44,1024
EX 67
Mvaa 84,144,48
AD 114,67
CV 97,66
Zvaa 88,160,48
EX 68
Mvaa 88,164,52
AD 114,68
Mvaa 88,168,56
DD 34,52,44,2048
EX 69
Mvaa 88,172,60
AD 114,69
CV 98,68
Zvaa 92,188,60
EX 70
Mvaa 92,184,56
AD 114,70
Mvaa 92,180,52
DD 35,52,44,3072
EX 71
Mvaa 92,176,48
AD 114,71
CV 99,70
Mvav 160,192,104
EX 72
Mvav 160,196,108
AD 114,72
Mvav 164,204,108
EX 73
Mvav 164,200,104
AD 114,73
CV 100,72
Mvav 168,208,104
EX 74
Mvav 168,212,108
AD 114,74
Mvav 172,220,108
EX 75
Mvav 172,216,104
AD 114,75
CV 101,74
Mvav 176,224,104
EX 76
Mvav 176,228,108
AD 114,76
Mvav 180,236,108
EX 77
Mvav 180,232,104
AD 114,77
CV 102,76
Mvav 184,240,104
EX 78
Mvav 184,244,108
AD 114,78
Mvav 188,252,108
EX 79
Mvav 188,248,104
AD 114,79
CV 103,78
v_mov_b32 v40, v113
s_nop 1
v_permlane32_swap_b32 v113, v40
AD 113,40
v_mov_b32 v40, v113
s_nop 1
v_permlane16_swap_b32 v113, v40
AD 113,40
v_subrev_u32 v40, 0x30800000, v113
v_cmp_lt_u32 vcc, 0x1b000000, v40
s_nop 1
s_cbranch_vccnz L1a_ffin1_slow
L1a_ffin1_rcp:
v_rcp_f32 v113, v113
s_add_u32 s50, s48, 135168
v_pk_mul_f32 v[40:41], v[160:161], v[112:113] op_sel:[0,1] op_sel_hi:[1,1]
v_pk_mul_f32 v[42:43], v[162:163], v[112:113] op_sel:[0,1] op_sel_hi:[1,1]
v_pk_mul_f32 v[44:45], v[164:165], v[112:113] op_sel:[0,1] op_sel_hi:[1,1]
v_pk_mul_f32 v[46:47], v[166:167], v[112:113] op_sel:[0,1] op_sel_hi:[1,1]
CV 160,40
CV 161,42
CV 162,44
CV 163,46
buffer_store_dwordx4 v[160:163], v1, s[24:27], s50 offen sc1
v_pk_mul_f32 v[40:41], v[168:169], v[112:113] op_sel:[0,1] op_sel_hi:[1,1]
v_pk_mul_f32 v[42:43], v[170:171], v[112:113] op_sel:[0,1] op_sel_hi:[1,1]
v_pk_mul_f32 v[44:45], v[172:173], v[112:113] op_sel:[0,1] op_sel_hi:[1,1]
v_pk_mul_f32 v[46:47], v[174:175], v[112:113] op_sel:[0,1] op_sel_hi:[1,1]
CV 164,40
CV 165,42
CV 166,44
CV 167,46
buffer_store_dwordx4 v[164:167], v1, s[24:27], s50 offen offset:1024 sc1
v_pk_mul_f32 v[40:41], v[176:177], v[112:113] op_sel:[0,1] op_sel_hi:[1,1]
v_pk_mul_f32 v[42:43], v[178:179], v[112:113] op_sel:[0,1] op_sel_hi:[1,1]
v_pk_mul_f32 v[44:45], v[180:181], v[112:113] op_sel:[0,1] op_sel_hi:[1,1]
v_pk_mul_f32 v[46:47], v[182:183], v[112:113] op_sel:[0,1] op_sel_hi:[1,1]
CV 168,40
CV 169,42
CV 170,44
CV 171,46
buffer_store_dwordx4 v[168:171], v1, s[24:27], s50 offen offset:2048 sc1
v_pk_mul_f32 v[40:41], v[184:185], v[112:113] op_sel:[0,1] op_sel_hi:[1,1]
v_pk_mul_f32 v[42:43], v[186:187], v[112:113] op_sel:[0,1] op_sel_hi:[1,1]
v_pk_mul_f32 v[44:45], v[188:189], v[112:113] op_sel:[0,1] op_sel_hi:[1,1]
v_pk_mul_f32 v[46:47], v[190:191], v[112:113] op_sel:[0,1] op_sel_hi:[1,1]
CV 172,40
CV 173,42
CV 174,44
CV 175,46
buffer_store_dwordx4 v[172:175], v1, s[24:27], s50 offen offset:3072 sc1
L1a_ffin1_done:
Mvav 192,192,96
EX 80
EX 81
Mvav 192,196,100
EX 82
EX 83
Mvav 196,204,100
EX 84
EX 85
Mvav 196,200,96
EX 86
EX 87
Mvav 200,208,96
AD 115,80
EX 88
EX 89
Mvav 200,212,100
AD 115,81
EX 90
EX 91
Mvav 204,220,100
AD 115,82
EX 92
EX 93
Mvav 204,216,96
AD 115,83
EX 94
EX 95
Mvav 208,224,96
AD 115,84
AD 115,85
CV 104,80
Mvav 208,228,100
AD 115,86
AD 115,87
CV 105,82
Mvav 212,236,100
AD 115,88
AD 115,89
CV 106,84
Mvav 212,232,96
AD 115,90
AD 115,91
CV 107,86
Mvav 216,240,96
AD 115,92
CV 108,88
Mvav 216,244,100
AD 115,93
CV 109,90
Mvav 220,252,100
AD 115,94
CV 110,92
Mvav 220,248,96
AD 115,95
CV 111,94
v_mov_b32 v40, v114
s_nop 1
v_permlane32_swap_b32 v114, v40
AD 114,40
v_mov_b32 v40, v114
s_nop 1
v_permlane16_swap_b32 v114, v40
AD 114,40
v_subrev_u32 v40, 0x30800000, v114
v_cmp_lt_u32 vcc, 0x1b000000, v40
s_nop 1
s_cbranch_vccnz L1a_ffin2_slow
L1a_ffin2_rcp:
v_rcp_f32 v114, v114
s_add_u32 s50, s48, 266240
v_pk_mul_f32 v[40:41], v[192:193], v[114:115] op_sel_hi:[1,0]
v_pk_mul_f32 v[42:43], v[194:195], v[114:115] op_sel_hi:[1,0]
v_pk_mul_f32 v[44:45], v[196:197], v[114:115] op_sel_hi:[1,0]
v_pk_mul_f32 v[46:47], v[198:199], v[114:115] op_sel_hi:[1,0]
CV 192,40
CV 193,42
CV 194,44
CV 195,46
buffer_store_dwordx4 v[192:195], v1, s[24:27], s50 offen sc1
v_pk_mul_f32 v[40:41], v[200:201], v[114:115] op_sel_hi:[1,0]
v_pk_mul_f32 v[42:43], v[202:203], v[114:115] op_sel_hi:[1,0]
v_pk_mul_f32 v[44:45], v[204:205], v[114:115] op_sel_hi:[1,0]
v_pk_mul_f32 v[46:47], v[206:207], v[114:115] op_sel_hi:[1,0]
CV 196,40
CV 197,42
CV 198,44
CV 199,46
buffer_store_dwordx4 v[196:199], v1, s[24:27], s50 offen offset:1024 sc1
v_pk_mul_f32 v[40:41], v[208:209], v[114:115] op_sel_hi:[1,0]
v_pk_mul_f32 v[42:43], v[210:211], v[114:115] op_sel_hi:[1,0]
v_pk_mul_f32 v[44:45], v[212:213], v[114:115] op_sel_hi:[1,0]
v_pk_mul_f32 v[46:47], v[214:215], v[114:115] op_sel_hi:[1,0]
CV 200,40
CV 201,42
CV 202,44
CV 203,46
buffer_store_dwordx4 v[200:203], v1, s[24:27], s50 offen offset:2048 sc1
v_pk_mul_f32 v[40:41], v[216:217], v[114:115] op_sel_hi:[1,0]
v_pk_mul_f32 v[42:43], v[218:219], v[114:115] op_sel_hi:[1,0]
v_pk_mul_f32 v[44:45], v[220:221], v[114:115] op_sel_hi:[1,0]
v_pk_mul_f32 v[46:47], v[222:223], v[114:115] op_sel_hi:[1,0]
CV 204,40
CV 205,42
CV 206,44
CV 207,46
buffer_store_dwordx4 v[204:207], v1, s[24:27], s50 offen offset:3072 sc1
L1a_ffin2_done:
Mvav 224,192,104
Mvav 224,196,108
Mvav 228,204,108
Mvav 228,200,104
Mvav 232,208,104
Mvav 232,212,108
Mvav 236,220,108
Mvav 236,216,104
Mvav 240,224,104
Mvav 240,228,108
Mvav 244,236,108
Mvav 244,232,104
Mvav 248,240,104
Mvav 248,244,108
Mvav 252,252,108
Mvav 252,248,104
s_waitcnt vmcnt(24)
s_barrier
v_add_u32 v24, 0x10000, v8
v_add_u32 v25, 0x10000, v9
v_add_u32 v26, 0x10000, v10
v_add_u32 v27, 0x10000, v11
v_add_u32 v28, 0x10000, v12
v_add_u32 v29, 0x10000, v13
v_add_u32 v30, 0x10000, v14
v_add_u32 v31, 0x10000, v15
v_subrev_u32 v16, 0x10000, v8
v_subrev_u32 v17, 0x10000, v9
v_subrev_u32 v18, 0x10000, v10
v_subrev_u32 v19, 0x10000, v11
v_subrev_u32 v20, 0x10000, v12
v_subrev_u32 v21, 0x10000, v13
v_subrev_u32 v22, 0x10000, v14
v_subrev_u32 v23, 0x10000, v15
Ta 192,24,0
Ta 194,24,4096
Ta 196,24,8192
Ta 198,24,12288
Ta 200,25,0
Ta 202,25,4096
Ta 204,25,8192
Ta 206,25,12288
Ta 208,26,0
Ta 210,26,4096
Ta 212,26,8192
Ta 214,26,12288
v_add_u32 v4, 0x0, v1
v_add_u32 v5, 0x20000, v1
v_add_u32 v6, 0x40000, v1
v_add_u32 v7, 0x60000, v1
v_mov_b32 v40, v115
s_nop 1
v_permlane32_swap_b32 v115, v40
AD 115,40
v_mov_b32 v40, v115
s_nop 1
v_permlane16_swap_b32 v115, v40
AD 115,40
v_subrev_u32 v40, 0x30800000, v115
v_cmp_lt_u32 vcc, 0x1b000000, v40
s_nop 1
s_cbranch_vccnz L1a_ffin3_slow
L1a_ffin3_rcp:
v_rcp_f32 v115, v115
s_add_u32 s50, s48, 397312
v_pk_mul_f32 v[40:41], v[224:225], v[114:115] op_sel:[0,1] op_sel_hi:[1,1]
v_pk_mul_f32 v[42:43], v[226:227], v[114:115] op_sel:[0,1] op_sel_hi:[1,1]
v_pk_mul_f32 v[44:45], v[228:229], v[114:115] op_sel:[0,1] op_sel_hi:[1,1]
v_pk_mul_f32 v[46:47], v[230:231], v[114:115] op_sel:[0,1] op_sel_hi:[1,1]
CV 224,40
CV 225,42
CV 226,44
CV 227,46
buffer_store_dwordx4 v[224:227], v1, s[24:27], s50 offen sc1
v_pk_mul_f32 v[40:41], v[232:233], v[114:115] op_sel:[0,1] op_sel_hi:[1,1]
v_pk_mul_f32 v[42:43], v[234:235], v[114:115] op_sel:[0,1] op_sel_hi:[1,1]
v_pk_mul_f32 v[44:45], v[236:237], v[114:115] op_sel:[0,1] op_sel_hi:[1,1]
v_pk_mul_f32 v[46:47], v[238:239], v[114:115] op_sel:[0,1] op_sel_hi:[1,1]
CV 228,40
CV 229,42
CV 230,44
CV 231,46
buffer_store_dwordx4 v[228:231], v1, s[24:27], s50 offen offset:1024 sc1
v_pk_mul_f32 v[40:41], v[240:241], v[114:115] op_sel:[0,1] op_sel_hi:[1,1]
v_pk_mul_f32 v[42:43], v[242:243], v[114:115] op_sel:[0,1] op_sel_hi:[1,1]
v_pk_mul_f32 v[44:45], v[244:245], v[114:115] op_sel:[0,1] op_sel_hi:[1,1]
v_pk_mul_f32 v[46:47], v[246:247], v[114:115] op_sel:[0,1] op_sel_hi:[1,1]
CV 232,40
CV 233,42
CV 234,44
CV 235,46
buffer_store_dwordx4 v[232:235], v1, s[24:27], s50 offen offset:2048 sc1
v_pk_mul_f32 v[40:41], v[248:249], v[114:115] op_sel:[0,1] op_sel_hi:[1,1]
v_pk_mul_f32 v[42:43], v[250:251], v[114:115] op_sel:[0,1] op_sel_hi:[1,1]
v_pk_mul_f32 v[44:45], v[252:253], v[114:115] op_sel:[0,1] op_sel_hi:[1,1]
v_pk_mul_f32 v[46:47], v[254:255], v[114:115] op_sel:[0,1] op_sel_hi:[1,1]
CV 236,40
CV 237,42
CV 238,44
CV 239,46
buffer_store_dwordx4 v[236:239], v1, s[24:27], s50 offen offset:3072 sc1
L1a_ffin3_done:
s_nop 1
s_waitcnt lgkmcnt(8)
Zaav 128,192,128
s_cmp_le_u32 s72, 0
s_addc_u32 s45, 0, 0
s_lshl_b32 s45, s45, 13
s_add_u32 s45, s45, s48
Ta 216,27,0
Maav 128,196,132
Zaav 144,196,164
Ta 218,27,4096
Maav 144,192,160
Lv 144,4,56,45,0
Zaav 160,192,192
Ta 220,27,8192
Maav 160,196,196
Zaav 176,196,228
Ta 222,27,12288
Lv 148,4,56,45,1024
Maav 176,192,224
s_waitcnt lgkmcnt(8)
Zaav 180,200,224
Ta 192,28,0
Maav 180,204,228
Zaav 164,204,196
Ta 194,28,4096
Maav 164,200,192
Lv 176,5,56,45,0
Zaav 148,200,160
Ta 196,28,8192
Maav 148,204,164
Zaav 132,204,132
Ta 198,28,12288
Lv 180,5,56,45,1024
Maav 132,200,128
s_waitcnt lgkmcnt(8)
Zaav 136,208,128
Ta 200,29,0
Maav 136,212,132
Zaav 152,212,164
Ta 202,29,4096
Maav 152,208,160
Lv 208,6,56,45,0
Zaav 168,208,192
Ta 204,29,8192
Maav 168,212,196
Zaav 184,212,228
Ta 206,29,12288
Maav 184,208,224
s_waitcnt lgkmcnt(8)
Zaav 188,216,224
Ta 208,30,0
Maav 188,220,228
Zaav 172,220,196
Ta 210,30,4096
Maav 172,216,192
Lv 212,6,56,45,1024
Zaav 156,216,160
Ta 212,30,8192
Maav 156,220,164
Zaav 140,220,132
Ta 214,30,12288
Lv 240,7,56,45,0
Maav 140,216,128
s_waitcnt lgkmcnt(8)
Zvav 64,192,128
Ta 216,31,0
Mvav 64,196,132
Zvav 80,196,164
Ta 218,31,4096
Mvav 80,192,160
Lv 244,7,56,45,1024
Zvav 96,192,192
Ta 220,31,8192
Mvav 96,196,196
Zvav 112,196,228
Ta 222,31,12288
Mvav 112,192,224
s_waitcnt lgkmcnt(8)
Zvav 116,200,224
s_cmp_le_u32 s72, 0
s_addc_u32 s45, 0, 0
s_lshl_b32 s45, s45, 13
s_add_u32 s45, s45, 0x800
s_add_u32 s45, s45, s48
Ta 192,24,16384
Mvav 116,204,228
Zvav 100,204,196
Ta 194,24,20480
Mvav 100,200,192
Lv 152,4,56,45,0
Zvav 84,200,160
Ta 196,24,24576
Mvav 84,204,164
Zvav 68,204,132
Ta 198,24,28672
Mvav 68,200,128
s_waitcnt lgkmcnt(8)
Zvav 72,208,128
Ta 200,25,16384
Mvav 72,212,132
Zvav 88,212,164
Ta 202,25,20480
Mvav 88,208,160
Lv 156,4,56,45,1024
Zvav 104,208,192
Ta 204,25,24576
Mvav 104,212,196
Zvav 120,212,228
Ta 206,25,28672
Mvav 120,208,224
s_waitcnt lgkmcnt(8)
Zvav 124,216,224
Ta 208,26,16384
Mvav 124,220,228
Zvav 108,220,196
Ta 210,26,20480
Mvav 108,216,192
Lv 184,5,56,45,0
Zvav 92,216,160
Ta 212,26,24576
Mvav 92,220,164
Zvav 76,220,132
Ta 214,26,28672
Mvav 76,216,128
s_waitcnt lgkmcnt(8)
Maav 128,192,136
Ta 216,27,16384
Maav 128,196,140
Maav 144,196,172
Ta 218,27,20480
Maav 144,192,168
Lv 188,5,56,45,1024
Maav 160,192,200
Ta 220,27,24576
Maav 160,196,204
Maav 176,196,236
Ta 222,27,28672
Maav 176,192,232
s_waitcnt lgkmcnt(8)
Maav 180,200,232
Ta 192,28,16384
Maav 180,204,236
Maav 164,204,204
Ta 194,28,20480
Maav 164,200,200
Lv 216,6,56,45,0
Maav 148,200,168
Ta 196,28,24576
Maav 148,204,172
Maav 132,204,140
Ta 198,28,28672
Maav 132,200,136
s_waitcnt lgkmcnt(8)
Maav 136,208,136
Ta 200,29,16384
Maav 136,212,140
Maav 152,212,172
Ta 202,29,20480
Maav 152,208,168
Lv 220,6,56,45,1024
Maav 168,208,200
Ta 204,29,24576
Maav 168,212,204
Maav 184,212,236
Ta 206,29,28672
Maav 184,208,232
s_waitcnt lgkmcnt(8)
Maav 188,216,232
Ta 208,30,16384
Maav 188,220,236
Maav 172,220,204
Ta 210,30,20480
Maav 172,216,200
Lv 248,7,56,45,0
Maav 156,216,168
Ta 212,30,24576
Maav 156,220,172
Maav 140,220,140
Ta 214,30,28672
Maav 140,216,136
s_waitcnt lgkmcnt(8)
Mvav 64,192,136
Ta 216,31,16384
Mvav 64,196,140
Mvav 80,196,172
Ta 218,31,20480
Mvav 80,192,168
Lv 252,7,56,45,1024
Mvav 96,192,200
Ta 220,31,24576
Mvav 96,196,204
Mvav 112,196,236
Ta 222,31,28672
Mvav 112,192,232
s_waitcnt vmcnt(16)
s_barrier
s_waitcnt lgkmcnt(8)
Mvav 116,200,232
s_cmp_le_u32 s72, 1
s_addc_u32 s45, 1, 0
s_lshl_b32 s45, s45, 13
s_add_u32 s45, s45, s48
Ta 192,16,0
Mvav 116,204,236
Mvav 100,204,204
Ta 194,16,4096
Mvav 100,200,200
La 0,4,56,45,0
Mvav 84,200,168
Ta 196,16,8192
Mvav 84,204,172
Mvav 68,204,140
Ta 198,16,12288
Mvav 68,200,136
s_waitcnt lgkmcnt(8)
Mvav 72,208,136
Ta 200,17,0
Mvav 72,212,140
Mvav 88,212,172
Ta 202,17,4096
Mvav 88,208,168
La 4,4,56,45,1024
Mvav 104,208,200
Ta 204,17,8192
Mvav 104,212,204
Mvav 120,212,236
Ta 206,17,12288
Mvav 120,208,232
s_waitcnt lgkmcnt(8)
Mvav 124,216,232
Ta 208,18,0
Mvav 124,220,236
Mvav 108,220,204
Ta 210,18,4096
Mvav 108,216,200
La 16,5,56,45,0
Mvav 92,216,168
Ta 212,18,8192
Mvav 92,220,172
Mvav 76,220,140
Ta 214,18,12288
Mvav 76,216,136
s_waitcnt lgkmcnt(8)
Maaa 128,192,64
Ta 216,19,0
Maaa 128,196,68
Maaa 144,196,84
Ta 218,19,4096
Maaa 144,192,80
La 20,5,56,45,1024
Maaa 160,192,96
Ta 220,19,8192
Maaa 160,196,100
Maaa 176,196,116
Ta 222,19,12288
Maaa 176,192,112
s_waitcnt lgkmcnt(8)
Maaa 180,200,112
Ta 192,20,0
Maaa 180,204,116
Maaa 164,204,100
Ta 194,20,4096
Maaa 164,200,96
La 32,6,56,45,0
Maaa 148,200,80
Ta 196,20,8192
Maaa 148,204,84
Maaa 132,204,68
Ta 198,20,12288
Maaa 132,200,64
s_waitcnt lgkmcnt(8)
Maaa 136,208,64
Ta 200,21,0
Maaa 136,212,68
Maaa 152,212,84
Ta 202,21,4096
Maaa 152,208,80
La 36,6,56,45,1024
Maaa 168,208,96
Ta 204,21,8192
Maaa 168,212,100
Maaa 184,212,116
Ta 206,21,12288
Maaa 184,208,112
s_waitcnt lgkmcnt(8)
Maaa 188,216,112
Ta 208,22,0
Maaa 188,220,116
Maaa 172,220,100
Ta 210,22,4096
Maaa 172,216,96
La 48,7,56,45,0
Maaa 156,216,80
Ta 212,22,8192
Maaa 156,220,84
Maaa 140,220,68
Ta 214,22,12288
Maaa 140,216,64
s_waitcnt lgkmcnt(8)
Mvaa 64,192,64
Ta 216,23,0
Mvaa 64,196,68
Mvaa 80,196,84
Ta 218,23,4096
Mvaa 80,192,80
La 52,7,56,45,1024
Mvaa 96,192,96
Ta 220,23,8192
Mvaa 96,196,100
Mvaa 112,196,116
Ta 222,23,12288
Mvaa 112,192,112
s_waitcnt lgkmcnt(8)
Mvaa 116,200,112
s_cmp_le_u32 s72, 1
s_addc_u32 s45, 1, 0
s_lshl_b32 s45, s45, 13
s_add_u32 s45, s45, 0x800
s_add_u32 s45, s45, s48
Ta 192,8,0
Mvaa 116,204,116
Mvaa 100,204,100
Ta 194,8,4096
v_lshrrev_b32 v40, 4, v1
Mvaa 100,200,96
La 8,4,56,45,0
v_and_b32 v41, 15, v40
Mvaa 84,200,80
Ta 196,8,8192
v_lshrrev_b32 v40, 4, v40
Mvaa 84,204,84
v_lshrrev_b32 v42, 2, v41
Mvaa 68,204,68
Ta 198,8,12288
v_and_b32 v43, 1, v41
Mvaa 68,200,64
s_waitcnt lgkmcnt(8)
v_lshlrev_b32 v43, 4, v43
Mvaa 72,208,64
Ta 200,9,0
v_mov_b32 v44, 0x3f80
Mvaa 72,212,68
v_lshlrev_b32 v44, v43, v44
Mvaa 88,212,84
Ta 202,9,4096
v_cmp_eq_u32 vcc, v42, v40
Mvaa 88,208,80
La 12,4,56,45,1024
v_and_b32 v41, 2, v41
Mvaa 104,208,96
Ta 204,9,8192
v_mov_b32 v56, 0
Mvaa 104,212,100
v_cndmask_b32 v44, v56, v44, vcc
Mvaa 120,212,116
Ta 206,9,12288
v_cmp_eq_u32 vcc, 0, v41
Mvaa 120,208,112
s_waitcnt lgkmcnt(8)
v_mov_b32 v57, 0
Mvaa 124,216,112
Ta 208,10,0
v_mov_b32 v60, 0
Mvaa 124,220,116
v_cndmask_b32 v58, v56, v44, vcc
Mvaa 108,220,100
Ta 210,10,4096
v_cndmask_b32 v59, v44, v56, vcc
Mvaa 108,216,96
La 24,5,56,45,0
v_mov_b32 v61, 0
Mvaa 92,216,80
Ta 212,10,8192
v_lshrrev_b32 v40, 4, v1
Mvaa 92,220,84
v_and_b32 v41, 15, v40
Mvaa 76,220,68
Ta 214,10,12288
v_lshrrev_b32 v40, 4, v40
Mvaa 76,216,64
s_waitcnt lgkmcnt(8)
v_lshlrev_b32 v40, 4, v40
Maaa 128,192,72
Ta 216,11,0
v_lshl_add_u32 v36, v41, 12, v40
Maaa 128,196,76
Maaa 144,196,92
Ta 218,11,4096
Maaa 144,192,88
La 28,5,56,45,1024
Maaa 160,192,104
Ta 220,11,8192
Maaa 160,196,108
Maaa 176,196,124
Ta 222,11,12288
Maaa 176,192,120
s_waitcnt lgkmcnt(8)
Maaa 180,200,120
Ta 192,12,0
Maaa 180,204,124
Maaa 164,204,108
Ta 194,12,4096
Maaa 164,200,104
La 40,6,56,45,0
Maaa 148,200,88
Ta 196,12,8192
Maaa 148,204,92
Maaa 132,204,76
Ta 198,12,12288
Maaa 132,200,72
s_waitcnt lgkmcnt(8)
Maaa 136,208,72
Ta 200,13,0
Maaa 136,212,76
Maaa 152,212,92
Ta 202,13,4096
Maaa 152,208,88
La 44,6,56,45,1024
Maaa 168,208,104
Ta 204,13,8192
Maaa 168,212,108
Maaa 184,212,124
Ta 206,13,12288
Maaa 184,208,120
s_waitcnt lgkmcnt(8)
Maaa 188,216,120
Ta 208,14,0
Maaa 188,220,124
Maaa 172,220,108
Ta 210,14,4096
Maaa 172,216,104
La 56,7,56,45,0
Maaa 156,216,88
Ta 212,14,8192
Maaa 156,220,92
Maaa 140,220,76
Ta 214,14,12288
Maaa 140,216,72
s_waitcnt lgkmcnt(8)
Mvaa 64,192,72
Ta 216,15,0
Mvaa 64,196,76
Mvaa 80,196,92
Ta 218,15,4096
Mvaa 80,192,88
La 60,7,56,45,1024
Mvaa 96,192,104
Ta 220,15,8192
Mvaa 96,196,108
Mvaa 112,196,124
Ta 222,15,12288
Mvaa 112,192,120
s_barrier
s_waitcnt lgkmcnt(8)
Mvaa 116,200,120
s_cmp_le_u32 s72, 2
s_addc_u32 s45, 2, 0
s_lshl_b32 s45, s45, 13
s_add_u32 s45, s45, s48
Ta 192,16,16384
Mvaa 116,204,124
Mvaa 100,204,108
Ta 194,16,20480
Mvaa 100,200,104
Lv 128,4,56,45,0
Mvaa 84,200,88
Ta 196,16,24576
Mvaa 84,204,92
Mvaa 68,204,76
Ta 198,16,28672
Mvaa 68,200,72
s_waitcnt lgkmcnt(8)
Mvaa 72,208,72
Ta 200,17,16384
Mvaa 72,212,76
Mvaa 88,212,92
Ta 202,17,20480
Mvaa 88,208,88
Lv 132,4,56,45,1024
Mvaa 104,208,104
Ta 204,17,24576
Mvaa 104,212,108
Mvaa 120,212,124
Ta 206,17,28672
Mvaa 120,208,120
s_waitcnt lgkmcnt(8)
Mvaa 124,216,120
Ta 208,18,16384
Mvaa 124,220,124
Mvaa 108,220,108
Ta 210,18,20480
Mvaa 108,216,104
Lv 160,5,56,45,0
Mvaa 92,216,88
Ta 212,18,24576
Mvaa 92,220,92
Mvaa 76,220,76
Ta 214,18,28672
Mvaa 76,216,72
s_waitcnt vmcnt(27) lgkmcnt(8)
Maav 128,192,144
Ta 216,19,16384
Maav 128,196,148
Maav 144,196,180
Ta 218,19,20480
Maav 144,192,176
Lv 164,5,56,45,1024
Maav 160,192,208
Ta 220,19,24576
Maav 160,196,212
Maav 176,196,244
Ta 222,19,28672
Maav 176,192,240
s_waitcnt lgkmcnt(8)
Maav 180,200,240
Ta 192,20,16384
Maav 180,204,244
Maav 164,204,212
Ta 194,20,20480
Maav 164,200,208
Lv 192,6,56,45,0
Maav 148,200,176
Ta 196,20,24576
Maav 148,204,180
Maav 132,204,148
Ta 198,20,28672
Maav 132,200,144
s_waitcnt lgkmcnt(8)
Maav 136,208,144
Ta 200,21,16384
Maav 136,212,148
Maav 152,212,180
Ta 202,21,20480
Maav 152,208,176
Lv 196,6,56,45,1024
Maav 168,208,208
Ta 204,21,24576
Maav 168,212,212
Maav 184,212,244
Ta 206,21,28672
Maav 184,208,240
s_waitcnt lgkmcnt(8)
Maav 188,216,240
Ta 208,22,16384
Maav 188,220,244
Maav 172,220,212
Ta 210,22,20480
Maav 172,216,208
Lv 224,7,56,45,0
Maav 156,216,176
Ta 212,22,24576
Maav 156,220,180
Maav 140,220,148
Ta 214,22,28672
Maav 140,216,144
s_waitcnt lgkmcnt(8)
Mvav 64,192,144
Ta 216,23,16384
Mvav 64,196,148
Mvav 80,196,180
Ta 218,23,20480
Mvav 80,192,176
Lv 228,7,56,45,1024
Mvav 96,192,208
Ta 220,23,24576
Mvav 96,196,212
Mvav 112,196,244
Ta 222,23,28672
Mvav 112,192,240
s_waitcnt lgkmcnt(8)
Mvav 116,200,240
s_cmp_le_u32 s72, 2
s_addc_u32 s45, 2, 0
s_lshl_b32 s45, s45, 13
s_add_u32 s45, s45, 0x800
s_add_u32 s45, s45, s48
Ta 192,8,16384
Mvav 116,204,244
Mvav 100,204,212
Ta 194,8,20480
Mvav 100,200,208
Lv 136,4,56,45,0
Mvav 84,200,176
Ta 196,8,24576
Mvav 84,204,180
Mvav 68,204,148
Ta 198,8,28672
Mvav 68,200,144
s_waitcnt lgkmcnt(8)
Mvav 72,208,144
Ta 200,9,16384
Mvav 72,212,148
Mvav 88,212,180
Ta 202,9,20480
Mvav 88,208,176
Lv 140,4,56,45,1024
Mvav 104,208,208
Ta 204,9,24576
Mvav 104,212,212
Mvav 120,212,244
Ta 206,9,28672
Mvav 120,208,240
s_waitcnt lgkmcnt(8)
Mvav 124,216,240
Ta 208,10,16384
Mvav 124,220,244
Mvav 108,220,212
Ta 210,10,20480
Mvav 108,216,208
Lv 168,5,56,45,0
Mvav 92,216,176
Ta 212,10,24576
Mvav 92,220,180
Mvav 76,220,148
Ta 214,10,28672
Mvav 76,216,144
s_waitcnt vmcnt(27) lgkmcnt(8)
Maav 128,192,152
Ta 216,11,16384
Maav 128,196,156
Maav 144,196,188
Ta 218,11,20480
Maav 144,192,184
Lv 172,5,56,45,1024
Maav 160,192,216
Ta 220,11,24576
Maav 160,196,220
Maav 176,196,252
Ta 222,11,28672
Maav 176,192,248
s_waitcnt lgkmcnt(8)
Maav 180,200,248
Ta 192,12,16384
Maav 180,204,252
Maav 164,204,220
Ta 194,12,20480
Maav 164,200,216
Lv 200,6,56,45,0
Maav 148,200,184
Ta 196,12,24576
Maav 148,204,188
Maav 132,204,156
Ta 198,12,28672
Maav 132,200,152
s_waitcnt lgkmcnt(8)
Maav 136,208,152
Ta 200,13,16384
Maav 136,212,156
Maav 152,212,188
Ta 202,13,20480
Maav 152,208,184
Lv 204,6,56,45,1024
Maav 168,208,216
Ta 204,13,24576
Maav 168,212,220
Maav 184,212,252
Ta 206,13,28672
Maav 184,208,248
s_waitcnt lgkmcnt(8)
Maav 188,216,248
Ta 208,14,16384
Maav 188,220,252
Maav 172,220,220
Ta 210,14,20480
Maav 172,216,216
Lv 232,7,56,45,0
Maav 156,216,184
Ta 212,14,24576
Maav 156,220,188
Maav 140,220,156
Ta 214,14,28672
Maav 140,216,152
s_waitcnt lgkmcnt(8)
Mvav 64,192,152
Ta 216,15,16384
Mvav 64,196,156
Mvav 80,196,188
Ta 218,15,20480
Mvav 80,192,184
Lv 236,7,56,45,1024
Mvav 96,192,216
Ta 220,15,24576
Mvav 96,196,220
Mvav 112,196,252
Ta 222,15,28672
Mvav 112,192,248
s_barrier
s_waitcnt lgkmcnt(8)
Mvav 116,200,248
s_cmp_le_u32 s72, 3
s_addc_u32 s45, 3, 0
s_lshl_b32 s45, s45, 13
s_add_u32 s45, s45, s48
Ta 192,16,32768
Mvav 116,204,252
Mvav 100,204,220
Ta 194,16,36864
Mvav 100,200,216
La 64,4,56,45,0
Mvav 84,200,184
Ta 196,16,40960
Mvav 84,204,188
Mvav 68,204,156
Ta 198,16,45056
Mvav 68,200,152
s_waitcnt lgkmcnt(8)
Mvav 72,208,152
Ta 200,17,32768
Mvav 72,212,156
Mvav 88,212,188
Ta 202,17,36864
Mvav 88,208,184
La 68,4,56,45,1024
Mvav 104,208,216
Ta 204,17,40960
Mvav 104,212,220
Mvav 120,212,252
Ta 206,17,45056
Mvav 120,208,248
s_waitcnt lgkmcnt(8)
Mvav 124,216,248
Ta 208,18,32768
Mvav 124,220,252
Mvav 108,220,220
Ta 210,18,36864
Mvav 108,216,216
La 80,5,56,45,0
Mvav 92,216,184
Ta 212,18,40960
Mvav 92,220,188
Mvav 76,220,156
Ta 214,18,45056
Mvav 76,216,152
s_waitcnt vmcnt(27) lgkmcnt(8)
Maaa 128,192,0
Ta 216,19,32768
Maaa 128,196,4
Maaa 144,196,20
Ta 218,19,36864
Maaa 144,192,16
La 84,5,56,45,1024
Maaa 160,192,32
Ta 220,19,40960
Maaa 160,196,36
Maaa 176,196,52
Ta 222,19,45056
Maaa 176,192,48
s_waitcnt lgkmcnt(8)
Maaa 180,200,48
Ta 192,20,32768
Maaa 180,204,52
Maaa 164,204,36
Ta 194,20,36864
Maaa 164,200,32
La 96,6,56,45,0
Maaa 148,200,16
Ta 196,20,40960
Maaa 148,204,20
Maaa 132,204,4
Ta 198,20,45056
Maaa 132,200,0
s_waitcnt lgkmcnt(8)
Maaa 136,208,0
Ta 200,21,32768
Maaa 136,212,4
Maaa 152,212,20
Ta 202,21,36864
Maaa 152,208,16
La 100,6,56,45,1024
Maaa 168,208,32
Ta 204,21,40960
Maaa 168,212,36
Maaa 184,212,52
Ta 206,21,45056
Maaa 184,208,48
s_waitcnt lgkmcnt(8)
Maaa 188,216,48
Ta 208,22,32768
Maaa 188,220,52
Maaa 172,220,36
Ta 210,22,36864
Maaa 172,216,32
La 112,7,56,45,0
Maaa 156,216,16
Ta 212,22,40960
Maaa 156,220,20
Maaa 140,220,4
Ta 214,22,45056
Maaa 140,216,0
s_waitcnt lgkmcnt(8)
Mvaa 64,192,0
Ta 216,23,32768
Mvaa 64,196,4
Mvaa 80,196,20
Ta 218,23,36864
Mvaa 80,192,16
La 116,7,56,45,1024
Mvaa 96,192,32
Ta 220,23,40960
Mvaa 96,196,36
Mvaa 112,196,52
Ta 222,23,45056
Mvaa 112,192,48
s_waitcnt lgkmcnt(8)
Mvaa 116,200,48
s_cmp_le_u32 s72, 3
s_addc_u32 s45, 3, 0
s_lshl_b32 s45, s45, 13
s_add_u32 s45, s45, 0x800
s_add_u32 s45, s45, s48
Ta 192,8,32768
Mvaa 116,204,52
Mvaa 100,204,36
Ta 194,8,36864
Mvaa 100,200,32
La 72,4,56,45,0
Mvaa 84,200,16
Ta 196,8,40960
Mvaa 84,204,20
Mvaa 68,204,4
Ta 198,8,45056
Mvaa 68,200,0
s_waitcnt lgkmcnt(8)
Mvaa 72,208,0
Ta 200,9,32768
Mvaa 72,212,4
Mvaa 88,212,20
Ta 202,9,36864
Mvaa 88,208,16
La 76,4,56,45,1024
Mvaa 104,208,32
Ta 204,9,40960
Mvaa 104,212,36
Mvaa 120,212,52
Ta 206,9,45056
Mvaa 120,208,48
s_waitcnt lgkmcnt(8)
Mvaa 124,216,48
Ta 208,10,32768
Mvaa 124,220,52
Mvaa 108,220,36
Ta 210,10,36864
Mvaa 108,216,32
La 88,5,56,45,0
Mvaa 92,216,16
Ta 212,10,40960
Mvaa 92,220,20
Mvaa 76,220,4
Ta 214,10,45056
Mvaa 76,216,0
s_waitcnt vmcnt(27) lgkmcnt(8)
Maaa 128,192,8
Ta 216,11,32768
Maaa 128,196,12
Maaa 144,196,28
Ta 218,11,36864
Maaa 144,192,24
La 92,5,56,45,1024
Maaa 160,192,40
Ta 220,11,40960
Maaa 160,196,44
Maaa 176,196,60
Ta 222,11,45056
Maaa 176,192,56
s_waitcnt lgkmcnt(8)
Maaa 180,200,56
Ta 192,12,32768
Maaa 180,204,60
Maaa 164,204,44
Ta 194,12,36864
Maaa 164,200,40
La 104,6,56,45,0
Maaa 148,200,24
Ta 196,12,40960
Maaa 148,204,28
Maaa 132,204,12
Ta 198,12,45056
Maaa 132,200,8
s_waitcnt lgkmcnt(8)
Maaa 136,208,8
Ta 200,13,32768
Maaa 136,212,12
Maaa 152,212,28
Ta 202,13,36864
Maaa 152,208,24
La 108,6,56,45,1024
Maaa 168,208,40
Ta 204,13,40960
Maaa 168,212,44
Maaa 184,212,60
Ta 206,13,45056
Maaa 184,208,56
s_waitcnt lgkmcnt(8)
Maaa 188,216,56
Ta 208,14,32768
Maaa 188,220,60
Maaa 172,220,44
Ta 210,14,36864
Maaa 172,216,40
La 120,7,56,45,0
Maaa 156,216,24
Ta 212,14,40960
Maaa 156,220,28
Maaa 140,220,12
Ta 214,14,45056
Maaa 140,216,8
s_waitcnt lgkmcnt(8)
Mvaa 64,192,8
Ta 216,15,32768
Mvaa 64,196,12
Mvaa 80,196,28
Ta 218,15,36864
Mvaa 80,192,24
La 124,7,56,45,1024
Mvaa 96,192,40
Ta 220,15,40960
Mvaa 96,196,44
Mvaa 112,196,60
Ta 222,15,45056
Mvaa 112,192,56
s_barrier
s_waitcnt lgkmcnt(8)
Mvaa 116,200,56
s_cmp_le_u32 s72, 4
s_addc_u32 s45, 4, 0
s_lshl_b32 s45, s45, 13
s_add_u32 s45, s45, s48
Ta 192,16,49152
Mvaa 116,204,60
Mvaa 100,204,44
Ta 194,16,53248
Mvaa 100,200,40
Lv 144,4,56,45,0
Mvaa 84,200,24
Ta 196,16,57344
Mvaa 84,204,28
Mvaa 68,204,12
Ta 198,16,61440
Mvaa 68,200,8
s_waitcnt lgkmcnt(8)
Mvaa 72,208,8
Ta 200,17,49152
Mvaa 72,212,12
Mvaa 88,212,28
Ta 202,17,53248
Mvaa 88,208,24
Lv 148,4,56,45,1024
Mvaa 104,208,40
Ta 204,17,57344
Mvaa 104,212,44
Mvaa 120,212,60
Ta 206,17,61440
Mvaa 120,208,56
s_waitcnt lgkmcnt(8)
Mvaa 124,216,56
Ta 208,18,49152
Mvaa 124,220,60
Mvaa 108,220,44
Ta 210,18,53248
Mvaa 108,216,40
Lv 176,5,56,45,0
Mvaa 92,216,24
Ta 212,18,57344
Mvaa 92,220,28
Mvaa 76,220,12
Ta 214,18,61440
Mvaa 76,216,8
s_waitcnt vmcnt(27) lgkmcnt(8)
Maav 128,192,128
Ta 216,19,49152
Maav 128,196,132
Maav 144,196,164
Ta 218,19,53248
Maav 144,192,160
Lv 180,5,56,45,1024
Maav 160,192,192
Ta 220,19,57344
Maav 160,196,196
Maav 176,196,228
Ta 222,19,61440
Maav 176,192,224
s_waitcnt lgkmcnt(8)
Maav 180,200,224
Ta 192,20,49152
Maav 180,204,228
Maav 164,204,196
Ta 194,20,53248
Maav 164,200,192
Lv 208,6,56,45,0
Maav 148,200,160
Ta 196,20,57344
Maav 148,204,164
Maav 132,204,132
Ta 198,20,61440
Maav 132,200,128
s_waitcnt lgkmcnt(8)
Maav 136,208,128
Ta 200,21,49152
Maav 136,212,132
Maav 152,212,164
Ta 202,21,53248
Maav 152,208,160
Lv 212,6,56,45,1024
Maav 168,208,192
Ta 204,21,57344
Maav 168,212,196
Maav 184,212,228
Ta 206,21,61440
Maav 184,208,224
s_waitcnt lgkmcnt(8)
Maav 188,216,224
Ta 208,22,49152
Maav 188,220,228
Maav 172,220,196
Ta 210,22,53248
Maav 172,216,192
Lv 240,7,56,45,0
Maav 156,216,160
Ta 212,22,57344
Maav 156,220,164
Maav 140,220,132
Ta 214,22,61440
Maav 140,216,128
s_waitcnt lgkmcnt(8)
Mvav 64,192,128
Ta 216,23,49152
Mvav 64,196,132
Mvav 80,196,164
Ta 218,23,53248
Mvav 80,192,160
Lv 244,7,56,45,1024
Mvav 96,192,192
Ta 220,23,57344
Mvav 96,196,196
Mvav 112,196,228
Ta 222,23,61440
Mvav 112,192,224
s_waitcnt lgkmcnt(8)
Mvav 116,200,224
s_cmp_le_u32 s72, 4
s_addc_u32 s45, 4, 0
s_lshl_b32 s45, s45, 13
s_add_u32 s45, s45, 0x800
s_add_u32 s45, s45, s48
Ta 192,8,49152
Mvav 116,204,228
Mvav 100,204,196
Ta 194,8,53248
Mvav 100,200,192
Lv 152,4,56,45,0
Mvav 84,200,160
Ta 196,8,57344
Mvav 84,204,164
Mvav 68,204,132
Ta 198,8,61440
Mvav 68,200,128
s_waitcnt lgkmcnt(8)
Mvav 72,208,128
Ta 200,9,49152
Mvav 72,212,132
Mvav 88,212,164
Ta 202,9,53248
Mvav 88,208,160
Lv 156,4,56,45,1024
Mvav 104,208,192
Ta 204,9,57344
Mvav 104,212,196
Mvav 120,212,228
Ta 206,9,61440
Mvav 120,208,224
s_waitcnt lgkmcnt(8)
Mvav 124,216,224
Ta 208,10,49152
Mvav 124,220,228
Mvav 108,220,196
Ta 210,10,53248
Mvav 108,216,192
Lv 184,5,56,45,0
Mvav 92,216,160
Ta 212,10,57344
Mvav 92,220,164
Mvav 76,220,132
Ta 214,10,61440
Mvav 76,216,128
s_waitcnt vmcnt(27) lgkmcnt(8)
Maav 128,192,136
Ta 216,11,49152
Maav 128,196,140
Maav 144,196,172
Ta 218,11,53248
Maav 144,192,168
Lv 188,5,56,45,1024
Maav 160,192,200
Ta 220,11,57344
Maav 160,196,204
Maav 176,196,236
Ta 222,11,61440
Maav 176,192,232
s_waitcnt lgkmcnt(8)
Maav 180,200,232
Ta 192,12,49152
Maav 180,204,236
Maav 164,204,204
Ta 194,12,53248
Maav 164,200,200
Lv 216,6,56,45,0
Maav 148,200,168
Ta 196,12,57344
Maav 148,204,172
Maav 132,204,140
Ta 198,12,61440
Maav 132,200,136
s_waitcnt lgkmcnt(8)
Maav 136,208,136
Ta 200,13,49152
Maav 136,212,140
Maav 152,212,172
Ta 202,13,53248
Maav 152,208,168
Lv 220,6,56,45,1024
Maav 168,208,200
Ta 204,13,57344
Maav 168,212,204
Maav 184,212,236
Ta 206,13,61440
Maav 184,208,232
s_waitcnt lgkmcnt(8)
Maav 188,216,232
Ta 208,14,49152
Maav 188,220,236
Maav 172,220,204
Ta 210,14,53248
Maav 172,216,200
Lv 248,7,56,45,0
Maav 156,216,168
Ta 212,14,57344
Maav 156,220,172
Maav 140,220,140
Ta 214,14,61440
Maav 140,216,136
s_waitcnt lgkmcnt(8)
Mvav 64,192,136
Ta 216,15,49152
Mvav 64,196,140
Mvav 80,196,172
Ta 218,15,53248
Mvav 80,192,168
Lv 252,7,56,45,1024
Mvav 96,192,200
Ta 220,15,57344
Mvav 96,196,204
Mvav 112,196,236
Ta 222,15,61440
Mvav 112,192,232
s_barrier
s_waitcnt lgkmcnt(8)
Mvav 116,200,232
s_cmp_le_u32 s72, 5
s_addc_u32 s45, 5, 0
s_lshl_b32 s45, s45, 13
s_add_u32 s45, s45, s48
Ta 192,24,0
Mvav 116,204,236
Mvav 100,204,204
Ta 194,24,4096
Mvav 100,200,200
La 0,4,56,45,0
Mvav 84,200,168
Ta 196,24,8192
Mvav 84,204,172
Mvav 68,204,140
Ta 198,24,12288
Mvav 68,200,136
s_waitcnt lgkmcnt(8)
Mvav 72,208,136
Ta 200,25,0
Mvav 72,212,140
Mvav 88,212,172
Ta 202,25,4096
Mvav 88,208,168
La 4,4,56,45,1024
Mvav 104,208,200
Ta 204,25,8192
Mvav 104,212,204
Mvav 120,212,236
Ta 206,25,12288
Mvav 120,208,232
s_waitcnt lgkmcnt(8)
Mvav 124,216,232
Ta 208,26,0
Mvav 124,220,236
Mvav 108,220,204
Ta 210,26,4096
Mvav 108,216,200
La 16,5,56,45,0
Mvav 92,216,168
Ta 212,26,8192
Mvav 92,220,172
Mvav 76,220,140
Ta 214,26,12288
Mvav 76,216,136
s_waitcnt vmcnt(27) lgkmcnt(8)
Maaa 128,192,64
Ta 216,27,0
Maaa 128,196,68
Maaa 144,196,84
Ta 218,27,4096
Maaa 144,192,80
La 20,5,56,45,1024
Maaa 160,192,96
Ta 220,27,8192
Maaa 160,196,100
Maaa 176,196,116
Ta 222,27,12288
Maaa 176,192,112
s_waitcnt lgkmcnt(8)
Maaa 180,200,112
Ta 192,28,0
Maaa 180,204,116
Maaa 164,204,100
Ta 194,28,4096
Maaa 164,200,96
La 32,6,56,45,0
Maaa 148,200,80
Ta 196,28,8192
Maaa 148,204,84
Maaa 132,204,68
Ta 198,28,12288
Maaa 132,200,64
s_waitcnt lgkmcnt(8)
Maaa 136,208,64
Ta 200,29,0
Maaa 136,212,68
Maaa 152,212,84
Ta 202,29,4096
Maaa 152,208,80
La 36,6,56,45,1024
Maaa 168,208,96
Ta 204,29,8192
Maaa 168,212,100
Maaa 184,212,116
Ta 206,29,12288
Maaa 184,208,112
s_waitcnt lgkmcnt(8)
Maaa 188,216,112
Ta 208,30,0
Maaa 188,220,116
Maaa 172,220,100
Ta 210,30,4096
Maaa 172,216,96
La 48,7,56,45,0
Maaa 156,216,80
Ta 212,30,8192
Maaa 156,220,84
Maaa 140,220,68
Ta 214,30,12288
Maaa 140,216,64
s_waitcnt lgkmcnt(8)
Mvaa 64,192,64
Ta 216,31,0
Mvaa 64,196,68
Mvaa 80,196,84
Ta 218,31,4096
Mvaa 80,192,80
La 52,7,56,45,1024
Mvaa 96,192,96
Ta 220,31,8192
Mvaa 96,196,100
Mvaa 112,196,116
Ta 222,31,12288
Mvaa 112,192,112
s_waitcnt lgkmcnt(8)
Mvaa 116,200,112
s_cmp_le_u32 s72, 5
s_addc_u32 s45, 5, 0
s_lshl_b32 s45, s45, 13
s_add_u32 s45, s45, 0x800
s_add_u32 s45, s45, s48
Ta 192,24,16384
Mvaa 116,204,116
Mvaa 100,204,100
Ta 194,24,20480
Mvaa 100,200,96
La 8,4,56,45,0
Mvaa 84,200,80
Ta 196,24,24576
Mvaa 84,204,84
Mvaa 68,204,68
Ta 198,24,28672
Mvaa 68,200,64
s_waitcnt lgkmcnt(8)
Mvaa 72,208,64
Ta 200,25,16384
Mvaa 72,212,68
Mvaa 88,212,84
Ta 202,25,20480
Mvaa 88,208,80
La 12,4,56,45,1024
Mvaa 104,208,96
Ta 204,25,24576
Mvaa 104,212,100
Mvaa 120,212,116
Ta 206,25,28672
Mvaa 120,208,112
s_waitcnt lgkmcnt(8)
Mvaa 124,216,112
Ta 208,26,16384
Mvaa 124,220,116
Mvaa 108,220,100
Ta 210,26,20480
Mvaa 108,216,96
La 24,5,56,45,0
Mvaa 92,216,80
Ta 212,26,24576
Mvaa 92,220,84
Mvaa 76,220,68
Ta 214,26,28672
Mvaa 76,216,64
s_waitcnt vmcnt(27) lgkmcnt(8)
Maaa 128,192,72
Ta 216,27,16384
Maaa 128,196,76
Maaa 144,196,92
Ta 218,27,20480
Maaa 144,192,88
La 28,5,56,45,1024
Maaa 160,192,104
Ta 220,27,24576
Maaa 160,196,108
Maaa 176,196,124
Ta 222,27,28672
Maaa 176,192,120
s_waitcnt lgkmcnt(8)
Maaa 180,200,120
Ta 192,28,16384
Maaa 180,204,124
Maaa 164,204,108
Ta 194,28,20480
Maaa 164,200,104
La 40,6,56,45,0
Maaa 148,200,88
Ta 196,28,24576
Maaa 148,204,92
Maaa 132,204,76
Ta 198,28,28672
Maaa 132,200,72
s_waitcnt lgkmcnt(8)
Maaa 136,208,72
Ta 200,29,16384
Maaa 136,212,76
Maaa 152,212,92
Ta 202,29,20480
Maaa 152,208,88
La 44,6,56,45,1024
Maaa 168,208,104
Ta 204,29,24576
Maaa 168,212,108
Maaa 184,212,124
Ta 206,29,28672
Maaa 184,208,120
s_waitcnt lgkmcnt(8)
Maaa 188,216,120
Ta 208,30,16384
Maaa 188,220,124
Maaa 172,220,108
Ta 210,30,20480
Maaa 172,216,104
La 56,7,56,45,0
Maaa 156,216,88
Ta 212,30,24576
Maaa 156,220,92
Maaa 140,220,76
Ta 214,30,28672
Maaa 140,216,72
s_waitcnt lgkmcnt(8)
Mvaa 64,192,72
Ta 216,31,16384
Mvaa 64,196,76
Mvaa 80,196,92
Ta 218,31,20480
Mvaa 80,192,88
La 60,7,56,45,1024
Mvaa 96,192,104
Ta 220,31,24576
Mvaa 96,196,108
Mvaa 112,196,124
Ta 222,31,28672
Mvaa 112,192,120
s_barrier
s_waitcnt lgkmcnt(8)
Mvaa 116,200,120
s_cmp_le_u32 s72, 6
s_addc_u32 s45, 6, 0
s_lshl_b32 s45, s45, 13
s_add_u32 s45, s45, s48
Ta 192,16,0
Mvaa 116,204,124
Mvaa 100,204,108
Ta 194,16,4096
Mvaa 100,200,104
Lv 128,4,56,45,0
Mvaa 84,200,88
Ta 196,16,8192
Mvaa 84,204,92
Mvaa 68,204,76
Ta 198,16,12288
Mvaa 68,200,72
s_waitcnt lgkmcnt(8)
Mvaa 72,208,72
Ta 200,17,0
Mvaa 72,212,76
Mvaa 88,212,92
Ta 202,17,4096
Mvaa 88,208,88
Lv 132,4,56,45,1024
Mvaa 104,208,104
Ta 204,17,8192
Mvaa 104,212,108
Mvaa 120,212,124
Ta 206,17,12288
Mvaa 120,208,120
s_waitcnt lgkmcnt(8)
Mvaa 124,216,120
Ta 208,18,0
Mvaa 124,220,124
Mvaa 108,220,108
Ta 210,18,4096
Mvaa 108,216,104
Lv 160,5,56,45,0
Mvaa 92,216,88
Ta 212,18,8192
Mvaa 92,220,92
Mvaa 76,220,76
Ta 214,18,12288
Mvaa 76,216,72
s_waitcnt vmcnt(27) lgkmcnt(8)
Maav 128,192,144
Ta 216,19,0
Maav 128,196,148
Maav 144,196,180
Ta 218,19,4096
Maav 144,192,176
Lv 164,5,56,45,1024
Maav 160,192,208
Ta 220,19,8192
Maav 160,196,212
Maav 176,196,244
Ta 222,19,12288
Maav 176,192,240
s_waitcnt lgkmcnt(8)
Maav 180,200,240
Ta 192,20,0
Maav 180,204,244
Maav 164,204,212
Ta 194,20,4096
Maav 164,200,208
Lv 192,6,56,45,0
Maav 148,200,176
Ta 196,20,8192
Maav 148,204,180
Maav 132,204,148
Ta 198,20,12288
Maav 132,200,144
s_waitcnt lgkmcnt(8)
Maav 136,208,144
Ta 200,21,0
Maav 136,212,148
Maav 152,212,180
Ta 202,21,4096
Maav 152,208,176
Lv 196,6,56,45,1024
Maav 168,208,208
Ta 204,21,8192
Maav 168,212,212
Maav 184,212,244
Ta 206,21,12288
Maav 184,208,240
s_waitcnt lgkmcnt(8)
Maav 188,216,240
Ta 208,22,0
Maav 188,220,244
Maav 172,220,212
Ta 210,22,4096
Maav 172,216,208
Lv 224,7,56,45,0
Maav 156,216,176
Ta 212,22,8192
Maav 156,220,180
Maav 140,220,148
Ta 214,22,12288
Maav 140,216,144
s_waitcnt lgkmcnt(8)
Mvav 64,192,144
Ta 216,23,0
Mvav 64,196,148
Mvav 80,196,180
Ta 218,23,4096
Mvav 80,192,176
Lv 228,7,56,45,1024
Mvav 96,192,208
Ta 220,23,8192
Mvav 96,196,212
Mvav 112,196,244
Ta 222,23,12288
Mvav 112,192,240
s_waitcnt lgkmcnt(8)
Mvav 116,200,240
s_cmp_le_u32 s72, 6
s_addc_u32 s45, 6, 0
s_lshl_b32 s45, s45, 13
s_add_u32 s45, s45, 0x800
s_add_u32 s45, s45, s48
Ta 192,8,0
Mvav 116,204,244
Mvav 100,204,212
Ta 194,8,4096
Mvav 100,200,208
Lv 136,4,56,45,0
Mvav 84,200,176
Ta 196,8,8192
Mvav 84,204,180
Mvav 68,204,148
Ta 198,8,12288
Mvav 68,200,144
s_waitcnt lgkmcnt(8)
Mvav 72,208,144
Ta 200,9,0
Mvav 72,212,148
Mvav 88,212,180
Ta 202,9,4096
Mvav 88,208,176
Lv 140,4,56,45,1024
Mvav 104,208,208
Ta 204,9,8192
Mvav 104,212,212
Mvav 120,212,244
Ta 206,9,12288
Mvav 120,208,240
s_waitcnt lgkmcnt(8)
Mvav 124,216,240
Ta 208,10,0
Mvav 124,220,244
Mvav 108,220,212
Ta 210,10,4096
Mvav 108,216,208
Lv 168,5,56,45,0
Mvav 92,216,176
Ta 212,10,8192
Mvav 92,220,180
Mvav 76,220,148
Ta 214,10,12288
Mvav 76,216,144
s_waitcnt vmcnt(27) lgkmcnt(8)
Maav 128,192,152
Ta 216,11,0
Maav 128,196,156
Maav 144,196,188
Ta 218,11,4096
Maav 144,192,184
Lv 172,5,56,45,1024
Maav 160,192,216
Ta 220,11,8192
Maav 160,196,220
Maav 176,196,252
Ta 222,11,12288
Maav 176,192,248
s_waitcnt lgkmcnt(8)
Maav 180,200,248
Ta 192,12,0
Maav 180,204,252
Maav 164,204,220
Ta 194,12,4096
Maav 164,200,216
Lv 200,6,56,45,0
Maav 148,200,184
Ta 196,12,8192
Maav 148,204,188
Maav 132,204,156
Ta 198,12,12288
Maav 132,200,152
s_waitcnt lgkmcnt(8)
Maav 136,208,152
Ta 200,13,0
Maav 136,212,156
Maav 152,212,188
Ta 202,13,4096
Maav 152,208,184
Lv 204,6,56,45,1024
Maav 168,208,216
Ta 204,13,8192
Maav 168,212,220
Maav 184,212,252
Ta 206,13,12288
Maav 184,208,248
s_waitcnt lgkmcnt(8)
Maav 188,216,248
Ta 208,14,0
Maav 188,220,252
Maav 172,220,220
Ta 210,14,4096
Maav 172,216,216
Lv 232,7,56,45,0
Maav 156,216,184
Ta 212,14,8192
Maav 156,220,188
Maav 140,220,156
Ta 214,14,12288
Maav 140,216,152
s_waitcnt lgkmcnt(8)
Mvav 64,192,152
Ta 216,15,0
Mvav 64,196,156
Mvav 80,196,188
Ta 218,15,4096
Mvav 80,192,184
Lv 236,7,56,45,1024
Mvav 96,192,216
Ta 220,15,8192
Mvav 96,196,220
Mvav 112,196,252
Ta 222,15,12288
Mvav 112,192,248
s_barrier
s_waitcnt lgkmcnt(8)
Mvav 116,200,248
s_cmp_le_u32 s72, 0
s_addc_u32 s45, 0, 0
s_lshl_b32 s45, s45, 13
s_add_u32 s45, s45, 0x1000
s_add_u32 s45, s45, s48
Ta 192,16,16384
Mvav 116,204,252
Mvav 100,204,220
Ta 194,16,20480
Mvav 100,200,216
La 64,4,56,45,0
Mvav 84,200,184
Ta 196,16,24576
Mvav 84,204,188
Mvav 68,204,156
Ta 198,16,28672
Mvav 68,200,152
s_waitcnt lgkmcnt(8)
Mvav 72,208,152
Ta 200,17,16384
Mvav 72,212,156
Mvav 88,212,188
Ta 202,17,20480
Mvav 88,208,184
La 68,4,56,45,1024
Mvav 104,208,216
Ta 204,17,24576
Mvav 104,212,220
Mvav 120,212,252
Ta 206,17,28672
Mvav 120,208,248
s_waitcnt lgkmcnt(8)
Mvav 124,216,248
Ta 208,18,16384
Mvav 124,220,252
Mvav 108,220,220
Ta 210,18,20480
Mvav 108,216,216
La 80,5,56,45,0
Mvav 92,216,184
Ta 212,18,24576
Mvav 92,220,188
Mvav 76,220,156
Ta 214,18,28672
Mvav 76,216,152
s_waitcnt vmcnt(27) lgkmcnt(8)
Maaa 128,192,0
Ta 216,19,16384
Maaa 128,196,4
Maaa 144,196,20
Ta 218,19,20480
Maaa 144,192,16
La 84,5,56,45,1024
Maaa 160,192,32
Ta 220,19,24576
Maaa 160,196,36
Maaa 176,196,52
Ta 222,19,28672
Maaa 176,192,48
s_waitcnt lgkmcnt(8)
Maaa 180,200,48
Ta 192,20,16384
Maaa 180,204,52
Maaa 164,204,36
Ta 194,20,20480
Maaa 164,200,32
La 96,6,56,45,0
Maaa 148,200,16
Ta 196,20,24576
Maaa 148,204,20
Maaa 132,204,4
Ta 198,20,28672
Maaa 132,200,0
s_waitcnt lgkmcnt(8)
Maaa 136,208,0
Ta 200,21,16384
Maaa 136,212,4
Maaa 152,212,20
Ta 202,21,20480
Maaa 152,208,16
La 100,6,56,45,1024
Maaa 168,208,32
Ta 204,21,24576
Maaa 168,212,36
Maaa 184,212,52
Ta 206,21,28672
Maaa 184,208,48
s_waitcnt lgkmcnt(8)
Maaa 188,216,48
Ta 208,22,16384
Maaa 188,220,52
Maaa 172,220,36
Ta 210,22,20480
Maaa 172,216,32
La 112,7,56,45,0
Maaa 156,216,16
Ta 212,22,24576
Maaa 156,220,20
Maaa 140,220,4
Ta 214,22,28672
Maaa 140,216,0
s_waitcnt lgkmcnt(8)
Mvaa 64,192,0
Ta 216,23,16384
Mvaa 64,196,4
Mvaa 80,196,20
Ta 218,23,20480
Mvaa 80,192,16
La 116,7,56,45,1024
Mvaa 96,192,32
Ta 220,23,24576
Mvaa 96,196,36
Mvaa 112,196,52
Ta 222,23,28672
Mvaa 112,192,48
s_waitcnt lgkmcnt(8)
Mvaa 116,200,48
s_cmp_le_u32 s72, 0
s_addc_u32 s45, 0, 0
s_lshl_b32 s45, s45, 13
s_add_u32 s45, s45, 0x1800
s_add_u32 s45, s45, s48
Ta 192,8,16384
Mvaa 116,204,52
Mvaa 100,204,36
Ta 194,8,20480
Mvaa 100,200,32
La 72,4,56,45,0
Mvaa 84,200,16
Ta 196,8,24576
Mvaa 84,204,20
Mvaa 68,204,4
Ta 198,8,28672
Mvaa 68,200,0
s_waitcnt lgkmcnt(8)
Mvaa 72,208,0
Ta 200,9,16384
Mvaa 72,212,4
Mvaa 88,212,20
Ta 202,9,20480
Mvaa 88,208,16
La 76,4,56,45,1024
Mvaa 104,208,32
Ta 204,9,24576
Mvaa 104,212,36
Mvaa 120,212,52
Ta 206,9,28672
Mvaa 120,208,48
s_waitcnt lgkmcnt(8)
Mvaa 124,216,48
Ta 208,10,16384
Mvaa 124,220,52
Mvaa 108,220,36
Ta 210,10,20480
Mvaa 108,216,32
La 88,5,56,45,0
Mvaa 92,216,16
Ta 212,10,24576
Mvaa 92,220,20
Mvaa 76,220,4
Ta 214,10,28672
Mvaa 76,216,0
s_waitcnt vmcnt(27) lgkmcnt(8)
Maaa 128,192,8
Ta 216,11,16384
Maaa 128,196,12
Maaa 144,196,28
Ta 218,11,20480
Maaa 144,192,24
La 92,5,56,45,1024
Maaa 160,192,40
Ta 220,11,24576
Maaa 160,196,44
Maaa 176,196,60
Ta 222,11,28672
Maaa 176,192,56
s_waitcnt lgkmcnt(8)
Maaa 180,200,56
Ta 192,12,16384
Maaa 180,204,60
Maaa 164,204,44
Ta 194,12,20480
Maaa 164,200,40
La 104,6,56,45,0
Maaa 148,200,24
Ta 196,12,24576
Maaa 148,204,28
Maaa 132,204,12
Ta 198,12,28672
Maaa 132,200,8
s_waitcnt lgkmcnt(8)
Maaa 136,208,8
Ta 200,13,16384
Maaa 136,212,12
Maaa 152,212,28
Ta 202,13,20480
Maaa 152,208,24
La 108,6,56,45,1024
Maaa 168,208,40
Ta 204,13,24576
Maaa 168,212,44
Maaa 184,212,60
Ta 206,13,28672
Maaa 184,208,56
s_waitcnt lgkmcnt(8)
Maaa 188,216,56
Ta 208,14,16384
Maaa 188,220,60
Maaa 172,220,44
Ta 210,14,20480
Maaa 172,216,40
La 120,7,56,45,0
Maaa 156,216,24
Ta 212,14,24576
Maaa 156,220,28
Maaa 140,220,12
Ta 214,14,28672
Maaa 140,216,8
s_waitcnt lgkmcnt(8)
Mvaa 64,192,8
Ta 216,15,16384
Mvaa 64,196,12
Mvaa 80,196,28
Ta 218,15,20480
Mvaa 80,192,24
La 124,7,56,45,1024
Mvaa 96,192,40
Ta 220,15,24576
Mvaa 96,196,44
Mvaa 112,196,60
Ta 222,15,28672
Mvaa 112,192,56
s_barrier
s_waitcnt lgkmcnt(8)
Mvaa 116,200,56
s_cmp_le_u32 s72, 1
s_addc_u32 s45, 1, 0
s_lshl_b32 s45, s45, 13
s_add_u32 s45, s45, 0x1000
s_add_u32 s45, s45, s48
Ta 192,16,32768
Mvaa 116,204,60
Mvaa 100,204,44
Ta 194,16,36864
Mvaa 100,200,40
Lv 144,4,56,45,0
Mvaa 84,200,24
Ta 196,16,40960
Mvaa 84,204,28
Mvaa 68,204,12
Ta 198,16,45056
Mvaa 68,200,8
s_waitcnt lgkmcnt(8)
Mvaa 72,208,8
Ta 200,17,32768
Mvaa 72,212,12
Mvaa 88,212,28
Ta 202,17,36864
Mvaa 88,208,24
Lv 148,4,56,45,1024
Mvaa 104,208,40
Ta 204,17,40960
Mvaa 104,212,44
Mvaa 120,212,60
Ta 206,17,45056
Mvaa 120,208,56
s_waitcnt lgkmcnt(8)
Mvaa 124,216,56
Ta 208,18,32768
Mvaa 124,220,60
Mvaa 108,220,44
Ta 210,18,36864
Mvaa 108,216,40
Lv 176,5,56,45,0
Mvaa 92,216,24
Ta 212,18,40960
Mvaa 92,220,28
Mvaa 76,220,12
Ta 214,18,45056
Mvaa 76,216,8
s_waitcnt vmcnt(27) lgkmcnt(8)
Maav 128,192,128
Ta 216,19,32768
Maav 128,196,132
Maav 144,196,164
Ta 218,19,36864
Maav 144,192,160
Lv 180,5,56,45,1024
Maav 160,192,192
Ta 220,19,40960
Maav 160,196,196
Maav 176,196,228
Ta 222,19,45056
Maav 176,192,224
s_waitcnt lgkmcnt(8)
Maav 180,200,224
Ta 192,20,32768
Maav 180,204,228
Maav 164,204,196
Ta 194,20,36864
Maav 164,200,192
Lv 208,6,56,45,0
Maav 148,200,160
Ta 196,20,40960
Maav 148,204,164
Maav 132,204,132
Ta 198,20,45056
Maav 132,200,128
s_waitcnt lgkmcnt(8)
Maav 136,208,128
Ta 200,21,32768
Maav 136,212,132
Maav 152,212,164
Ta 202,21,36864
Maav 152,208,160
Lv 212,6,56,45,1024
Maav 168,208,192
Ta 204,21,40960
Maav 168,212,196
Maav 184,212,228
Ta 206,21,45056
Maav 184,208,224
s_waitcnt lgkmcnt(8)
Maav 188,216,224
Ta 208,22,32768
Maav 188,220,228
Maav 172,220,196
Ta 210,22,36864
Maav 172,216,192
Lv 240,7,56,45,0
Maav 156,216,160
Ta 212,22,40960
Maav 156,220,164
Maav 140,220,132
Ta 214,22,45056
Maav 140,216,128
s_waitcnt lgkmcnt(8)
Mvav 64,192,128
Ta 216,23,32768
Mvav 64,196,132
Mvav 80,196,164
Ta 218,23,36864
Mvav 80,192,160
Lv 244,7,56,45,1024
Mvav 96,192,192
Ta 220,23,40960
Mvav 96,196,196
Mvav 112,196,228
Ta 222,23,45056
Mvav 112,192,224
s_waitcnt lgkmcnt(8)
Mvav 116,200,224
s_cmp_le_u32 s72, 1
s_addc_u32 s45, 1, 0
s_lshl_b32 s45, s45, 13
s_add_u32 s45, s45, 0x1800
s_add_u32 s45, s45, s48
Ta 192,8,32768
Mvav 116,204,228
Mvav 100,204,196
Ta 194,8,36864
Mvav 100,200,192
Lv 152,4,56,45,0
Mvav 84,200,160
Ta 196,8,40960
Mvav 84,204,164
Mvav 68,204,132
Ta 198,8,45056
Mvav 68,200,128
s_waitcnt lgkmcnt(8)
Mvav 72,208,128
Ta 200,9,32768
Mvav 72,212,132
Mvav 88,212,164
Ta 202,9,36864
Mvav 88,208,160
Lv 156,4,56,45,1024
Mvav 104,208,192
Ta 204,9,40960
Mvav 104,212,196
Mvav 120,212,228
Ta 206,9,45056
Mvav 120,208,224
s_waitcnt lgkmcnt(8)
Mvav 124,216,224
Ta 208,10,32768
Mvav 124,220,228
Mvav 108,220,196
Ta 210,10,36864
Mvav 108,216,192
Lv 184,5,56,45,0
Mvav 92,216,160
Ta 212,10,40960
Mvav 92,220,164
Mvav 76,220,132
Ta 214,10,45056
Mvav 76,216,128
s_waitcnt vmcnt(27) lgkmcnt(8)
Maav 128,192,136
Ta 216,11,32768
Maav 128,196,140
Maav 144,196,172
Ta 218,11,36864
Maav 144,192,168
Lv 188,5,56,45,1024
Maav 160,192,200
Ta 220,11,40960
Maav 160,196,204
Maav 176,196,236
Ta 222,11,45056
Maav 176,192,232
s_waitcnt lgkmcnt(8)
Maav 180,200,232
Ta 192,12,32768
Maav 180,204,236
Maav 164,204,204
Ta 194,12,36864
Maav 164,200,200
Lv 216,6,56,45,0
Maav 148,200,168
Ta 196,12,40960
Maav 148,204,172
Maav 132,204,140
Ta 198,12,45056
Maav 132,200,136
s_waitcnt lgkmcnt(8)
Maav 136,208,136
Ta 200,13,32768
Maav 136,212,140
Maav 152,212,172
Ta 202,13,36864
Maav 152,208,168
Lv 220,6,56,45,1024
Maav 168,208,200
Ta 204,13,40960
Maav 168,212,204
Maav 184,212,236
Ta 206,13,45056
Maav 184,208,232
s_waitcnt lgkmcnt(8)
Maav 188,216,232
Ta 208,14,32768
Maav 188,220,236
Maav 172,220,204
Ta 210,14,36864
Maav 172,216,200
Lv 248,7,56,45,0
Maav 156,216,168
Ta 212,14,40960
Maav 156,220,172
Maav 140,220,140
Ta 214,14,45056
Maav 140,216,136
s_waitcnt lgkmcnt(8)
Mvav 64,192,136
Ta 216,15,32768
Mvav 64,196,140
Mvav 80,196,172
Ta 218,15,36864
Mvav 80,192,168
Lv 252,7,56,45,1024
Mvav 96,192,200
Ta 220,15,40960
Mvav 96,196,204
Mvav 112,196,236
Ta 222,15,45056
Mvav 112,192,232
s_barrier
s_waitcnt lgkmcnt(8)
Mvav 116,200,232
s_cmp_le_u32 s72, 2
s_addc_u32 s45, 2, 0
s_lshl_b32 s45, s45, 13
s_add_u32 s45, s45, 0x1000
s_add_u32 s45, s45, s48
Ta 192,16,49152
Mvav 116,204,236
Mvav 100,204,204
Ta 194,16,53248
Mvav 100,200,200
La 0,4,56,45,0
Mvav 84,200,168
Ta 196,16,57344
Mvav 84,204,172
Mvav 68,204,140
Ta 198,16,61440
Mvav 68,200,136
s_waitcnt lgkmcnt(8)
Mvav 72,208,136
Ta 200,17,49152
Mvav 72,212,140
Mvav 88,212,172
Ta 202,17,53248
Mvav 88,208,168
La 4,4,56,45,1024
Mvav 104,208,200
Ta 204,17,57344
Mvav 104,212,204
Mvav 120,212,236
Ta 206,17,61440
Mvav 120,208,232
s_waitcnt lgkmcnt(8)
Mvav 124,216,232
Ta 208,18,49152
Mvav 124,220,236
Mvav 108,220,204
Ta 210,18,53248
Mvav 108,216,200
La 16,5,56,45,0
Mvav 92,216,168
Ta 212,18,57344
Mvav 92,220,172
Mvav 76,220,140
Ta 214,18,61440
Mvav 76,216,136
s_waitcnt vmcnt(27) lgkmcnt(8)
Maaa 128,192,64
Ta 216,19,49152
Maaa 128,196,68
Maaa 144,196,84
Ta 218,19,53248
Maaa 144,192,80
La 20,5,56,45,1024
Maaa 160,192,96
Ta 220,19,57344
Maaa 160,196,100
Maaa 176,196,116
Ta 222,19,61440
Maaa 176,192,112
s_waitcnt lgkmcnt(8)
Maaa 180,200,112
Ta 192,20,49152
Maaa 180,204,116
Maaa 164,204,100
Ta 194,20,53248
Maaa 164,200,96
La 32,6,56,45,0
Maaa 148,200,80
Ta 196,20,57344
Maaa 148,204,84
Maaa 132,204,68
Ta 198,20,61440
Maaa 132,200,64
s_waitcnt lgkmcnt(8)
Maaa 136,208,64
Ta 200,21,49152
Maaa 136,212,68
Maaa 152,212,84
Ta 202,21,53248
Maaa 152,208,80
La 36,6,56,45,1024
Maaa 168,208,96
Ta 204,21,57344
Maaa 168,212,100
Maaa 184,212,116
Ta 206,21,61440
Maaa 184,208,112
s_waitcnt lgkmcnt(8)
Maaa 188,216,112
Ta 208,22,49152
Maaa 188,220,116
Maaa 172,220,100
Ta 210,22,53248
Maaa 172,216,96
La 48,7,56,45,0
Maaa 156,216,80
Ta 212,22,57344
Maaa 156,220,84
Maaa 140,220,68
Ta 214,22,61440
Maaa 140,216,64
s_waitcnt lgkmcnt(8)
Mvaa 64,192,64
Ta 216,23,49152
Mvaa 64,196,68
Mvaa 80,196,84
Ta 218,23,53248
Mvaa 80,192,80
La 52,7,56,45,1024
Mvaa 96,192,96
Ta 220,23,57344
Mvaa 96,196,100
Mvaa 112,196,116
Ta 222,23,61440
Mvaa 112,192,112
s_waitcnt lgkmcnt(8)
Mvaa 116,200,112
s_cmp_le_u32 s72, 2
s_addc_u32 s45, 2, 0
s_lshl_b32 s45, s45, 13
s_add_u32 s45, s45, 0x1800
s_add_u32 s45, s45, s48
Ta 192,8,49152
Mvaa 116,204,116
Mvaa 100,204,100
Ta 194,8,53248
Mvaa 100,200,96
La 8,4,56,45,0
Mvaa 84,200,80
Ta 196,8,57344
Mvaa 84,204,84
Mvaa 68,204,68
Ta 198,8,61440
Mvaa 68,200,64
s_waitcnt lgkmcnt(8)
Mvaa 72,208,64
Ta 200,9,49152
Mvaa 72,212,68
Mvaa 88,212,84
Ta 202,9,53248
Mvaa 88,208,80
La 12,4,56,45,1024
Mvaa 104,208,96
Ta 204,9,57344
Mvaa 104,212,100
Mvaa 120,212,116
Ta 206,9,61440
Mvaa 120,208,112
s_waitcnt lgkmcnt(8)
Mvaa 124,216,112
Ta 208,10,49152
Mvaa 124,220,116
Mvaa 108,220,100
Ta 210,10,53248
Mvaa 108,216,96
La 24,5,56,45,0
Mvaa 92,216,80
Ta 212,10,57344
Mvaa 92,220,84
Mvaa 76,220,68
Ta 214,10,61440
Mvaa 76,216,64
s_waitcnt vmcnt(27) lgkmcnt(8)
Maaa 128,192,72
Ta 216,11,49152
Maaa 128,196,76
Maaa 144,196,92
Ta 218,11,53248
Maaa 144,192,88
La 28,5,56,45,1024
Maaa 160,192,104
Ta 220,11,57344
Maaa 160,196,108
Maaa 176,196,124
Ta 222,11,61440
Maaa 176,192,120
s_waitcnt lgkmcnt(8)
Maaa 180,200,120
Ta 192,12,49152
Maaa 180,204,124
Maaa 164,204,108
Ta 194,12,53248
Maaa 164,200,104
La 40,6,56,45,0
Maaa 148,200,88
Ta 196,12,57344
Maaa 148,204,92
Maaa 132,204,76
Ta 198,12,61440
Maaa 132,200,72
s_waitcnt lgkmcnt(8)
Maaa 136,208,72
Ta 200,13,49152
Maaa 136,212,76
Maaa 152,212,92
Ta 202,13,53248
Maaa 152,208,88
La 44,6,56,45,1024
Maaa 168,208,104
Ta 204,13,57344
Maaa 168,212,108
Maaa 184,212,124
Ta 206,13,61440
Maaa 184,208,120
s_waitcnt lgkmcnt(8)
Maaa 188,216,120
Ta 208,14,49152
Maaa 188,220,124
Maaa 172,220,108
Ta 210,14,53248
Maaa 172,216,104
La 56,7,56,45,0
Maaa 156,216,88
Ta 212,14,57344
Maaa 156,220,92
Maaa 140,220,76
Ta 214,14,61440
Maaa 140,216,72
s_waitcnt lgkmcnt(8)
Mvaa 64,192,72
Ta 216,15,49152
Mvaa 64,196,76
Mvaa 80,196,92
Ta 218,15,53248
Mvaa 80,192,88
La 60,7,56,45,1024
Mvaa 96,192,104
Ta 220,15,57344
Mvaa 96,196,108
Mvaa 112,196,124
Ta 222,15,61440
Mvaa 112,192,120
s_barrier
s_waitcnt lgkmcnt(8)
Mvaa 116,200,120
s_cmp_le_u32 s72, 3
s_addc_u32 s45, 3, 0
s_lshl_b32 s45, s45, 13
s_add_u32 s45, s45, 0x1000
s_add_u32 s45, s45, s48
Ta 192,24,0
Mvaa 116,204,124
Mvaa 100,204,108
Ta 194,24,4096
Mvaa 100,200,104
Lv 128,4,56,45,0
Mvaa 84,200,88
Ta 196,24,8192
Mvaa 84,204,92
Mvaa 68,204,76
Ta 198,24,12288
Mvaa 68,200,72
s_waitcnt lgkmcnt(8)
Mvaa 72,208,72
Ta 200,25,0
Mvaa 72,212,76
Mvaa 88,212,92
Ta 202,25,4096
Mvaa 88,208,88
Lv 132,4,56,45,1024
Mvaa 104,208,104
Ta 204,25,8192
Mvaa 104,212,108
Mvaa 120,212,124
Ta 206,25,12288
Mvaa 120,208,120
s_waitcnt lgkmcnt(8)
Mvaa 124,216,120
Ta 208,26,0
Mvaa 124,220,124
Mvaa 108,220,108
Ta 210,26,4096
Mvaa 108,216,104
Lv 160,5,56,45,0
Mvaa 92,216,88
Ta 212,26,8192
Mvaa 92,220,92
Mvaa 76,220,76
Ta 214,26,12288
Mvaa 76,216,72
s_waitcnt vmcnt(27) lgkmcnt(8)
Maav 128,192,144
Ta 216,27,0
Maav 128,196,148
Maav 144,196,180
Ta 218,27,4096
Maav 144,192,176
Lv 164,5,56,45,1024
Maav 160,192,208
Ta 220,27,8192
Maav 160,196,212
Maav 176,196,244
Ta 222,27,12288
Maav 176,192,240
s_waitcnt lgkmcnt(8)
Maav 180,200,240
Ta 192,28,0
Maav 180,204,244
Maav 164,204,212
Ta 194,28,4096
Maav 164,200,208
Lv 192,6,56,45,0
Maav 148,200,176
Ta 196,28,8192
Maav 148,204,180
Maav 132,204,148
Ta 198,28,12288
Maav 132,200,144
s_waitcnt lgkmcnt(8)
Maav 136,208,144
Ta 200,29,0
Maav 136,212,148
Maav 152,212,180
Ta 202,29,4096
Maav 152,208,176
Lv 196,6,56,45,1024
Maav 168,208,208
Ta 204,29,8192
Maav 168,212,212
Maav 184,212,244
Ta 206,29,12288
Maav 184,208,240
s_waitcnt lgkmcnt(8)
Maav 188,216,240
Ta 208,30,0
Maav 188,220,244
Maav 172,220,212
Ta 210,30,4096
Maav 172,216,208
Lv 224,7,56,45,0
Maav 156,216,176
Ta 212,30,8192
Maav 156,220,180
Maav 140,220,148
Ta 214,30,12288
Maav 140,216,144
s_waitcnt lgkmcnt(8)
Mvav 64,192,144
Ta 216,31,0
Mvav 64,196,148
Mvav 80,196,180
Ta 218,31,4096
Mvav 80,192,176
Lv 228,7,56,45,1024
Mvav 96,192,208
Ta 220,31,8192
Mvav 96,196,212
Mvav 112,196,244
Ta 222,31,12288
Mvav 112,192,240
s_waitcnt lgkmcnt(8)
Mvav 116,200,240
s_cmp_le_u32 s72, 3
s_addc_u32 s45, 3, 0
s_lshl_b32 s45, s45, 13
s_add_u32 s45, s45, 0x1800
s_add_u32 s45, s45, s48
Ta 192,24,16384
Mvav 116,204,244
Lv 136,4,56,45,0
Mvav 100,204,212
Ta 194,24,20480
Mvav 100,200,208
Lv 140,4,56,45,1024
Mvav 84,200,176
Ta 196,24,24576
Mvav 84,204,180
Mvav 68,204,148
Ta 198,24,28672
Mvav 68,200,144
s_waitcnt lgkmcnt(8)
Mvav 72,208,144
Ta 200,25,16384
Mvav 72,212,148
Lv 168,5,56,45,0
Mvav 88,212,180
Ta 202,25,20480
Mvav 88,208,176
Lv 172,5,56,45,1024
Mvav 104,208,208
Ta 204,25,24576
Mvav 104,212,212
Mvav 120,212,244
Ta 206,25,28672
Mvav 120,208,240
s_waitcnt lgkmcnt(8)
Mvav 124,216,240
Ta 208,26,16384
Mvav 124,220,244
Lv 200,6,56,45,0
Mvav 108,220,212
Ta 210,26,20480
Mvav 108,216,208
Lv 204,6,56,45,1024
Mvav 92,216,176
Ta 212,26,24576
Mvav 92,220,180
Mvav 76,220,148
Ta 214,26,28672
Mvav 76,216,144
s_waitcnt vmcnt(30) lgkmcnt(8)
Maav 128,192,152
Ta 216,27,16384
Maav 128,196,156
Lv 232,7,56,45,0
Maav 144,196,188
Ta 218,27,20480
Maav 144,192,184
Lv 236,7,56,45,1024
Maav 160,192,216
Ta 220,27,24576
Maav 160,196,220
Maav 176,196,252
Ta 222,27,28672
Maav 176,192,248
s_waitcnt lgkmcnt(8)
Maav 180,200,248
s_cmp_le_u32 s72, 4
s_addc_u32 s45, 4, 0
s_lshl_b32 s45, s45, 13
s_add_u32 s45, s45, 0x1000
s_add_u32 s45, s45, s48
Ta 192,28,16384
Maav 180,204,252
La 64,4,56,45,0
Maav 164,204,220
Ta 194,28,20480
Maav 164,200,216
La 68,4,56,45,1024
Maav 148,200,184
Ta 196,28,24576
Maav 148,204,188
Maav 132,204,156
Ta 198,28,28672
Maav 132,200,152
s_waitcnt lgkmcnt(8)
Maav 136,208,152
Ta 200,29,16384
Maav 136,212,156
La 80,5,56,45,0
Maav 152,212,188
Ta 202,29,20480
Maav 152,208,184
La 84,5,56,45,1024
Maav 168,208,216
Ta 204,29,24576
Maav 168,212,220
Maav 184,212,252
Ta 206,29,28672
Maav 184,208,248
s_waitcnt lgkmcnt(8)
Maav 188,216,248
Ta 208,30,16384
Maav 188,220,252
La 96,6,56,45,0
Maav 172,220,220
Ta 210,30,20480
Maav 172,216,216
La 100,6,56,45,1024
Maav 156,216,184
Ta 212,30,24576
Maav 156,220,188
Maav 140,220,156
Ta 214,30,28672
Maav 140,216,152
s_waitcnt lgkmcnt(8)
Mvav 64,192,152
Ta 216,31,16384
Mvav 64,196,156
La 112,7,56,45,0
Mvav 80,196,188
Ta 218,31,20480
Mvav 80,192,184
La 116,7,56,45,1024
Mvav 96,192,216
Ta 220,31,24576
Mvav 96,196,220
Mvav 112,196,252
Ta 222,31,28672
Mvav 112,192,248
s_barrier
s_waitcnt lgkmcnt(8)
Mvav 116,200,248
s_cmp_le_u32 s72, 4
s_addc_u32 s45, 4, 0
s_lshl_b32 s45, s45, 13
s_add_u32 s45, s45, 0x1800
s_add_u32 s45, s45, s48
Ta 192,16,0
Mvav 116,204,252
La 72,4,56,45,0
Mvav 100,204,220
Ta 194,16,4096
Mvav 100,200,216
La 76,4,56,45,1024
Mvav 84,200,184
Ta 196,16,8192
Mvav 84,204,188
Mvav 68,204,156
Ta 198,16,12288
Mvav 68,200,152
s_waitcnt lgkmcnt(8)
Mvav 72,208,152
Ta 200,17,0
Mvav 72,212,156
La 88,5,56,45,0
Mvav 88,212,188
Ta 202,17,4096
Mvav 88,208,184
La 92,5,56,45,1024
Mvav 104,208,216
Ta 204,17,8192
Mvav 104,212,220
Mvav 120,212,252
Ta 206,17,12288
Mvav 120,208,248
s_waitcnt lgkmcnt(8)
Mvav 124,216,248
Ta 208,18,0
Mvav 124,220,252
La 104,6,56,45,0
Mvav 108,220,220
Ta 210,18,4096
Mvav 108,216,216
La 108,6,56,45,1024
Mvav 92,216,184
Ta 212,18,8192
Mvav 92,220,188
Mvav 76,220,156
Ta 214,18,12288
Mvav 76,216,152
s_waitcnt vmcnt(38) lgkmcnt(8)
Maaa 128,192,0
Ta 216,19,0
Maaa 128,196,4
La 120,7,56,45,0
Maaa 144,196,20
Ta 218,19,4096
Maaa 144,192,16
La 124,7,56,45,1024
Maaa 160,192,32
Ta 220,19,8192
Maaa 160,196,36
Maaa 176,196,52
Ta 222,19,12288
Maaa 176,192,48
s_waitcnt lgkmcnt(8)
Maaa 180,200,48
s_cmp_le_u32 s72, 5
s_addc_u32 s45, 5, 0
s_lshl_b32 s45, s45, 13
s_add_u32 s45, s45, 0x1000
s_add_u32 s45, s45, s48
Ta 192,20,0
Maaa 180,204,52
Lv 144,4,56,45,0
Maaa 164,204,36
Ta 194,20,4096
Maaa 164,200,32
Lv 148,4,56,45,1024
Maaa 148,200,16
Ta 196,20,8192
Maaa 148,204,20
Maaa 132,204,4
Ta 198,20,12288
Maaa 132,200,0
s_waitcnt lgkmcnt(8)
Maaa 136,208,0
Ta 200,21,0
Maaa 136,212,4
Lv 176,5,56,45,0
Maaa 152,212,20
Ta 202,21,4096
Maaa 152,208,16
Lv 180,5,56,45,1024
Maaa 168,208,32
Ta 204,21,8192
Maaa 168,212,36
Maaa 184,212,52
Ta 206,21,12288
Maaa 184,208,48
s_waitcnt lgkmcnt(8)
Maaa 188,216,48
Ta 208,22,0
Maaa 188,220,52
Lv 208,6,56,45,0
Maaa 172,220,36
Ta 210,22,4096
Maaa 172,216,32
Lv 212,6,56,45,1024
Maaa 156,216,16
Ta 212,22,8192
Maaa 156,220,20
Maaa 140,220,4
Ta 214,22,12288
Maaa 140,216,0
s_waitcnt lgkmcnt(8)
Mvaa 64,192,0
Ta 216,23,0
Mvaa 64,196,4
Lv 240,7,56,45,0
Mvaa 80,196,20
Ta 218,23,4096
Mvaa 80,192,16
Lv 244,7,56,45,1024
Mvaa 96,192,32
Ta 220,23,8192
Mvaa 96,196,36
Mvaa 112,196,52
Ta 222,23,12288
Mvaa 112,192,48
s_waitcnt lgkmcnt(8)
Mvaa 116,200,48
s_cmp_le_u32 s72, 5
s_addc_u32 s45, 5, 0
s_lshl_b32 s45, s45, 13
s_add_u32 s45, s45, 0x1800
s_add_u32 s45, s45, s48
Ta 192,8,0
Mvaa 116,204,52
Lv 152,4,56,45,0
Mvaa 100,204,36
Ta 194,8,4096
Mvaa 100,200,32
Lv 156,4,56,45,1024
Mvaa 84,200,16
Ta 196,8,8192
Mvaa 84,204,20
Mvaa 68,204,4
Ta 198,8,12288
Mvaa 68,200,0
s_waitcnt lgkmcnt(8)
Mvaa 72,208,0
Ta 200,9,0
Mvaa 72,212,4
Lv 184,5,56,45,0
Mvaa 88,212,20
Ta 202,9,4096
Mvaa 88,208,16
Lv 188,5,56,45,1024
Mvaa 104,208,32
Ta 204,9,8192
Mvaa 104,212,36
Mvaa 120,212,52
Ta 206,9,12288
Mvaa 120,208,48
s_waitcnt lgkmcnt(8)
Mvaa 124,216,48
Ta 208,10,0
Mvaa 124,220,52
Lv 216,6,56,45,0
Mvaa 108,220,36
Ta 210,10,4096
Mvaa 108,216,32
Lv 220,6,56,45,1024
Mvaa 92,216,16
Ta 212,10,8192
Mvaa 92,220,20
Mvaa 76,220,4
Ta 214,10,12288
Mvaa 76,216,0
s_waitcnt vmcnt(46) lgkmcnt(8)
Maaa 128,192,8
Ta 216,11,0
Maaa 128,196,12
Lv 248,7,56,45,0
Maaa 144,196,28
Ta 218,11,4096
Maaa 144,192,24
Lv 252,7,56,45,1024
Maaa 160,192,40
Ta 220,11,8192
Maaa 160,196,44
Maaa 176,196,60
Ta 222,11,12288
Maaa 176,192,56
s_waitcnt lgkmcnt(8)
Maaa 180,200,56
s_cmp_le_u32 s72, 6
s_addc_u32 s45, 6, 0
s_lshl_b32 s45, s45, 13
s_add_u32 s45, s45, 0x1000
s_add_u32 s45, s45, s48
Ta 192,12,0
Maaa 180,204,60
La 0,4,56,45,0
Maaa 164,204,44
Ta 194,12,4096
Maaa 164,200,40
La 4,4,56,45,1024
Maaa 148,200,24
Ta 196,12,8192
Maaa 148,204,28
Maaa 132,204,12
Ta 198,12,12288
Maaa 132,200,8
s_waitcnt lgkmcnt(8)
Maaa 136,208,8
Ta 200,13,0
Maaa 136,212,12
La 16,5,56,45,0
Maaa 152,212,28
Ta 202,13,4096
Maaa 152,208,24
La 20,5,56,45,1024
Maaa 168,208,40
Ta 204,13,8192
Maaa 168,212,44
Maaa 184,212,60
Ta 206,13,12288
Maaa 184,208,56
s_waitcnt lgkmcnt(8)
Maaa 188,216,56
Ta 208,14,0
Maaa 188,220,60
La 32,6,56,45,0
Maaa 172,220,44
Ta 210,14,4096
Maaa 172,216,40
La 36,6,56,45,1024
Maaa 156,216,24
Ta 212,14,8192
Maaa 156,220,28
Maaa 140,220,12
Ta 214,14,12288
Maaa 140,216,8
s_waitcnt lgkmcnt(8)
Mvaa 64,192,8
Ta 216,15,0
Mvaa 64,196,12
La 48,7,56,45,0
Mvaa 80,196,28
Ta 218,15,4096
Mvaa 80,192,24
La 52,7,56,45,1024
Mvaa 96,192,40
Ta 220,15,8192
Mvaa 96,196,44
Mvaa 112,196,60
Ta 222,15,12288
Mvaa 112,192,56
s_barrier
s_waitcnt lgkmcnt(8)
Mvaa 116,200,56
Ta 192,16,16384
Mvaa 116,204,60
Mvaa 100,204,44
Ta 194,16,20480
Mvaa 100,200,40
Mvaa 84,200,24
Ta 196,16,24576
Mvaa 84,204,28
Mvaa 68,204,12
Ta 198,16,28672
Mvaa 68,200,8
s_waitcnt lgkmcnt(8)
Mvaa 72,208,8
Ta 200,17,16384
Mvaa 72,212,12
Mvaa 88,212,28
Ta 202,17,20480
Mvaa 88,208,24
Mvaa 104,208,40
Ta 204,17,24576
Mvaa 104,212,44
Mvaa 120,212,60
Ta 206,17,28672
Mvaa 120,208,56
s_waitcnt lgkmcnt(8)
Mvaa 124,216,56
Ta 208,18,16384
Mvaa 124,220,60
Mvaa 108,220,44
Ta 210,18,20480
Mvaa 108,216,40
Mvaa 92,216,24
Ta 212,18,24576
Mvaa 92,220,28
Mvaa 76,220,12
Ta 214,18,28672
Mvaa 76,216,8
s_waitcnt vmcnt(48) lgkmcnt(8)
Maav 128,192,128
s_cmp_le_u32 s72, 6
s_addc_u32 s45, 6, 0
s_lshl_b32 s45, s45, 13
s_add_u32 s45, s45, 0x1800
s_add_u32 s45, s45, s48
Ta 216,19,16384
Maav 128,196,132
Maav 144,196,164
Ta 218,19,20480
Maav 144,192,160
La 8,4,56,45,0
Maav 160,192,192
Ta 220,19,24576
Maav 160,196,196
Maav 176,196,228
Ta 222,19,28672
La 12,4,56,45,1024
Maav 176,192,224
s_waitcnt lgkmcnt(8)
Maav 180,200,224
Ta 192,8,16384
Maav 180,204,228
Maav 164,204,196
Ta 194,8,20480
Maav 164,200,192
La 24,5,56,45,0
Maav 148,200,160
Ta 196,8,24576
Maav 148,204,164
Maav 132,204,132
Ta 198,8,28672
La 28,5,56,45,1024
Maav 132,200,128
s_waitcnt lgkmcnt(8)
Maav 136,208,128
Ta 200,9,16384
Maav 136,212,132
Maav 152,212,164
Ta 202,9,20480
Maav 152,208,160
La 40,6,56,45,0
Maav 168,208,192
Ta 204,9,24576
Maav 168,212,196
Maav 184,212,228
Ta 206,9,28672
Maav 184,208,224
s_waitcnt lgkmcnt(8)
Maav 188,216,224
Ta 208,10,16384
Maav 188,220,228
Maav 172,220,196
Ta 210,10,20480
Maav 172,216,192
La 44,6,56,45,1024
Maav 156,216,160
Ta 212,10,24576
Maav 156,220,164
Maav 140,220,132
Ta 214,10,28672
La 56,7,56,45,0
Maav 140,216,128
s_waitcnt vmcnt(47) lgkmcnt(8)
Maav 128,192,136
Ta 216,11,16384
Maav 128,196,140
Maav 144,196,172
Ta 218,11,20480
Maav 144,192,168
La 60,7,56,45,1024
Maav 160,192,200
Ta 220,11,24576
Maav 160,196,204
Maav 176,196,236
Ta 222,11,28672
Maav 176,192,232
s_waitcnt lgkmcnt(8)
Maav 180,200,232
Ta 192,16,32768
Maav 180,204,236
Maav 164,204,204
Ta 194,16,36864
Maav 164,200,200
Maav 148,200,168
Ta 196,16,40960
Maav 148,204,172
Maav 132,204,140
Ta 198,16,45056
Maav 132,200,136
s_waitcnt lgkmcnt(8)
Maav 136,208,136
Ta 200,17,32768
Maav 136,212,140
Maav 152,212,172
Ta 202,17,36864
Maav 152,208,168
Maav 168,208,200
Ta 204,17,40960
Maav 168,212,204
Maav 184,212,236
Ta 206,17,45056
Maav 184,208,232
s_waitcnt lgkmcnt(8)
Maav 188,216,232
Ta 208,18,32768
Maav 188,220,236
Maav 172,220,204
Ta 210,18,36864
Maav 172,216,200
Maav 156,216,168
Ta 212,18,40960
Maav 156,220,172
Maav 140,220,140
Ta 214,18,45056
Maav 140,216,136
s_waitcnt vmcnt(40) lgkmcnt(8)
Maaa 128,192,64
Ta 216,19,32768
Maaa 128,196,68
Maaa 144,196,84
Ta 218,19,36864
Maaa 144,192,80
Maaa 160,192,96
Ta 220,19,40960
Maaa 160,196,100
Maaa 176,196,116
Ta 222,19,45056
Maaa 176,192,112
s_waitcnt lgkmcnt(8)
Maaa 180,200,112
Ta 192,8,32768
Maaa 180,204,116
Maaa 164,204,100
Ta 194,8,36864
Maaa 164,200,96
Maaa 148,200,80
Ta 196,8,40960
Maaa 148,204,84
Maaa 132,204,68
Ta 198,8,45056
Maaa 132,200,64
s_waitcnt lgkmcnt(8)
Maaa 136,208,64
Ta 200,9,32768
Maaa 136,212,68
Maaa 152,212,84
Ta 202,9,36864
Maaa 152,208,80
Maaa 168,208,96
Ta 204,9,40960
Maaa 168,212,100
Maaa 184,212,116
Ta 206,9,45056
Maaa 184,208,112
s_waitcnt lgkmcnt(8)
Maaa 188,216,112
Ta 208,10,32768
Maaa 188,220,116
Maaa 172,220,100
Ta 210,10,36864
Maaa 172,216,96
Maaa 156,216,80
Ta 212,10,40960
Maaa 156,220,84
Maaa 140,220,68
Ta 214,10,45056
Maaa 140,216,64
s_waitcnt vmcnt(32) lgkmcnt(8)
Maaa 128,192,72
Ta 216,11,32768
Maaa 128,196,76
Maaa 144,196,92
Ta 218,11,36864
Maaa 144,192,88
Maaa 160,192,104
Ta 220,11,40960
Maaa 160,196,108
Maaa 176,196,124
Ta 222,11,45056
Maaa 176,192,120
s_barrier
s_waitcnt lgkmcnt(8)
Maaa 180,200,120
Ta 192,16,49152
Maaa 180,204,124
Maaa 164,204,108
Ta 194,16,53248
Maaa 164,200,104
Maaa 148,200,88
Ta 196,16,57344
Maaa 148,204,92
Maaa 132,204,76
Ta 198,16,61440
Maaa 132,200,72
s_waitcnt lgkmcnt(8)
Maaa 136,208,72
Ta 200,17,49152
Maaa 136,212,76
Maaa 152,212,92
Ta 202,17,53248
Maaa 152,208,88
Maaa 168,208,104
Ta 204,17,57344
Maaa 168,212,108
Maaa 184,212,124
Ta 206,17,61440
Maaa 184,208,120
s_waitcnt lgkmcnt(8)
Maaa 188,216,120
Ta 208,18,49152
Maaa 188,220,124
Maaa 172,220,108
Ta 210,18,53248
Maaa 172,216,104
Maaa 156,216,88
Ta 212,18,57344
Maaa 156,220,92
Maaa 140,220,76
Ta 214,18,61440
Maaa 140,216,72
s_waitcnt vmcnt(24) lgkmcnt(8)
Maav 128,192,144
Ta 216,19,49152
Maav 128,196,148
Maav 144,196,180
Ta 218,19,53248
Maav 144,192,176
Maav 160,192,208
Ta 220,19,57344
Maav 160,196,212
Maav 176,196,244
Ta 222,19,61440
Maav 176,192,240
s_waitcnt lgkmcnt(8)
Maav 180,200,240
Ta 192,8,49152
Maav 180,204,244
Maav 164,204,212
Ta 194,8,53248
Maav 164,200,208
Maav 148,200,176
Ta 196,8,57344
Maav 148,204,180
Maav 132,204,148
Ta 198,8,61440
Maav 132,200,144
s_waitcnt lgkmcnt(8)
Maav 136,208,144
Ta 200,9,49152
Maav 136,212,148
Maav 152,212,180
Ta 202,9,53248
Maav 152,208,176
Maav 168,208,208
Ta 204,9,57344
Maav 168,212,212
Maav 184,212,244
Ta 206,9,61440
Maav 184,208,240
s_waitcnt lgkmcnt(8)
Maav 188,216,240
Ta 208,10,49152
Maav 188,220,244
Maav 172,220,212
Ta 210,10,53248
Maav 172,216,208
Maav 156,216,176
Ta 212,10,57344
Maav 156,220,180
Maav 140,220,148
Ta 214,10,61440
Maav 140,216,144
s_waitcnt vmcnt(16) lgkmcnt(8)
Maav 128,192,152
Ta 216,11,49152
Maav 128,196,156
Maav 144,196,188
Ta 218,11,53248
Maav 144,192,184
Maav 160,192,216
Ta 220,11,57344
Maav 160,196,220
Maav 176,196,252
Ta 222,11,61440
Maav 176,192,248
s_waitcnt lgkmcnt(8)
Maav 180,200,248
Ta 192,24,0
Maav 180,204,252
Maav 164,204,220
Ta 194,24,4096
Maav 164,200,216
Maav 148,200,184
Ta 196,24,8192
Maav 148,204,188
Maav 132,204,156
Ta 198,24,12288
Maav 132,200,152
s_waitcnt lgkmcnt(8)
Maav 136,208,152
Ta 200,25,0
Maav 136,212,156
Maav 152,212,188
Ta 202,25,4096
Maav 152,208,184
Maav 168,208,216
Ta 204,25,8192
Maav 168,212,220
Maav 184,212,252
Ta 206,25,12288
Maav 184,208,248
s_waitcnt lgkmcnt(8)
Maav 188,216,248
Ta 208,26,0
Maav 188,220,252
Maav 172,220,220
Ta 210,26,4096
Maav 172,216,216
Maav 156,216,184
Ta 212,26,8192
Maav 156,220,188
Maav 140,220,156
Ta 214,26,12288
Maav 140,216,152
s_waitcnt vmcnt(8) lgkmcnt(8)
Maaa 128,192,0
Ta 216,27,0
Maaa 128,196,4
Maaa 144,196,20
Ta 218,27,4096
Maaa 144,192,16
Maaa 160,192,32
Ta 220,27,8192
Maaa 160,196,36
Maaa 176,196,52
Ta 222,27,12288
Maaa 176,192,48
s_waitcnt lgkmcnt(8)
Maaa 180,200,48
Ta 192,24,16384
Maaa 180,204,52
Maaa 164,204,36
Ta 194,24,20480
Maaa 164,200,32
Maaa 148,200,16
Ta 196,24,24576
Maaa 148,204,20
Maaa 132,204,4
Ta 198,24,28672
Maaa 132,200,0
s_waitcnt lgkmcnt(8)
Maaa 136,208,0
Ta 200,25,16384
Maaa 136,212,4
Maaa 152,212,20
Ta 202,25,20480
Maaa 152,208,16
Maaa 168,208,32
Ta 204,25,24576
Maaa 168,212,36
Maaa 184,212,52
Ta 206,25,28672
Maaa 184,208,48
s_waitcnt lgkmcnt(8)
Maaa 188,216,48
Ta 208,26,16384
Maaa 188,220,52
Maaa 172,220,36
Ta 210,26,20480
Maaa 172,216,32
Maaa 156,216,16
Ta 212,26,24576
Maaa 156,220,20
Maaa 140,220,4
Ta 214,26,28672
Maaa 140,216,0
s_waitcnt vmcnt(0) lgkmcnt(8)
Maaa 128,192,8
s_add_u32 s37, s51, 4096
Ta 216,27,16384
Maaa 128,196,12
Maaa 144,196,28
Ta 218,27,20480
Maaa 144,192,24
Maaa 160,192,40
Ta 220,27,24576
Maaa 160,196,44
Maaa 176,196,60
Ta 222,27,28672
Maaa 176,192,56
s_waitcnt lgkmcnt(8)
Maaa 180,200,56
Ta 192,20,16384
Maaa 180,204,60
Maaa 164,204,44
Ta 194,20,20480
Maaa 164,200,40
Maaa 148,200,24
Ta 196,20,24576
Maaa 148,204,28
Maaa 132,204,12
Ta 198,20,28672
Maaa 132,200,8
s_waitcnt lgkmcnt(8)
Maaa 136,208,8
Ta 200,21,16384
Maaa 136,212,12
Maaa 152,212,28
Ta 202,21,20480
Maaa 152,208,24
Maaa 168,208,40
Ta 204,21,24576
Maaa 168,212,44
Maaa 184,212,60
Ta 206,21,28672
Maaa 184,208,56
s_waitcnt lgkmcnt(8)
Maaa 188,216,56
Ta 208,22,16384
Maaa 188,220,60
AR 40,128
AR 41,129
Maaa 172,220,44
Ta 210,22,20480
AR 42,130
AR 43,131
Maaa 172,216,40
AR 44,132
AR 45,133
Maaa 156,216,24
Ta 212,22,24576
AR 46,134
AR 47,135
Maaa 156,220,28
CV 48,40
CV 49,42
Maaa 140,220,12
Ta 214,22,28672
CV 50,44
CV 51,46
Maaa 140,216,8
s_waitcnt lgkmcnt(8)
v_min_u32 v48, -2, v48
v_min_u32 v49, -2, v49
Mvav 64,192,128
Ta 216,23,16384
v_min_u32 v50, -2, v50
v_min_u32 v51, -2, v51
Mvav 64,196,132
buffer_store_dwordx4 v[48:51], v1, s[60:63], s51 offen sc1
Mvav 80,196,164
Ta 218,23,20480
AR 40,144
AR 41,145
Mvav 80,192,160
AR 42,146
AR 43,147
Mvav 96,192,192
Ta 220,23,24576
AR 44,148
AR 45,149
Mvav 96,196,196
AR 46,150
AR 47,151
Mvav 112,196,228
Ta 222,23,28672
CV 52,40
CV 53,42
Mvav 112,192,224
s_waitcnt lgkmcnt(8)
CV 54,44
CV 55,46
Mvav 116,200,224
Ta 192,12,16384
v_min_u32 v52, -2, v52
v_min_u32 v53, -2, v53
Mvav 116,204,228
v_min_u32 v54, -2, v54
v_min_u32 v55, -2, v55
Mvav 100,204,196
Ta 194,12,20480
buffer_store_dwordx4 v[52:55], v1, s[60:63], s51 offen offset:2048 sc1
Mvav 100,200,192
AR 40,160
AR 41,161
Mvav 84,200,160
Ta 196,12,24576
AR 42,162
AR 43,163
Mvav 84,204,164
AR 44,164
AR 45,165
Mvav 68,204,132
Ta 198,12,28672
AR 46,166
AR 47,167
Mvav 68,200,128
s_waitcnt lgkmcnt(8)
CV 48,40
CV 49,42
Mvav 72,208,128
Ta 200,13,16384
CV 50,44
CV 51,46
Mvav 72,212,132
v_min_u32 v48, -2, v48
v_min_u32 v49, -2, v49
Mvav 88,212,164
Ta 202,13,20480
v_min_u32 v50, -2, v50
v_min_u32 v51, -2, v51
Mvav 88,208,160
buffer_store_dwordx4 v[48:51], v1, s[60:63], s37 offen sc1
Mvav 104,208,192
Ta 204,13,24576
AR 40,176
AR 41,177
Mvav 104,212,196
AR 42,178
AR 43,179
Mvav 120,212,228
Ta 206,13,28672
AR 44,180
AR 45,181
Mvav 120,208,224
s_waitcnt lgkmcnt(8)
AR 46,182
AR 47,183
Mvav 124,216,224
Ta 208,14,16384
CV 52,40
CV 53,42
Mvav 124,220,228
CV 54,44
CV 55,46
Mvav 108,220,196
Ta 210,14,20480
v_min_u32 v52, -2, v52
v_min_u32 v53, -2, v53
Mvav 108,216,192
v_min_u32 v54, -2, v54
v_min_u32 v55, -2, v55
Mvav 92,216,160
Ta 212,14,24576
buffer_store_dwordx4 v[52:55], v1, s[60:63], s37 offen offset:2048 sc1
Mvav 92,220,164
AR 40,136
AR 41,137
Mvav 76,220,132
Ta 214,14,28672
AR 42,138
AR 43,139
Mvav 76,216,128
s_waitcnt lgkmcnt(8)
AR 44,140
AR 45,141
Mvav 64,192,136
s_add_u32 s36, s75, 4096
Ta 216,15,16384
AR 46,142
AR 47,143
Mvav 64,196,140
CV 48,40
CV 49,42
Mvav 80,196,172
Ta 218,15,20480
CV 50,44
CV 51,46
Mvav 80,192,168
v_min_u32 v48, -2, v48
v_min_u32 v49, -2, v49
Mvav 96,192,200
Ta 220,15,24576
v_min_u32 v50, -2, v50
v_min_u32 v51, -2, v51
Mvav 96,196,204
buffer_store_dwordx4 v[48:51], v1, s[60:63], s51 offen offset:1024 sc1
Mvav 112,196,236
Ta 222,15,28672
AR 40,152
AR 41,153
Mvav 112,192,232
s_waitcnt lgkmcnt(8)
AR 42,154
AR 43,155
Mvav 116,200,232
Ta 192,20,32768
AR 44,156
AR 45,157
Mvav 116,204,236
AR 46,158
AR 47,159
Mvav 100,204,204
Ta 194,20,36864
CV 52,40
CV 53,42
Mvav 100,200,200
CV 54,44
CV 55,46
Mvav 84,200,168
Ta 196,20,40960
v_min_u32 v52, -2, v52
v_min_u32 v53, -2, v53
Mvav 84,204,172
v_min_u32 v54, -2, v54
v_min_u32 v55, -2, v55
Mvav 68,204,140
Ta 198,20,45056
buffer_store_dwordx4 v[52:55], v1, s[60:63], s51 offen offset:3072 sc1
Mvav 68,200,136
s_waitcnt lgkmcnt(8)
AR 40,168
AR 41,169
Mvav 72,208,136
Ta 200,21,32768
AR 42,170
AR 43,171
Mvav 72,212,140
AR 44,172
AR 45,173
Mvav 88,212,172
Ta 202,21,36864
AR 46,174
AR 47,175
Mvav 88,208,168
CV 48,40
CV 49,42
Mvav 104,208,200
Ta 204,21,40960
CV 50,44
CV 51,46
Mvav 104,212,204
v_min_u32 v48, -2, v48
v_min_u32 v49, -2, v49
Mvav 120,212,236
Ta 206,21,45056
v_min_u32 v50, -2, v50
v_min_u32 v51, -2, v51
Mvav 120,208,232
s_waitcnt lgkmcnt(8)
buffer_store_dwordx4 v[48:51], v1, s[60:63], s37 offen offset:1024 sc1
Mvav 124,216,232
Ta 208,22,32768
AR 40,184
AR 41,185
Mvav 124,220,236
AR 42,186
AR 43,187
Mvav 108,220,204
Ta 210,22,36864
AR 44,188
AR 45,189
Mvav 108,216,200
AR 46,190
AR 47,191
Mvav 92,216,168
Ta 212,22,40960
CV 52,40
CV 53,42
Mvav 92,220,172
CV 54,44
CV 55,46
Mvav 76,220,140
Ta 214,22,45056
v_min_u32 v52, -2, v52
v_min_u32 v53, -2, v53
Mvav 76,216,136
s_waitcnt lgkmcnt(8)
v_min_u32 v54, -2, v54
v_min_u32 v55, -2, v55
Mvaa 64,192,64
Ta 216,23,32768
buffer_store_dwordx4 v[52:55], v1, s[60:63], s37 offen offset:3072 sc1
Mvaa 64,196,68
Mvaa 80,196,84
Ta 218,23,36864
Mvaa 80,192,80
Mvaa 96,192,96
Ta 220,23,40960
Mvaa 96,196,100
Mvaa 112,196,116
Ta 222,23,45056
Mvaa 112,192,112
s_waitcnt lgkmcnt(8)
Mvaa 116,200,112
Ta 192,12,32768
Mvaa 116,204,116
Mvaa 100,204,100
Ta 194,12,36864
Mvaa 100,200,96
Mvaa 84,200,80
Ta 196,12,40960
Mvaa 84,204,84
Mvaa 68,204,68
Ta 198,12,45056
Mvaa 68,200,64
s_waitcnt lgkmcnt(8)
Mvaa 72,208,64
Ta 200,13,32768
Mvaa 72,212,68
Mvaa 88,212,84
Ta 202,13,36864
Mvaa 88,208,80
Mvaa 104,208,96
Ta 204,13,40960
Mvaa 104,212,100
Mvaa 120,212,116
Ta 206,13,45056
Mvaa 120,208,112
s_waitcnt lgkmcnt(8)
Mvaa 124,216,112
Ta 208,14,32768
Mvaa 124,220,116
Mvaa 108,220,100
Ta 210,14,36864
Mvaa 108,216,96
Mvaa 92,216,80
Ta 212,14,40960
Mvaa 92,220,84
Mvaa 76,220,68
Ta 214,14,45056
Mvaa 76,216,64
s_waitcnt lgkmcnt(8)
Mvaa 64,192,72
Ta 216,15,32768
Mvaa 64,196,76
Mvaa 80,196,92
Ta 218,15,36864
Mvaa 80,192,88
Mvaa 96,192,104
Ta 220,15,40960
Mvaa 96,196,108
Mvaa 112,196,124
Ta 222,15,45056
Mvaa 112,192,120
s_waitcnt lgkmcnt(8)
Mvaa 116,200,120
Ta 192,20,49152
Mvaa 116,204,124
Mvaa 100,204,108
Ta 194,20,53248
Mvaa 100,200,104
Mvaa 84,200,88
Ta 196,20,57344
Mvaa 84,204,92
Mvaa 68,204,76
Ta 198,20,61440
Mvaa 68,200,72
s_waitcnt lgkmcnt(8)
Mvaa 72,208,72
Ta 200,21,49152
Mvaa 72,212,76
Mvaa 88,212,92
Ta 202,21,53248
Mvaa 88,208,88
Mvaa 104,208,104
Ta 204,21,57344
Mvaa 104,212,108
Mvaa 120,212,124
Ta 206,21,61440
Mvaa 120,208,120
s_waitcnt lgkmcnt(8)
Mvaa 124,216,120
Ta 208,22,49152
Mvaa 124,220,124
Mvaa 108,220,108
Ta 210,22,53248
Mvaa 108,216,104
Mvaa 92,216,88
Ta 212,22,57344
Mvaa 92,220,92
Mvaa 76,220,76
Ta 214,22,61440
Mvaa 76,216,72
s_waitcnt lgkmcnt(8)
Mvav 64,192,144
Ta 216,23,49152
Mvav 64,196,148
Mvav 80,196,180
Ta 218,23,53248
Mvav 80,192,176
Mvav 96,192,208
Ta 220,23,57344
Mvav 96,196,212
Mvav 112,196,244
Ta 222,23,61440
Mvav 112,192,240
s_waitcnt lgkmcnt(8)
Mvav 116,200,240
Ta 192,12,49152
Mvav 116,204,244
Mvav 100,204,212
Ta 194,12,53248
Mvav 100,200,208
Mvav 84,200,176
Ta 196,12,57344
Mvav 84,204,180
Mvav 68,204,148
Ta 198,12,61440
Mvav 68,200,144
s_waitcnt lgkmcnt(8)
Mvav 72,208,144
Ta 200,13,49152
Mvav 72,212,148
Mvav 88,212,180
Ta 202,13,53248
Mvav 88,208,176
Mvav 104,208,208
Ta 204,13,57344
Mvav 104,212,212
Mvav 120,212,244
Ta 206,13,61440
Mvav 120,208,240
s_waitcnt lgkmcnt(8)
Mvav 124,216,240
Ta 208,14,49152
Mvav 124,220,244
Mvav 108,220,212
Ta 210,14,53248
Mvav 108,216,208
Mvav 92,216,176
Ta 212,14,57344
Mvav 92,220,180
Mvav 76,220,148
Ta 214,14,61440
Mvav 76,216,144
s_waitcnt lgkmcnt(8)
Mvav 64,192,152
Ta 216,15,49152
Mvav 64,196,156
Mvav 80,196,188
Ta 218,15,53248
Mvav 80,192,184
Mvav 96,192,216
Ta 220,15,57344
Mvav 96,196,220
Mvav 112,196,252
Ta 222,15,61440
Mvav 112,192,248
s_waitcnt lgkmcnt(8)
Mvav 116,200,248
Ta 192,28,0
Lv 128,1,60,75,0
Mvav 116,204,252
Mvav 100,204,220
Ta 194,28,4096
Lv 132,1,60,75,1024
Mvav 100,200,216
Mvav 84,200,184
Ta 196,28,8192
Lv 160,1,60,75,2048
Mvav 84,204,188
Mvav 68,204,156
Ta 198,28,12288
Lv 164,1,60,75,3072
Mvav 68,200,152
s_waitcnt lgkmcnt(8)
Mvav 72,208,152
Ta 200,29,0
Lv 192,1,60,36,0
Mvav 72,212,156
Mvav 88,212,188
Ta 202,29,4096
Lv 196,1,60,36,1024
Mvav 88,208,184
Mvav 104,208,216
Ta 204,29,8192
Lv 224,1,60,36,2048
Mvav 104,212,220
Mvav 120,212,252
Ta 206,29,12288
Lv 228,1,60,36,3072
Mvav 120,208,248
s_waitcnt lgkmcnt(8)
Mvav 124,216,248
Ta 208,30,0
Mvav 124,220,252
Mvav 108,220,220
Ta 210,30,4096
Mvav 108,216,216
Mvav 92,216,184
Ta 212,30,8192
Mvav 92,220,188
Mvav 76,220,156
Ta 214,30,12288
Mvav 76,216,152
s_waitcnt lgkmcnt(8)
Mvaa 64,192,0
Ta 216,31,0
Mvaa 64,196,4
Mvaa 80,196,20
Ta 218,31,4096
Mvaa 80,192,16
Mvaa 96,192,32
Ta 220,31,8192
Mvaa 96,196,36
Mvaa 112,196,52
Ta 222,31,12288
Mvaa 112,192,48
s_waitcnt lgkmcnt(8)
Mvaa 116,200,48
Ta 192,28,16384
Mvaa 116,204,52
Mvaa 100,204,36
Ta 194,28,20480
Mvaa 100,200,32
Mvaa 84,200,16
Ta 196,28,24576
Mvaa 84,204,20
Mvaa 68,204,4
Ta 198,28,28672
Mvaa 68,200,0
s_waitcnt lgkmcnt(8)
Mvaa 72,208,0
Ta 200,29,16384
Mvaa 72,212,4
Mvaa 88,212,20
Ta 202,29,20480
Mvaa 88,208,16
Mvaa 104,208,32
Ta 204,29,24576
Mvaa 104,212,36
Mvaa 120,212,52
Ta 206,29,28672
Mvaa 120,208,48
s_waitcnt lgkmcnt(8)
Mvaa 124,216,48
Ta 208,30,16384
Mvaa 124,220,52
Mvaa 108,220,36
Ta 210,30,20480
Mvaa 108,216,32
Mvaa 92,216,16
Ta 212,30,24576
Mvaa 92,220,20
Mvaa 76,220,4
Ta 214,30,28672
Mvaa 76,216,0
s_waitcnt lgkmcnt(8)
Mvaa 64,192,8
Ta 216,31,16384
Mvaa 64,196,12
Mvaa 80,196,28
Ta 218,31,20480
Mvaa 80,192,24
Mvaa 96,192,40
Ta 220,31,24576
Mvaa 96,196,44
Mvaa 112,196,60
Ta 222,31,28672
Mvaa 112,192,56
s_waitcnt lgkmcnt(8)
Mvaa 116,200,56
Mvaa 116,204,60
Mvaa 100,204,44
Mvaa 100,200,40
Mvaa 84,200,24
Mvaa 84,204,28
Mvaa 68,204,12
Mvaa 68,200,8
s_waitcnt lgkmcnt(4)
Mvaa 72,208,8
Mvaa 72,212,12
Mvaa 88,212,28
Mvaa 88,208,24
Mvaa 104,208,40
Mvaa 104,212,44
Mvaa 120,212,60
Mvaa 120,208,56
s_waitcnt lgkmcnt(0)
Mvaa 124,216,56
Mvaa 124,220,60
Mvaa 108,220,44
Mvaa 108,216,40
Mvaa 92,216,24
Mvaa 92,220,28
Mvaa 76,220,12
Mvaa 76,216,8
s_waitcnt vmcnt(0)
s_waitcnt vmcnt(1)
s_waitcnt vmcnt(2)
s_waitcnt vmcnt(3)
s_waitcnt vmcnt(4)
s_waitcnt vmcnt(5)
s_waitcnt vmcnt(6)
s_waitcnt vmcnt(7)
v_max3_u32 v40, v128, v129, v130
v_max3_u32 v40, v40, v131, v132
v_max3_u32 v40, v40, v133, v134
v_max3_u32 v40, v40, v135, v160
v_max3_u32 v40, v40, v161, v162
v_max3_u32 v40, v40, v163, v164
v_max3_u32 v40, v40, v165, v166
v_max3_u32 v40, v40, v167, v192
v_max3_u32 v40, v40, v193, v194
v_max3_u32 v40, v40, v195, v196
v_max3_u32 v40, v40, v197, v198
v_max3_u32 v40, v40, v199, v224
v_max3_u32 v40, v40, v225, v226
v_max3_u32 v40, v40, v227, v228
v_max3_u32 v40, v40, v229, v230
v_max_u32 v40, v40, v231
v_cmp_eq_u32 vcc, -1, v40
s_nop 1
s_cbranch_vccnz L1a_rspin
L1a_rspin_back:
Mvvv 64,58,128
Mvvv 68,56,128
Mvvv 72,58,132
Mvvv 76,56,132
Mvvv 80,58,160
Mvvv 84,56,160
Mvvv 88,58,164
Mvvv 92,56,164
Mvvv 96,58,192
Mvvv 100,56,192
Mvvv 104,58,196
Mvvv 108,56,196
Mvvv 112,58,224
Mvvv 116,56,224
Mvvv 120,58,228
Mvvv 124,56,228
s_lshl_b32 s38, s28, 18
s_nop 3
CV 40,64
CV 41,66
CV 42,68
CV 43,70
s_nop 0
v_permlane32_swap_b32 v40, v42
v_permlane32_swap_b32 v41, v43
s_nop 0
v_permlane16_swap_b32 v40, v42
v_permlane16_swap_b32 v41, v43
buffer_store_dwordx4 v[40:43], v36, s[64:67], s38 offen sc1
CV 44,72
CV 45,74
CV 46,76
CV 47,78
s_nop 0
v_permlane32_swap_b32 v44, v46
v_permlane32_swap_b32 v45, v47
s_nop 0
v_permlane16_swap_b32 v44, v46
v_permlane16_swap_b32 v45, v47
buffer_store_dwordx4 v[44:47], v36, s[64:67], s38 offen offset:64 sc1
s_add_u32 s38, s38, 0x10000
CV 48,80
CV 49,82
CV 50,84
CV 51,86
s_nop 0
v_permlane32_swap_b32 v48, v50
v_permlane32_swap_b32 v49, v51
s_nop 0
v_permlane16_swap_b32 v48, v50
v_permlane16_swap_b32 v49, v51
buffer_store_dwordx4 v[48:51], v36, s[64:67], s38 offen sc1
CV 52,88
CV 53,90
CV 54,92
CV 55,94
s_nop 0
v_permlane32_swap_b32 v52, v54
v_permlane32_swap_b32 v53, v55
s_nop 0
v_permlane16_swap_b32 v52, v54
v_permlane16_swap_b32 v53, v55
buffer_store_dwordx4 v[52:55], v36, s[64:67], s38 offen offset:64 sc1
s_add_u32 s38, s38, 0x10000
CV 40,96
CV 41,98
CV 42,100
CV 43,102
s_nop 0
v_permlane32_swap_b32 v40, v42
v_permlane32_swap_b32 v41, v43
s_nop 0
v_permlane16_swap_b32 v40, v42
v_permlane16_swap_b32 v41, v43
buffer_store_dwordx4 v[40:43], v36, s[64:67], s38 offen sc1
CV 44,104
CV 45,106
CV 46,108
CV 47,110
s_nop 0
v_permlane32_swap_b32 v44, v46
v_permlane32_swap_b32 v45, v47
s_nop 0
v_permlane16_swap_b32 v44, v46
v_permlane16_swap_b32 v45, v47
buffer_store_dwordx4 v[44:47], v36, s[64:67], s38 offen offset:64 sc1
s_add_u32 s38, s38, 0x10000
CV 48,112
CV 49,114
CV 50,116
CV 51,118
s_nop 0
v_permlane32_swap_b32 v48, v50
v_permlane32_swap_b32 v49, v51
s_nop 0
v_permlane16_swap_b32 v48, v50
v_permlane16_swap_b32 v49, v51
buffer_store_dwordx4 v[48:51], v36, s[64:67], s38 offen sc1
CV 52,120
CV 53,122
CV 54,124
CV 55,126
s_nop 0
v_permlane32_swap_b32 v52, v54
v_permlane32_swap_b32 v53, v55
s_nop 0
v_permlane16_swap_b32 v52, v54
v_permlane16_swap_b32 v53, v55
buffer_store_dwordx4 v[52:55], v36, s[64:67], s38 offen offset:64 sc1

s_endpgm
L1a_flush0:
v_mov_b32 v40, v112
s_nop 1
v_permlane32_swap_b32 v112, v40
AD 112,40
v_mov_b32 v40, v112
s_nop 1
v_permlane16_swap_b32 v112, v40
AD 112,40
v_subrev_u32 v40, 0x30800000, v112
v_cmp_lt_u32 vcc, 0x1b000000, v40
s_nop 1
s_cbranch_vccnz L1a_flush0_slow
L1a_flush0_rcp:
v_rcp_f32 v112, v112
s_add_u32 s50, s48, 0
v_pk_mul_f32 v[40:41], v[128:129], v[112:113] op_sel_hi:[1,0]
v_pk_mul_f32 v[42:43], v[130:131], v[112:113] op_sel_hi:[1,0]
v_pk_mul_f32 v[44:45], v[132:133], v[112:113] op_sel_hi:[1,0]
v_pk_mul_f32 v[46:47], v[134:135], v[112:113] op_sel_hi:[1,0]
CV 48,40
CV 49,42
CV 50,44
CV 51,46
buffer_store_dwordx4 v[48:51], v1, s[24:27], s50 offen sc1
v_pk_mul_f32 v[40:41], v[136:137], v[112:113] op_sel_hi:[1,0]
v_pk_mul_f32 v[42:43], v[138:139], v[112:113] op_sel_hi:[1,0]
v_pk_mul_f32 v[44:45], v[140:141], v[112:113] op_sel_hi:[1,0]
v_pk_mul_f32 v[46:47], v[142:143], v[112:113] op_sel_hi:[1,0]
CV 52,40
CV 53,42
CV 54,44
CV 55,46
buffer_store_dwordx4 v[52:55], v1, s[24:27], s50 offen offset:1024 sc1
v_pk_mul_f32 v[40:41], v[144:145], v[112:113] op_sel_hi:[1,0]
v_pk_mul_f32 v[42:43], v[146:147], v[112:113] op_sel_hi:[1,0]
v_pk_mul_f32 v[44:45], v[148:149], v[112:113] op_sel_hi:[1,0]
v_pk_mul_f32 v[46:47], v[150:151], v[112:113] op_sel_hi:[1,0]
CV 56,40
CV 57,42
CV 58,44
CV 59,46
buffer_store_dwordx4 v[56:59], v1, s[24:27], s50 offen offset:2048 sc1
v_pk_mul_f32 v[40:41], v[152:153], v[112:113] op_sel_hi:[1,0]
v_pk_mul_f32 v[42:43], v[154:155], v[112:113] op_sel_hi:[1,0]
v_pk_mul_f32 v[44:45], v[156:157], v[112:113] op_sel_hi:[1,0]
v_pk_mul_f32 v[46:47], v[158:159], v[112:113] op_sel_hi:[1,0]
CV 60,40
CV 61,42
CV 62,44
CV 63,46
buffer_store_dwordx4 v[60:63], v1, s[24:27], s50 offen offset:3072 sc1
L1a_flush0_done:
v_mov_b64 v[40:41], 0
v_mov_b64 v[42:43], 0
AM 0,64
AM 1,65
AM 2,66
AM 3,67
AM 4,68
AM 5,69
AM 6,70
AM 7,71
AM 8,72
AM 9,73
AM 10,74
AM 11,75
AM 12,76
AM 13,77
AM 14,78
AM 15,79
v_mfma_f32_32x32x16_bf16 v[128:143], v[40:43], v[40:43], 0
v_mfma_f32_32x32x16_bf16 v[144:159], v[40:43], v[40:43], 0
v_mov_b32 v112, 0
AW 64,48
AW 65,49
AW 66,50
AW 67,51
AW 68,52
AW 69,53
AW 70,54
AW 71,55
AW 72,56
AW 73,57
AW 74,58
AW 75,59
AW 76,60
AW 77,61
AW 78,62
AW 79,63
s_nop 1
s_branch L1a_flush0_back
L1a_flush1:
v_mov_b32 v40, v113
s_nop 1
v_permlane32_swap_b32 v113, v40
AD 113,40
v_mov_b32 v40, v113
s_nop 1
v_permlane16_swap_b32 v113, v40
AD 113,40
v_subrev_u32 v40, 0x30800000, v113
v_cmp_lt_u32 vcc, 0x1b000000, v40
s_nop 1
s_cbranch_vccnz L1a_flush1_slow
L1a_flush1_rcp:
v_rcp_f32 v113, v113
s_add_u32 s50, s48, 131072
v_pk_mul_f32 v[40:41], v[160:161], v[112:113] op_sel:[0,1] op_sel_hi:[1,1]
v_pk_mul_f32 v[42:43], v[162:163], v[112:113] op_sel:[0,1] op_sel_hi:[1,1]
v_pk_mul_f32 v[44:45], v[164:165], v[112:113] op_sel:[0,1] op_sel_hi:[1,1]
v_pk_mul_f32 v[46:47], v[166:167], v[112:113] op_sel:[0,1] op_sel_hi:[1,1]
CV 48,40
CV 49,42
CV 50,44
CV 51,46
buffer_store_dwordx4 v[48:51], v1, s[24:27], s50 offen sc1
v_pk_mul_f32 v[40:41], v[168:169], v[112:113] op_sel:[0,1] op_sel_hi:[1,1]
v_pk_mul_f32 v[42:43], v[170:171], v[112:113] op_sel:[0,1] op_sel_hi:[1,1]
v_pk_mul_f32 v[44:45], v[172:173], v[112:113] op_sel:[0,1] op_sel_hi:[1,1]
v_pk_mul_f32 v[46:47], v[174:175], v[112:113] op_sel:[0,1] op_sel_hi:[1,1]
CV 52,40
CV 53,42
CV 54,44
CV 55,46
buffer_store_dwordx4 v[52:55], v1, s[24:27], s50 offen offset:1024 sc1
v_pk_mul_f32 v[40:41], v[176:177], v[112:113] op_sel:[0,1] op_sel_hi:[1,1]
v_pk_mul_f32 v[42:43], v[178:179], v[112:113] op_sel:[0,1] op_sel_hi:[1,1]
v_pk_mul_f32 v[44:45], v[180:181], v[112:113] op_sel:[0,1] op_sel_hi:[1,1]
v_pk_mul_f32 v[46:47], v[182:183], v[112:113] op_sel:[0,1] op_sel_hi:[1,1]
CV 56,40
CV 57,42
CV 58,44
CV 59,46
buffer_store_dwordx4 v[56:59], v1, s[24:27], s50 offen offset:2048 sc1
v_pk_mul_f32 v[40:41], v[184:185], v[112:113] op_sel:[0,1] op_sel_hi:[1,1]
v_pk_mul_f32 v[42:43], v[186:187], v[112:113] op_sel:[0,1] op_sel_hi:[1,1]
v_pk_mul_f32 v[44:45], v[188:189], v[112:113] op_sel:[0,1] op_sel_hi:[1,1]
v_pk_mul_f32 v[46:47], v[190:191], v[112:113] op_sel:[0,1] op_sel_hi:[1,1]
CV 60,40
CV 61,42
CV 62,44
CV 63,46
buffer_store_dwordx4 v[60:63], v1, s[24:27], s50 offen offset:3072 sc1
L1a_flush1_done:
v_mov_b64 v[40:41], 0
v_mov_b64 v[42:43], 0
AM 16,80
AM 17,81
AM 18,82
AM 19,83
AM 20,84
AM 21,85
AM 22,86
AM 23,87
AM 24,88
AM 25,89
AM 26,90
AM 27,91
AM 28,92
AM 29,93
AM 30,94
AM 31,95
v_mfma_f32_32x32x16_bf16 v[160:175], v[40:43], v[40:43], 0
v_mfma_f32_32x32x16_bf16 v[176:191], v[40:43], v[40:43], 0
v_mov_b32 v113, 0
AW 80,48
AW 81,49
AW 82,50
AW 83,51
AW 84,52
AW 85,53
AW 86,54
AW 87,55
AW 88,56
AW 89,57
AW 90,58
AW 91,59
AW 92,60
AW 93,61
AW 94,62
AW 95,63
s_nop 1
s_branch L1a_flush1_back
L1a_flush2:
v_mov_b32 v40, v114
s_nop 1
v_permlane32_swap_b32 v114, v40
AD 114,40
v_mov_b32 v40, v114
s_nop 1
v_permlane16_swap_b32 v114, v40
AD 114,40
v_subrev_u32 v40, 0x30800000, v114
v_cmp_lt_u32 vcc, 0x1b000000, v40
s_nop 1
s_cbranch_vccnz L1a_flush2_slow
L1a_flush2_rcp:
v_rcp_f32 v114, v114
s_add_u32 s50, s48, 262144
v_pk_mul_f32 v[40:41], v[192:193], v[114:115] op_sel_hi:[1,0]
v_pk_mul_f32 v[42:43], v[194:195], v[114:115] op_sel_hi:[1,0]
v_pk_mul_f32 v[44:45], v[196:197], v[114:115] op_sel_hi:[1,0]
v_pk_mul_f32 v[46:47], v[198:199], v[114:115] op_sel_hi:[1,0]
CV 48,40
CV 49,42
CV 50,44
CV 51,46
buffer_store_dwordx4 v[48:51], v1, s[24:27], s50 offen sc1
v_pk_mul_f32 v[40:41], v[200:201], v[114:115] op_sel_hi:[1,0]
v_pk_mul_f32 v[42:43], v[202:203], v[114:115] op_sel_hi:[1,0]
v_pk_mul_f32 v[44:45], v[204:205], v[114:115] op_sel_hi:[1,0]
v_pk_mul_f32 v[46:47], v[206:207], v[114:115] op_sel_hi:[1,0]
CV 52,40
CV 53,42
CV 54,44
CV 55,46
buffer_store_dwordx4 v[52:55], v1, s[24:27], s50 offen offset:1024 sc1
v_pk_mul_f32 v[40:41], v[208:209], v[114:115] op_sel_hi:[1,0]
v_pk_mul_f32 v[42:43], v[210:211], v[114:115] op_sel_hi:[1,0]
v_pk_mul_f32 v[44:45], v[212:213], v[114:115] op_sel_hi:[1,0]
v_pk_mul_f32 v[46:47], v[214:215], v[114:115] op_sel_hi:[1,0]
CV 56,40
CV 57,42
CV 58,44
CV 59,46
buffer_store_dwordx4 v[56:59], v1, s[24:27], s50 offen offset:2048 sc1
v_pk_mul_f32 v[40:41], v[216:217], v[114:115] op_sel_hi:[1,0]
v_pk_mul_f32 v[42:43], v[218:219], v[114:115] op_sel_hi:[1,0]
v_pk_mul_f32 v[44:45], v[220:221], v[114:115] op_sel_hi:[1,0]
v_pk_mul_f32 v[46:47], v[222:223], v[114:115] op_sel_hi:[1,0]
CV 60,40
CV 61,42
CV 62,44
CV 63,46
buffer_store_dwordx4 v[60:63], v1, s[24:27], s50 offen offset:3072 sc1
L1a_flush2_done:
v_mov_b64 v[40:41], 0
v_mov_b64 v[42:43], 0
AM 32,96
AM 33,97
AM 34,98
AM 35,99
AM 36,100
AM 37,101
AM 38,102
AM 39,103
AM 40,104
AM 41,105
AM 42,106
AM 43,107
AM 44,108
AM 45,109
AM 46,110
AM 47,111
v_mfma_f32_32x32x16_bf16 v[192:207], v[40:43], v[40:43], 0
v_mfma_f32_32x32x16_bf16 v[208:223], v[40:43], v[40:43], 0
v_mov_b32 v114, 0
AW 96,48
AW 97,49
AW 98,50
AW 99,51
AW 100,52
AW 101,53
AW 102,54
AW 103,55
AW 104,56
AW 105,57
AW 106,58
AW 107,59
AW 108,60
AW 109,61
AW 110,62
AW 111,63
s_nop 1
s_branch L1a_flush2_back
L1a_flush3:
v_mov_b32 v40, v115
s_nop 1
v_permlane32_swap_b32 v115, v40
AD 115,40
v_mov_b32 v40, v115
s_nop 1
v_permlane16_swap_b32 v115, v40
AD 115,40
v_subrev_u32 v40, 0x30800000, v115
v_cmp_lt_u32 vcc, 0x1b000000, v40
s_nop 1
s_cbranch_vccnz L1a_flush3_slow
L1a_flush3_rcp:
v_rcp_f32 v115, v115
s_add_u32 s50, s48, 393216
v_pk_mul_f32 v[40:41], v[224:225], v[114:115] op_sel:[0,1] op_sel_hi:[1,1]
v_pk_mul_f32 v[42:43], v[226:227], v[114:115] op_sel:[0,1] op_sel_hi:[1,1]
v_pk_mul_f32 v[44:45], v[228:229], v[114:115] op_sel:[0,1] op_sel_hi:[1,1]
v_pk_mul_f32 v[46:47], v[230:231], v[114:115] op_sel:[0,1] op_sel_hi:[1,1]
CV 48,40
CV 49,42
CV 50,44
CV 51,46
buffer_store_dwordx4 v[48:51], v1, s[24:27], s50 offen sc1
v_pk_mul_f32 v[40:41], v[232:233], v[114:115] op_sel:[0,1] op_sel_hi:[1,1]
v_pk_mul_f32 v[42:43], v[234:235], v[114:115] op_sel:[0,1] op_sel_hi:[1,1]
v_pk_mul_f32 v[44:45], v[236:237], v[114:115] op_sel:[0,1] op_sel_hi:[1,1]
v_pk_mul_f32 v[46:47], v[238:239], v[114:115] op_sel:[0,1] op_sel_hi:[1,1]
CV 52,40
CV 53,42
CV 54,44
CV 55,46
buffer_store_dwordx4 v[52:55], v1, s[24:27], s50 offen offset:1024 sc1
v_pk_mul_f32 v[40:41], v[240:241], v[114:115] op_sel:[0,1] op_sel_hi:[1,1]
v_pk_mul_f32 v[42:43], v[242:243], v[114:115] op_sel:[0,1] op_sel_hi:[1,1]
v_pk_mul_f32 v[44:45], v[244:245], v[114:115] op_sel:[0,1] op_sel_hi:[1,1]
v_pk_mul_f32 v[46:47], v[246:247], v[114:115] op_sel:[0,1] op_sel_hi:[1,1]
CV 56,40
CV 57,42
CV 58,44
CV 59,46
buffer_store_dwordx4 v[56:59], v1, s[24:27], s50 offen offset:2048 sc1
v_pk_mul_f32 v[40:41], v[248:249], v[114:115] op_sel:[0,1] op_sel_hi:[1,1]
v_pk_mul_f32 v[42:43], v[250:251], v[114:115] op_sel:[0,1] op_sel_hi:[1,1]
v_pk_mul_f32 v[44:45], v[252:253], v[114:115] op_sel:[0,1] op_sel_hi:[1,1]
v_pk_mul_f32 v[46:47], v[254:255], v[114:115] op_sel:[0,1] op_sel_hi:[1,1]
CV 60,40
CV 61,42
CV 62,44
CV 63,46
buffer_store_dwordx4 v[60:63], v1, s[24:27], s50 offen offset:3072 sc1
L1a_flush3_done:
v_mov_b64 v[40:41], 0
v_mov_b64 v[42:43], 0
AM 48,112
AM 49,113
AM 50,114
AM 51,115
AM 52,116
AM 53,117
AM 54,118
AM 55,119
AM 56,120
AM 57,121
AM 58,122
AM 59,123
AM 60,124
AM 61,125
AM 62,126
AM 63,127
v_mfma_f32_32x32x16_bf16 v[224:239], v[40:43], v[40:43], 0
v_mfma_f32_32x32x16_bf16 v[240:255], v[40:43], v[40:43], 0
v_mov_b32 v115, 0
AW 112,48
AW 113,49
AW 114,50
AW 115,51
AW 116,52
AW 117,53
AW 118,54
AW 119,55
AW 120,56
AW 121,57
AW 122,58
AW 123,59
AW 124,60
AW 125,61
AW 126,62
AW 127,63
s_nop 1
s_branch L1a_flush3_back
L1a_rspin:
s_mov_b32 s34, 400000
L1a_rspin_loop:
Lv 128,1,60,75,0
Lv 132,1,60,75,1024
Lv 160,1,60,75,2048
Lv 164,1,60,75,3072
Lv 192,1,60,36,0
Lv 196,1,60,36,1024
Lv 224,1,60,36,2048
Lv 228,1,60,36,3072
s_waitcnt vmcnt(0)
v_max3_u32 v40, v128, v129, v130
v_max3_u32 v40, v40, v131, v132
v_max3_u32 v40, v40, v133, v134
v_max3_u32 v40, v40, v135, v160
v_max3_u32 v40, v40, v161, v162
v_max3_u32 v40, v40, v163, v164
v_max3_u32 v40, v40, v165, v166
v_max3_u32 v40, v40, v167, v192
v_max3_u32 v40, v40, v193, v194
v_max3_u32 v40, v40, v195, v196
v_max3_u32 v40, v40, v197, v198
v_max3_u32 v40, v40, v199, v224
v_max3_u32 v40, v40, v225, v226
v_max3_u32 v40, v40, v227, v228
v_max3_u32 v40, v40, v229, v230
v_max_u32 v40, v40, v231
v_cmp_eq_u32 vcc, -1, v40
s_nop 1
s_cbranch_vccz L1a_rspin_back
s_sub_u32 s34, s34, 1
s_cmp_lg_u32 s34, 0
s_cbranch_scc1 L1a_rspin_loop
s_branch L1a_rspin_back
L1b_start:
s_mov_b32 s44, 0
s_mov_b32 s45, 0
s_mov_b32 s47, 0
s_lshr_b32 s33, s2, 4
s_xor_b32 s33, s33, s2
s_and_b32 s33, s33, 15
s_lshl_b32 s33, s33, 14
s_add_u32 s47, s47, s33
s_mov_b32 s33, s47
s_mov_b32 s32, 0
s_and_b32 s33, s33, 0x3c000
s_mov_b32 s32, 0xffffc000
s_mov_b32 s90, 0
s_add_u32 s32, s32, 16384
s_add_u32 s47, s32, s33
s_and_b32 s50, s47, 0x20000
s_lshr_b32 s47, s47, 3
s_and_b32 s47, s47, 0x3800
s_or_b32 s47, s47, s50
s_and_b32 s50, s32, 0x40000
s_or_b32 s47, s47, s50
s_add_u32 s47, s47, s90
v_add_u32 v28, 14336, v28
v_add_u32 v29, 14336, v29
s_add_u32 s32, s32, 16384
s_add_u32 s47, s32, s33
s_and_b32 s50, s47, 0x20000
s_lshr_b32 s47, s47, 3
s_and_b32 s47, s47, 0x3800
s_or_b32 s47, s47, s50
s_and_b32 s50, s32, 0x40000
s_or_b32 s47, s47, s50
s_add_u32 s47, s47, s90
s_mov_b64 s[94:95], 0
v_lshrrev_b32 v70, 4, v1
s_mul_i32 s34, s72, 3
s_add_u32 s34, s34, s28
s_mul_i32 s34, s34, 10
v_lshrrev_b32 v71, 1, v70
v_add_u32 v71, s34, v71
v_lshlrev_b32 v71, 11, v71
v_and_b32 v72, 1, v70
v_lshl_add_u32 v71, v72, 7, v71
v_mov_b32 v72, 0x40000000
v_cmp_gt_u32 vcc, 20, v70
s_lshr_b32 s35, s74, 3
s_and_b32 s35, s35, 3
s_mul_i32 s35, s35, 3
s_add_u32 s35, s35, s28
s_mul_i32 s35, s35, 11
v_cndmask_b32 v67, v72, v71, vcc
v_lshrrev_b32 v71, 2, v70
v_add_u32 v71, s35, v71
v_lshlrev_b32 v71, 13, v71
v_and_b32 v73, 3, v70
v_lshl_add_u32 v71, v73, 7, v71
v_cmp_gt_u32 vcc, 44, v70
s_mov_b32 s34, 512
s_mov_b32 s35, 2097152
v_cndmask_b32 v68, v72, v71, vcc
s_mul_i32 s39, s28, 0
v_lshrrev_b32 v71, 1, v70
v_add_u32 v71, s39, v71
v_lshlrev_b32 v71, 11, v71
v_and_b32 v73, 1, v70
v_lshl_add_u32 v71, v73, 7, v71
v_cmp_gt_u32 vcc, 20, v70
s_and_b32 s39, s74, 0x38
s_lshl_b32 s39, s39, 16
v_cndmask_b32 v74, v72, v71, vcc
s_mov_b32 s44, 524544
s_mov_b32 s45, 128
s_waitcnt vmcnt(4)
s_barrier
Ta 64,16,0
Ta 66,16,1024
Ta 68,16,8192
Ta 70,16,9216
Ta 72,17,0
Ta 74,17,1024
Ta 76,17,8192
Ta 78,17,9216
Ta 80,18,0
Ta 82,18,1024
Ta 84,18,8192
Ta 86,18,9216
Ra 0,24,0
Ra 4,25,0
Ra 8,24,2048
Ra 12,25,2048
Ra 16,24,4096
Ra 20,25,4096
s_waitcnt lgkmcnt(0)
Mvaa 128,64,0
s_mov_b32 m0, 0x1c000
s_add_u32 s46, s45, 0x40000
Ta 88,19,0
Ta 90,19,1024
Mvaa 128,68,4
Ta 92,19,8192
Ta 94,19,9216
DD 36,8,46,0
DD 37,8,46,1024
Mvaa 160,68,12
DD 38,8,46,2048
DD 39,8,46,3072
Mvaa 160,64,8
s_mov_b32 m0, 0x1d000
s_add_u32 s46, s45, 0x50000
Mvaa 192,64,16
DD 36,8,46,0
DD 37,8,46,1024
Mvaa 192,68,20
DD 38,8,46,2048
DD 39,8,46,3072
Mvaa 196,76,20
s_mov_b32 m0, 0x1e000
s_add_u32 s46, s45, 0x60000
Ta 64,20,0
Ta 66,20,1024
Mvaa 196,72,16
Ta 68,20,8192
Ta 70,20,9216
DD 36,8,46,0
DD 37,8,46,1024
Mvaa 164,72,8
DD 38,8,46,2048
DD 39,8,46,3072
Mvaa 164,76,12
s_mov_b32 m0, 0x1f000
s_add_u32 s46, s45, 0x70000
Mvaa 132,76,4
DD 36,8,46,0
DD 37,8,46,1024
Mvaa 132,72,0
Mvaa 136,80,0
s_mov_b32 m0, 0xc000
s_add_u32 s46, s44, 0x0
Ta 72,21,0
Ta 74,21,1024
Mvaa 136,84,4
Ta 76,21,8192
Ta 78,21,9216
DN 32,12,46,0
DN 33,12,46,1024
Mvaa 168,84,12
DN 34,12,46,2048
DN 35,12,46,3072
Mvaa 168,80,8
s_mov_b32 m0, 0xd000
s_add_u32 s46, s44, 0x20000
Mvaa 200,80,16
DN 32,12,46,0
DN 33,12,46,1024
Mvaa 200,84,20
s_waitcnt lgkmcnt(8)
DN 34,12,46,2048
DN 35,12,46,3072
Mvaa 204,92,20
s_mov_b32 m0, 0xe000
s_add_u32 s46, s44, 0x40000
Ta 80,22,0
Ta 82,22,1024
Mvaa 204,88,16
Ta 84,22,8192
Ta 86,22,9216
Mvaa 172,88,8
DN 32,12,46,0
Mvaa 172,92,12
DN 33,12,46,1024
Mvaa 140,92,4
DN 34,12,46,2048
Mvaa 140,88,0
s_waitcnt lgkmcnt(8)
DN 35,12,46,3072
Mvaa 144,64,0
s_mov_b32 m0, 0xf000
s_add_u32 s46, s44, 0x60000
Ta 88,23,0
Ta 90,23,1024
Mvaa 144,68,4
Ta 92,23,8192
Ta 94,23,9216
Mvaa 176,68,12
DN 32,12,46,0
Mvaa 176,64,8
DN 33,12,46,1024
Mvaa 208,64,16
DN 34,12,46,2048
Mvaa 208,68,20
DN 35,12,46,3072
buffer_load_dword v69, v74, s[52:55], s39 offen
s_add_u32 s44, s44, 524032
s_add_u32 s45, s45, 128
s_waitcnt vmcnt(31)
s_mov_b32 s30, 7
L1b_qloop:
s_waitcnt vmcnt(63) lgkmcnt(0)
s_barrier
Mvaa 212,76,20
s_mov_b32 m0, 0x10000
s_add_u32 s46, s45, 0x0
Ta 64,16,16384
Ta 66,16,17408
Mvaa 212,72,16
Ta 68,16,24576
Ta 70,16,25600
Mvaa 180,72,8
DD 36,8,46,0
Mvaa 180,76,12
DD 37,8,46,1024
Mvaa 148,76,4
DD 38,8,46,2048
Mvaa 148,72,0
DD 39,8,46,3072
Mvaa 152,80,0
s_mov_b32 m0, 0x11000
s_add_u32 s46, s45, 0x10000
Ta 72,17,16384
Ta 74,17,17408
Mvaa 152,84,4
Ta 76,17,24576
Ta 78,17,25600
Mvaa 184,84,12
DD 36,8,46,0
Mvaa 184,80,8
DD 37,8,46,1024
Mvaa 216,80,16
DD 38,8,46,2048
Mvaa 216,84,20
DD 39,8,46,3072
Mvaa 220,92,20
s_mov_b32 m0, 0x12000
s_add_u32 s46, s45, 0x20000
Ta 80,18,16384
Ta 82,18,17408
Mvaa 220,88,16
Ta 84,18,24576
Ta 86,18,25600
Mvaa 188,88,8
DD 36,8,46,0
Mvaa 188,92,12
DD 37,8,46,1024
Mvaa 156,92,4
DD 38,8,46,2048
Mvaa 156,88,0
s_waitcnt lgkmcnt(8)
DD 39,8,46,3072
Maaa 128,64,0
s_mov_b32 m0, 0x13000
s_add_u32 s46, s45, 0x30000
Ta 88,19,16384
Ta 90,19,17408
Maaa 128,68,4
Ta 92,19,24576
Ta 94,19,25600
Maaa 160,68,12
DD 36,8,46,0
Maaa 160,64,8
DD 37,8,46,1024
Maaa 192,64,16
DD 38,8,46,2048
Maaa 192,68,20
s_waitcnt lgkmcnt(8)
DD 39,8,46,3072
Maaa 196,76,20
s_mov_b32 m0, 0x0
s_add_u32 s46, s44, 0x0
Ta 64,20,16384
Ta 66,20,17408
Maaa 196,72,16
Ta 68,20,24576
Ta 70,20,25600
Maaa 164,72,8
DN 32,12,46,0
Maaa 164,76,12
DN 33,12,46,1024
Maaa 132,76,4
DN 34,12,46,2048
Maaa 132,72,0
s_waitcnt lgkmcnt(8)
DN 35,12,46,3072
Maaa 136,80,0
s_mov_b32 m0, 0x1000
s_add_u32 s46, s44, 0x20000
Ta 72,21,16384
Ta 74,21,17408
Maaa 136,84,4
Ta 76,21,24576
Ta 78,21,25600
Maaa 168,84,12
DN 32,12,46,0
Maaa 168,80,8
DN 33,12,46,1024
Maaa 200,80,16
DN 34,12,46,2048
Maaa 200,84,20
s_waitcnt lgkmcnt(8)
DN 35,12,46,3072
Maaa 204,92,20
s_mov_b32 m0, 0x2000
s_add_u32 s46, s44, 0x40000
Ta 80,22,16384
Ta 82,22,17408
Maaa 204,88,16
Ta 84,22,24576
Ta 86,22,25600
Maaa 172,88,8
DN 32,12,46,0
Maaa 172,92,12
DN 33,12,46,1024
Maaa 140,92,4
DN 34,12,46,2048
Maaa 140,88,0
s_waitcnt lgkmcnt(8)
DN 35,12,46,3072
Maaa 144,64,0
s_mov_b32 m0, 0x3000
s_add_u32 s46, s44, 0x60000
Ta 88,23,16384
Ta 90,23,17408
Maaa 144,68,4
Ta 92,23,24576
Ta 94,23,25600
Maaa 176,68,12
DN 32,12,46,0
Maaa 176,64,8
DN 33,12,46,1024
buffer_load_dword v69, v74, s[52:55], s39 offen
Maaa 208,64,16
s_add_u32 s39, s39, 20480
DN 34,12,46,2048
Maaa 208,68,20
DN 35,12,46,3072
s_add_u32 s44, s44, 256
s_waitcnt vmcnt(50) lgkmcnt(0)
s_barrier
Maaa 212,76,20
s_mov_b32 m0, 0x14000
s_add_u32 s46, s45, 0x40000
Ta 64,16,32768
Ta 66,16,33792
Maaa 212,72,16
Ta 68,16,40960
Ta 70,16,41984
Maaa 180,72,8
Ra 96,24,32768
DD 36,8,46,0
Maaa 180,76,12
Ra 100,25,32768
DD 37,8,46,1024
Maaa 148,76,4
DD 38,8,46,2048
Maaa 148,72,0
DD 39,8,46,3072
Maaa 152,80,0
s_mov_b32 m0, 0x15000
s_add_u32 s46, s45, 0x50000
Ta 72,17,32768
Ta 74,17,33792
Maaa 152,84,4
Ta 76,17,40960
Ta 78,17,41984
Maaa 184,84,12
Ra 104,24,34816
DD 36,8,46,0
Maaa 184,80,8
Ra 108,25,34816
DD 37,8,46,1024
Maaa 216,80,16
DD 38,8,46,2048
Maaa 216,84,20
DD 39,8,46,3072
Maaa 220,92,20
s_mov_b32 m0, 0x16000
s_add_u32 s46, s45, 0x60000
Ta 80,18,32768
Ta 82,18,33792
Maaa 220,88,16
Ta 84,18,40960
Ta 86,18,41984
Maaa 188,88,8
Ra 112,24,36864
DD 36,8,46,0
Maaa 188,92,12
Ra 116,25,36864
DD 37,8,46,1024
Maaa 156,92,4
DD 38,8,46,2048
Maaa 156,88,0
s_waitcnt lgkmcnt(12)
DD 39,8,46,3072
Mvaa 128,64,96
s_mov_b32 m0, 0x17000
s_add_u32 s46, s45, 0x70000
Ta 88,19,32768
Ta 90,19,33792
Mvaa 128,68,100
s_waitcnt lgkmcnt(8)
Ta 92,19,40960
Ta 94,19,41984
Mvaa 160,68,108
DD 36,8,46,0
Mvaa 160,64,104
s_waitcnt lgkmcnt(4)
DD 37,8,46,1024
Mvaa 192,64,112
Mvaa 192,68,116
Mvaa 196,76,116
s_mov_b32 m0, 0x4000
s_add_u32 s46, s44, 0x0
Ta 64,20,32768
Ta 66,20,33792
Mvaa 196,72,112
Ta 68,20,40960
Ta 70,20,41984
Mvaa 164,72,104
DN 32,12,46,0
Mvaa 164,76,108
DN 33,12,46,1024
Mvaa 132,76,100
DN 34,12,46,2048
Mvaa 132,72,96
DN 35,12,46,3072
Mvaa 136,80,96
s_mov_b32 m0, 0x5000
s_add_u32 s46, s44, 0x20000
Ta 72,21,32768
Ta 74,21,33792
Mvaa 136,84,100
Ta 76,21,40960
Ta 78,21,41984
Mvaa 168,84,108
DN 32,12,46,0
Mvaa 168,80,104
DN 33,12,46,1024
Mvaa 200,80,112
DN 34,12,46,2048
Mvaa 200,84,116
s_waitcnt lgkmcnt(8)
DN 35,12,46,3072
Mvaa 204,92,116
s_mov_b32 m0, 0x6000
s_add_u32 s46, s44, 0x40000
Ta 80,22,32768
Ta 82,22,33792
Mvaa 204,88,112
Ta 84,22,40960
Ta 86,22,41984
Mvaa 172,88,104
DN 32,12,46,0
Mvaa 172,92,108
DN 33,12,46,1024
Mvaa 140,92,100
DN 34,12,46,2048
Mvaa 140,88,96
s_waitcnt lgkmcnt(8)
DN 35,12,46,3072
Mvaa 144,64,96
s_mov_b32 m0, 0x7000
s_add_u32 s46, s44, 0x60000
Ta 88,23,32768
Ta 90,23,33792
Mvaa 144,68,100
Ta 92,23,40960
Ta 94,23,41984
Mvaa 176,68,108
DN 32,12,46,0
Mvaa 176,64,104
DN 33,12,46,1024
buffer_load_dword v69, v74, s[52:55], s39 offen
Mvaa 208,64,112
s_add_u32 s39, s39, 20480
DN 34,12,46,2048
Mvaa 208,68,116
DN 35,12,46,3072
s_add_u32 s44, s44, 524032
s_add_u32 s45, s45, 128
s_waitcnt vmcnt(63) lgkmcnt(0)
s_barrier
Mvaa 212,76,116
s_mov_b32 m0, 0x18000
s_add_u32 s46, s45, 0x0
Ta 64,16,49152
Ta 66,16,50176
Mvaa 212,72,112
Ta 68,16,57344
Ta 70,16,58368
Mvaa 180,72,104
DD 36,8,46,0
Mvaa 180,76,108
DD 37,8,46,1024
Mvaa 148,76,100
DD 38,8,46,2048
Mvaa 148,72,96
DD 39,8,46,3072
Mvaa 152,80,96
s_mov_b32 m0, 0x19000
s_add_u32 s46, s45, 0x10000
Ta 72,17,49152
Ta 74,17,50176
Mvaa 152,84,100
Ta 76,17,57344
Ta 78,17,58368
Mvaa 184,84,108
DD 36,8,46,0
Mvaa 184,80,104
DD 37,8,46,1024
Mvaa 216,80,112
DD 38,8,46,2048
Mvaa 216,84,116
DD 39,8,46,3072
Mvaa 220,92,116
s_mov_b32 m0, 0x1a000
s_add_u32 s46, s45, 0x20000
Ta 80,18,49152
Ta 82,18,50176
Mvaa 220,88,112
Ta 84,18,57344
Ta 86,18,58368
Mvaa 188,88,104
DD 36,8,46,0
Mvaa 188,92,108
DD 37,8,46,1024
Mvaa 156,92,100
DD 38,8,46,2048
Mvaa 156,88,96
s_waitcnt lgkmcnt(8)
DD 39,8,46,3072
Maaa 128,64,96
s_mov_b32 m0, 0x1b000
s_add_u32 s46, s45, 0x30000
Ta 88,19,49152
Ta 90,19,50176
Maaa 128,68,100
Ta 92,19,57344
Ta 94,19,58368
Maaa 160,68,108
DD 36,8,46,0
Maaa 160,64,104
DD 37,8,46,1024
Maaa 192,64,112
DD 38,8,46,2048
Maaa 192,68,116
s_waitcnt lgkmcnt(8)
DD 39,8,46,3072
Maaa 196,76,116
s_mov_b32 m0, 0x8000
s_add_u32 s46, s44, 0x0
Ta 64,20,49152
Ta 66,20,50176
Maaa 196,72,112
Ta 68,20,57344
Ta 70,20,58368
Maaa 164,72,104
DN 32,12,46,0
Maaa 164,76,108
DN 33,12,46,1024
Maaa 132,76,100
DN 34,12,46,2048
Maaa 132,72,96
s_waitcnt lgkmcnt(8)
DN 35,12,46,3072
Maaa 136,80,96
s_mov_b32 m0, 0x9000
s_add_u32 s46, s44, 0x20000
Ta 72,21,49152
Ta 74,21,50176
Maaa 136,84,100
Ta 76,21,57344
Ta 78,21,58368
Maaa 168,84,108
DN 32,12,46,0
Maaa 168,80,104
DN 33,12,46,1024
Maaa 200,80,112
DN 34,12,46,2048
Maaa 200,84,116
s_waitcnt lgkmcnt(8)
DN 35,12,46,3072
Maaa 204,92,116
s_mov_b32 m0, 0xa000
s_add_u32 s46, s44, 0x40000
Ta 80,22,49152
Ta 82,22,50176
Maaa 204,88,112
Ta 84,22,57344
Ta 86,22,58368
Maaa 172,88,104
DN 32,12,46,0
Maaa 172,92,108
DN 33,12,46,1024
Maaa 140,92,100
DN 34,12,46,2048
Maaa 140,88,96
s_waitcnt lgkmcnt(8)
DN 35,12,46,3072
Maaa 144,64,96
s_mov_b32 m0, 0xb000
s_add_u32 s46, s44, 0x60000
Ta 88,23,49152
Ta 90,23,50176
Maaa 144,68,100
Ta 92,23,57344
Ta 94,23,58368
Maaa 176,68,108
DN 32,12,46,0
Maaa 176,64,104
DN 33,12,46,1024
buffer_load_dword v69, v74, s[52:55], s39 offen
Maaa 208,64,112
s_add_u32 s39, s39, 20480
DN 34,12,46,2048
Maaa 208,68,116
DN 35,12,46,3072
s_add_u32 s44, s44, 256
s_waitcnt vmcnt(50) lgkmcnt(0)
s_barrier
Maaa 212,76,116
s_mov_b32 m0, 0x1c000
s_add_u32 s46, s45, 0x40000
Ta 64,16,0
Ta 66,16,1024
Maaa 212,72,112
Ta 68,16,8192
Ta 70,16,9216
Maaa 180,72,104
Ra 0,24,0
DD 36,8,46,0
Maaa 180,76,108
Ra 4,25,0
DD 37,8,46,1024
Maaa 148,76,100
DD 38,8,46,2048
Maaa 148,72,96
DD 39,8,46,3072
Maaa 152,80,96
s_mov_b32 m0, 0x1d000
s_add_u32 s46, s45, 0x50000
Ta 72,17,0
Ta 74,17,1024
Maaa 152,84,100
Ta 76,17,8192
Ta 78,17,9216
Maaa 184,84,108
Ra 8,24,2048
DD 36,8,46,0
Maaa 184,80,104
Ra 12,25,2048
DD 37,8,46,1024
Maaa 216,80,112
DD 38,8,46,2048
Maaa 216,84,116
DD 39,8,46,3072
Maaa 220,92,116
s_mov_b32 m0, 0x1e000
s_add_u32 s46, s45, 0x60000
Ta 80,18,0
Ta 82,18,1024
Maaa 220,88,112
Ta 84,18,8192
Ta 86,18,9216
Maaa 188,88,104
Ra 16,24,4096
DD 36,8,46,0
Maaa 188,92,108
Ra 20,25,4096
DD 37,8,46,1024
Maaa 156,92,100
DD 38,8,46,2048
Maaa 156,88,96
s_waitcnt lgkmcnt(12)
DD 39,8,46,3072
Mvaa 128,64,0
s_mov_b32 m0, 0x1f000
s_add_u32 s46, s45, 0x70000
Ta 88,19,0
Ta 90,19,1024
Mvaa 128,68,4
s_waitcnt lgkmcnt(8)
Ta 92,19,8192
Ta 94,19,9216
Mvaa 160,68,12
DD 36,8,46,0
Mvaa 160,64,8
s_waitcnt lgkmcnt(4)
DD 37,8,46,1024
Mvaa 192,64,16
Mvaa 192,68,20
Mvaa 196,76,20
s_mov_b32 m0, 0xc000
s_add_u32 s46, s44, 0x0
Ta 64,20,0
Ta 66,20,1024
Mvaa 196,72,16
Ta 68,20,8192
Ta 70,20,9216
Mvaa 164,72,8
DN 32,12,46,0
Mvaa 164,76,12
DN 33,12,46,1024
Mvaa 132,76,4
DN 34,12,46,2048
Mvaa 132,72,0
DN 35,12,46,3072
Mvaa 136,80,0
s_mov_b32 m0, 0xd000
s_add_u32 s46, s44, 0x20000
Ta 72,21,0
Ta 74,21,1024
Mvaa 136,84,4
Ta 76,21,8192
Ta 78,21,9216
Mvaa 168,84,12
DN 32,12,46,0
Mvaa 168,80,8
DN 33,12,46,1024
Mvaa 200,80,16
DN 34,12,46,2048
Mvaa 200,84,20
s_waitcnt lgkmcnt(8)
DN 35,12,46,3072
Mvaa 204,92,20
s_mov_b32 m0, 0xe000
s_add_u32 s46, s44, 0x40000
Ta 80,22,0
Ta 82,22,1024
Mvaa 204,88,16
Ta 84,22,8192
Ta 86,22,9216
Mvaa 172,88,8
DN 32,12,46,0
Mvaa 172,92,12
DN 33,12,46,1024
Mvaa 140,92,4
DN 34,12,46,2048
Mvaa 140,88,0
s_waitcnt lgkmcnt(8)
DN 35,12,46,3072
Mvaa 144,64,0
s_mov_b32 m0, 0xf000
s_add_u32 s46, s44, 0x60000
Ta 88,23,0
Ta 90,23,1024
Mvaa 144,68,4
Ta 92,23,8192
Ta 94,23,9216
Mvaa 176,68,12
DN 32,12,46,0
Mvaa 176,64,8
DN 33,12,46,1024
buffer_load_dword v69, v74, s[52:55], s39 offen
Mvaa 208,64,16
s_add_u32 s39, s39, 20480
DN 34,12,46,2048
Mvaa 208,68,20
DN 35,12,46,3072
s_add_u32 s44, s44, 524032
s_add_u32 s45, s45, 128
s_sub_u32 s30, s30, 1
s_cmp_lg_u32 s30, 0
s_cbranch_scc1 L1b_qloop
s_waitcnt vmcnt(63) lgkmcnt(0)
s_barrier
Mvaa 212,76,20
Ta 64,16,16384
Ta 66,16,17408
v_add_u32 v36, 14336, v30
v_add_u32 v37, 14336, v31
Mvaa 212,72,16
Ta 68,16,24576
Ta 70,16,25600
Mvaa 180,72,8
v_lshrrev_b32 v40, 4, v1
Mvaa 180,76,12
v_and_b32 v41, 15, v40
Mvaa 148,76,4
v_lshrrev_b32 v40, 4, v40
Mvaa 148,72,0
v_add_u32 v32, 0, v40
Mvaa 152,80,0
Ta 72,17,16384
Ta 74,17,17408
Mvaa 152,84,4
Ta 76,17,24576
Ta 78,17,25600
Mvaa 184,84,12
v_lshlrev_b32 v32, 1, v32
Mvaa 184,80,8
v_xor_b32 v32, v32, v41
Mvaa 216,80,16
v_lshlrev_b32 v32, 4, v32
Mvaa 216,84,20
v_xor_b32 v32, s31, v32
Mvaa 220,92,20
Ta 80,18,16384
Ta 82,18,17408
Mvaa 220,88,16
Ta 84,18,24576
Ta 86,18,25600
Mvaa 188,88,8
v_lshl_add_u32 v32, v40, 11, v32
Mvaa 188,92,12
v_add_u32 v33, 4, v40
Mvaa 156,92,4
v_lshlrev_b32 v33, 1, v33
Mvaa 156,88,0
s_waitcnt lgkmcnt(8)
v_xor_b32 v33, v33, v41
Maaa 128,64,0
Ta 88,19,16384
Ta 90,19,17408
Maaa 128,68,4
Ta 92,19,24576
Ta 94,19,25600
Maaa 160,68,12
v_lshlrev_b32 v33, 4, v33
Maaa 160,64,8
v_xor_b32 v33, s31, v33
Maaa 192,64,16
v_lshl_add_u32 v33, v40, 11, v33
Maaa 192,68,20
s_waitcnt lgkmcnt(8)
v_add_u32 v33, 7168, v33
Maaa 196,76,20
Ta 64,20,16384
Ta 66,20,17408
Maaa 196,72,16
Ta 68,20,24576
Ta 70,20,25600
Maaa 164,72,8
v_add_u32 v34, 0, v40
Maaa 164,76,12
v_lshlrev_b32 v34, 1, v34
Maaa 132,76,4
v_xor_b32 v34, v34, v41
Maaa 132,72,0
s_waitcnt lgkmcnt(8)
v_lshlrev_b32 v34, 4, v34
Maaa 136,80,0
Ta 72,21,16384
Ta 74,21,17408
Maaa 136,84,4
Ta 76,21,24576
Ta 78,21,25600
Maaa 168,84,12
v_xor_b32 v34, s31, v34
Maaa 168,80,8
v_lshl_add_u32 v34, v40, 11, v34
Maaa 200,80,16
v_add_u32 v34, 14336, v34
Maaa 200,84,20
s_waitcnt lgkmcnt(8)
v_add_u32 v35, 4, v40
Maaa 204,92,20
Ta 80,22,16384
Ta 82,22,17408
Maaa 204,88,16
Ta 84,22,24576
Ta 86,22,25600
Maaa 172,88,8
v_lshlrev_b32 v35, 1, v35
Maaa 172,92,12
v_xor_b32 v35, v35, v41
Maaa 140,92,4
v_lshlrev_b32 v35, 4, v35
Maaa 140,88,0
s_waitcnt lgkmcnt(8)
v_xor_b32 v35, s31, v35
Maaa 144,64,0
Ta 88,23,16384
Ta 90,23,17408
Maaa 144,68,4
Ta 92,23,24576
Ta 94,23,25600
Maaa 176,68,12
v_lshl_add_u32 v35, v40, 11, v35
Maaa 176,64,8
v_add_u32 v35, 21504, v35
Maaa 208,64,16
s_lshl_b32 s39, s28, 15
Maaa 208,68,20
s_waitcnt vmcnt(17) lgkmcnt(0)
s_barrier
Maaa 212,76,20
s_mov_b32 m0, 0x7000
s_add_u32 s46, s47, 0x18000
Ta 64,16,32768
Ta 66,16,33792
Maaa 212,72,16
Ta 68,16,40960
Ta 70,16,41984
Maaa 180,72,8
Ra 96,24,32768
DN 26,16,46,0
Maaa 180,76,12
Ra 100,25,32768
DN 27,16,46,1024
Maaa 148,76,4
DN 28,16,46,2048
Maaa 148,72,0
DN 29,16,46,3072
Maaa 152,80,0
s_mov_b32 m0, 0x14000
s_add_u32 s46, s47, 0x0
Ta 72,17,32768
Ta 74,17,33792
Maaa 152,84,4
Ta 76,17,40960
Ta 78,17,41984
Maaa 184,84,12
Ra 104,24,34816
DN 30,20,46,0
Maaa 184,80,8
Ra 108,25,34816
DN 31,20,46,1024
Maaa 216,80,16
DN 36,20,46,2048
Maaa 216,84,20
DN 37,20,46,3072
Maaa 220,92,20
s_mov_b32 m0, 0x15000
s_add_u32 s46, s47, 0x8000
Ta 80,18,32768
Ta 82,18,33792
Maaa 220,88,16
Ta 84,18,40960
Ta 86,18,41984
Maaa 188,88,8
Ra 112,24,36864
DN 30,20,46,0
Maaa 188,92,12
Ra 116,25,36864
DN 31,20,46,1024
Maaa 156,92,4
DN 36,20,46,2048
Maaa 156,88,0
s_waitcnt lgkmcnt(12)
DN 37,20,46,3072
Mvaa 128,64,96
s_mov_b32 m0, 0x16000
s_add_u32 s46, s47, 0x10000
Ta 88,19,32768
Ta 90,19,33792
Mvaa 128,68,100
s_waitcnt lgkmcnt(8)
Ta 92,19,40960
Ta 94,19,41984
Mvaa 160,68,108
DN 30,20,46,0
Mvaa 160,64,104
s_waitcnt lgkmcnt(4)
DN 31,20,46,1024
Mvaa 192,64,112
DN 36,20,46,2048
Mvaa 192,68,116
DN 37,20,46,3072
Mvaa 196,76,116
s_mov_b32 m0, 0x17000
s_add_u32 s46, s47, 0x18000
Ta 64,20,32768
Ta 66,20,33792
Mvaa 196,72,112
Ta 68,20,40960
Ta 70,20,41984
Mvaa 164,72,104
DN 30,20,46,0
Mvaa 164,76,108
DN 31,20,46,1024
Mvaa 132,76,100
DN 36,20,46,2048
Mvaa 132,72,96
DN 37,20,46,3072
Mvaa 136,80,96
Ta 72,21,32768
Ta 74,21,33792
Mvaa 136,84,100
Ta 76,21,40960
Ta 78,21,41984
Mvaa 168,84,108
Mvaa 168,80,104
v_mul_f32 v40, s40, v128
Mvaa 200,80,112
v_mul_f32 v41, s40, v129
Mvaa 200,84,116
s_waitcnt lgkmcnt(8)
v_mul_f32 v42, s40, v130
Mvaa 204,92,116
Ta 80,22,32768
Ta 82,22,33792
Mvaa 204,88,112
Ta 84,22,40960
Ta 86,22,41984
Mvaa 172,88,104
v_mul_f32 v43, s40, v131
Mvaa 172,92,108
v_mul_f32 v44, s40, v132
Mvaa 140,92,100
v_mul_f32 v45, s40, v133
Mvaa 140,88,96
s_waitcnt lgkmcnt(8)
v_mul_f32 v46, s40, v134
Mvaa 144,64,96
Ta 88,23,32768
Ta 90,23,33792
Mvaa 144,68,100
Ta 92,23,40960
Ta 94,23,41984
Mvaa 176,68,108
v_mul_f32 v47, s40, v135
Mvaa 176,64,104
CV 48,40
Mvaa 208,64,112
CV 49,42
Mvaa 208,68,116
s_add_u32 s32, s32, 16384
s_add_u32 s47, s32, s33
s_and_b32 s50, s47, 0x20000
s_lshr_b32 s47, s47, 3
s_and_b32 s47, s47, 0x3800
s_or_b32 s47, s47, s50
s_and_b32 s50, s32, 0x40000
s_or_b32 s47, s47, s50
s_add_u32 s47, s47, s90
CV 50,44
s_waitcnt vmcnt(20) lgkmcnt(0)
s_barrier
Mvaa 212,76,116
s_mov_b32 m0, 0xb000
s_add_u32 s46, s47, 0x18000
Ta 64,16,49152
Ta 66,16,50176
Mvaa 212,72,112
Ta 68,16,57344
Ta 70,16,58368
Mvaa 180,72,104
DN 26,16,46,0
CV 51,46
Mvaa 180,76,108
DN 27,16,46,1024
v_permlane32_swap_b32 v48, v50
Mvaa 148,76,100
DN 28,16,46,2048
v_permlane32_swap_b32 v49, v51
Mvaa 148,72,96
DN 29,16,46,3072
v_permlane16_swap_b32 v48, v50
Mvaa 152,80,96
s_mov_b32 m0, 0x18000
s_add_u32 s46, s47, 0x0
Ta 72,17,49152
Ta 74,17,50176
Mvaa 152,84,100
Ta 76,17,57344
Ta 78,17,58368
Mvaa 184,84,108
DN 30,20,46,0
v_permlane16_swap_b32 v49, v51
Mvaa 184,80,104
DN 31,20,46,1024
v_mul_f32 v52, s40, v160
v_mul_f32 v53, s40, v161
Mvaa 216,80,112
DN 36,20,46,2048
v_mul_f32 v54, s40, v162
v_mul_f32 v55, s40, v163
Mvaa 216,84,116
DN 37,20,46,3072
v_mul_f32 v56, s40, v164
v_mul_f32 v57, s40, v165
Mvaa 220,92,116
s_mov_b32 m0, 0x19000
s_add_u32 s46, s47, 0x8000
Ta 80,18,49152
Ta 82,18,50176
Mvaa 220,88,112
Ta 84,18,57344
Ta 86,18,58368
Mvaa 188,88,104
DN 30,20,46,0
v_mul_f32 v58, s40, v166
v_mul_f32 v59, s40, v167
Mvaa 188,92,108
DN 31,20,46,1024
CV 60,52
CV 61,54
Mvaa 156,92,100
DN 36,20,46,2048
CV 62,56
CV 63,58
Mvaa 156,88,96
s_waitcnt lgkmcnt(8)
DN 37,20,46,3072
AW 0,48
AW 1,49
Maaa 128,64,96
s_mov_b32 m0, 0x1a000
s_add_u32 s46, s47, 0x10000
Ta 88,19,49152
Ta 90,19,50176
Maaa 128,68,100
Ta 92,19,57344
Ta 94,19,58368
Maaa 160,68,108
DN 30,20,46,0
AW 2,50
AW 3,51
Maaa 160,64,104
DN 31,20,46,1024
v_permlane32_swap_b32 v60, v62
Maaa 192,64,112
DN 36,20,46,2048
v_permlane32_swap_b32 v61, v63
Maaa 192,68,116
s_waitcnt lgkmcnt(8)
DN 37,20,46,3072
v_permlane16_swap_b32 v60, v62
Maaa 196,76,116
s_mov_b32 m0, 0x1b000
s_add_u32 s46, s47, 0x18000
Ta 64,20,49152
Ta 66,20,50176
Maaa 196,72,112
Ta 68,20,57344
Ta 70,20,58368
Maaa 164,72,104
DN 30,20,46,0
v_permlane16_swap_b32 v61, v63
Maaa 164,76,108
DN 31,20,46,1024
v_mul_f32 v40, s40, v192
v_mul_f32 v41, s40, v193
Maaa 132,76,100
DN 36,20,46,2048
v_mul_f32 v42, s40, v194
v_mul_f32 v43, s40, v195
Maaa 132,72,96
s_waitcnt lgkmcnt(8)
DN 37,20,46,3072
v_mul_f32 v44, s40, v196
v_mul_f32 v45, s40, v197
Maaa 136,80,96
Ta 72,21,49152
Ta 74,21,50176
Maaa 136,84,100
Ta 76,21,57344
Ta 78,21,58368
Maaa 168,84,108
v_mul_f32 v46, s40, v198
v_mul_f32 v47, s40, v199
Maaa 168,80,104
CV 48,40
CV 49,42
Maaa 200,80,112
CV 50,44
CV 51,46
Maaa 200,84,116
s_waitcnt lgkmcnt(8)
AW 16,60
AW 17,61
Maaa 204,92,116
Ta 80,22,49152
Ta 82,22,50176
Maaa 204,88,112
Ta 84,22,57344
Ta 86,22,58368
Maaa 172,88,104
AW 18,62
AW 19,63
Maaa 172,92,108
v_permlane32_swap_b32 v48, v50
Maaa 140,92,100
v_permlane32_swap_b32 v49, v51
Maaa 140,88,96
s_waitcnt lgkmcnt(8)
v_permlane16_swap_b32 v48, v50
Maaa 144,64,96
Ta 88,23,49152
Ta 90,23,50176
Maaa 144,68,100
Ta 92,23,57344
Ta 94,23,58368
Maaa 176,68,108
v_permlane16_swap_b32 v49, v51
Maaa 176,64,104
v_mul_f32 v52, s40, v136
v_mul_f32 v53, s40, v137
Maaa 208,64,112
v_mul_f32 v54, s40, v138
v_mul_f32 v55, s40, v139
Maaa 208,68,116
s_add_u32 s32, s32, 16384
s_add_u32 s47, s32, s33
s_and_b32 s50, s47, 0x20000
s_lshr_b32 s47, s47, 3
s_and_b32 s47, s47, 0x3800
s_or_b32 s47, s47, s50
s_and_b32 s50, s32, 0x40000
s_or_b32 s47, s47, s50
s_add_u32 s47, s47, s90
v_mul_f32 v56, s40, v140
v_mul_f32 v57, s40, v141
s_waitcnt lgkmcnt(0)
s_barrier
Maaa 212,76,116
s_mov_b32 m0, 0xf000
s_add_u32 s46, s47, 0x18000
v_mul_f32 v58, s40, v142
v_mul_f32 v59, s40, v143
Maaa 212,72,112
DN 26,16,46,0
CV 60,52
CV 61,54
DN 27,16,46,1024
CV 62,56
CV 63,58
AW 32,48
AW 33,49
Maaa 180,72,104
DN 28,16,46,2048
AW 34,50
AW 35,51
DN 29,16,46,3072
v_permlane32_swap_b32 v60, v62
v_permlane32_swap_b32 v61, v63
Maaa 180,76,108
s_mov_b32 m0, 0x1c000
s_add_u32 s46, s47, 0x0
v_permlane16_swap_b32 v60, v62
Maaa 148,76,100
DN 30,20,46,0
v_permlane16_swap_b32 v61, v63
DN 31,20,46,1024
v_mul_f32 v40, s40, v168
v_mul_f32 v41, s40, v169
v_mul_f32 v42, s40, v170
v_mul_f32 v43, s40, v171
Maaa 148,72,96
DN 36,20,46,2048
v_mul_f32 v44, s40, v172
v_mul_f32 v45, s40, v173
DN 37,20,46,3072
v_mul_f32 v46, s40, v174
v_mul_f32 v47, s40, v175
CV 48,40
CV 49,42
Maaa 152,80,96
s_mov_b32 m0, 0x1d000
s_add_u32 s46, s47, 0x8000
CV 50,44
CV 51,46
Maaa 152,84,100
DN 30,20,46,0
AW 4,60
AW 5,61
DN 31,20,46,1024
AW 6,62
AW 7,63
v_permlane32_swap_b32 v48, v50
Maaa 184,84,108
DN 36,20,46,2048
v_permlane32_swap_b32 v49, v51
DN 37,20,46,3072
v_permlane16_swap_b32 v48, v50
v_permlane16_swap_b32 v49, v51
Maaa 184,80,104
s_mov_b32 m0, 0x1e000
s_add_u32 s46, s47, 0x10000
v_mul_f32 v52, s40, v200
v_mul_f32 v53, s40, v201
Maaa 216,80,112
DN 30,20,46,0
v_mul_f32 v54, s40, v202
v_mul_f32 v55, s40, v203
DN 31,20,46,1024
v_mul_f32 v56, s40, v204
v_mul_f32 v57, s40, v205
v_mul_f32 v58, s40, v206
v_mul_f32 v59, s40, v207
Maaa 216,84,116
DN 36,20,46,2048
CV 60,52
CV 61,54
DN 37,20,46,3072
CV 62,56
CV 63,58
AW 20,48
AW 21,49
Maaa 220,92,116
s_mov_b32 m0, 0x1f000
s_add_u32 s46, s47, 0x18000
AW 22,50
AW 23,51
Maaa 220,88,112
DN 30,20,46,0
v_permlane32_swap_b32 v60, v62
DN 31,20,46,1024
v_permlane32_swap_b32 v61, v63
v_permlane16_swap_b32 v60, v62
Maaa 188,88,104
DN 36,20,46,2048
v_permlane16_swap_b32 v61, v63
DN 37,20,46,3072
v_mul_f32 v40, s40, v144
v_mul_f32 v41, s40, v145
v_mul_f32 v42, s40, v146
v_mul_f32 v43, s40, v147
Maaa 188,92,108
v_mul_f32 v44, s40, v148
v_mul_f32 v45, s40, v149
Maaa 156,92,100
v_mul_f32 v46, s40, v150
v_mul_f32 v47, s40, v151
Maaa 156,88,96
s_add_u32 s32, s32, 16384
s_add_u32 s47, s32, s33
s_and_b32 s50, s47, 0x20000
s_lshr_b32 s47, s47, 3
s_and_b32 s47, s47, 0x3800
s_or_b32 s47, s47, s50
s_and_b32 s50, s32, 0x40000
s_or_b32 s47, s47, s50
s_add_u32 s47, s47, s90
CV 48,40
CV 49,42
CV 50,44
CV 51,46
AW 36,60
AW 37,61
AW 38,62
AW 39,63
v_permlane32_swap_b32 v48, v50
v_permlane32_swap_b32 v49, v51
s_nop 0
v_permlane16_swap_b32 v48, v50
v_permlane16_swap_b32 v49, v51
v_mul_f32 v52, s40, v176
v_mul_f32 v53, s40, v177
v_mul_f32 v54, s40, v178
v_mul_f32 v55, s40, v179
v_mul_f32 v56, s40, v180
v_mul_f32 v57, s40, v181
v_mul_f32 v58, s40, v182
v_mul_f32 v59, s40, v183
CV 60,52
CV 61,54
CV 62,56
CV 63,58
AW 8,48
AW 9,49
AW 10,50
AW 11,51
v_permlane32_swap_b32 v60, v62
v_permlane32_swap_b32 v61, v63
s_nop 0
v_permlane16_swap_b32 v60, v62
v_permlane16_swap_b32 v61, v63
v_pk_mul_f32 v[40:41], v[208:209], s[40:41]
v_pk_mul_f32 v[42:43], v[210:211], s[40:41]
v_pk_mul_f32 v[44:45], v[212:213], s[40:41]
v_pk_mul_f32 v[46:47], v[214:215], s[40:41]
CV 48,40
CV 49,42
CV 50,44
CV 51,46
AW 24,60
AW 25,61
AW 26,62
AW 27,63
v_permlane32_swap_b32 v48, v50
v_permlane32_swap_b32 v49, v51
s_nop 0
v_permlane16_swap_b32 v48, v50
v_permlane16_swap_b32 v49, v51
v_pk_mul_f32 v[52:53], v[152:153], s[40:41]
v_pk_mul_f32 v[54:55], v[154:155], s[40:41]
v_pk_mul_f32 v[56:57], v[156:157], s[40:41]
v_pk_mul_f32 v[58:59], v[158:159], s[40:41]
CV 60,52
CV 61,54
CV 62,56
CV 63,58
AW 40,48
AW 41,49
AW 42,50
AW 43,51
v_permlane32_swap_b32 v60, v62
v_permlane32_swap_b32 v61, v63
s_nop 0
v_permlane16_swap_b32 v60, v62
v_permlane16_swap_b32 v61, v63
v_pk_mul_f32 v[40:41], v[184:185], s[40:41]
v_pk_mul_f32 v[42:43], v[186:187], s[40:41]
v_pk_mul_f32 v[44:45], v[188:189], s[40:41]
v_pk_mul_f32 v[46:47], v[190:191], s[40:41]
CV 48,40
CV 49,42
CV 50,44
CV 51,46
AW 12,60
AW 13,61
AW 14,62
AW 15,63
v_permlane32_swap_b32 v48, v50
v_permlane32_swap_b32 v49, v51
s_nop 0
v_permlane16_swap_b32 v48, v50
v_permlane16_swap_b32 v49, v51
v_pk_mul_f32 v[52:53], v[216:217], s[40:41]
v_pk_mul_f32 v[54:55], v[218:219], s[40:41]
v_pk_mul_f32 v[56:57], v[220:221], s[40:41]
v_pk_mul_f32 v[58:59], v[222:223], s[40:41]
CV 60,52
CV 61,54
CV 62,56
CV 63,58
AW 28,48
AW 29,49
AW 30,50
AW 31,51
v_permlane32_swap_b32 v60, v62
v_permlane32_swap_b32 v61, v63
s_nop 0
v_permlane16_swap_b32 v60, v62
v_permlane16_swap_b32 v61, v63
AW 44,60
AW 45,61
AW 46,62
AW 47,63
v_mov_b64 v[96:97], 0
v_mov_b64 v[98:99], 0
AR 40,128
AR 41,129
AR 42,130
AR 43,131
AR 44,132
AR 45,133
AR 46,134
AR 47,135
v_pk_mul_f32 v[40:41], v[40:41], s[40:41]
v_pk_mul_f32 v[42:43], v[42:43], s[40:41]
v_pk_mul_f32 v[44:45], v[44:45], s[40:41]
v_pk_mul_f32 v[46:47], v[46:47], s[40:41]
v_mfma_f32_32x32x16_bf16 v[128:143], v[96:99], v[96:99], 0
CV 48,40
CV 49,42
CV 50,44
CV 51,46
s_nop 1
v_permlane32_swap_b32 v48, v50
v_permlane32_swap_b32 v49, v51
s_nop 0
v_permlane16_swap_b32 v48, v50
v_permlane16_swap_b32 v49, v51
AR 52,136
AR 53,137
AR 54,138
AR 55,139
AR 56,140
AR 57,141
AR 58,142
AR 59,143
v_pk_mul_f32 v[52:53], v[52:53], s[40:41]
v_pk_mul_f32 v[54:55], v[54:55], s[40:41]
v_pk_mul_f32 v[56:57], v[56:57], s[40:41]
v_pk_mul_f32 v[58:59], v[58:59], s[40:41]
v_mfma_f32_32x32x16_bf16 v[144:159], v[96:99], v[96:99], 0
CV 60,52
CV 61,54
CV 62,56
CV 63,58
AW 64,48
AW 65,49
AW 66,50
AW 67,51
v_permlane32_swap_b32 v60, v62
v_permlane32_swap_b32 v61, v63
s_nop 0
v_permlane16_swap_b32 v60, v62
v_permlane16_swap_b32 v61, v63
AR 40,144
AR 41,145
AR 42,146
AR 43,147
AR 44,148
AR 45,149
AR 46,150
AR 47,151
v_pk_mul_f32 v[40:41], v[40:41], s[40:41]
v_pk_mul_f32 v[42:43], v[42:43], s[40:41]
v_pk_mul_f32 v[44:45], v[44:45], s[40:41]
v_pk_mul_f32 v[46:47], v[46:47], s[40:41]
v_mfma_f32_32x32x16_bf16 v[160:175], v[96:99], v[96:99], 0
CV 48,40
CV 49,42
CV 50,44
CV 51,46
AW 68,60
AW 69,61
AW 70,62
AW 71,63
v_permlane32_swap_b32 v48, v50
v_permlane32_swap_b32 v49, v51
s_nop 0
v_permlane16_swap_b32 v48, v50
v_permlane16_swap_b32 v49, v51
AR 52,152
AR 53,153
AR 54,154
AR 55,155
AR 56,156
AR 57,157
AR 58,158
AR 59,159
v_pk_mul_f32 v[52:53], v[52:53], s[40:41]
v_pk_mul_f32 v[54:55], v[54:55], s[40:41]
v_pk_mul_f32 v[56:57], v[56:57], s[40:41]
v_pk_mul_f32 v[58:59], v[58:59], s[40:41]
v_mfma_f32_32x32x16_bf16 v[176:191], v[96:99], v[96:99], 0
CV 60,52
CV 61,54
CV 62,56
CV 63,58
AW 72,48
AW 73,49
AW 74,50
AW 75,51
v_permlane32_swap_b32 v60, v62
v_permlane32_swap_b32 v61, v63
s_nop 0
v_permlane16_swap_b32 v60, v62
v_permlane16_swap_b32 v61, v63
AR 40,160
AR 41,161
AR 42,162
AR 43,163
AR 44,164
AR 45,165
AR 46,166
AR 47,167
v_pk_mul_f32 v[40:41], v[40:41], s[40:41]
v_pk_mul_f32 v[42:43], v[42:43], s[40:41]
v_pk_mul_f32 v[44:45], v[44:45], s[40:41]
v_pk_mul_f32 v[46:47], v[46:47], s[40:41]
v_mfma_f32_32x32x16_bf16 v[192:207], v[96:99], v[96:99], 0
CV 48,40
CV 49,42
CV 50,44
CV 51,46
AW 76,60
AW 77,61
AW 78,62
AW 79,63
v_permlane32_swap_b32 v48, v50
v_permlane32_swap_b32 v49, v51
s_nop 0
v_permlane16_swap_b32 v48, v50
v_permlane16_swap_b32 v49, v51
AR 52,168
AR 53,169
AR 54,170
AR 55,171
AR 56,172
AR 57,173
AR 58,174
AR 59,175
v_pk_mul_f32 v[52:53], v[52:53], s[40:41]
v_pk_mul_f32 v[54:55], v[54:55], s[40:41]
v_pk_mul_f32 v[56:57], v[56:57], s[40:41]
v_pk_mul_f32 v[58:59], v[58:59], s[40:41]
v_mfma_f32_32x32x16_bf16 v[208:223], v[96:99], v[96:99], 0
CV 60,52
CV 61,54
CV 62,56
CV 63,58
AW 80,48
AW 81,49
AW 82,50
AW 83,51
v_permlane32_swap_b32 v60, v62
v_permlane32_swap_b32 v61, v63
s_nop 0
v_permlane16_swap_b32 v60, v62
v_permlane16_swap_b32 v61, v63
AR 40,176
AR 41,177
AR 42,178
AR 43,179
AR 44,180
AR 45,181
AR 46,182
AR 47,183
v_pk_mul_f32 v[40:41], v[40:41], s[40:41]
v_pk_mul_f32 v[42:43], v[42:43], s[40:41]
v_pk_mul_f32 v[44:45], v[44:45], s[40:41]
v_pk_mul_f32 v[46:47], v[46:47], s[40:41]
v_mfma_f32_32x32x16_bf16 v[224:239], v[96:99], v[96:99], 0
CV 48,40
CV 49,42
CV 50,44
CV 51,46
AW 84,60
AW 85,61
AW 86,62
AW 87,63
v_permlane32_swap_b32 v48, v50
v_permlane32_swap_b32 v49, v51
s_nop 0
v_permlane16_swap_b32 v48, v50
v_permlane16_swap_b32 v49, v51
AR 52,184
AR 53,185
AR 54,186
AR 55,187
AR 56,188
AR 57,189
AR 58,190
AR 59,191
v_add_u32 v16, 0x20000, v4
v_add_u32 v17, 0x20000, v5
v_add_u32 v18, 0x20000, v6
v_add_u32 v19, 0x20000, v7
v_pk_mul_f32 v[52:53], v[52:53], s[40:41]
v_pk_mul_f32 v[54:55], v[54:55], s[40:41]
v_pk_mul_f32 v[56:57], v[56:57], s[40:41]
Ra 128,16,0
v_pk_mul_f32 v[58:59], v[58:59], s[40:41]
v_mfma_f32_32x32x16_bf16 v[240:255], v[96:99], v[96:99], 0
CV 60,52
CV 61,54
Ra 132,17,0
CV 62,56
CV 63,58
AW 88,48
Ra 136,18,0
AW 89,49
AW 90,50
AW 91,51
v_permlane32_swap_b32 v60, v62
v_permlane32_swap_b32 v61, v63
s_nop 0
v_permlane16_swap_b32 v60, v62
v_permlane16_swap_b32 v61, v63
AR 40,192
Ra 140,19,0
Ra 144,16,4096
AR 41,193
AR 42,194
Ra 148,17,4096
AR 43,195
AR 44,196
AR 45,197
Ra 152,18,4096
AR 46,198
AR 47,199
v_pk_mul_f32 v[40:41], v[40:41], s[40:41]
v_pk_mul_f32 v[42:43], v[42:43], s[40:41]
Ra 156,19,4096
v_pk_mul_f32 v[44:45], v[44:45], s[40:41]
v_pk_mul_f32 v[46:47], v[46:47], s[40:41]
CV 48,40
Ra 160,16,8192
CV 49,42
CV 50,44
CV 51,46
AW 92,60
Ra 164,17,8192
AW 93,61
AW 94,62
AW 95,63
v_permlane32_swap_b32 v48, v50
v_permlane32_swap_b32 v49, v51
s_nop 0
v_permlane16_swap_b32 v48, v50
v_permlane16_swap_b32 v49, v51
AR 52,200
Ra 168,18,8192
Ra 172,19,8192
AR 53,201
Ra 176,16,12288
AR 54,202
AR 55,203
AR 56,204
AR 57,205
Ra 180,17,12288
AR 58,206
AR 59,207
v_pk_mul_f32 v[52:53], v[52:53], s[40:41]
Ra 184,18,12288
v_pk_mul_f32 v[54:55], v[54:55], s[40:41]
v_pk_mul_f32 v[56:57], v[56:57], s[40:41]
v_pk_mul_f32 v[58:59], v[58:59], s[40:41]
CV 60,52
Ra 188,19,12288
CV 61,54
CV 62,56
CV 63,58
AW 96,48
AW 97,49
AW 98,50
AW 99,51
v_permlane32_swap_b32 v60, v62
v_permlane32_swap_b32 v61, v63
s_nop 0
v_permlane16_swap_b32 v60, v62
v_permlane16_swap_b32 v61, v63
AR 40,208
AR 41,209
AR 42,210
AR 43,211
AR 44,212
AR 45,213
AR 46,214
AR 47,215
v_pk_mul_f32 v[40:41], v[40:41], s[40:41]
v_pk_mul_f32 v[42:43], v[42:43], s[40:41]
v_pk_mul_f32 v[44:45], v[44:45], s[40:41]
v_pk_mul_f32 v[46:47], v[46:47], s[40:41]
CV 48,40
CV 49,42
CV 50,44
CV 51,46
AW 100,60
AW 101,61
AW 102,62
AW 103,63
v_permlane32_swap_b32 v48, v50
v_permlane32_swap_b32 v49, v51
s_nop 0
v_permlane16_swap_b32 v48, v50
v_permlane16_swap_b32 v49, v51
AR 52,216
AR 53,217
AR 54,218
AR 55,219
AR 56,220
AR 57,221
AR 58,222
AR 59,223
v_pk_mul_f32 v[52:53], v[52:53], s[40:41]
v_pk_mul_f32 v[54:55], v[54:55], s[40:41]
v_pk_mul_f32 v[56:57], v[56:57], s[40:41]
v_pk_mul_f32 v[58:59], v[58:59], s[40:41]
CV 60,52
CV 61,54
CV 62,56
CV 63,58
AW 104,48
AW 105,49
AW 106,50
AW 107,51
v_permlane32_swap_b32 v60, v62
v_permlane32_swap_b32 v61, v63
s_nop 0
v_permlane16_swap_b32 v60, v62
v_permlane16_swap_b32 v61, v63
AW 108,60
AW 109,61
AW 110,62
AW 111,63
v_mov_b32 v112, 0
v_mov_b32 v113, 0
v_mov_b32 v114, 0
v_mov_b32 v115, 0
s_mov_b32 s29, 0
s_nop 1
s_waitcnt lgkmcnt(12)
Zvaa 64,128,0
v_add_u32 v16, 0x14000, v8
v_add_u32 v17, 0x14000, v9
v_add_u32 v18, 0x14000, v10
v_add_u32 v19, 0x14000, v11
Mvaa 64,132,4
v_add_u32 v20, 0x14000, v12
v_add_u32 v21, 0x14000, v13
v_add_u32 v22, 0x14000, v14
v_add_u32 v23, 0x14000, v15
Mvaa 64,136,8
Ta 192,16,0
Ta 194,16,4096
Mvaa 64,140,12
s_waitcnt lgkmcnt(10)
Ta 196,16,8192
Zvaa 68,156,12
Ta 198,16,12288
Mvaa 68,152,8
Ta 200,17,0
Mvaa 68,148,4
Ta 202,17,4096
Mvaa 68,144,0
s_waitcnt lgkmcnt(10)
Ta 204,17,8192
Zvaa 72,160,0
Ta 206,17,12288
EX 64
Mvaa 72,164,4
Ta 208,18,0
AD 112,64
EX 65
Mvaa 72,168,8
Ta 210,18,4096
AD 112,65
CV 96,64
Mvaa 72,172,12
s_waitcnt lgkmcnt(10)
Ta 212,18,8192
EX 66
Zvaa 76,188,12
Ta 214,18,12288
AD 112,66
EX 67
Mvaa 76,184,8
Ta 216,19,0
AD 112,67
CV 97,66
Mvaa 76,180,4
Ta 218,19,4096
EX 68
Mvaa 76,176,0
Ta 220,19,8192
AD 112,68
EX 69
Zvaa 80,128,16
Ta 222,19,12288
AD 112,69
CV 98,68
Mvaa 80,132,20
Ta 224,20,0
Ta 226,20,4096
EX 70
Mvaa 80,136,24
Ta 228,20,8192
AD 112,70
EX 71
Mvaa 80,140,28
Ta 230,20,12288
AD 112,71
CV 99,70
Zvaa 84,156,28
Ta 232,21,0
EX 72
Mvaa 84,152,24
Ta 234,21,4096
AD 112,72
EX 73
Mvaa 84,148,20
Ta 236,21,8192
AD 112,73
CV 100,72
Mvaa 84,144,16
Ta 238,21,12288
EX 74
Zvaa 88,160,16
Ta 240,22,0
AD 112,74
EX 75
Mvaa 88,164,20
Ta 242,22,4096
AD 112,75
CV 101,74
Mvaa 88,168,24
Ta 244,22,8192
EX 76
Mvaa 88,172,28
Ta 246,22,12288
AD 112,76
EX 77
Zvaa 92,188,28
Ta 248,23,0
AD 112,77
CV 102,76
Mvaa 92,184,24
Ta 250,23,4096
EX 78
Mvaa 92,180,20
Ta 252,23,8192
AD 112,78
EX 79
Mvaa 92,176,16
Ta 254,23,12288
AD 112,79
CV 103,78
s_mov_b32 m0, 0x3000
s_add_u32 s46, s47, 0x18000
s_nop 0
DN 26,16,46,0
DN 27,16,46,1024
DN 28,16,46,2048
DN 29,16,46,3072
s_mov_b32 m0, 0x10000
s_add_u32 s46, s47, 0x0
s_nop 0
DN 30,20,46,0
DN 31,20,46,1024
DN 36,20,46,2048
DN 37,20,46,3072
s_mov_b32 m0, 0x11000
s_add_u32 s46, s47, 0x8000
s_nop 0
DN 30,20,46,0
DN 31,20,46,1024
DN 36,20,46,2048
DN 37,20,46,3072
s_mov_b32 m0, 0x12000
s_add_u32 s46, s47, 0x10000
s_nop 0
DN 30,20,46,0
DN 31,20,46,1024
DN 36,20,46,2048
DN 37,20,46,3072
s_mov_b32 m0, 0x13000
s_add_u32 s46, s47, 0x18000
s_nop 0
DN 30,20,46,0
DN 31,20,46,1024
DN 36,20,46,2048
DN 37,20,46,3072
L1b_aloop:
s_waitcnt vmcnt(40) lgkmcnt(0)
s_barrier
s_cmp_eq_u32 s29, 24
s_cbranch_scc1 L1_sig0
L1_sig0_back:
Zvaa 64,128,32
s_mov_b32 m0, 0x3000
s_add_u32 s46, s47, 0x18000
EX 80
Mvaa 64,132,36
s_mov_b64 exec, s[94:95]
DN 26,16,46,0
s_mov_b64 exec, -1
AD 113,80
Mvaa 64,136,40
EX 81
Mvaa 64,140,44
AD 113,81
CV 104,80
Zvaa 68,156,44
EX 82
Mvaa 68,152,40
AD 113,82
Mvaa 68,148,36
s_mov_b64 exec, s[94:95]
DN 27,16,46,1024
s_mov_b64 exec, -1
EX 83
Mvaa 68,144,32
AD 113,83
CV 105,82
Zvaa 72,160,32
EX 84
Mvaa 72,164,36
AD 113,84
Mvaa 72,168,40
EX 85
Mvaa 72,172,44
s_mov_b64 exec, s[94:95]
DN 28,16,46,2048
s_mov_b64 exec, -1
AD 113,85
CV 106,84
Zvaa 76,188,44
EX 86
Mvaa 76,184,40
AD 113,86
Mvaa 76,180,36
EX 87
Mvaa 76,176,32
AD 113,87
CV 107,86
Mvav 128,192,96
s_mov_b64 exec, s[94:95]
DN 29,16,46,3072
s_mov_b64 exec, -1
EX 88
Mvav 128,196,100
AD 113,88
Mvav 132,204,100
EX 89
Mvav 132,200,96
s_mov_b32 m0, 0x10000
s_add_u32 s46, s47, 0x0
AD 113,89
CV 108,88
Mvav 136,208,96
Ra 128,4,16384
s_mov_b64 exec, s[94:95]
DN 30,20,46,0
s_mov_b64 exec, -1
EX 90
Mvav 136,212,100
Ra 132,5,16384
AD 113,90
Mvav 140,220,100
Ra 136,6,16384
EX 91
Mvav 140,216,96
Ra 140,7,16384
AD 113,91
CV 109,90
Mvav 144,224,96
Ra 144,4,20480
EX 92
Mvav 144,228,100
Ra 148,5,20480
s_mov_b64 exec, s[94:95]
DN 31,20,46,1024
s_mov_b64 exec, -1
AD 113,92
Mvav 148,236,100
Ra 152,6,20480
EX 93
Mvav 148,232,96
Ra 156,7,20480
AD 113,93
CV 110,92
Mvav 152,240,96
Ra 160,4,24576
EX 94
Mvav 152,244,100
Ra 164,5,24576
AD 113,94
Mvav 156,252,100
Ra 168,6,24576
s_mov_b64 exec, s[94:95]
DN 36,20,46,2048
s_mov_b64 exec, -1
EX 95
Mvav 156,248,96
s_waitcnt lgkmcnt(7)
Ra 172,7,24576
AD 113,95
CV 111,94
Zvaa 80,128,0
Ra 176,4,28672
EX 64
Mvaa 80,132,4
Ra 180,5,28672
AD 114,64
Mvaa 80,136,8
Ra 184,6,28672
EX 65
Mvaa 80,140,12
s_waitcnt lgkmcnt(7)
Ra 188,7,28672
s_mov_b64 exec, s[94:95]
DN 37,20,46,3072
s_mov_b64 exec, -1
AD 114,65
CV 96,64
Zvaa 84,156,12
EX 66
Mvaa 84,152,8
AD 114,66
Mvaa 84,148,4
s_mov_b32 m0, 0x11000
s_add_u32 s46, s47, 0x8000
EX 67
Mvaa 84,144,0
s_waitcnt lgkmcnt(4)
s_mov_b64 exec, s[94:95]
DN 30,20,46,0
s_mov_b64 exec, -1
AD 114,67
CV 97,66
Zvaa 88,160,0
EX 68
Mvaa 88,164,4
AD 114,68
Mvaa 88,168,8
EX 69
Mvaa 88,172,12
s_waitcnt lgkmcnt(0)
AD 114,69
CV 98,68
Zvaa 92,188,12
s_mov_b64 exec, s[94:95]
DN 31,20,46,1024
s_mov_b64 exec, -1
EX 70
Mvaa 92,184,8
AD 114,70
Mvaa 92,180,4
EX 71
Mvaa 92,176,0
AD 114,71
CV 99,70
Mvav 160,192,104
EX 72
Mvav 160,196,108
s_mov_b64 exec, s[94:95]
DN 36,20,46,2048
s_mov_b64 exec, -1
AD 114,72
Mvav 164,204,108
EX 73
Mvav 164,200,104
AD 114,73
CV 100,72
Mvav 168,208,104
EX 74
Mvav 168,212,108
AD 114,74
Mvav 172,220,108
s_mov_b64 exec, s[94:95]
DN 37,20,46,3072
s_mov_b64 exec, -1
EX 75
Mvav 172,216,104
AD 114,75
CV 101,74
Mvav 176,224,104
EX 76
Mvav 176,228,108
s_mov_b32 m0, 0x12000
s_add_u32 s46, s47, 0x10000
AD 114,76
Mvav 180,236,108
s_mov_b64 exec, s[94:95]
DN 30,20,46,0
s_mov_b64 exec, -1
EX 77
Mvav 180,232,104
AD 114,77
CV 102,76
Mvav 184,240,104
EX 78
Mvav 184,244,108
AD 114,78
Mvav 188,252,108
EX 79
Mvav 188,248,104
s_mov_b64 exec, s[94:95]
DN 31,20,46,1024
s_mov_b64 exec, -1
AD 114,79
CV 103,78
Zvaa 64,128,16
EX 80
Mvaa 64,132,20
AD 112,80
Mvaa 64,136,24
EX 81
Mvaa 64,140,28
AD 112,81
CV 104,80
Zvaa 68,156,28
s_mov_b64 exec, s[94:95]
DN 36,20,46,2048
s_mov_b64 exec, -1
EX 82
Mvaa 68,152,24
AD 112,82
Mvaa 68,148,20
EX 83
Mvaa 68,144,16
AD 112,83
CV 105,82
Zvaa 72,160,16
EX 84
Mvaa 72,164,20
s_mov_b64 exec, s[94:95]
DN 37,20,46,3072
s_mov_b64 exec, -1
AD 112,84
Mvaa 72,168,24
EX 85
Mvaa 72,172,28
AD 112,85
CV 106,84
Zvaa 76,188,28
s_mov_b32 m0, 0x13000
s_add_u32 s46, s47, 0x18000
EX 86
Mvaa 76,184,24
s_mov_b64 exec, s[94:95]
DN 30,20,46,0
s_mov_b64 exec, -1
AD 112,86
Mvaa 76,180,20
EX 87
Mvaa 76,176,16
AD 112,87
CV 107,86
Mvav 192,192,96
Ta 192,8,16384
Ta 194,8,20480
EX 88
Mvav 192,196,100
Ta 196,8,24576
Ta 198,8,28672
AD 112,88
Mvav 196,204,100
Ta 204,9,24576
Ta 206,9,28672
s_mov_b64 exec, s[94:95]
DN 31,20,46,1024
s_mov_b64 exec, -1
EX 89
Mvav 196,200,96
Ta 200,9,16384
Ta 202,9,20480
AD 112,89
CV 108,88
Mvav 200,208,96
Ta 208,10,16384
Ta 210,10,20480
EX 90
Mvav 200,212,100
Ta 212,10,24576
Ta 214,10,28672
AD 112,90
Mvav 204,220,100
Ta 220,11,24576
Ta 222,11,28672
EX 91
Mvav 204,216,96
Ta 216,11,16384
Ta 218,11,20480
s_mov_b64 exec, s[94:95]
DN 36,20,46,2048
s_mov_b64 exec, -1
AD 112,91
CV 109,90
Mvav 208,224,96
Ta 224,12,16384
Ta 226,12,20480
EX 92
Mvav 208,228,100
Ta 228,12,24576
Ta 230,12,28672
AD 112,92
Mvav 212,236,100
Ta 236,13,24576
Ta 238,13,28672
EX 93
Mvav 212,232,96
Ta 232,13,16384
Ta 234,13,20480
AD 112,93
CV 110,92
Mvav 216,240,96
Ta 240,14,16384
Ta 242,14,20480
s_mov_b64 exec, s[94:95]
DN 37,20,46,3072
s_mov_b64 exec, -1
EX 94
Mvav 216,244,100
Ta 244,14,24576
Ta 246,14,28672
AD 112,94
Mvav 220,252,100
Ta 252,15,24576
Ta 254,15,28672
EX 95
Mvav 220,248,96
s_add_u32 s32, s32, 16384
s_add_u32 s47, s32, s33
s_and_b32 s50, s47, 0x20000
s_lshr_b32 s47, s47, 3
s_and_b32 s47, s47, 0x3800
s_or_b32 s47, s47, s50
s_and_b32 s50, s32, 0x40000
s_or_b32 s47, s47, s50
s_add_u32 s47, s47, s90
s_mov_b64 s[94:95], -1
Ta 248,15,16384
Ta 250,15,20480
AD 112,95
CV 111,94
s_add_u32 s29, s29, 1
s_waitcnt vmcnt(40) lgkmcnt(0)
s_barrier
Zvaa 80,128,32
s_mov_b32 m0, 0x7000
s_add_u32 s46, s47, 0x18000
EX 64
Mvaa 80,132,36
DN 26,16,46,0
AD 113,64
Mvaa 80,136,40
EX 65
Mvaa 80,140,44
AD 113,65
CV 96,64
Zvaa 84,156,44
EX 66
Mvaa 84,152,40
AD 113,66
Mvaa 84,148,36
DN 27,16,46,1024
EX 67
Mvaa 84,144,32
AD 113,67
CV 97,66
Zvaa 88,160,32
EX 68
Mvaa 88,164,36
AD 113,68
Mvaa 88,168,40
EX 69
Mvaa 88,172,44
DN 28,16,46,2048
AD 113,69
CV 98,68
Zvaa 92,188,44
EX 70
Mvaa 92,184,40
AD 113,70
Mvaa 92,180,36
EX 71
Mvaa 92,176,32
AD 113,71
CV 99,70
Mvav 128,192,104
DN 29,16,46,3072
EX 72
Mvav 128,196,108
AD 113,72
Mvav 132,204,108
EX 73
Mvav 132,200,104
s_mov_b32 m0, 0x14000
s_add_u32 s46, s47, 0x0
AD 113,73
CV 100,72
Mvav 136,208,104
Ra 128,4,32768
DN 30,20,46,0
EX 74
Mvav 136,212,108
Ra 132,5,32768
AD 113,74
Mvav 140,220,108
Ra 136,6,32768
EX 75
Mvav 140,216,104
Ra 140,7,32768
AD 113,75
CV 101,74
Mvav 144,224,104
Ra 144,4,36864
EX 76
Mvav 144,228,108
Ra 148,5,36864
DN 31,20,46,1024
AD 113,76
Mvav 148,236,108
Ra 152,6,36864
EX 77
Mvav 148,232,104
Ra 156,7,36864
AD 113,77
CV 102,76
Mvav 152,240,104
Ra 160,4,40960
EX 78
Mvav 152,244,108
Ra 164,5,40960
AD 113,78
Mvav 156,252,108
Ra 168,6,40960
DN 36,20,46,2048
EX 79
Mvav 156,248,104
s_waitcnt lgkmcnt(7)
Ra 172,7,40960
AD 113,79
CV 103,78
Zvaa 64,128,0
Ra 176,4,45056
EX 80
Mvaa 64,132,4
Ra 180,5,45056
AD 114,80
Mvaa 64,136,8
Ra 184,6,45056
EX 81
Mvaa 64,140,12
s_waitcnt lgkmcnt(7)
Ra 188,7,45056
DN 37,20,46,3072
AD 114,81
CV 104,80
Zvaa 68,156,12
EX 82
Mvaa 68,152,8
AD 114,82
Mvaa 68,148,4
s_mov_b32 m0, 0x15000
s_add_u32 s46, s47, 0x8000
EX 83
Mvaa 68,144,0
s_waitcnt lgkmcnt(4)
DN 30,20,46,0
AD 114,83
CV 105,82
Zvaa 72,160,0
EX 84
Mvaa 72,164,4
AD 114,84
Mvaa 72,168,8
EX 85
Mvaa 72,172,12
s_waitcnt lgkmcnt(0)
AD 114,85
CV 106,84
Zvaa 76,188,12
DN 31,20,46,1024
EX 86
Mvaa 76,184,8
AD 114,86
Mvaa 76,180,4
EX 87
Mvaa 76,176,0
AD 114,87
CV 107,86
Mvav 160,192,96
EX 88
Mvav 160,196,100
DN 36,20,46,2048
AD 114,88
Mvav 164,204,100
EX 89
Mvav 164,200,96
AD 114,89
CV 108,88
Mvav 168,208,96
EX 90
Mvav 168,212,100
AD 114,90
Mvav 172,220,100
DN 37,20,46,3072
EX 91
Mvav 172,216,96
AD 114,91
CV 109,90
Mvav 176,224,96
EX 92
Mvav 176,228,100
s_mov_b32 m0, 0x16000
s_add_u32 s46, s47, 0x10000
AD 114,92
Mvav 180,236,100
DN 30,20,46,0
EX 93
Mvav 180,232,96
AD 114,93
CV 110,92
Mvav 184,240,96
s_cmp_lg_u32 s29, 25
s_cbranch_scc1 L1_noct1
s_getpc_b64 s[96:97]
L1_pc1:
s_sub_u32 s96, s96, L1_pc1-concat_heads__mha_block_cached__gqa_block_cached__near_ridge_kernel
s_subb_u32 s97, s97, 0
s_lshr_b32 s92, s2, 3
s_lshl_b32 s92, s92, 13
v_lshlrev_b32 v122, 3, v1
v_add_u32 v122, s92, v122
s_mov_b32 s92, L1_codeend-concat_heads__mha_block_cached__gqa_block_cached__near_ridge_kernel-4
v_min_u32 v122, s92, v122
v_mov_b32 v123, s97
v_add_co_u32 v122, vcc, s96, v122
v_addc_co_u32 v123, vcc, 0, v123, vcc
global_load_dword v121, v[122:123], off
L1_noct1:
EX 94
Mvav 184,244,100
AD 114,94
Mvav 188,252,100
EX 95
Mvav 188,248,96
DN 31,20,46,1024
AD 114,95
CV 111,94
Zvaa 80,128,16
EX 64
Mvaa 80,132,20
AD 112,64
Mvaa 80,136,24
EX 65
Mvaa 80,140,28
AD 112,65
CV 96,64
Zvaa 84,156,28
DN 36,20,46,2048
EX 66
Mvaa 84,152,24
AD 112,66
Mvaa 84,148,20
EX 67
Mvaa 84,144,16
AD 112,67
CV 97,66
Zvaa 88,160,16
EX 68
Mvaa 88,164,20
DN 37,20,46,3072
AD 112,68
Mvaa 88,168,24
EX 69
Mvaa 88,172,28
AD 112,69
CV 98,68
Zvaa 92,188,28
s_mov_b32 m0, 0x17000
s_add_u32 s46, s47, 0x18000
EX 70
Mvaa 92,184,24
DN 30,20,46,0
AD 112,70
Mvaa 92,180,20
EX 71
Mvaa 92,176,16
AD 112,71
CV 99,70
Mvav 192,192,104
Ta 192,8,32768
Ta 194,8,36864
EX 72
Mvav 192,196,108
Ta 196,8,40960
Ta 198,8,45056
AD 112,72
Mvav 196,204,108
Ta 204,9,40960
Ta 206,9,45056
DN 31,20,46,1024
EX 73
Mvav 196,200,104
Ta 200,9,32768
Ta 202,9,36864
AD 112,73
CV 100,72
Mvav 200,208,104
Ta 208,10,32768
Ta 210,10,36864
EX 74
Mvav 200,212,108
Ta 212,10,40960
Ta 214,10,45056
AD 112,74
Mvav 204,220,108
Ta 220,11,40960
Ta 222,11,45056
EX 75
Mvav 204,216,104
Ta 216,11,32768
Ta 218,11,36864
DN 36,20,46,2048
AD 112,75
CV 101,74
Mvav 208,224,104
Ta 224,12,32768
Ta 226,12,36864
EX 76
Mvav 208,228,108
Ta 228,12,40960
Ta 230,12,45056
AD 112,76
Mvav 212,236,108
Ta 236,13,40960
Ta 238,13,45056
EX 77
Mvav 212,232,104
Ta 232,13,32768
Ta 234,13,36864
AD 112,77
CV 102,76
Mvav 216,240,104
Ta 240,14,32768
Ta 242,14,36864
DN 37,20,46,3072
EX 78
Mvav 216,244,108
Ta 244,14,40960
Ta 246,14,45056
AD 112,78
Mvav 220,252,108
Ta 252,15,40960
Ta 254,15,45056
EX 79
Mvav 220,248,104
s_add_u32 s32, s32, 16384
s_add_u32 s47, s32, s33
s_and_b32 s50, s47, 0x20000
s_lshr_b32 s47, s47, 3
s_and_b32 s47, s47, 0x3800
s_or_b32 s47, s47, s50
s_and_b32 s50, s32, 0x40000
s_or_b32 s47, s47, s50
s_add_u32 s47, s47, s90
Ta 248,15,32768
Ta 250,15,36864
AD 112,79
CV 103,78
s_add_u32 s29, s29, 1
s_waitcnt vmcnt(40) lgkmcnt(0)
s_barrier
Zvaa 64,128,32
s_mov_b32 m0, 0xb000
s_add_u32 s46, s47, 0x18000
EX 80
Mvaa 64,132,36
DN 26,16,46,0
AD 113,80
Mvaa 64,136,40
EX 81
Mvaa 64,140,44
AD 113,81
CV 104,80
Zvaa 68,156,44
EX 82
Mvaa 68,152,40
AD 113,82
Mvaa 68,148,36
DN 27,16,46,1024
EX 83
Mvaa 68,144,32
AD 113,83
CV 105,82
Zvaa 72,160,32
EX 84
Mvaa 72,164,36
AD 113,84
Mvaa 72,168,40
EX 85
Mvaa 72,172,44
DN 28,16,46,2048
AD 113,85
CV 106,84
Zvaa 76,188,44
EX 86
Mvaa 76,184,40
AD 113,86
Mvaa 76,180,36
EX 87
Mvaa 76,176,32
AD 113,87
CV 107,86
Mvav 128,192,96
DN 29,16,46,3072
EX 88
Mvav 128,196,100
AD 113,88
Mvav 132,204,100
EX 89
Mvav 132,200,96
s_mov_b32 m0, 0x18000
s_add_u32 s46, s47, 0x0
AD 113,89
CV 108,88
Mvav 136,208,96
Ra 128,4,49152
DN 30,20,46,0
EX 90
Mvav 136,212,100
Ra 132,5,49152
AD 113,90
Mvav 140,220,100
Ra 136,6,49152
EX 91
Mvav 140,216,96
Ra 140,7,49152
AD 113,91
CV 109,90
Mvav 144,224,96
Ra 144,4,53248
EX 92
Mvav 144,228,100
Ra 148,5,53248
DN 31,20,46,1024
AD 113,92
Mvav 148,236,100
Ra 152,6,53248
EX 93
Mvav 148,232,96
Ra 156,7,53248
AD 113,93
CV 110,92
Mvav 152,240,96
Ra 160,4,57344
EX 94
Mvav 152,244,100
Ra 164,5,57344
AD 113,94
Mvav 156,252,100
Ra 168,6,57344
DN 36,20,46,2048
EX 95
Mvav 156,248,96
s_waitcnt lgkmcnt(7)
Ra 172,7,57344
AD 113,95
CV 111,94
Zvaa 80,128,0
Ra 176,4,61440
EX 64
Mvaa 80,132,4
Ra 180,5,61440
AD 114,64
Mvaa 80,136,8
Ra 184,6,61440
EX 65
Mvaa 80,140,12
s_waitcnt lgkmcnt(7)
Ra 188,7,61440
DN 37,20,46,3072
AD 114,65
CV 96,64
Zvaa 84,156,12
EX 66
Mvaa 84,152,8
AD 114,66
Mvaa 84,148,4
s_mov_b32 m0, 0x19000
s_add_u32 s46, s47, 0x8000
EX 67
Mvaa 84,144,0
s_waitcnt lgkmcnt(4)
DN 30,20,46,0
AD 114,67
CV 97,66
Zvaa 88,160,0
EX 68
Mvaa 88,164,4
AD 114,68
Mvaa 88,168,8
EX 69
Mvaa 88,172,12
s_waitcnt lgkmcnt(0)
AD 114,69
CV 98,68
Zvaa 92,188,12
DN 31,20,46,1024
EX 70
Mvaa 92,184,8
AD 114,70
Mvaa 92,180,4
EX 71
Mvaa 92,176,0
AD 114,71
CV 99,70
Mvav 160,192,104
EX 72
Mvav 160,196,108
DN 36,20,46,2048
AD 114,72
Mvav 164,204,108
EX 73
Mvav 164,200,104
AD 114,73
CV 100,72
Mvav 168,208,104
EX 74
Mvav 168,212,108
AD 114,74
Mvav 172,220,108
DN 37,20,46,3072
EX 75
Mvav 172,216,104
AD 114,75
CV 101,74
Mvav 176,224,104
EX 76
Mvav 176,228,108
s_mov_b32 m0, 0x1a000
s_add_u32 s46, s47, 0x10000
AD 114,76
Mvav 180,236,108
DN 30,20,46,0
EX 77
Mvav 180,232,104
AD 114,77
CV 102,76
Mvav 184,240,104
EX 78
Mvav 184,244,108
AD 114,78
Mvav 188,252,108
EX 79
Mvav 188,248,104
DN 31,20,46,1024
AD 114,79
CV 103,78
Zvaa 64,128,16
EX 80
Mvaa 64,132,20
AD 112,80
Mvaa 64,136,24
EX 81
Mvaa 64,140,28
AD 112,81
CV 104,80
Zvaa 68,156,28
DN 36,20,46,2048
EX 82
Mvaa 68,152,24
AD 112,82
Mvaa 68,148,20
EX 83
Mvaa 68,144,16
AD 112,83
CV 105,82
Zvaa 72,160,16
EX 84
Mvaa 72,164,20
DN 37,20,46,3072
AD 112,84
Mvaa 72,168,24
EX 85
Mvaa 72,172,28
AD 112,85
CV 106,84
Zvaa 76,188,28
s_mov_b32 m0, 0x1b000
s_add_u32 s46, s47, 0x18000
EX 86
Mvaa 76,184,24
DN 30,20,46,0
AD 112,86
Mvaa 76,180,20
EX 87
Mvaa 76,176,16
AD 112,87
CV 107,86
Mvav 192,192,96
Ta 192,8,49152
Ta 194,8,53248
EX 88
Mvav 192,196,100
Ta 196,8,57344
Ta 198,8,61440
AD 112,88
Mvav 196,204,100
Ta 204,9,57344
Ta 206,9,61440
DN 31,20,46,1024
EX 89
Mvav 196,200,96
Ta 200,9,49152
Ta 202,9,53248
AD 112,89
CV 108,88
Mvav 200,208,96
Ta 208,10,49152
Ta 210,10,53248
EX 90
Mvav 200,212,100
Ta 212,10,57344
Ta 214,10,61440
AD 112,90
Mvav 204,220,100
Ta 220,11,57344
Ta 222,11,61440
EX 91
Mvav 204,216,96
Ta 216,11,49152
Ta 218,11,53248
DN 36,20,46,2048
AD 112,91
CV 109,90
Mvav 208,224,96
Ta 224,12,49152
Ta 226,12,53248
EX 92
Mvav 208,228,100
Ta 228,12,57344
Ta 230,12,61440
AD 112,92
Mvav 212,236,100
Ta 236,13,57344
Ta 238,13,61440
EX 93
Mvav 212,232,96
Ta 232,13,49152
Ta 234,13,53248
AD 112,93
CV 110,92
Mvav 216,240,96
Ta 240,14,49152
Ta 242,14,53248
DN 37,20,46,3072
EX 94
Mvav 216,244,100
Ta 244,14,57344
Ta 246,14,61440
AD 112,94
Mvav 220,252,100
Ta 252,15,57344
Ta 254,15,61440
EX 95
Mvav 220,248,96
s_add_u32 s32, s32, 16384
s_add_u32 s47, s32, s33
s_and_b32 s50, s47, 0x20000
s_lshr_b32 s47, s47, 3
s_and_b32 s47, s47, 0x3800
s_or_b32 s47, s47, s50
s_and_b32 s50, s32, 0x40000
s_or_b32 s47, s47, s50
s_add_u32 s47, s47, s90
Ta 248,15,49152
Ta 250,15,53248
AD 112,95
CV 111,94
s_add_u32 s29, s29, 1
s_waitcnt vmcnt(40) lgkmcnt(0)
s_barrier
Zvaa 80,128,32
s_mov_b32 m0, 0xf000
s_add_u32 s46, s47, 0x18000
EX 64
Mvaa 80,132,36
DN 26,16,46,0
AD 113,64
Mvaa 80,136,40
EX 65
Mvaa 80,140,44
AD 113,65
CV 96,64
Zvaa 84,156,44
EX 66
Mvaa 84,152,40
AD 113,66
Mvaa 84,148,36
DN 27,16,46,1024
EX 67
Mvaa 84,144,32
AD 113,67
CV 97,66
Zvaa 88,160,32
EX 68
Mvaa 88,164,36
AD 113,68
Mvaa 88,168,40
EX 69
Mvaa 88,172,44
DN 28,16,46,2048
AD 113,69
CV 98,68
Zvaa 92,188,44
EX 70
Mvaa 92,184,40
AD 113,70
Mvaa 92,180,36
EX 71
Mvaa 92,176,32
AD 113,71
CV 99,70
Mvav 128,192,104
DN 29,16,46,3072
EX 72
Mvav 128,196,108
AD 113,72
Mvav 132,204,108
EX 73
Mvav 132,200,104
s_mov_b32 m0, 0x1c000
s_add_u32 s46, s47, 0x0
AD 113,73
CV 100,72
Mvav 136,208,104
Ra 128,4,0
DN 30,20,46,0
EX 74
Mvav 136,212,108
Ra 132,5,0
AD 113,74
Mvav 140,220,108
Ra 136,6,0
EX 75
Mvav 140,216,104
Ra 140,7,0
AD 113,75
CV 101,74
Mvav 144,224,104
Ra 144,4,4096
EX 76
Mvav 144,228,108
Ra 148,5,4096
DN 31,20,46,1024
AD 113,76
Mvav 148,236,108
Ra 152,6,4096
EX 77
Mvav 148,232,104
Ra 156,7,4096
AD 113,77
CV 102,76
Mvav 152,240,104
Ra 160,4,8192
EX 78
Mvav 152,244,108
Ra 164,5,8192
AD 113,78
Mvav 156,252,108
Ra 168,6,8192
DN 36,20,46,2048
EX 79
Mvav 156,248,104
s_cmp_eq_u32 s29, 15
s_cbranch_scc1 L1b_flush0
L1b_flush0_back:
Ra 172,7,8192
AD 113,79
CV 103,78
s_waitcnt lgkmcnt(8)
Zvaa 64,128,0
Ra 176,4,12288
EX 80
Mvaa 64,132,4
Ra 180,5,12288
AD 114,80
Mvaa 64,136,8
Ra 184,6,12288
EX 81
Mvaa 64,140,12
s_waitcnt lgkmcnt(7)
Ra 188,7,12288
DN 37,20,46,3072
AD 114,81
CV 104,80
Zvaa 68,156,12
EX 82
Mvaa 68,152,8
AD 114,82
Mvaa 68,148,4
s_mov_b32 m0, 0x1d000
s_add_u32 s46, s47, 0x8000
EX 83
Mvaa 68,144,0
s_waitcnt lgkmcnt(4)
DN 30,20,46,0
AD 114,83
CV 105,82
Zvaa 72,160,0
EX 84
Mvaa 72,164,4
AD 114,84
Mvaa 72,168,8
EX 85
Mvaa 72,172,12
s_waitcnt lgkmcnt(0)
AD 114,85
CV 106,84
Zvaa 76,188,12
DN 31,20,46,1024
EX 86
Mvaa 76,184,8
AD 114,86
Mvaa 76,180,4
EX 87
Mvaa 76,176,0
AD 114,87
CV 107,86
Mvav 160,192,96
EX 88
Mvav 160,196,100
DN 36,20,46,2048
AD 114,88
Mvav 164,204,100
EX 89
Mvav 164,200,96
AD 114,89
CV 108,88
Mvav 168,208,96
EX 90
Mvav 168,212,100
AD 114,90
Mvav 172,220,100
DN 37,20,46,3072
EX 91
Mvav 172,216,96
AD 114,91
CV 109,90
Mvav 176,224,96
EX 92
Mvav 176,228,100
s_mov_b32 m0, 0x1e000
s_add_u32 s46, s47, 0x10000
AD 114,92
Mvav 180,236,100
DN 30,20,46,0
EX 93
Mvav 180,232,96
AD 114,93
CV 110,92
Mvav 184,240,96
EX 94
Mvav 184,244,100
AD 114,94
Mvav 188,252,100
EX 95
Mvav 188,248,96
s_cmp_eq_u32 s29, 15
s_cbranch_scc1 L1b_flush1
L1b_flush1_back:
DN 31,20,46,1024
AD 114,95
CV 111,94
Zvaa 80,128,16
EX 64
Mvaa 80,132,20
AD 112,64
Mvaa 80,136,24
EX 65
Mvaa 80,140,28
AD 112,65
CV 96,64
Zvaa 84,156,28
DN 36,20,46,2048
EX 66
Mvaa 84,152,24
AD 112,66
Mvaa 84,148,20
EX 67
Mvaa 84,144,16
AD 112,67
CV 97,66
Zvaa 88,160,16
EX 68
Mvaa 88,164,20
DN 37,20,46,3072
AD 112,68
Mvaa 88,168,24
EX 69
Mvaa 88,172,28
AD 112,69
CV 98,68
Zvaa 92,188,28
s_mov_b32 m0, 0x1f000
s_add_u32 s46, s47, 0x18000
EX 70
Mvaa 92,184,24
DN 30,20,46,0
AD 112,70
Mvaa 92,180,20
EX 71
Mvaa 92,176,16
AD 112,71
CV 99,70
Mvav 192,192,104
Ta 192,8,0
Ta 194,8,4096
EX 72
Mvav 192,196,108
Ta 196,8,8192
Ta 198,8,12288
AD 112,72
Mvav 196,204,108
Ta 204,9,8192
Ta 206,9,12288
DN 31,20,46,1024
EX 73
Mvav 196,200,104
Ta 200,9,0
Ta 202,9,4096
AD 112,73
CV 100,72
Mvav 200,208,104
Ta 208,10,0
Ta 210,10,4096
EX 74
Mvav 200,212,108
Ta 212,10,8192
Ta 214,10,12288
AD 112,74
Mvav 204,220,108
Ta 220,11,8192
Ta 222,11,12288
EX 75
Mvav 204,216,104
Ta 216,11,0
Ta 218,11,4096
DN 36,20,46,2048
AD 112,75
CV 101,74
Mvav 208,224,104
Ta 224,12,0
Ta 226,12,4096
EX 76
Mvav 208,228,108
Ta 228,12,8192
Ta 230,12,12288
AD 112,76
Mvav 212,236,108
Ta 236,13,8192
Ta 238,13,12288
EX 77
Mvav 212,232,104
Ta 232,13,0
Ta 234,13,4096
AD 112,77
CV 102,76
Mvav 216,240,104
Ta 240,14,0
Ta 242,14,4096
DN 37,20,46,3072
EX 78
Mvav 216,244,108
Ta 244,14,8192
Ta 246,14,12288
AD 112,78
Mvav 220,252,108
Ta 252,15,8192
Ta 254,15,12288
EX 79
Mvav 220,248,104
s_cmp_eq_u32 s29, 15
s_cbranch_scc1 L1b_flush2
L1b_flush2_back:
s_add_u32 s32, s32, 16384
s_add_u32 s47, s32, s33
s_and_b32 s50, s47, 0x20000
s_lshr_b32 s47, s47, 3
s_and_b32 s47, s47, 0x3800
s_or_b32 s47, s47, s50
s_and_b32 s50, s32, 0x40000
s_or_b32 s47, s47, s50
s_add_u32 s47, s47, s90
Ta 248,15,0
Ta 250,15,4096
AD 112,79
CV 103,78
s_add_u32 s29, s29, 1
s_cmp_lg_u32 s29, 28
s_cbranch_scc1 L1b_aloop
s_waitcnt vmcnt(40) lgkmcnt(0)
s_barrier
Zvaa 64,128,32
s_lshl_b32 s44, s72, 19
s_add_u32 s44, s44, 0x40000
s_mov_b32 m0, 0x23000
s_add_u32 s46, s44, 0x18000
EX 80
Mvaa 64,132,36
DD 32,52,46,0
AD 113,80
Mvaa 64,136,40
DD 33,52,46,1024
EX 81
Mvaa 64,140,44
DD 34,52,46,2048
AD 113,81
CV 104,80
Zvaa 68,156,44
DD 35,52,46,3072
EX 82
Mvaa 68,152,40
AD 113,82
Mvaa 68,148,36
s_lshl_b32 s44, s72, 19
s_add_u32 s44, s44, 0x60000
s_mov_b32 m0, 0x24000
s_add_u32 s46, s44, 0x0
EX 83
Mvaa 68,144,32
DD 32,52,46,0
AD 113,83
CV 105,82
Zvaa 72,160,32
DD 33,52,46,1024
EX 84
Mvaa 72,164,36
DD 34,52,46,2048
AD 113,84
Mvaa 72,168,40
DD 35,52,46,3072
EX 85
Mvaa 72,172,44
AD 113,85
CV 106,84
Zvaa 76,188,44
s_mov_b32 m0, 0x25000
s_add_u32 s46, s44, 0x8000
EX 86
Mvaa 76,184,40
DD 32,52,46,0
AD 113,86
Mvaa 76,180,36
DD 33,52,46,1024
EX 87
Mvaa 76,176,32
DD 34,52,46,2048
AD 113,87
CV 107,86
Mvav 128,192,96
DD 35,52,46,3072
EX 88
Mvav 128,196,100
AD 113,88
Mvav 132,204,100
s_mov_b32 m0, 0x26000
s_add_u32 s46, s44, 0x10000
EX 89
Mvav 132,200,96
DD 32,52,46,0
AD 113,89
CV 108,88
Mvav 136,208,96
Ra 128,4,16384
DD 33,52,46,1024
EX 90
Mvav 136,212,100
Ra 132,5,16384
DD 34,52,46,2048
AD 113,90
Mvav 140,220,100
Ra 136,6,16384
DD 35,52,46,3072
EX 91
Mvav 140,216,96
Ra 140,7,16384
AD 113,91
CV 109,90
Mvav 144,224,96
s_mov_b32 m0, 0x27000
s_add_u32 s46, s44, 0x18000
Ra 144,4,20480
EX 92
Mvav 144,228,100
Ra 148,5,20480
DD 32,52,46,0
AD 113,92
Mvav 148,236,100
Ra 152,6,20480
DD 33,52,46,1024
EX 93
Mvav 148,232,96
Ra 156,7,20480
DD 34,52,46,2048
AD 113,93
CV 110,92
Mvav 152,240,96
Ra 160,4,24576
DD 35,52,46,3072
EX 94
Mvav 152,244,100
Ra 164,5,24576
AD 113,94
Mvav 156,252,100
Ra 168,6,24576
EX 95
Mvav 156,248,96
s_waitcnt lgkmcnt(7)
Ra 172,7,24576
AD 113,95
CV 111,94
Zvaa 80,128,0
Ra 176,4,28672
EX 64
Mvaa 80,132,4
Ra 180,5,28672
AD 114,64
Mvaa 80,136,8
Ra 184,6,28672
EX 65
Mvaa 80,140,12
s_waitcnt lgkmcnt(7)
Ra 188,7,28672
AD 114,65
CV 96,64
Zvaa 84,156,12
EX 66
Mvaa 84,152,8
AD 114,66
Mvaa 84,148,4
EX 67
Mvaa 84,144,0
s_waitcnt lgkmcnt(4)
AD 114,67
CV 97,66
Zvaa 88,160,0
buffer_load_dwordx2 v[2:3], off, s[68:71], s74 sc1
EX 68
Mvaa 88,164,4
AD 114,68
Mvaa 88,168,8
EX 69
Mvaa 88,172,12
s_waitcnt lgkmcnt(0)
AD 114,69
CV 98,68
Zvaa 92,188,12
EX 70
Mvaa 92,184,8
AD 114,70
Mvaa 92,180,4
EX 71
Mvaa 92,176,0
AD 114,71
CV 99,70
Mvav 160,192,104
EX 72
Mvav 160,196,108
AD 114,72
Mvav 164,204,108
EX 73
Mvav 164,200,104
AD 114,73
CV 100,72
Mvav 168,208,104
EX 74
Mvav 168,212,108
AD 114,74
Mvav 172,220,108
EX 75
Mvav 172,216,104
AD 114,75
CV 101,74
Mvav 176,224,104
EX 76
Mvav 176,228,108
AD 114,76
Mvav 180,236,108
EX 77
Mvav 180,232,104
AD 114,77
CV 102,76
Mvav 184,240,104
EX 78
Mvav 184,244,108
AD 114,78
Mvav 188,252,108
EX 79
Mvav 188,248,104
AD 114,79
CV 103,78
Zvaa 64,128,16
EX 80
Mvaa 64,132,20
AD 112,80
Mvaa 64,136,24
EX 81
Mvaa 64,140,28
AD 112,81
CV 104,80
Zvaa 68,156,28
EX 82
Mvaa 68,152,24
AD 112,82
Mvaa 68,148,20
EX 83
Mvaa 68,144,16
AD 112,83
CV 105,82
Zvaa 72,160,16
EX 84
Mvaa 72,164,20
AD 112,84
Mvaa 72,168,24
EX 85
Mvaa 72,172,28
AD 112,85
CV 106,84
Zvaa 76,188,28
EX 86
Mvaa 76,184,24
AD 112,86
Mvaa 76,180,20
EX 87
Mvaa 76,176,16
AD 112,87
CV 107,86
Mvav 192,192,96
Ta 192,8,16384
Ta 194,8,20480
EX 88
Mvav 192,196,100
Ta 196,8,24576
Ta 198,8,28672
AD 112,88
Mvav 196,204,100
Ta 204,9,24576
Ta 206,9,28672
EX 89
Mvav 196,200,96
Ta 200,9,16384
Ta 202,9,20480
AD 112,89
CV 108,88
Mvav 200,208,96
Ta 208,10,16384
Ta 210,10,20480
EX 90
Mvav 200,212,100
Ta 212,10,24576
Ta 214,10,28672
AD 112,90
Mvav 204,220,100
Ta 220,11,24576
Ta 222,11,28672
EX 91
Mvav 204,216,96
Ta 216,11,16384
Ta 218,11,20480
AD 112,91
CV 109,90
Mvav 208,224,96
Ta 224,12,16384
Ta 226,12,20480
EX 92
Mvav 208,228,100
Ta 228,12,24576
Ta 230,12,28672
AD 112,92
Mvav 212,236,100
Ta 236,13,24576
Ta 238,13,28672
EX 93
Mvav 212,232,96
Ta 232,13,16384
Ta 234,13,20480
AD 112,93
CV 110,92
Mvav 216,240,96
Ta 240,14,16384
Ta 242,14,20480
EX 94
Mvav 216,244,100
Ta 244,14,24576
Ta 246,14,28672
AD 112,94
Mvav 220,252,100
Ta 252,15,24576
Ta 254,15,28672
EX 95
Mvav 220,248,96
s_waitcnt vmcnt(0)
Ta 248,15,16384
Ta 250,15,20480
AD 112,95
CV 111,94
s_add_u32 s29, s29, 1
v_readfirstlane_b32 s35, v2
v_readfirstlane_b32 s36, v3
s_nop 1
s_and_b32 s35, s35, s36
s_bitcmp1_b32 s35, 3
s_cbranch_scc0 L1_spin0
L1_spin0_back:
s_waitcnt lgkmcnt(0)
s_barrier
Zvaa 80,128,32
s_lshl_b32 s44, s72, 19
s_mov_b32 m0, 0x3000
s_add_u32 s46, s44, 0x18000
EX 64
Mvaa 80,132,36
DD 32,52,46,0
AD 113,64
Mvaa 80,136,40
DD 33,52,46,1024
EX 65
Mvaa 80,140,44
DD 34,52,46,2048
AD 113,65
CV 96,64
Zvaa 84,156,44
DD 35,52,46,3072
EX 66
Mvaa 84,152,40
AD 113,66
Mvaa 84,148,36
s_lshl_b32 s44, s72, 19
s_add_u32 s44, s44, 0x20000
s_mov_b32 m0, 0x10000
s_add_u32 s46, s44, 0x0
EX 67
Mvaa 84,144,32
DD 32,52,46,0
AD 113,67
CV 97,66
Zvaa 88,160,32
DD 33,52,46,1024
EX 68
Mvaa 88,164,36
DD 34,52,46,2048
AD 113,68
Mvaa 88,168,40
DD 35,52,46,3072
EX 69
Mvaa 88,172,44
AD 113,69
CV 98,68
Zvaa 92,188,44
s_mov_b32 m0, 0x11000
s_add_u32 s46, s44, 0x8000
EX 70
Mvaa 92,184,40
DD 32,52,46,0
AD 113,70
Mvaa 92,180,36
DD 33,52,46,1024
EX 71
Mvaa 92,176,32
DD 34,52,46,2048
AD 113,71
CV 99,70
Mvav 128,192,104
DD 35,52,46,3072
EX 72
Mvav 128,196,108
AD 113,72
Mvav 132,204,108
s_mov_b32 m0, 0x12000
s_add_u32 s46, s44, 0x10000
EX 73
Mvav 132,200,104
DD 32,52,46,0
AD 113,73
CV 100,72
Mvav 136,208,104
Ra 128,4,32768
DD 33,52,46,1024
EX 74
Mvav 136,212,108
Ra 132,5,32768
DD 34,52,46,2048
AD 113,74
Mvav 140,220,108
Ra 136,6,32768
DD 35,52,46,3072
EX 75
Mvav 140,216,104
Ra 140,7,32768
AD 113,75
CV 101,74
Mvav 144,224,104
s_mov_b32 m0, 0x13000
s_add_u32 s46, s44, 0x18000
Ra 144,4,36864
EX 76
Mvav 144,228,108
Ra 148,5,36864
DD 32,52,46,0
AD 113,76
Mvav 148,236,108
Ra 152,6,36864
DD 33,52,46,1024
EX 77
Mvav 148,232,104
Ra 156,7,36864
DD 34,52,46,2048
AD 113,77
CV 102,76
Mvav 152,240,104
Ra 160,4,40960
DD 35,52,46,3072
EX 78
Mvav 152,244,108
Ra 164,5,40960
AD 113,78
Mvav 156,252,108
Ra 168,6,40960
EX 79
Mvav 156,248,104
s_waitcnt lgkmcnt(7)
Ra 172,7,40960
AD 113,79
CV 103,78
Zvaa 64,128,0
Ra 176,4,45056
EX 80
Mvaa 64,132,4
Ra 180,5,45056
AD 114,80
Mvaa 64,136,8
Ra 184,6,45056
EX 81
Mvaa 64,140,12
s_waitcnt lgkmcnt(7)
Ra 188,7,45056
AD 114,81
CV 104,80
Zvaa 68,156,12
EX 82
Mvaa 68,152,8
AD 114,82
Mvaa 68,148,4
EX 83
Mvaa 68,144,0
s_waitcnt lgkmcnt(4)
AD 114,83
CV 105,82
Zvaa 72,160,0
EX 84
Mvaa 72,164,4
AD 114,84
Mvaa 72,168,8
EX 85
Mvaa 72,172,12
s_waitcnt lgkmcnt(0)
AD 114,85
CV 106,84
Zvaa 76,188,12
EX 86
Mvaa 76,184,8
AD 114,86
Mvaa 76,180,4
EX 87
Mvaa 76,176,0
AD 114,87
CV 107,86
Mvav 160,192,96
EX 88
Mvav 160,196,100
AD 114,88
Mvav 164,204,100
EX 89
Mvav 164,200,96
AD 114,89
CV 108,88
Mvav 168,208,96
EX 90
Mvav 168,212,100
AD 114,90
Mvav 172,220,100
EX 91
Mvav 172,216,96
AD 114,91
CV 109,90
Mvav 176,224,96
EX 92
Mvav 176,228,100
AD 114,92
Mvav 180,236,100
EX 93
Mvav 180,232,96
AD 114,93
CV 110,92
Mvav 184,240,96
EX 94
Mvav 184,244,100
AD 114,94
Mvav 188,252,100
EX 95
Mvav 188,248,96
AD 114,95
CV 111,94
Zvaa 80,128,16
EX 64
Mvaa 80,132,20
AD 112,64
Mvaa 80,136,24
EX 65
Mvaa 80,140,28
AD 112,65
CV 96,64
Zvaa 84,156,28
EX 66
Mvaa 84,152,24
AD 112,66
Mvaa 84,148,20
EX 67
Mvaa 84,144,16
AD 112,67
CV 97,66
Zvaa 88,160,16
EX 68
Mvaa 88,164,20
AD 112,68
Mvaa 88,168,24
EX 69
Mvaa 88,172,28
AD 112,69
CV 98,68
Zvaa 92,188,28
EX 70
Mvaa 92,184,24
AD 112,70
Mvaa 92,180,20
EX 71
Mvaa 92,176,16
AD 112,71
CV 99,70
Mvav 192,192,104
Ta 192,8,32768
Ta 194,8,36864
EX 72
Mvav 192,196,108
Ta 196,8,40960
Ta 198,8,45056
AD 112,72
Mvav 196,204,108
Ta 204,9,40960
Ta 206,9,45056
EX 73
Mvav 196,200,104
Ta 200,9,32768
Ta 202,9,36864
AD 112,73
CV 100,72
Mvav 200,208,104
Ta 208,10,32768
Ta 210,10,36864
EX 74
Mvav 200,212,108
Ta 212,10,40960
Ta 214,10,45056
AD 112,74
Mvav 204,220,108
Ta 220,11,40960
Ta 222,11,45056
EX 75
Mvav 204,216,104
Ta 216,11,32768
Ta 218,11,36864
AD 112,75
CV 101,74
Mvav 208,224,104
Ta 224,12,32768
Ta 226,12,36864
EX 76
Mvav 208,228,108
Ta 228,12,40960
Ta 230,12,45056
AD 112,76
Mvav 212,236,108
Ta 236,13,40960
Ta 238,13,45056
EX 77
Mvav 212,232,104
Ta 232,13,32768
Ta 234,13,36864
AD 112,77
CV 102,76
Mvav 216,240,104
Ta 240,14,32768
Ta 242,14,36864
EX 78
Mvav 216,244,108
Ta 244,14,40960
Ta 246,14,45056
AD 112,78
Mvav 220,252,108
Ta 252,15,40960
Ta 254,15,45056
EX 79
Mvav 220,248,104
Ta 248,15,32768
Ta 250,15,36864
AD 112,79
CV 103,78
s_add_u32 s29, s29, 1
s_waitcnt lgkmcnt(0)
s_barrier
Zvaa 64,128,32
s_cmp_le_u32 s72, 0
s_addc_u32 s44, 0, 0
s_lshl_b32 s44, s44, 19
s_mov_b32 m0, 0x7000
s_add_u32 s46, s44, 0x18000
EX 80
Mvaa 64,132,36
DD 32,52,46,0
AD 113,80
Mvaa 64,136,40
DD 33,52,46,1024
EX 81
Mvaa 64,140,44
DD 34,52,46,2048
AD 113,81
CV 104,80
Zvaa 68,156,44
DD 35,52,46,3072
EX 82
Mvaa 68,152,40
AD 113,82
Mvaa 68,148,36
s_cmp_le_u32 s72, 0
s_addc_u32 s44, 0, 0
s_lshl_b32 s44, s44, 19
s_add_u32 s44, s44, 0x20000
s_mov_b32 m0, 0x14000
s_add_u32 s46, s44, 0x0
EX 83
Mvaa 68,144,32
DD 32,52,46,0
AD 113,83
CV 105,82
Zvaa 72,160,32
DD 33,52,46,1024
EX 84
Mvaa 72,164,36
DD 34,52,46,2048
AD 113,84
Mvaa 72,168,40
DD 35,52,46,3072
EX 85
Mvaa 72,172,44
AD 113,85
CV 106,84
Zvaa 76,188,44
s_mov_b32 m0, 0x15000
s_add_u32 s46, s44, 0x8000
EX 86
Mvaa 76,184,40
DD 32,52,46,0
AD 113,86
Mvaa 76,180,36
DD 33,52,46,1024
EX 87
Mvaa 76,176,32
DD 34,52,46,2048
AD 113,87
CV 107,86
Mvav 128,192,96
DD 35,52,46,3072
EX 88
Mvav 128,196,100
AD 113,88
Mvav 132,204,100
s_mov_b32 m0, 0x16000
s_add_u32 s46, s44, 0x10000
EX 89
Mvav 132,200,96
DD 32,52,46,0
AD 113,89
CV 108,88
Mvav 136,208,96
Ra 128,4,49152
DD 33,52,46,1024
EX 90
Mvav 136,212,100
Ra 132,5,49152
DD 34,52,46,2048
AD 113,90
Mvav 140,220,100
Ra 136,6,49152
DD 35,52,46,3072
EX 91
Mvav 140,216,96
Ra 140,7,49152
AD 113,91
CV 109,90
Mvav 144,224,96
s_mov_b32 m0, 0x17000
s_add_u32 s46, s44, 0x18000
Ra 144,4,53248
EX 92
Mvav 144,228,100
Ra 148,5,53248
DD 32,52,46,0
AD 113,92
Mvav 148,236,100
Ra 152,6,53248
DD 33,52,46,1024
EX 93
Mvav 148,232,96
Ra 156,7,53248
DD 34,52,46,2048
AD 113,93
CV 110,92
Mvav 152,240,96
Ra 160,4,57344
DD 35,52,46,3072
EX 94
Mvav 152,244,100
Ra 164,5,57344
AD 113,94
Mvav 156,252,100
Ra 168,6,57344
EX 95
Mvav 156,248,96
s_waitcnt lgkmcnt(7)
Ra 172,7,57344
AD 113,95
CV 111,94
Zvaa 80,128,0
Ra 176,4,61440
EX 64
Mvaa 80,132,4
Ra 180,5,61440
AD 114,64
Mvaa 80,136,8
Ra 184,6,61440
EX 65
Mvaa 80,140,12
s_waitcnt lgkmcnt(7)
Ra 188,7,61440
AD 114,65
CV 96,64
Zvaa 84,156,12
EX 66
Mvaa 84,152,8
AD 114,66
Mvaa 84,148,4
EX 67
Mvaa 84,144,0
s_waitcnt lgkmcnt(4)
AD 114,67
CV 97,66
Zvaa 88,160,0
EX 68
Mvaa 88,164,4
AD 114,68
Mvaa 88,168,8
EX 69
Mvaa 88,172,12
s_waitcnt lgkmcnt(0)
AD 114,69
CV 98,68
Zvaa 92,188,12
EX 70
Mvaa 92,184,8
AD 114,70
Mvaa 92,180,4
EX 71
Mvaa 92,176,0
AD 114,71
CV 99,70
Mvav 160,192,104
EX 72
Mvav 160,196,108
AD 114,72
Mvav 164,204,108
EX 73
Mvav 164,200,104
AD 114,73
CV 100,72
Mvav 168,208,104
EX 74
Mvav 168,212,108
AD 114,74
Mvav 172,220,108
EX 75
Mvav 172,216,104
AD 114,75
CV 101,74
Mvav 176,224,104
EX 76
Mvav 176,228,108
AD 114,76
Mvav 180,236,108
EX 77
Mvav 180,232,104
AD 114,77
CV 102,76
Mvav 184,240,104
EX 78
Mvav 184,244,108
AD 114,78
Mvav 188,252,108
EX 79
Mvav 188,248,104
AD 114,79
CV 103,78
Zvaa 64,128,16
EX 80
Mvaa 64,132,20
AD 112,80
Mvaa 64,136,24
EX 81
Mvaa 64,140,28
AD 112,81
CV 104,80
Zvaa 68,156,28
EX 82
Mvaa 68,152,24
AD 112,82
Mvaa 68,148,20
EX 83
Mvaa 68,144,16
AD 112,83
CV 105,82
Zvaa 72,160,16
EX 84
Mvaa 72,164,20
AD 112,84
Mvaa 72,168,24
EX 85
Mvaa 72,172,28
AD 112,85
CV 106,84
Zvaa 76,188,28
EX 86
Mvaa 76,184,24
AD 112,86
Mvaa 76,180,20
EX 87
Mvaa 76,176,16
AD 112,87
CV 107,86
Mvav 192,192,96
Ta 192,8,49152
Ta 194,8,53248
EX 88
Mvav 192,196,100
Ta 196,8,57344
Ta 198,8,61440
AD 112,88
Mvav 196,204,100
Ta 204,9,57344
Ta 206,9,61440
EX 89
Mvav 196,200,96
Ta 200,9,49152
Ta 202,9,53248
AD 112,89
CV 108,88
Mvav 200,208,96
Ta 208,10,49152
Ta 210,10,53248
EX 90
Mvav 200,212,100
Ta 212,10,57344
Ta 214,10,61440
AD 112,90
Mvav 204,220,100
Ta 220,11,57344
Ta 222,11,61440
EX 91
Mvav 204,216,96
Ta 216,11,49152
Ta 218,11,53248
AD 112,91
CV 109,90
Mvav 208,224,96
Ta 224,12,49152
Ta 226,12,53248
EX 92
Mvav 208,228,100
Ta 228,12,57344
Ta 230,12,61440
AD 112,92
Mvav 212,236,100
Ta 236,13,57344
Ta 238,13,61440
EX 93
Mvav 212,232,96
Ta 232,13,49152
Ta 234,13,53248
AD 112,93
CV 110,92
Mvav 216,240,96
Ta 240,14,49152
Ta 242,14,53248
EX 94
Mvav 216,244,100
Ta 244,14,57344
Ta 246,14,61440
AD 112,94
Mvav 220,252,100
Ta 252,15,57344
Ta 254,15,61440
EX 95
Mvav 220,248,96
Ta 248,15,49152
Ta 250,15,53248
AD 112,95
CV 111,94
s_add_u32 s29, s29, 1
Zvaa 80,128,32
s_cmp_le_u32 s72, 1
s_addc_u32 s44, 1, 0
s_lshl_b32 s44, s44, 19
s_mov_b32 m0, 0xb000
s_add_u32 s46, s44, 0x18000
EX 64
Mvaa 80,132,36
DD 32,52,46,0
AD 113,64
Mvaa 80,136,40
DD 33,52,46,1024
EX 65
Mvaa 80,140,44
DD 34,52,46,2048
AD 113,65
CV 96,64
Zvaa 84,156,44
DD 35,52,46,3072
EX 66
Mvaa 84,152,40
AD 113,66
Mvaa 84,148,36
s_cmp_le_u32 s72, 1
s_addc_u32 s44, 1, 0
s_lshl_b32 s44, s44, 19
s_add_u32 s44, s44, 0x20000
s_mov_b32 m0, 0x18000
s_add_u32 s46, s44, 0x0
EX 67
Mvaa 84,144,32
DD 32,52,46,0
AD 113,67
CV 97,66
Zvaa 88,160,32
DD 33,52,46,1024
EX 68
Mvaa 88,164,36
DD 34,52,46,2048
AD 113,68
Mvaa 88,168,40
DD 35,52,46,3072
EX 69
Mvaa 88,172,44
AD 113,69
CV 98,68
Zvaa 92,188,44
s_mov_b32 m0, 0x19000
s_add_u32 s46, s44, 0x8000
EX 70
Mvaa 92,184,40
DD 32,52,46,0
AD 113,70
Mvaa 92,180,36
DD 33,52,46,1024
EX 71
Mvaa 92,176,32
s_waitcnt lgkmcnt(15)
DD 34,52,46,2048
AD 113,71
CV 99,70
Mvav 128,192,104
DD 35,52,46,3072
EX 72
Mvav 128,196,108
s_waitcnt lgkmcnt(15)
AD 113,72
Mvav 132,204,108
s_mov_b32 m0, 0x1a000
s_add_u32 s46, s44, 0x10000
EX 73
Mvav 132,200,104
s_waitcnt lgkmcnt(15)
DD 32,52,46,0
AD 113,73
CV 100,72
Mvav 136,208,104
DD 33,52,46,1024
EX 74
Mvav 136,212,108
s_waitcnt lgkmcnt(15)
DD 34,52,46,2048
AD 113,74
Mvav 140,220,108
DD 35,52,46,3072
EX 75
Mvav 140,216,104
s_waitcnt lgkmcnt(12)
AD 113,75
CV 101,74
Mvav 144,224,104
s_mov_b32 m0, 0x1b000
s_add_u32 s46, s44, 0x18000
EX 76
Mvav 144,228,108
s_waitcnt lgkmcnt(8)
DD 32,52,46,0
AD 113,76
Mvav 148,236,108
DD 33,52,46,1024
EX 77
Mvav 148,232,104
s_waitcnt lgkmcnt(4)
DD 34,52,46,2048
AD 113,77
CV 102,76
Mvav 152,240,104
DD 35,52,46,3072
EX 78
Mvav 152,244,108
s_waitcnt lgkmcnt(0)
AD 113,78
Mvav 156,252,108
EX 79
Mvav 156,248,104
AD 113,79
CV 103,78
v_mov_b32 v40, v112
s_nop 1
v_permlane32_swap_b32 v112, v40
AD 112,40
v_mov_b32 v40, v112
s_nop 1
v_permlane16_swap_b32 v112, v40
AD 112,40
v_subrev_u32 v40, 0x30800000, v112
v_cmp_lt_u32 vcc, 0x1b000000, v40
s_nop 1
s_cbranch_vccnz L1b_ffin0_slow
L1b_ffin0_rcp:
v_rcp_f32 v112, v112
s_add_u32 s50, s48, 4096
v_pk_mul_f32 v[40:41], v[128:129], v[112:113] op_sel_hi:[1,0]
v_pk_mul_f32 v[42:43], v[130:131], v[112:113] op_sel_hi:[1,0]
v_pk_mul_f32 v[44:45], v[132:133], v[112:113] op_sel_hi:[1,0]
v_pk_mul_f32 v[46:47], v[134:135], v[112:113] op_sel_hi:[1,0]
CV 128,40
CV 129,42
CV 130,44
CV 131,46
buffer_store_dwordx4 v[128:131], v1, s[24:27], s50 offen sc1
v_pk_mul_f32 v[40:41], v[136:137], v[112:113] op_sel_hi:[1,0]
v_pk_mul_f32 v[42:43], v[138:139], v[112:113] op_sel_hi:[1,0]
v_pk_mul_f32 v[44:45], v[140:141], v[112:113] op_sel_hi:[1,0]
v_pk_mul_f32 v[46:47], v[142:143], v[112:113] op_sel_hi:[1,0]
CV 132,40
CV 133,42
CV 134,44
CV 135,46
buffer_store_dwordx4 v[132:135], v1, s[24:27], s50 offen offset:1024 sc1
v_pk_mul_f32 v[40:41], v[144:145], v[112:113] op_sel_hi:[1,0]
v_pk_mul_f32 v[42:43], v[146:147], v[112:113] op_sel_hi:[1,0]
v_pk_mul_f32 v[44:45], v[148:149], v[112:113] op_sel_hi:[1,0]
v_pk_mul_f32 v[46:47], v[150:151], v[112:113] op_sel_hi:[1,0]
CV 136,40
CV 137,42
CV 138,44
CV 139,46
buffer_store_dwordx4 v[136:139], v1, s[24:27], s50 offen offset:2048 sc1
v_pk_mul_f32 v[40:41], v[152:153], v[112:113] op_sel_hi:[1,0]
v_pk_mul_f32 v[42:43], v[154:155], v[112:113] op_sel_hi:[1,0]
v_pk_mul_f32 v[44:45], v[156:157], v[112:113] op_sel_hi:[1,0]
v_pk_mul_f32 v[46:47], v[158:159], v[112:113] op_sel_hi:[1,0]
CV 140,40
CV 141,42
CV 142,44
CV 143,46
buffer_store_dwordx4 v[140:143], v1, s[24:27], s50 offen offset:3072 sc1
L1b_ffin0_done:
Mvav 160,192,96
EX 80
EX 81
Mvav 160,196,100
EX 82
EX 83
Mvav 164,204,100
EX 84
EX 85
Mvav 164,200,96
EX 86
EX 87
Mvav 168,208,96
AD 114,80
EX 88
EX 89
Mvav 168,212,100
AD 114,81
EX 90
EX 91
Mvav 172,220,100
AD 114,82
EX 92
EX 93
Mvav 172,216,96
AD 114,83
EX 94
EX 95
Mvav 176,224,96
AD 114,84
AD 114,85
CV 104,80
Mvav 176,228,100
AD 114,86
AD 114,87
CV 105,82
Mvav 180,236,100
AD 114,88
AD 114,89
CV 106,84
Mvav 180,232,96
AD 114,90
AD 114,91
CV 107,86
Mvav 184,240,96
AD 114,92
CV 108,88
Mvav 184,244,100
AD 114,93
CV 109,90
Mvav 188,252,100
AD 114,94
CV 110,92
Mvav 188,248,96
AD 114,95
CV 111,94
v_mov_b32 v40, v113
s_nop 1
v_permlane32_swap_b32 v113, v40
AD 113,40
v_mov_b32 v40, v113
s_nop 1
v_permlane16_swap_b32 v113, v40
AD 113,40
v_subrev_u32 v40, 0x30800000, v113
v_cmp_lt_u32 vcc, 0x1b000000, v40
s_nop 1
s_cbranch_vccnz L1b_ffin1_slow
L1b_ffin1_rcp:
v_rcp_f32 v113, v113
s_add_u32 s50, s48, 135168
v_pk_mul_f32 v[40:41], v[160:161], v[112:113] op_sel:[0,1] op_sel_hi:[1,1]
v_pk_mul_f32 v[42:43], v[162:163], v[112:113] op_sel:[0,1] op_sel_hi:[1,1]
v_pk_mul_f32 v[44:45], v[164:165], v[112:113] op_sel:[0,1] op_sel_hi:[1,1]
v_pk_mul_f32 v[46:47], v[166:167], v[112:113] op_sel:[0,1] op_sel_hi:[1,1]
CV 160,40
CV 161,42
CV 162,44
CV 163,46
buffer_store_dwordx4 v[160:163], v1, s[24:27], s50 offen sc1
v_pk_mul_f32 v[40:41], v[168:169], v[112:113] op_sel:[0,1] op_sel_hi:[1,1]
v_pk_mul_f32 v[42:43], v[170:171], v[112:113] op_sel:[0,1] op_sel_hi:[1,1]
v_pk_mul_f32 v[44:45], v[172:173], v[112:113] op_sel:[0,1] op_sel_hi:[1,1]
v_pk_mul_f32 v[46:47], v[174:175], v[112:113] op_sel:[0,1] op_sel_hi:[1,1]
CV 164,40
CV 165,42
CV 166,44
CV 167,46
buffer_store_dwordx4 v[164:167], v1, s[24:27], s50 offen offset:1024 sc1
v_pk_mul_f32 v[40:41], v[176:177], v[112:113] op_sel:[0,1] op_sel_hi:[1,1]
v_pk_mul_f32 v[42:43], v[178:179], v[112:113] op_sel:[0,1] op_sel_hi:[1,1]
v_pk_mul_f32 v[44:45], v[180:181], v[112:113] op_sel:[0,1] op_sel_hi:[1,1]
v_pk_mul_f32 v[46:47], v[182:183], v[112:113] op_sel:[0,1] op_sel_hi:[1,1]
CV 168,40
CV 169,42
CV 170,44
CV 171,46
buffer_store_dwordx4 v[168:171], v1, s[24:27], s50 offen offset:2048 sc1
v_pk_mul_f32 v[40:41], v[184:185], v[112:113] op_sel:[0,1] op_sel_hi:[1,1]
v_pk_mul_f32 v[42:43], v[186:187], v[112:113] op_sel:[0,1] op_sel_hi:[1,1]
v_pk_mul_f32 v[44:45], v[188:189], v[112:113] op_sel:[0,1] op_sel_hi:[1,1]
v_pk_mul_f32 v[46:47], v[190:191], v[112:113] op_sel:[0,1] op_sel_hi:[1,1]
CV 172,40
CV 173,42
CV 174,44
CV 175,46
buffer_store_dwordx4 v[172:175], v1, s[24:27], s50 offen offset:3072 sc1
L1b_ffin1_done:
Mvav 192,192,104
Mvav 192,196,108
Mvav 196,204,108
Mvav 196,200,104
Mvav 200,208,104
Mvav 200,212,108
Mvav 204,220,108
Mvav 204,216,104
Mvav 208,224,104
Mvav 208,228,108
Mvav 212,236,108
Mvav 212,232,104
Mvav 216,240,104
Mvav 216,244,108
Mvav 220,252,108
Mvav 220,248,104
s_barrier
v_add_u32 v24, 0x10000, v8
v_add_u32 v25, 0x10000, v9
v_add_u32 v26, 0x10000, v10
v_add_u32 v27, 0x10000, v11
v_add_u32 v28, 0x10000, v12
v_add_u32 v29, 0x10000, v13
v_add_u32 v30, 0x10000, v14
v_add_u32 v31, 0x10000, v15
v_subrev_u32 v16, 0x10000, v8
v_subrev_u32 v17, 0x10000, v9
v_subrev_u32 v18, 0x10000, v10
v_subrev_u32 v19, 0x10000, v11
v_subrev_u32 v20, 0x10000, v12
v_subrev_u32 v21, 0x10000, v13
v_subrev_u32 v22, 0x10000, v14
v_subrev_u32 v23, 0x10000, v15
Ta 192,24,0
Ta 194,24,4096
Ta 196,24,8192
Ta 198,24,12288
Ta 200,25,0
Ta 202,25,4096
Ta 204,25,8192
Ta 206,25,12288
Ta 208,26,0
Ta 210,26,4096
Ta 212,26,8192
Ta 214,26,12288
v_add_u32 v4, 0x0, v1
v_add_u32 v5, 0x20000, v1
v_add_u32 v6, 0x40000, v1
v_add_u32 v7, 0x60000, v1
v_mov_b32 v40, v114
s_nop 1
v_permlane32_swap_b32 v114, v40
AD 114,40
v_mov_b32 v40, v114
s_nop 1
v_permlane16_swap_b32 v114, v40
AD 114,40
v_subrev_u32 v40, 0x30800000, v114
v_cmp_lt_u32 vcc, 0x1b000000, v40
s_nop 1
s_cbranch_vccnz L1b_ffin2_slow
L1b_ffin2_rcp:
v_rcp_f32 v114, v114
s_add_u32 s50, s48, 266240
v_pk_mul_f32 v[40:41], v[192:193], v[114:115] op_sel_hi:[1,0]
v_pk_mul_f32 v[42:43], v[194:195], v[114:115] op_sel_hi:[1,0]
v_pk_mul_f32 v[44:45], v[196:197], v[114:115] op_sel_hi:[1,0]
v_pk_mul_f32 v[46:47], v[198:199], v[114:115] op_sel_hi:[1,0]
CV 192,40
CV 193,42
CV 194,44
CV 195,46
buffer_store_dwordx4 v[192:195], v1, s[24:27], s50 offen sc1
v_pk_mul_f32 v[40:41], v[200:201], v[114:115] op_sel_hi:[1,0]
v_pk_mul_f32 v[42:43], v[202:203], v[114:115] op_sel_hi:[1,0]
v_pk_mul_f32 v[44:45], v[204:205], v[114:115] op_sel_hi:[1,0]
v_pk_mul_f32 v[46:47], v[206:207], v[114:115] op_sel_hi:[1,0]
CV 196,40
CV 197,42
CV 198,44
CV 199,46
buffer_store_dwordx4 v[196:199], v1, s[24:27], s50 offen offset:1024 sc1
v_pk_mul_f32 v[40:41], v[208:209], v[114:115] op_sel_hi:[1,0]
v_pk_mul_f32 v[42:43], v[210:211], v[114:115] op_sel_hi:[1,0]
v_pk_mul_f32 v[44:45], v[212:213], v[114:115] op_sel_hi:[1,0]
v_pk_mul_f32 v[46:47], v[214:215], v[114:115] op_sel_hi:[1,0]
CV 200,40
CV 201,42
CV 202,44
CV 203,46
buffer_store_dwordx4 v[200:203], v1, s[24:27], s50 offen offset:2048 sc1
v_pk_mul_f32 v[40:41], v[216:217], v[114:115] op_sel_hi:[1,0]
v_pk_mul_f32 v[42:43], v[218:219], v[114:115] op_sel_hi:[1,0]
v_pk_mul_f32 v[44:45], v[220:221], v[114:115] op_sel_hi:[1,0]
v_pk_mul_f32 v[46:47], v[222:223], v[114:115] op_sel_hi:[1,0]
CV 204,40
CV 205,42
CV 206,44
CV 207,46
buffer_store_dwordx4 v[204:207], v1, s[24:27], s50 offen offset:3072 sc1
L1b_ffin2_done:
s_nop 1
s_waitcnt lgkmcnt(8)
Zaav 128,192,128
s_cmp_le_u32 s72, 2
s_addc_u32 s44, 2, 0
s_lshl_b32 s44, s44, 19
s_mov_b32 m0, 0xc000
s_add_u32 s46, s44, 0x0
s_cmp_le_u32 s72, 0
s_addc_u32 s45, 0, 0
s_lshl_b32 s45, s45, 13
s_add_u32 s45, s45, s48
Ta 216,27,0
Maav 128,196,132
Ta 218,27,4096
Lv 144,4,56,45,0
Zaav 144,196,164
Ta 220,27,8192
DD 32,52,46,0
Maav 144,192,160
Ta 222,27,12288
DD 33,52,46,1024
Zaav 160,192,192
DD 34,52,46,2048
Maav 160,196,196
s_waitcnt lgkmcnt(8)
DD 35,52,46,3072
Lv 148,4,56,45,1024
Zaav 164,204,196
Ta 192,28,0
Maav 164,200,192
Ta 194,28,4096
Lv 176,5,56,45,0
Zaav 148,200,160
Ta 196,28,8192
Maav 148,204,164
Ta 198,28,12288
Zaav 132,204,132
Maav 132,200,128
s_waitcnt lgkmcnt(8)
Zaav 136,208,128
s_mov_b32 m0, 0xd000
s_add_u32 s46, s44, 0x8000
Ta 200,29,0
Maav 136,212,132
Ta 202,29,4096
Lv 180,5,56,45,1024
Zaav 152,212,164
Ta 204,29,8192
DD 32,52,46,0
Maav 152,208,160
Ta 206,29,12288
DD 33,52,46,1024
Zaav 168,208,192
DD 34,52,46,2048
Maav 168,212,196
s_waitcnt lgkmcnt(8)
DD 35,52,46,3072
Zaav 172,220,196
Ta 208,30,0
Maav 172,216,192
Ta 210,30,4096
Lv 208,6,56,45,0
Zaav 156,216,160
Ta 212,30,8192
Maav 156,220,164
Ta 214,30,12288
Zaav 140,220,132
Maav 140,216,128
s_waitcnt lgkmcnt(8)
Zvav 64,192,128
s_mov_b32 m0, 0xe000
s_add_u32 s46, s44, 0x10000
Ta 216,31,0
Mvav 64,196,132
Ta 218,31,4096
Lv 212,6,56,45,1024
Zvav 80,196,164
Ta 220,31,8192
DD 32,52,46,0
Mvav 80,192,160
Ta 222,31,12288
DD 33,52,46,1024
Zvav 96,192,192
DD 34,52,46,2048
Mvav 96,196,196
s_waitcnt lgkmcnt(8)
DD 35,52,46,3072
Zvav 100,204,196
s_cmp_le_u32 s72, 0
s_addc_u32 s45, 0, 0
s_lshl_b32 s45, s45, 13
s_add_u32 s45, s45, 0x800
s_add_u32 s45, s45, s48
Ta 192,24,16384
Mvav 100,200,192
Ta 194,24,20480
Lv 152,4,56,45,0
Zvav 84,200,160
Ta 196,24,24576
Mvav 84,204,164
Ta 198,24,28672
Zvav 68,204,132
Mvav 68,200,128
s_waitcnt lgkmcnt(8)
Zvav 72,208,128
s_mov_b32 m0, 0xf000
s_add_u32 s46, s44, 0x18000
Ta 200,25,16384
Mvav 72,212,132
Ta 202,25,20480
Lv 156,4,56,45,1024
Zvav 88,212,164
Ta 204,25,24576
DD 32,52,46,0
Mvav 88,208,160
Ta 206,25,28672
DD 33,52,46,1024
Zvav 104,208,192
DD 34,52,46,2048
Mvav 104,212,196
s_waitcnt lgkmcnt(8)
DD 35,52,46,3072
Zvav 108,220,196
Ta 208,26,16384
Mvav 108,216,192
Ta 210,26,20480
Lv 184,5,56,45,0
Zvav 92,216,160
Ta 212,26,24576
Mvav 92,220,164
Ta 214,26,28672
Zvav 76,220,132
Mvav 76,216,128
s_waitcnt lgkmcnt(8)
Maav 128,192,136
Ta 216,27,16384
Maav 128,196,140
Ta 218,27,20480
Maav 144,196,172
Ta 220,27,24576
Maav 144,192,168
Ta 222,27,28672
Maav 160,192,200
Maav 160,196,204
s_waitcnt lgkmcnt(8)
Maav 164,204,204
Ta 192,28,16384
Maav 164,200,200
Ta 194,28,20480
Lv 188,5,56,45,1024
Maav 148,200,168
Ta 196,28,24576
Maav 148,204,172
Ta 198,28,28672
Maav 132,204,140
Maav 132,200,136
s_waitcnt lgkmcnt(8)
Maav 136,208,136
Ta 200,29,16384
Maav 136,212,140
Ta 202,29,20480
Lv 216,6,56,45,0
Maav 152,212,172
Ta 204,29,24576
Maav 152,208,168
Ta 206,29,28672
Maav 168,208,200
Maav 168,212,204
s_waitcnt lgkmcnt(8)
Maav 172,220,204
Ta 208,30,16384
Maav 172,216,200
Ta 210,30,20480
Lv 220,6,56,45,1024
Maav 156,216,168
Ta 212,30,24576
Maav 156,220,172
Ta 214,30,28672
Maav 140,220,140
Maav 140,216,136
s_waitcnt lgkmcnt(8)
Mvav 64,192,136
Ta 216,31,16384
Mvav 64,196,140
Ta 218,31,20480
Mvav 80,196,172
Ta 220,31,24576
Mvav 80,192,168
Ta 222,31,28672
Mvav 96,192,200
Mvav 96,196,204
s_waitcnt vmcnt(28)
s_barrier
s_mov_b64 exec, 1
v_mov_b32 v2, 0x100
buffer_atomic_add v2, off, s[68:71], s73 sc1
s_mov_b64 exec, -1
s_waitcnt lgkmcnt(8)
Mvav 100,204,204
s_cmp_le_u32 s72, 2
s_addc_u32 s44, 2, 0
s_lshl_b32 s44, s44, 19
s_add_u32 s44, s44, 0x20000
s_mov_b32 m0, 0x1c000
s_add_u32 s46, s44, 0x0
s_cmp_le_u32 s72, 1
s_addc_u32 s45, 1, 0
s_lshl_b32 s45, s45, 13
s_add_u32 s45, s45, s48
Ta 192,16,0
Mvav 100,200,200
Ta 194,16,4096
La 0,4,56,45,0
Mvav 84,200,168
Ta 196,16,8192
DD 32,52,46,0
Mvav 84,204,172
Ta 198,16,12288
DD 33,52,46,1024
Mvav 68,204,140
DD 34,52,46,2048
Mvav 68,200,136
s_waitcnt lgkmcnt(8)
DD 35,52,46,3072
Mvav 72,208,136
Ta 200,17,0
Mvav 72,212,140
Ta 202,17,4096
La 4,4,56,45,1024
Mvav 88,212,172
Ta 204,17,8192
Mvav 88,208,168
Ta 206,17,12288
Mvav 104,208,200
Mvav 104,212,204
s_waitcnt lgkmcnt(8)
Mvav 108,220,204
s_mov_b32 m0, 0x1d000
s_add_u32 s46, s44, 0x8000
Ta 208,18,0
Mvav 108,216,200
Ta 210,18,4096
La 16,5,56,45,0
Mvav 92,216,168
Ta 212,18,8192
DD 32,52,46,0
Mvav 92,220,172
Ta 214,18,12288
DD 33,52,46,1024
Mvav 76,220,140
DD 34,52,46,2048
Mvav 76,216,136
s_waitcnt lgkmcnt(8)
DD 35,52,46,3072
Maaa 128,192,64
Ta 216,19,0
Maaa 128,196,68
Ta 218,19,4096
Maaa 144,196,84
Ta 220,19,8192
Maaa 144,192,80
Ta 222,19,12288
Maaa 160,192,96
Maaa 160,196,100
s_waitcnt lgkmcnt(8)
Maaa 164,204,100
s_mov_b32 m0, 0x1e000
s_add_u32 s46, s44, 0x10000
Ta 192,20,0
Maaa 164,200,96
Ta 194,20,4096
La 20,5,56,45,1024
Maaa 148,200,80
Ta 196,20,8192
DD 32,52,46,0
Maaa 148,204,84
Ta 198,20,12288
DD 33,52,46,1024
Maaa 132,204,68
DD 34,52,46,2048
Maaa 132,200,64
s_waitcnt lgkmcnt(8)
DD 35,52,46,3072
Maaa 136,208,64
Ta 200,21,0
Maaa 136,212,68
Ta 202,21,4096
La 32,6,56,45,0
Maaa 152,212,84
Ta 204,21,8192
Maaa 152,208,80
Ta 206,21,12288
Maaa 168,208,96
Maaa 168,212,100
s_waitcnt lgkmcnt(8)
Maaa 172,220,100
s_mov_b32 m0, 0x1f000
s_add_u32 s46, s44, 0x18000
Ta 208,22,0
Maaa 172,216,96
Ta 210,22,4096
La 36,6,56,45,1024
Maaa 156,216,80
Ta 212,22,8192
DD 32,52,46,0
Maaa 156,220,84
Ta 214,22,12288
DD 33,52,46,1024
Maaa 140,220,68
DD 34,52,46,2048
Maaa 140,216,64
s_waitcnt lgkmcnt(8)
DD 35,52,46,3072
Mvaa 64,192,64
Ta 216,23,0
Mvaa 64,196,68
Ta 218,23,4096
Mvaa 80,196,84
Ta 220,23,8192
Mvaa 80,192,80
Ta 222,23,12288
Mvaa 96,192,96
Mvaa 96,196,100
s_waitcnt lgkmcnt(8)
Mvaa 100,204,100
s_cmp_le_u32 s72, 3
s_addc_u32 s44, 3, 0
s_lshl_b32 s44, s44, 19
s_mov_b32 m0, 0x20000
s_add_u32 s46, s44, 0x0
s_cmp_le_u32 s72, 1
s_addc_u32 s45, 1, 0
s_lshl_b32 s45, s45, 13
s_add_u32 s45, s45, 0x800
s_add_u32 s45, s45, s48
Ta 192,8,0
Mvaa 100,200,96
Ta 194,8,4096
La 8,4,56,45,0
Mvaa 84,200,80
Ta 196,8,8192
DD 32,52,46,0
v_lshrrev_b32 v40, 4, v1
Mvaa 84,204,84
Ta 198,8,12288
DD 33,52,46,1024
v_and_b32 v41, 15, v40
Mvaa 68,204,68
DD 34,52,46,2048
v_lshrrev_b32 v40, 4, v40
Mvaa 68,200,64
s_waitcnt lgkmcnt(8)
DD 35,52,46,3072
v_lshrrev_b32 v42, 2, v41
Mvaa 72,208,64
Ta 200,9,0
v_and_b32 v43, 1, v41
Mvaa 72,212,68
Ta 202,9,4096
La 12,4,56,45,1024
v_lshlrev_b32 v43, 4, v43
Mvaa 88,212,84
Ta 204,9,8192
v_mov_b32 v44, 0x3f80
Mvaa 88,208,80
Ta 206,9,12288
v_lshlrev_b32 v44, v43, v44
Mvaa 104,208,96
v_cmp_eq_u32 vcc, v42, v40
Mvaa 104,212,100
s_waitcnt lgkmcnt(8)
v_and_b32 v41, 2, v41
Mvaa 108,220,100
s_mov_b32 m0, 0x21000
s_add_u32 s46, s44, 0x8000
Ta 208,10,0
v_mov_b32 v56, 0
Mvaa 108,216,96
Ta 210,10,4096
La 24,5,56,45,0
v_cndmask_b32 v44, v56, v44, vcc
Mvaa 92,216,80
Ta 212,10,8192
DD 32,52,46,0
v_cmp_eq_u32 vcc, 0, v41
Mvaa 92,220,84
Ta 214,10,12288
DD 33,52,46,1024
v_mov_b32 v57, 0
Mvaa 76,220,68
DD 34,52,46,2048
v_mov_b32 v60, 0
Mvaa 76,216,64
s_waitcnt lgkmcnt(8)
DD 35,52,46,3072
v_cndmask_b32 v58, v56, v44, vcc
Maaa 128,192,72
Ta 216,11,0
v_cndmask_b32 v59, v44, v56, vcc
Maaa 128,196,76
Ta 218,11,4096
v_mov_b32 v61, 0
Maaa 144,196,92
Ta 220,11,8192
v_lshrrev_b32 v40, 4, v1
Maaa 144,192,88
Ta 222,11,12288
v_and_b32 v41, 15, v40
Maaa 160,192,104
v_lshrrev_b32 v40, 4, v40
Maaa 160,196,108
s_waitcnt lgkmcnt(8)
v_lshlrev_b32 v40, 4, v40
Maaa 164,204,108
s_mov_b32 m0, 0x22000
s_add_u32 s46, s44, 0x10000
Ta 192,12,0
v_lshl_add_u32 v36, v41, 12, v40
Maaa 164,200,104
Ta 194,12,4096
La 28,5,56,45,1024
Maaa 148,200,88
Ta 196,12,8192
DD 32,52,46,0
Maaa 148,204,92
Ta 198,12,12288
DD 33,52,46,1024
Maaa 132,204,76
DD 34,52,46,2048
Maaa 132,200,72
s_waitcnt lgkmcnt(8)
DD 35,52,46,3072
Maaa 136,208,72
Ta 200,13,0
Maaa 136,212,76
Ta 202,13,4096
La 40,6,56,45,0
Maaa 152,212,92
Ta 204,13,8192
Maaa 152,208,88
Ta 206,13,12288
Maaa 168,208,104
Maaa 168,212,108
s_waitcnt lgkmcnt(8)
Maaa 172,220,108
s_mov_b32 m0, 0x23000
s_add_u32 s46, s44, 0x18000
Ta 208,14,0
Maaa 172,216,104
Ta 210,14,4096
La 44,6,56,45,1024
Maaa 156,216,88
Ta 212,14,8192
DD 32,52,46,0
Maaa 156,220,92
Ta 214,14,12288
DD 33,52,46,1024
Maaa 140,220,76
DD 34,52,46,2048
Maaa 140,216,72
s_waitcnt lgkmcnt(8)
DD 35,52,46,3072
Mvaa 64,192,72
Ta 216,15,0
Mvaa 64,196,76
Ta 218,15,4096
Mvaa 80,196,92
Ta 220,15,8192
Mvaa 80,192,88
Ta 222,15,12288
Mvaa 96,192,104
Mvaa 96,196,108
s_barrier
s_waitcnt lgkmcnt(8)
Mvaa 100,204,108
s_cmp_le_u32 s72, 3
s_addc_u32 s44, 3, 0
s_lshl_b32 s44, s44, 19
s_add_u32 s44, s44, 0x20000
s_mov_b32 m0, 0x24000
s_add_u32 s46, s44, 0x0
s_cmp_le_u32 s72, 2
s_addc_u32 s45, 2, 0
s_lshl_b32 s45, s45, 13
s_add_u32 s45, s45, s48
Ta 192,16,16384
Mvaa 100,200,104
Ta 194,16,20480
Lv 128,4,56,45,0
Mvaa 84,200,88
Ta 196,16,24576
DD 32,52,46,0
Mvaa 84,204,92
Ta 198,16,28672
DD 33,52,46,1024
Mvaa 68,204,76
DD 34,52,46,2048
Mvaa 68,200,72
s_waitcnt lgkmcnt(8)
DD 35,52,46,3072
Mvaa 72,208,72
Ta 200,17,16384
Mvaa 72,212,76
Ta 202,17,20480
Lv 132,4,56,45,1024
Mvaa 88,212,92
Ta 204,17,24576
Mvaa 88,208,88
Ta 206,17,28672
Mvaa 104,208,104
Mvaa 104,212,108
s_waitcnt lgkmcnt(8)
Mvaa 108,220,108
s_mov_b32 m0, 0x25000
s_add_u32 s46, s44, 0x8000
Ta 208,18,16384
Mvaa 108,216,104
Ta 210,18,20480
Lv 160,5,56,45,0
Mvaa 92,216,88
Ta 212,18,24576
DD 32,52,46,0
Mvaa 92,220,92
Ta 214,18,28672
DD 33,52,46,1024
Mvaa 76,220,76
DD 34,52,46,2048
Mvaa 76,216,72
s_waitcnt vmcnt(63) lgkmcnt(8)
DD 35,52,46,3072
Maav 128,192,144
s_waitcnt vmcnt(63)
Ta 216,19,16384
Maav 128,196,148
Ta 218,19,20480
Maav 144,196,180
Ta 220,19,24576
Maav 144,192,176
s_waitcnt vmcnt(63)
Ta 222,19,28672
Maav 160,192,208
Maav 160,196,212
s_waitcnt lgkmcnt(8)
Maav 164,204,212
s_mov_b32 m0, 0x26000
s_add_u32 s46, s44, 0x10000
Ta 192,20,16384
Maav 164,200,208
Ta 194,20,20480
Lv 164,5,56,45,1024
Maav 148,200,176
Ta 196,20,24576
DD 32,52,46,0
Maav 148,204,180
Ta 198,20,28672
DD 33,52,46,1024
Maav 132,204,148
DD 34,52,46,2048
Maav 132,200,144
s_waitcnt lgkmcnt(8)
DD 35,52,46,3072
Maav 136,208,144
Ta 200,21,16384
Maav 136,212,148
Ta 202,21,20480
Lv 192,6,56,45,0
Maav 152,212,180
Ta 204,21,24576
Maav 152,208,176
Ta 206,21,28672
Maav 168,208,208
Maav 168,212,212
s_waitcnt lgkmcnt(8)
Maav 172,220,212
s_mov_b32 m0, 0x27000
s_add_u32 s46, s44, 0x18000
Ta 208,22,16384
Maav 172,216,208
Ta 210,22,20480
Lv 196,6,56,45,1024
Maav 156,216,176
Ta 212,22,24576
DD 32,52,46,0
Maav 156,220,180
Ta 214,22,28672
DD 33,52,46,1024
Maav 140,220,148
DD 34,52,46,2048
Maav 140,216,144
s_waitcnt lgkmcnt(8)
DD 35,52,46,3072
Mvav 64,192,144
Ta 216,23,16384
Mvav 64,196,148
Ta 218,23,20480
Mvav 80,196,180
Ta 220,23,24576
Mvav 80,192,176
Ta 222,23,28672
Mvav 96,192,208
Mvav 96,196,212
s_waitcnt lgkmcnt(8)
Mvav 100,204,212
s_cmp_le_u32 s72, 4
s_addc_u32 s44, 4, 0
s_lshl_b32 s44, s44, 19
s_mov_b32 m0, 0x0
s_add_u32 s46, s44, 0x0
s_cmp_le_u32 s72, 2
s_addc_u32 s45, 2, 0
s_lshl_b32 s45, s45, 13
s_add_u32 s45, s45, 0x800
s_add_u32 s45, s45, s48
Ta 192,8,16384
Mvav 100,200,208
Ta 194,8,20480
Lv 136,4,56,45,0
Mvav 84,200,176
Ta 196,8,24576
DD 32,52,46,0
Mvav 84,204,180
Ta 198,8,28672
DD 33,52,46,1024
Mvav 68,204,148
DD 34,52,46,2048
Mvav 68,200,144
s_waitcnt lgkmcnt(8)
DD 35,52,46,3072
Mvav 72,208,144
Ta 200,9,16384
Mvav 72,212,148
Ta 202,9,20480
Lv 140,4,56,45,1024
Mvav 88,212,180
Ta 204,9,24576
Mvav 88,208,176
Ta 206,9,28672
Mvav 104,208,208
Mvav 104,212,212
s_waitcnt lgkmcnt(8)
Mvav 108,220,212
s_mov_b32 m0, 0x1000
s_add_u32 s46, s44, 0x8000
Ta 208,10,16384
Mvav 108,216,208
Ta 210,10,20480
Lv 168,5,56,45,0
Mvav 92,216,176
Ta 212,10,24576
DD 32,52,46,0
Mvav 92,220,180
Ta 214,10,28672
DD 33,52,46,1024
Mvav 76,220,148
DD 34,52,46,2048
Mvav 76,216,144
s_waitcnt vmcnt(63) lgkmcnt(8)
DD 35,52,46,3072
Maav 128,192,152
Ta 216,11,16384
Maav 128,196,156
s_waitcnt vmcnt(63)
Ta 218,11,20480
Maav 144,196,188
Ta 220,11,24576
Maav 144,192,184
Ta 222,11,28672
Maav 160,192,216
Maav 160,196,220
s_waitcnt lgkmcnt(8)
Maav 164,204,220
s_mov_b32 m0, 0x2000
s_add_u32 s46, s44, 0x10000
Ta 192,12,16384
Maav 164,200,216
Ta 194,12,20480
Lv 172,5,56,45,1024
Maav 148,200,184
Ta 196,12,24576
DD 32,52,46,0
Maav 148,204,188
Ta 198,12,28672
DD 33,52,46,1024
Maav 132,204,156
DD 34,52,46,2048
Maav 132,200,152
s_waitcnt lgkmcnt(8)
DD 35,52,46,3072
Maav 136,208,152
Ta 200,13,16384
Maav 136,212,156
Ta 202,13,20480
Lv 200,6,56,45,0
Maav 152,212,188
Ta 204,13,24576
Maav 152,208,184
Ta 206,13,28672
Maav 168,208,216
Maav 168,212,220
s_waitcnt lgkmcnt(8)
Maav 172,220,220
s_mov_b32 m0, 0x3000
s_add_u32 s46, s44, 0x18000
Ta 208,14,16384
Maav 172,216,216
Ta 210,14,20480
Lv 204,6,56,45,1024
Maav 156,216,184
Ta 212,14,24576
DD 32,52,46,0
Maav 156,220,188
Ta 214,14,28672
DD 33,52,46,1024
Maav 140,220,156
DD 34,52,46,2048
Maav 140,216,152
s_waitcnt lgkmcnt(8)
DD 35,52,46,3072
Mvav 64,192,152
Ta 216,15,16384
Mvav 64,196,156
Ta 218,15,20480
Mvav 80,196,188
Ta 220,15,24576
Mvav 80,192,184
Ta 222,15,28672
Mvav 96,192,216
Mvav 96,196,220
s_barrier
s_waitcnt lgkmcnt(8)
Mvav 100,204,220
s_cmp_le_u32 s72, 4
s_addc_u32 s44, 4, 0
s_lshl_b32 s44, s44, 19
s_add_u32 s44, s44, 0x20000
s_mov_b32 m0, 0x10000
s_add_u32 s46, s44, 0x0
s_cmp_le_u32 s72, 3
s_addc_u32 s45, 3, 0
s_lshl_b32 s45, s45, 13
s_add_u32 s45, s45, s48
Ta 192,16,32768
Mvav 100,200,216
Ta 194,16,36864
La 64,4,56,45,0
Mvav 84,200,184
Ta 196,16,40960
DD 32,52,46,0
Mvav 84,204,188
Ta 198,16,45056
DD 33,52,46,1024
Mvav 68,204,156
DD 34,52,46,2048
Mvav 68,200,152
s_waitcnt lgkmcnt(8)
DD 35,52,46,3072
Mvav 72,208,152
Ta 200,17,32768
Mvav 72,212,156
Ta 202,17,36864
La 68,4,56,45,1024
Mvav 88,212,188
Ta 204,17,40960
Mvav 88,208,184
Ta 206,17,45056
Mvav 104,208,216
Mvav 104,212,220
s_waitcnt lgkmcnt(8)
Mvav 108,220,220
s_mov_b32 m0, 0x11000
s_add_u32 s46, s44, 0x8000
Ta 208,18,32768
Mvav 108,216,216
Ta 210,18,36864
La 80,5,56,45,0
Mvav 92,216,184
Ta 212,18,40960
DD 32,52,46,0
Mvav 92,220,188
Ta 214,18,45056
DD 33,52,46,1024
Mvav 76,220,156
DD 34,52,46,2048
Mvav 76,216,152
s_waitcnt vmcnt(63) lgkmcnt(8)
DD 35,52,46,3072
Maaa 128,192,0
s_waitcnt vmcnt(63)
Ta 216,19,32768
Maaa 128,196,4
s_waitcnt vmcnt(63)
Ta 218,19,36864
Maaa 144,196,20
Ta 220,19,40960
Maaa 144,192,16
s_waitcnt vmcnt(63)
Ta 222,19,45056
Maaa 160,192,32
Maaa 160,196,36
s_waitcnt lgkmcnt(8)
Maaa 164,204,36
s_mov_b32 m0, 0x12000
s_add_u32 s46, s44, 0x10000
Ta 192,20,32768
Maaa 164,200,32
Ta 194,20,36864
La 84,5,56,45,1024
Maaa 148,200,16
Ta 196,20,40960
DD 32,52,46,0
Maaa 148,204,20
Ta 198,20,45056
DD 33,52,46,1024
Maaa 132,204,4
DD 34,52,46,2048
Maaa 132,200,0
s_waitcnt lgkmcnt(8)
DD 35,52,46,3072
Maaa 136,208,0
Ta 200,21,32768
Maaa 136,212,4
Ta 202,21,36864
La 96,6,56,45,0
Maaa 152,212,20
Ta 204,21,40960
Maaa 152,208,16
Ta 206,21,45056
Maaa 168,208,32
Maaa 168,212,36
s_waitcnt lgkmcnt(8)
Maaa 172,220,36
s_mov_b32 m0, 0x13000
s_add_u32 s46, s44, 0x18000
Ta 208,22,32768
Maaa 172,216,32
Ta 210,22,36864
La 100,6,56,45,1024
Maaa 156,216,16
Ta 212,22,40960
DD 32,52,46,0
Maaa 156,220,20
Ta 214,22,45056
DD 33,52,46,1024
Maaa 140,220,4
DD 34,52,46,2048
Maaa 140,216,0
s_waitcnt lgkmcnt(8)
DD 35,52,46,3072
Mvaa 64,192,0
Ta 216,23,32768
Mvaa 64,196,4
Ta 218,23,36864
Mvaa 80,196,20
Ta 220,23,40960
Mvaa 80,192,16
Ta 222,23,45056
Mvaa 96,192,32
Mvaa 96,196,36
s_waitcnt lgkmcnt(8)
Mvaa 100,204,36
s_cmp_le_u32 s72, 5
s_addc_u32 s44, 5, 0
s_lshl_b32 s44, s44, 19
s_mov_b32 m0, 0x4000
s_add_u32 s46, s44, 0x0
s_cmp_le_u32 s72, 3
s_addc_u32 s45, 3, 0
s_lshl_b32 s45, s45, 13
s_add_u32 s45, s45, 0x800
s_add_u32 s45, s45, s48
Ta 192,8,32768
Mvaa 100,200,32
Ta 194,8,36864
La 72,4,56,45,0
Mvaa 84,200,16
Ta 196,8,40960
DD 32,52,46,0
Mvaa 84,204,20
Ta 198,8,45056
DD 33,52,46,1024
Mvaa 68,204,4
DD 34,52,46,2048
Mvaa 68,200,0
s_waitcnt lgkmcnt(8)
DD 35,52,46,3072
Mvaa 72,208,0
Ta 200,9,32768
Mvaa 72,212,4
Ta 202,9,36864
La 76,4,56,45,1024
Mvaa 88,212,20
Ta 204,9,40960
Mvaa 88,208,16
Ta 206,9,45056
Mvaa 104,208,32
Mvaa 104,212,36
s_waitcnt lgkmcnt(8)
Mvaa 108,220,36
s_mov_b32 m0, 0x5000
s_add_u32 s46, s44, 0x8000
Ta 208,10,32768
Mvaa 108,216,32
Ta 210,10,36864
La 88,5,56,45,0
Mvaa 92,216,16
Ta 212,10,40960
DD 32,52,46,0
Mvaa 92,220,20
Ta 214,10,45056
DD 33,52,46,1024
Mvaa 76,220,4
DD 34,52,46,2048
Mvaa 76,216,0
s_waitcnt vmcnt(63) lgkmcnt(8)
DD 35,52,46,3072
Maaa 128,192,8
s_waitcnt vmcnt(63)
Ta 216,11,32768
Maaa 128,196,12
s_waitcnt vmcnt(63)
Ta 218,11,36864
Maaa 144,196,28
Ta 220,11,40960
Maaa 144,192,24
s_waitcnt vmcnt(63)
Ta 222,11,45056
Maaa 160,192,40
Maaa 160,196,44
s_waitcnt lgkmcnt(8)
Maaa 164,204,44
s_mov_b32 m0, 0x6000
s_add_u32 s46, s44, 0x10000
Ta 192,12,32768
Maaa 164,200,40
Ta 194,12,36864
La 92,5,56,45,1024
Maaa 148,200,24
Ta 196,12,40960
DD 32,52,46,0
Maaa 148,204,28
Ta 198,12,45056
DD 33,52,46,1024
Maaa 132,204,12
DD 34,52,46,2048
Maaa 132,200,8
s_waitcnt lgkmcnt(8)
DD 35,52,46,3072
Maaa 136,208,8
Ta 200,13,32768
Maaa 136,212,12
Ta 202,13,36864
La 104,6,56,45,0
Maaa 152,212,28
Ta 204,13,40960
Maaa 152,208,24
Ta 206,13,45056
Maaa 168,208,40
Maaa 168,212,44
s_waitcnt lgkmcnt(8)
Maaa 172,220,44
s_mov_b32 m0, 0x7000
s_add_u32 s46, s44, 0x18000
Ta 208,14,32768
Maaa 172,216,40
Ta 210,14,36864
La 108,6,56,45,1024
Maaa 156,216,24
Ta 212,14,40960
DD 32,52,46,0
Maaa 156,220,28
Ta 214,14,45056
DD 33,52,46,1024
Maaa 140,220,12
DD 34,52,46,2048
Maaa 140,216,8
s_waitcnt lgkmcnt(8)
DD 35,52,46,3072
Mvaa 64,192,8
Ta 216,15,32768
Mvaa 64,196,12
Ta 218,15,36864
Mvaa 80,196,28
Ta 220,15,40960
Mvaa 80,192,24
Ta 222,15,45056
Mvaa 96,192,40
Mvaa 96,196,44
s_barrier
s_waitcnt lgkmcnt(8)
Mvaa 100,204,44
s_cmp_le_u32 s72, 5
s_addc_u32 s44, 5, 0
s_lshl_b32 s44, s44, 19
s_add_u32 s44, s44, 0x20000
s_mov_b32 m0, 0x14000
s_add_u32 s46, s44, 0x0
s_cmp_le_u32 s72, 4
s_addc_u32 s45, 4, 0
s_lshl_b32 s45, s45, 13
s_add_u32 s45, s45, s48
Ta 192,16,49152
Mvaa 100,200,40
Ta 194,16,53248
Lv 144,4,56,45,0
Mvaa 84,200,24
Ta 196,16,57344
DD 32,52,46,0
Mvaa 84,204,28
Ta 198,16,61440
DD 33,52,46,1024
Mvaa 68,204,12
DD 34,52,46,2048
Mvaa 68,200,8
s_waitcnt lgkmcnt(8)
DD 35,52,46,3072
Mvaa 72,208,8
Ta 200,17,49152
Mvaa 72,212,12
Ta 202,17,53248
Lv 148,4,56,45,1024
Mvaa 88,212,28
Ta 204,17,57344
Mvaa 88,208,24
Ta 206,17,61440
Mvaa 104,208,40
Mvaa 104,212,44
s_waitcnt lgkmcnt(8)
Mvaa 108,220,44
s_mov_b32 m0, 0x15000
s_add_u32 s46, s44, 0x8000
Ta 208,18,49152
Mvaa 108,216,40
Ta 210,18,53248
Lv 176,5,56,45,0
Mvaa 92,216,24
Ta 212,18,57344
DD 32,52,46,0
Mvaa 92,220,28
Ta 214,18,61440
DD 33,52,46,1024
Mvaa 76,220,12
DD 34,52,46,2048
Mvaa 76,216,8
s_waitcnt vmcnt(63) lgkmcnt(8)
DD 35,52,46,3072
Maav 128,192,128
s_waitcnt vmcnt(63)
Ta 216,19,49152
Maav 128,196,132
s_waitcnt vmcnt(63)
Ta 218,19,53248
Maav 144,196,164
Ta 220,19,57344
Maav 144,192,160
s_waitcnt vmcnt(63)
Ta 222,19,61440
Maav 160,192,192
Maav 160,196,196
s_waitcnt lgkmcnt(8)
Maav 164,204,196
s_mov_b32 m0, 0x16000
s_add_u32 s46, s44, 0x10000
Ta 192,20,49152
Maav 164,200,192
Ta 194,20,53248
Lv 180,5,56,45,1024
Maav 148,200,160
Ta 196,20,57344
DD 32,52,46,0
Maav 148,204,164
Ta 198,20,61440
DD 33,52,46,1024
Maav 132,204,132
DD 34,52,46,2048
Maav 132,200,128
s_waitcnt lgkmcnt(8)
DD 35,52,46,3072
Maav 136,208,128
Ta 200,21,49152
Maav 136,212,132
Ta 202,21,53248
Lv 208,6,56,45,0
Maav 152,212,164
Ta 204,21,57344
Maav 152,208,160
Ta 206,21,61440
Maav 168,208,192
Maav 168,212,196
s_waitcnt lgkmcnt(8)
Maav 172,220,196
s_mov_b32 m0, 0x17000
s_add_u32 s46, s44, 0x18000
Ta 208,22,49152
Maav 172,216,192
Ta 210,22,53248
Lv 212,6,56,45,1024
Maav 156,216,160
Ta 212,22,57344
DD 32,52,46,0
Maav 156,220,164
Ta 214,22,61440
DD 33,52,46,1024
Maav 140,220,132
DD 34,52,46,2048
Maav 140,216,128
s_waitcnt lgkmcnt(8)
DD 35,52,46,3072
Mvav 64,192,128
Ta 216,23,49152
Mvav 64,196,132
Ta 218,23,53248
Mvav 80,196,164
Ta 220,23,57344
Mvav 80,192,160
Ta 222,23,61440
Mvav 96,192,192
Mvav 96,196,196
s_waitcnt lgkmcnt(8)
Mvav 100,204,196
s_cmp_le_u32 s72, 6
s_addc_u32 s44, 6, 0
s_lshl_b32 s44, s44, 19
s_mov_b32 m0, 0x8000
s_add_u32 s46, s44, 0x0
s_cmp_le_u32 s72, 4
s_addc_u32 s45, 4, 0
s_lshl_b32 s45, s45, 13
s_add_u32 s45, s45, 0x800
s_add_u32 s45, s45, s48
Ta 192,8,49152
Mvav 100,200,192
Ta 194,8,53248
Lv 152,4,56,45,0
Mvav 84,200,160
Ta 196,8,57344
DD 32,52,46,0
Mvav 84,204,164
Ta 198,8,61440
DD 33,52,46,1024
Mvav 68,204,132
DD 34,52,46,2048
Mvav 68,200,128
s_waitcnt lgkmcnt(8)
DD 35,52,46,3072
Mvav 72,208,128
Ta 200,9,49152
Mvav 72,212,132
Ta 202,9,53248
Lv 156,4,56,45,1024
Mvav 88,212,164
Ta 204,9,57344
Mvav 88,208,160
Ta 206,9,61440
Mvav 104,208,192
Mvav 104,212,196
s_waitcnt lgkmcnt(8)
Mvav 108,220,196
s_mov_b32 m0, 0x9000
s_add_u32 s46, s44, 0x8000
Ta 208,10,49152
Mvav 108,216,192
Ta 210,10,53248
Lv 184,5,56,45,0
Mvav 92,216,160
Ta 212,10,57344
DD 32,52,46,0
Mvav 92,220,164
Ta 214,10,61440
DD 33,52,46,1024
Mvav 76,220,132
DD 34,52,46,2048
Mvav 76,216,128
s_waitcnt vmcnt(63) lgkmcnt(8)
DD 35,52,46,3072
Maav 128,192,136
s_waitcnt vmcnt(63)
Ta 216,11,49152
Maav 128,196,140
s_waitcnt vmcnt(63)
Ta 218,11,53248
Maav 144,196,172
Ta 220,11,57344
Maav 144,192,168
s_waitcnt vmcnt(63)
Ta 222,11,61440
Maav 160,192,200
Maav 160,196,204
s_waitcnt lgkmcnt(8)
Maav 164,204,204
s_mov_b32 m0, 0xa000
s_add_u32 s46, s44, 0x10000
Ta 192,12,49152
Maav 164,200,200
Ta 194,12,53248
Lv 188,5,56,45,1024
Maav 148,200,168
Ta 196,12,57344
DD 32,52,46,0
Maav 148,204,172
Ta 198,12,61440
DD 33,52,46,1024
Maav 132,204,140
DD 34,52,46,2048
Maav 132,200,136
s_waitcnt lgkmcnt(8)
DD 35,52,46,3072
Maav 136,208,136
Ta 200,13,49152
Maav 136,212,140
Ta 202,13,53248
Lv 216,6,56,45,0
Maav 152,212,172
Ta 204,13,57344
Maav 152,208,168
Ta 206,13,61440
Maav 168,208,200
Maav 168,212,204
s_waitcnt lgkmcnt(8)
Maav 172,220,204
s_mov_b32 m0, 0xb000
s_add_u32 s46, s44, 0x18000
Ta 208,14,49152
Maav 172,216,200
Ta 210,14,53248
Lv 220,6,56,45,1024
Maav 156,216,168
Ta 212,14,57344
DD 32,52,46,0
Maav 156,220,172
Ta 214,14,61440
DD 33,52,46,1024
Maav 140,220,140
DD 34,52,46,2048
Maav 140,216,136
s_waitcnt lgkmcnt(8)
DD 35,52,46,3072
Mvav 64,192,136
Ta 216,15,49152
Mvav 64,196,140
Ta 218,15,53248
Mvav 80,196,172
Ta 220,15,57344
Mvav 80,192,168
Ta 222,15,61440
Mvav 96,192,200
Mvav 96,196,204
s_barrier
s_waitcnt lgkmcnt(8)
Mvav 100,204,204
s_cmp_le_u32 s72, 6
s_addc_u32 s44, 6, 0
s_lshl_b32 s44, s44, 19
s_add_u32 s44, s44, 0x20000
s_mov_b32 m0, 0x18000
s_add_u32 s46, s44, 0x0
s_cmp_le_u32 s72, 5
s_addc_u32 s45, 5, 0
s_lshl_b32 s45, s45, 13
s_add_u32 s45, s45, s48
Ta 192,24,0
Mvav 100,200,200
Ta 194,24,4096
La 0,4,56,45,0
Mvav 84,200,168
Ta 196,24,8192
DD 32,52,46,0
Mvav 84,204,172
Ta 198,24,12288
DD 33,52,46,1024
Mvav 68,204,140
DD 34,52,46,2048
Mvav 68,200,136
s_waitcnt lgkmcnt(8)
DD 35,52,46,3072
Mvav 72,208,136
Ta 200,25,0
Mvav 72,212,140
Ta 202,25,4096
La 4,4,56,45,1024
Mvav 88,212,172
Ta 204,25,8192
Mvav 88,208,168
Ta 206,25,12288
Mvav 104,208,200
Mvav 104,212,204
s_waitcnt lgkmcnt(8)
Mvav 108,220,204
s_mov_b32 m0, 0x19000
s_add_u32 s46, s44, 0x8000
Ta 208,26,0
Mvav 108,216,200
Ta 210,26,4096
La 16,5,56,45,0
Mvav 92,216,168
Ta 212,26,8192
DD 32,52,46,0
Mvav 92,220,172
Ta 214,26,12288
DD 33,52,46,1024
Mvav 76,220,140
DD 34,52,46,2048
Mvav 76,216,136
s_waitcnt vmcnt(63) lgkmcnt(8)
DD 35,52,46,3072
Maaa 128,192,64
s_waitcnt vmcnt(63)
Ta 216,27,0
Maaa 128,196,68
s_waitcnt vmcnt(63)
Ta 218,27,4096
Maaa 144,196,84
Ta 220,27,8192
Maaa 144,192,80
s_waitcnt vmcnt(63)
Ta 222,27,12288
Maaa 160,192,96
Maaa 160,196,100
s_waitcnt lgkmcnt(8)
Maaa 164,204,100
s_mov_b32 m0, 0x1a000
s_add_u32 s46, s44, 0x10000
Ta 192,28,0
Maaa 164,200,96
Ta 194,28,4096
La 20,5,56,45,1024
Maaa 148,200,80
Ta 196,28,8192
DD 32,52,46,0
Maaa 148,204,84
Ta 198,28,12288
DD 33,52,46,1024
Maaa 132,204,68
DD 34,52,46,2048
Maaa 132,200,64
s_waitcnt lgkmcnt(8)
DD 35,52,46,3072
Maaa 136,208,64
Ta 200,29,0
Maaa 136,212,68
Ta 202,29,4096
La 32,6,56,45,0
Maaa 152,212,84
Ta 204,29,8192
Maaa 152,208,80
Ta 206,29,12288
Maaa 168,208,96
Maaa 168,212,100
s_waitcnt lgkmcnt(8)
Maaa 172,220,100
s_mov_b32 m0, 0x1b000
s_add_u32 s46, s44, 0x18000
Ta 208,30,0
Maaa 172,216,96
Ta 210,30,4096
La 36,6,56,45,1024
Maaa 156,216,80
Ta 212,30,8192
DD 32,52,46,0
Maaa 156,220,84
Ta 214,30,12288
DD 33,52,46,1024
Maaa 140,220,68
DD 34,52,46,2048
Maaa 140,216,64
s_waitcnt lgkmcnt(8)
DD 35,52,46,3072
Mvaa 64,192,64
Ta 216,31,0
Mvaa 64,196,68
Ta 218,31,4096
Mvaa 80,196,84
Ta 220,31,8192
Mvaa 80,192,80
Ta 222,31,12288
Mvaa 96,192,96
Mvaa 96,196,100
s_waitcnt lgkmcnt(8)
Mvaa 100,204,100
s_cmp_le_u32 s72, 0
s_addc_u32 s44, 0, 0
s_lshl_b32 s44, s44, 19
s_add_u32 s44, s44, 0x40000
s_mov_b32 m0, 0xc000
s_add_u32 s46, s44, 0x0
s_cmp_le_u32 s72, 5
s_addc_u32 s45, 5, 0
s_lshl_b32 s45, s45, 13
s_add_u32 s45, s45, 0x800
s_add_u32 s45, s45, s48
Ta 192,24,16384
Mvaa 100,200,96
Ta 194,24,20480
La 8,4,56,45,0
Mvaa 84,200,80
Ta 196,24,24576
DD 32,52,46,0
Mvaa 84,204,84
Ta 198,24,28672
DD 33,52,46,1024
Mvaa 68,204,68
DD 34,52,46,2048
Mvaa 68,200,64
s_waitcnt lgkmcnt(8)
DD 35,52,46,3072
Mvaa 72,208,64
Ta 200,25,16384
Mvaa 72,212,68
Ta 202,25,20480
La 12,4,56,45,1024
Mvaa 88,212,84
Ta 204,25,24576
Mvaa 88,208,80
Ta 206,25,28672
Mvaa 104,208,96
Mvaa 104,212,100
s_waitcnt lgkmcnt(8)
Mvaa 108,220,100
s_mov_b32 m0, 0xd000
s_add_u32 s46, s44, 0x8000
Ta 208,26,16384
Mvaa 108,216,96
Ta 210,26,20480
La 24,5,56,45,0
Mvaa 92,216,80
Ta 212,26,24576
DD 32,52,46,0
Mvaa 92,220,84
Ta 214,26,28672
DD 33,52,46,1024
Mvaa 76,220,68
DD 34,52,46,2048
Mvaa 76,216,64
s_waitcnt vmcnt(63) lgkmcnt(8)
DD 35,52,46,3072
Maaa 128,192,72
s_waitcnt vmcnt(63)
Ta 216,27,16384
Maaa 128,196,76
s_waitcnt vmcnt(63)
Ta 218,27,20480
Maaa 144,196,92
Ta 220,27,24576
Maaa 144,192,88
s_waitcnt vmcnt(63)
Ta 222,27,28672
Maaa 160,192,104
Maaa 160,196,108
s_waitcnt lgkmcnt(8)
Maaa 164,204,108
s_mov_b32 m0, 0xe000
s_add_u32 s46, s44, 0x10000
Ta 192,28,16384
Maaa 164,200,104
Ta 194,28,20480
La 28,5,56,45,1024
Maaa 148,200,88
Ta 196,28,24576
DD 32,52,46,0
Maaa 148,204,92
Ta 198,28,28672
DD 33,52,46,1024
Maaa 132,204,76
DD 34,52,46,2048
Maaa 132,200,72
s_waitcnt lgkmcnt(8)
DD 35,52,46,3072
Maaa 136,208,72
Ta 200,29,16384
Maaa 136,212,76
Ta 202,29,20480
La 40,6,56,45,0
Maaa 152,212,92
Ta 204,29,24576
Maaa 152,208,88
Ta 206,29,28672
Maaa 168,208,104
Maaa 168,212,108
s_waitcnt lgkmcnt(8)
Maaa 172,220,108
s_mov_b32 m0, 0xf000
s_add_u32 s46, s44, 0x18000
Ta 208,30,16384
Maaa 172,216,104
Ta 210,30,20480
La 44,6,56,45,1024
Maaa 156,216,88
Ta 212,30,24576
DD 32,52,46,0
Maaa 156,220,92
Ta 214,30,28672
DD 33,52,46,1024
Maaa 140,220,76
DD 34,52,46,2048
Maaa 140,216,72
s_waitcnt lgkmcnt(8)
DD 35,52,46,3072
Mvaa 64,192,72
Ta 216,31,16384
Mvaa 64,196,76
Ta 218,31,20480
Mvaa 80,196,92
Ta 220,31,24576
Mvaa 80,192,88
Ta 222,31,28672
Mvaa 96,192,104
Mvaa 96,196,108
s_barrier
s_waitcnt lgkmcnt(8)
Mvaa 100,204,108
s_cmp_le_u32 s72, 0
s_addc_u32 s44, 0, 0
s_lshl_b32 s44, s44, 19
s_add_u32 s44, s44, 0x60000
s_mov_b32 m0, 0x1c000
s_add_u32 s46, s44, 0x0
s_cmp_le_u32 s72, 6
s_addc_u32 s45, 6, 0
s_lshl_b32 s45, s45, 13
s_add_u32 s45, s45, s48
Ta 192,16,0
Mvaa 100,200,104
Ta 194,16,4096
Lv 128,4,56,45,0
Mvaa 84,200,88
Ta 196,16,8192
DD 32,52,46,0
Mvaa 84,204,92
Ta 198,16,12288
DD 33,52,46,1024
Mvaa 68,204,76
DD 34,52,46,2048
Mvaa 68,200,72
s_waitcnt lgkmcnt(8)
DD 35,52,46,3072
Mvaa 72,208,72
Ta 200,17,0
Mvaa 72,212,76
Ta 202,17,4096
Lv 132,4,56,45,1024
buffer_load_dword v2, off, s[68:71], s73 sc1
Mvaa 88,212,92
Ta 204,17,8192
Mvaa 88,208,88
Ta 206,17,12288
Mvaa 104,208,104
Mvaa 104,212,108
s_waitcnt lgkmcnt(8)
Mvaa 108,220,108
s_mov_b32 m0, 0x1d000
s_add_u32 s46, s44, 0x8000
Ta 208,18,0
Mvaa 108,216,104
Ta 210,18,4096
Lv 160,5,56,45,0
Mvaa 92,216,88
Ta 212,18,8192
DD 32,52,46,0
Mvaa 92,220,92
Ta 214,18,12288
DD 33,52,46,1024
Mvaa 76,220,76
DD 34,52,46,2048
Mvaa 76,216,72
s_waitcnt vmcnt(63) lgkmcnt(8)
DD 35,52,46,3072
Maav 128,192,144
s_waitcnt vmcnt(63)
Ta 216,19,0
Maav 128,196,148
s_waitcnt vmcnt(63)
Ta 218,19,4096
Maav 144,196,180
Ta 220,19,8192
Maav 144,192,176
s_waitcnt vmcnt(63)
Ta 222,19,12288
Maav 160,192,208
Maav 160,196,212
s_waitcnt lgkmcnt(8)
Maav 164,204,212
s_mov_b32 m0, 0x1e000
s_add_u32 s46, s44, 0x10000
Ta 192,20,0
Maav 164,200,208
Ta 194,20,4096
Lv 164,5,56,45,1024
Maav 148,200,176
Ta 196,20,8192
DD 32,52,46,0
Maav 148,204,180
Ta 198,20,12288
DD 33,52,46,1024
Maav 132,204,148
DD 34,52,46,2048
Maav 132,200,144
s_waitcnt lgkmcnt(8)
DD 35,52,46,3072
Maav 136,208,144
Ta 200,21,0
Maav 136,212,148
Ta 202,21,4096
Lv 192,6,56,45,0
Maav 152,212,180
Ta 204,21,8192
Maav 152,208,176
Ta 206,21,12288
Maav 168,208,208
Maav 168,212,212
s_waitcnt lgkmcnt(8)
Maav 172,220,212
s_mov_b32 m0, 0x1f000
s_add_u32 s46, s44, 0x18000
Ta 208,22,0
Maav 172,216,208
Ta 210,22,4096
Lv 196,6,56,45,1024
Maav 156,216,176
Ta 212,22,8192
DD 32,52,46,0
Maav 156,220,180
Ta 214,22,12288
DD 33,52,46,1024
Maav 140,220,148
DD 34,52,46,2048
Maav 140,216,144
s_waitcnt lgkmcnt(8)
DD 35,52,46,3072
Mvav 64,192,144
Ta 216,23,0
Mvav 64,196,148
Ta 218,23,4096
Mvav 80,196,180
Ta 220,23,8192
Mvav 80,192,176
Ta 222,23,12288
Mvav 96,192,208
Mvav 96,196,212
s_waitcnt lgkmcnt(8)
Mvav 100,204,212
s_cmp_le_u32 s72, 1
s_addc_u32 s44, 1, 0
s_lshl_b32 s44, s44, 19
s_add_u32 s44, s44, 0x40000
s_mov_b32 m0, 0x20000
s_add_u32 s46, s44, 0x0
s_cmp_le_u32 s72, 6
s_addc_u32 s45, 6, 0
s_lshl_b32 s45, s45, 13
s_add_u32 s45, s45, 0x800
s_add_u32 s45, s45, s48
Ta 192,8,0
Mvav 100,200,208
Ta 194,8,4096
Lv 136,4,56,45,0
Mvav 84,200,176
Ta 196,8,8192
DD 32,52,46,0
Mvav 84,204,180
Ta 198,8,12288
DD 33,52,46,1024
Mvav 68,204,148
DD 34,52,46,2048
Mvav 68,200,144
s_waitcnt lgkmcnt(8)
DD 35,52,46,3072
Mvav 72,208,144
Ta 200,9,0
Mvav 72,212,148
Ta 202,9,4096
Lv 140,4,56,45,1024
Mvav 88,212,180
Ta 204,9,8192
Mvav 88,208,176
Ta 206,9,12288
Mvav 104,208,208
Mvav 104,212,212
s_waitcnt lgkmcnt(8)
Mvav 108,220,212
s_mov_b32 m0, 0x21000
s_add_u32 s46, s44, 0x8000
Ta 208,10,0
Mvav 108,216,208
Ta 210,10,4096
Lv 168,5,56,45,0
Mvav 92,216,176
Ta 212,10,8192
DD 32,52,46,0
Mvav 92,220,180
Ta 214,10,12288
DD 33,52,46,1024
Mvav 76,220,148
DD 34,52,46,2048
Mvav 76,216,144
s_waitcnt vmcnt(63) lgkmcnt(8)
DD 35,52,46,3072
Maav 128,192,152
s_waitcnt vmcnt(63)
Ta 216,11,0
Maav 128,196,156
s_waitcnt vmcnt(63)
Ta 218,11,4096
Maav 144,196,188
Ta 220,11,8192
Maav 144,192,184
s_waitcnt vmcnt(63)
Ta 222,11,12288
Maav 160,192,216
Maav 160,196,220
s_waitcnt lgkmcnt(8)
Maav 164,204,220
s_mov_b32 m0, 0x22000
s_add_u32 s46, s44, 0x10000
Ta 192,12,0
Maav 164,200,216
Ta 194,12,4096
Lv 172,5,56,45,1024
Maav 148,200,184
Ta 196,12,8192
DD 32,52,46,0
Maav 148,204,188
Ta 198,12,12288
DD 33,52,46,1024
Maav 132,204,156
DD 34,52,46,2048
Maav 132,200,152
s_waitcnt lgkmcnt(8)
DD 35,52,46,3072
Maav 136,208,152
Ta 200,13,0
Maav 136,212,156
Ta 202,13,4096
Lv 200,6,56,45,0
Maav 152,212,188
Ta 204,13,8192
Maav 152,208,184
Ta 206,13,12288
Maav 168,208,216
Maav 168,212,220
s_waitcnt lgkmcnt(8)
Maav 172,220,220
s_mov_b32 m0, 0x23000
s_add_u32 s46, s44, 0x18000
Ta 208,14,0
Maav 172,216,216
Ta 210,14,4096
Lv 204,6,56,45,1024
Maav 156,216,184
Ta 212,14,8192
DD 32,52,46,0
Maav 156,220,188
Ta 214,14,12288
DD 33,52,46,1024
Maav 140,220,156
DD 34,52,46,2048
Maav 140,216,152
s_waitcnt lgkmcnt(8)
DD 35,52,46,3072
Mvav 64,192,152
Ta 216,15,0
Mvav 64,196,156
Ta 218,15,4096
Mvav 80,196,188
Ta 220,15,8192
Mvav 80,192,184
Ta 222,15,12288
Mvav 96,192,216
Mvav 96,196,220
s_waitcnt vmcnt(38)
v_readfirstlane_b32 s35, v2
s_nop 1
s_bitcmp1_b32 s35, 11
s_cbranch_scc0 L1_spin1
L1_spin1_back:
s_barrier
s_waitcnt lgkmcnt(8)
Mvav 100,204,220
s_cmp_le_u32 s72, 1
s_addc_u32 s44, 1, 0
s_lshl_b32 s44, s44, 19
s_add_u32 s44, s44, 0x60000
s_mov_b32 m0, 0x24000
s_add_u32 s46, s44, 0x0
s_cmp_le_u32 s72, 0
s_addc_u32 s45, 0, 0
s_lshl_b32 s45, s45, 13
s_add_u32 s45, s45, 0x1000
s_add_u32 s45, s45, s48
Ta 192,16,16384
Mvav 100,200,216
Ta 194,16,20480
La 64,4,56,45,0
Mvav 84,200,184
Ta 196,16,24576
DD 32,52,46,0
Mvav 84,204,188
Ta 198,16,28672
DD 33,52,46,1024
Mvav 68,204,156
DD 34,52,46,2048
Mvav 68,200,152
s_waitcnt lgkmcnt(8)
DD 35,52,46,3072
Mvav 72,208,152
Ta 200,17,16384
Mvav 72,212,156
Ta 202,17,20480
La 68,4,56,45,1024
Mvav 88,212,188
Ta 204,17,24576
Mvav 88,208,184
Ta 206,17,28672
Mvav 104,208,216
Mvav 104,212,220
s_waitcnt lgkmcnt(8)
Mvav 108,220,220
s_mov_b32 m0, 0x25000
s_add_u32 s46, s44, 0x8000
Ta 208,18,16384
Mvav 108,216,216
Ta 210,18,20480
La 80,5,56,45,0
Mvav 92,216,184
Ta 212,18,24576
DD 32,52,46,0
Mvav 92,220,188
Ta 214,18,28672
DD 33,52,46,1024
Mvav 76,220,156
DD 34,52,46,2048
Mvav 76,216,152
s_waitcnt lgkmcnt(8)
DD 35,52,46,3072
Maaa 128,192,0
Ta 216,19,16384
Maaa 128,196,4
Ta 218,19,20480
Maaa 144,196,20
Ta 220,19,24576
Maaa 144,192,16
Ta 222,19,28672
Maaa 160,192,32
Maaa 160,196,36
s_waitcnt lgkmcnt(8)
Maaa 164,204,36
s_mov_b32 m0, 0x26000
s_add_u32 s46, s44, 0x10000
Ta 192,20,16384
Maaa 164,200,32
Ta 194,20,20480
La 84,5,56,45,1024
Maaa 148,200,16
Ta 196,20,24576
DD 32,52,46,0
Maaa 148,204,20
Ta 198,20,28672
DD 33,52,46,1024
Maaa 132,204,4
DD 34,52,46,2048
Maaa 132,200,0
s_waitcnt lgkmcnt(8)
DD 35,52,46,3072
Maaa 136,208,0
Ta 200,21,16384
Maaa 136,212,4
Ta 202,21,20480
La 96,6,56,45,0
Maaa 152,212,20
Ta 204,21,24576
Maaa 152,208,16
Ta 206,21,28672
Maaa 168,208,32
Maaa 168,212,36
s_waitcnt lgkmcnt(8)
Maaa 172,220,36
s_mov_b32 m0, 0x27000
s_add_u32 s46, s44, 0x18000
Ta 208,22,16384
Maaa 172,216,32
Ta 210,22,20480
La 100,6,56,45,1024
Maaa 156,216,16
Ta 212,22,24576
DD 32,52,46,0
Maaa 156,220,20
Ta 214,22,28672
DD 33,52,46,1024
Maaa 140,220,4
DD 34,52,46,2048
Maaa 140,216,0
s_waitcnt lgkmcnt(8)
DD 35,52,46,3072
Mvaa 64,192,0
Ta 216,23,16384
Mvaa 64,196,4
Ta 218,23,20480
Mvaa 80,196,20
Ta 220,23,24576
Mvaa 80,192,16
Ta 222,23,28672
Mvaa 96,192,32
Mvaa 96,196,36
s_waitcnt lgkmcnt(8)
Mvaa 100,204,36
s_cmp_le_u32 s72, 2
s_addc_u32 s44, 2, 0
s_lshl_b32 s44, s44, 19
s_add_u32 s44, s44, 0x40000
s_mov_b32 m0, 0x0
s_add_u32 s46, s44, 0x0
s_cmp_le_u32 s72, 0
s_addc_u32 s45, 0, 0
s_lshl_b32 s45, s45, 13
s_add_u32 s45, s45, 0x1800
s_add_u32 s45, s45, s48
Ta 192,8,16384
Mvaa 100,200,32
Ta 194,8,20480
La 72,4,56,45,0
Mvaa 84,200,16
Ta 196,8,24576
DD 32,52,46,0
Mvaa 84,204,20
Ta 198,8,28672
DD 33,52,46,1024
Mvaa 68,204,4
DD 34,52,46,2048
Mvaa 68,200,0
s_waitcnt lgkmcnt(8)
DD 35,52,46,3072
Mvaa 72,208,0
Ta 200,9,16384
Mvaa 72,212,4
Ta 202,9,20480
La 76,4,56,45,1024
Mvaa 88,212,20
Ta 204,9,24576
Mvaa 88,208,16
Ta 206,9,28672
Mvaa 104,208,32
Mvaa 104,212,36
s_waitcnt lgkmcnt(8)
Mvaa 108,220,36
s_mov_b32 m0, 0x1000
s_add_u32 s46, s44, 0x8000
Ta 208,10,16384
Mvaa 108,216,32
Ta 210,10,20480
La 88,5,56,45,0
Mvaa 92,216,16
Ta 212,10,24576
DD 32,52,46,0
Mvaa 92,220,20
Ta 214,10,28672
DD 33,52,46,1024
Mvaa 76,220,4
DD 34,52,46,2048
Mvaa 76,216,0
s_waitcnt lgkmcnt(8)
DD 35,52,46,3072
Maaa 128,192,8
Ta 216,11,16384
Maaa 128,196,12
Ta 218,11,20480
Maaa 144,196,28
Ta 220,11,24576
Maaa 144,192,24
Ta 222,11,28672
Maaa 160,192,40
Maaa 160,196,44
s_waitcnt lgkmcnt(8)
Maaa 164,204,44
s_mov_b32 m0, 0x2000
s_add_u32 s46, s44, 0x10000
Ta 192,12,16384
Maaa 164,200,40
Ta 194,12,20480
La 92,5,56,45,1024
Maaa 148,200,24
Ta 196,12,24576
DD 32,52,46,0
Maaa 148,204,28
Ta 198,12,28672
DD 33,52,46,1024
Maaa 132,204,12
DD 34,52,46,2048
Maaa 132,200,8
s_waitcnt lgkmcnt(8)
DD 35,52,46,3072
Maaa 136,208,8
Ta 200,13,16384
Maaa 136,212,12
Ta 202,13,20480
La 104,6,56,45,0
Maaa 152,212,28
Ta 204,13,24576
Maaa 152,208,24
Ta 206,13,28672
Maaa 168,208,40
Maaa 168,212,44
s_waitcnt lgkmcnt(8)
Maaa 172,220,44
s_mov_b32 m0, 0x3000
s_add_u32 s46, s44, 0x18000
Ta 208,14,16384
Maaa 172,216,40
Ta 210,14,20480
La 108,6,56,45,1024
Maaa 156,216,24
Ta 212,14,24576
DD 32,52,46,0
Maaa 156,220,28
Ta 214,14,28672
DD 33,52,46,1024
Maaa 140,220,12
DD 34,52,46,2048
Maaa 140,216,8
s_waitcnt lgkmcnt(8)
DD 35,52,46,3072
Mvaa 64,192,8
Ta 216,15,16384
Mvaa 64,196,12
Ta 218,15,20480
Mvaa 80,196,28
Ta 220,15,24576
Mvaa 80,192,24
Ta 222,15,28672
Mvaa 96,192,40
Mvaa 96,196,44
s_barrier
s_waitcnt lgkmcnt(8)
Mvaa 100,204,44
s_cmp_le_u32 s72, 2
s_addc_u32 s44, 2, 0
s_lshl_b32 s44, s44, 19
s_add_u32 s44, s44, 0x60000
s_mov_b32 m0, 0x10000
s_add_u32 s46, s44, 0x0
s_cmp_le_u32 s72, 1
s_addc_u32 s45, 1, 0
s_lshl_b32 s45, s45, 13
s_add_u32 s45, s45, 0x1000
s_add_u32 s45, s45, s48
Ta 192,16,32768
Mvaa 100,200,40
Ta 194,16,36864
Lv 144,4,56,45,0
Mvaa 84,200,24
Ta 196,16,40960
DD 32,52,46,0
Mvaa 84,204,28
Ta 198,16,45056
DD 33,52,46,1024
Mvaa 68,204,12
DD 34,52,46,2048
Mvaa 68,200,8
s_waitcnt lgkmcnt(8)
DD 35,52,46,3072
Mvaa 72,208,8
Ta 200,17,32768
Mvaa 72,212,12
Ta 202,17,36864
Lv 148,4,56,45,1024
Mvaa 88,212,28
Ta 204,17,40960
Mvaa 88,208,24
Ta 206,17,45056
Mvaa 104,208,40
Mvaa 104,212,44
s_waitcnt lgkmcnt(8)
Mvaa 108,220,44
s_mov_b32 m0, 0x11000
s_add_u32 s46, s44, 0x8000
Ta 208,18,32768
Mvaa 108,216,40
Ta 210,18,36864
Lv 176,5,56,45,0
Mvaa 92,216,24
Ta 212,18,40960
DD 32,52,46,0
Mvaa 92,220,28
Ta 214,18,45056
DD 33,52,46,1024
Mvaa 76,220,12
DD 34,52,46,2048
Mvaa 76,216,8
s_waitcnt lgkmcnt(8)
DD 35,52,46,3072
Maav 128,192,128
Ta 216,19,32768
Maav 128,196,132
s_waitcnt vmcnt(63)
Ta 218,19,36864
Maav 144,196,164
Ta 220,19,40960
Maav 144,192,160
s_waitcnt vmcnt(63)
Ta 222,19,45056
Maav 160,192,192
Maav 160,196,196
s_waitcnt lgkmcnt(8)
Maav 164,204,196
s_mov_b32 m0, 0x12000
s_add_u32 s46, s44, 0x10000
Ta 192,20,32768
Maav 164,200,192
Ta 194,20,36864
Lv 180,5,56,45,1024
Maav 148,200,160
Ta 196,20,40960
DD 32,52,46,0
Maav 148,204,164
Ta 198,20,45056
DD 33,52,46,1024
Maav 132,204,132
DD 34,52,46,2048
Maav 132,200,128
s_waitcnt lgkmcnt(8)
DD 35,52,46,3072
Maav 136,208,128
Ta 200,21,32768
Maav 136,212,132
Ta 202,21,36864
Lv 208,6,56,45,0
Maav 152,212,164
Ta 204,21,40960
Maav 152,208,160
Ta 206,21,45056
Maav 168,208,192
Maav 168,212,196
s_waitcnt lgkmcnt(8)
Maav 172,220,196
s_mov_b32 m0, 0x13000
s_add_u32 s46, s44, 0x18000
Ta 208,22,32768
Maav 172,216,192
Ta 210,22,36864
Lv 212,6,56,45,1024
Maav 156,216,160
Ta 212,22,40960
DD 32,52,46,0
Maav 156,220,164
Ta 214,22,45056
DD 33,52,46,1024
Maav 140,220,132
DD 34,52,46,2048
Maav 140,216,128
s_waitcnt lgkmcnt(8)
DD 35,52,46,3072
Mvav 64,192,128
Ta 216,23,32768
Mvav 64,196,132
Ta 218,23,36864
Mvav 80,196,164
Ta 220,23,40960
Mvav 80,192,160
Ta 222,23,45056
Mvav 96,192,192
Mvav 96,196,196
s_waitcnt lgkmcnt(8)
Mvav 100,204,196
s_cmp_le_u32 s72, 3
s_addc_u32 s44, 3, 0
s_lshl_b32 s44, s44, 19
s_add_u32 s44, s44, 0x40000
s_mov_b32 m0, 0x4000
s_add_u32 s46, s44, 0x0
s_cmp_le_u32 s72, 1
s_addc_u32 s45, 1, 0
s_lshl_b32 s45, s45, 13
s_add_u32 s45, s45, 0x1800
s_add_u32 s45, s45, s48
Ta 192,8,32768
Mvav 100,200,192
Ta 194,8,36864
Lv 152,4,56,45,0
Mvav 84,200,160
Ta 196,8,40960
DD 32,52,46,0
Mvav 84,204,164
Ta 198,8,45056
DD 33,52,46,1024
Mvav 68,204,132
DD 34,52,46,2048
Mvav 68,200,128
s_waitcnt lgkmcnt(8)
DD 35,52,46,3072
Mvav 72,208,128
Ta 200,9,32768
Mvav 72,212,132
Ta 202,9,36864
Lv 156,4,56,45,1024
Mvav 88,212,164
Ta 204,9,40960
Mvav 88,208,160
Ta 206,9,45056
Mvav 104,208,192
Mvav 104,212,196
s_waitcnt lgkmcnt(8)
Mvav 108,220,196
s_mov_b32 m0, 0x5000
s_add_u32 s46, s44, 0x8000
Ta 208,10,32768
Mvav 108,216,192
Ta 210,10,36864
Lv 184,5,56,45,0
Mvav 92,216,160
Ta 212,10,40960
DD 32,52,46,0
Mvav 92,220,164
Ta 214,10,45056
DD 33,52,46,1024
Mvav 76,220,132
DD 34,52,46,2048
Mvav 76,216,128
s_waitcnt vmcnt(63) lgkmcnt(8)
DD 35,52,46,3072
Maav 128,192,136
s_waitcnt vmcnt(63)
Ta 216,11,32768
Maav 128,196,140
s_waitcnt vmcnt(63)
Ta 218,11,36864
Maav 144,196,172
Ta 220,11,40960
Maav 144,192,168
s_waitcnt vmcnt(63)
Ta 222,11,45056
Maav 160,192,200
Maav 160,196,204
s_waitcnt lgkmcnt(8)
Maav 164,204,204
s_mov_b32 m0, 0x6000
s_add_u32 s46, s44, 0x10000
Ta 192,12,32768
Maav 164,200,200
Ta 194,12,36864
Lv 188,5,56,45,1024
Maav 148,200,168
Ta 196,12,40960
DD 32,52,46,0
Maav 148,204,172
Ta 198,12,45056
DD 33,52,46,1024
Maav 132,204,140
DD 34,52,46,2048
Maav 132,200,136
s_waitcnt lgkmcnt(8)
DD 35,52,46,3072
Maav 136,208,136
Ta 200,13,32768
Maav 136,212,140
Ta 202,13,36864
Lv 216,6,56,45,0
Maav 152,212,172
Ta 204,13,40960
Maav 152,208,168
Ta 206,13,45056
Maav 168,208,200
Maav 168,212,204
s_waitcnt lgkmcnt(8)
Maav 172,220,204
s_mov_b32 m0, 0x7000
s_add_u32 s46, s44, 0x18000
Ta 208,14,32768
Maav 172,216,200
Ta 210,14,36864
Lv 220,6,56,45,1024
Maav 156,216,168
Ta 212,14,40960
DD 32,52,46,0
Maav 156,220,172
Ta 214,14,45056
DD 33,52,46,1024
Maav 140,220,140
DD 34,52,46,2048
Maav 140,216,136
s_waitcnt lgkmcnt(8)
DD 35,52,46,3072
Mvav 64,192,136
Ta 216,15,32768
Mvav 64,196,140
Ta 218,15,36864
Mvav 80,196,172
Ta 220,15,40960
Mvav 80,192,168
Ta 222,15,45056
Mvav 96,192,200
Mvav 96,196,204
s_barrier
s_waitcnt lgkmcnt(8)
Mvav 100,204,204
s_cmp_le_u32 s72, 3
s_addc_u32 s44, 3, 0
s_lshl_b32 s44, s44, 19
s_add_u32 s44, s44, 0x60000
s_mov_b32 m0, 0x14000
s_add_u32 s46, s44, 0x0
s_cmp_le_u32 s72, 2
s_addc_u32 s45, 2, 0
s_lshl_b32 s45, s45, 13
s_add_u32 s45, s45, 0x1000
s_add_u32 s45, s45, s48
Ta 192,16,49152
Mvav 100,200,200
Ta 194,16,53248
La 0,4,56,45,0
Mvav 84,200,168
Ta 196,16,57344
DD 32,52,46,0
Mvav 84,204,172
Ta 198,16,61440
DD 33,52,46,1024
Mvav 68,204,140
DD 34,52,46,2048
Mvav 68,200,136
s_waitcnt lgkmcnt(8)
DD 35,52,46,3072
Mvav 72,208,136
Ta 200,17,49152
Mvav 72,212,140
Ta 202,17,53248
La 4,4,56,45,1024
Mvav 88,212,172
Ta 204,17,57344
Mvav 88,208,168
Ta 206,17,61440
Mvav 104,208,200
Mvav 104,212,204
s_waitcnt lgkmcnt(8)
Mvav 108,220,204
s_mov_b32 m0, 0x15000
s_add_u32 s46, s44, 0x8000
Ta 208,18,49152
Mvav 108,216,200
Ta 210,18,53248
La 16,5,56,45,0
Mvav 92,216,168
Ta 212,18,57344
DD 32,52,46,0
Mvav 92,220,172
Ta 214,18,61440
DD 33,52,46,1024
Mvav 76,220,140
DD 34,52,46,2048
Mvav 76,216,136
s_waitcnt vmcnt(63) lgkmcnt(8)
DD 35,52,46,3072
Maaa 128,192,64
s_waitcnt vmcnt(63)
Ta 216,19,49152
Maaa 128,196,68
s_waitcnt vmcnt(63)
Ta 218,19,53248
Maaa 144,196,84
Ta 220,19,57344
Maaa 144,192,80
s_waitcnt vmcnt(63)
Ta 222,19,61440
Maaa 160,192,96
Maaa 160,196,100
s_waitcnt lgkmcnt(8)
Maaa 164,204,100
s_mov_b32 m0, 0x16000
s_add_u32 s46, s44, 0x10000
Ta 192,20,49152
Maaa 164,200,96
Ta 194,20,53248
La 20,5,56,45,1024
Maaa 148,200,80
Ta 196,20,57344
DD 32,52,46,0
Maaa 148,204,84
Ta 198,20,61440
DD 33,52,46,1024
Maaa 132,204,68
DD 34,52,46,2048
Maaa 132,200,64
s_waitcnt lgkmcnt(8)
DD 35,52,46,3072
Maaa 136,208,64
Ta 200,21,49152
Maaa 136,212,68
Ta 202,21,53248
La 32,6,56,45,0
Maaa 152,212,84
Ta 204,21,57344
Maaa 152,208,80
Ta 206,21,61440
Maaa 168,208,96
Maaa 168,212,100
s_waitcnt lgkmcnt(8)
Maaa 172,220,100
s_mov_b32 m0, 0x17000
s_add_u32 s46, s44, 0x18000
Ta 208,22,49152
Maaa 172,216,96
Ta 210,22,53248
La 36,6,56,45,1024
Maaa 156,216,80
Ta 212,22,57344
DD 32,52,46,0
Maaa 156,220,84
Ta 214,22,61440
DD 33,52,46,1024
Maaa 140,220,68
DD 34,52,46,2048
Maaa 140,216,64
s_waitcnt lgkmcnt(8)
DD 35,52,46,3072
Mvaa 64,192,64
Ta 216,23,49152
Mvaa 64,196,68
Ta 218,23,53248
Mvaa 80,196,84
Ta 220,23,57344
Mvaa 80,192,80
Ta 222,23,61440
Mvaa 96,192,96
Mvaa 96,196,100
s_waitcnt lgkmcnt(8)
Mvaa 100,204,100
s_cmp_le_u32 s72, 4
s_addc_u32 s44, 4, 0
s_lshl_b32 s44, s44, 19
s_add_u32 s44, s44, 0x40000
s_mov_b32 m0, 0x8000
s_add_u32 s46, s44, 0x0
s_cmp_le_u32 s72, 2
s_addc_u32 s45, 2, 0
s_lshl_b32 s45, s45, 13
s_add_u32 s45, s45, 0x1800
s_add_u32 s45, s45, s48
Ta 192,8,49152
Mvaa 100,200,96
Ta 194,8,53248
La 8,4,56,45,0
Mvaa 84,200,80
Ta 196,8,57344
DD 32,52,46,0
Mvaa 84,204,84
Ta 198,8,61440
DD 33,52,46,1024
Mvaa 68,204,68
DD 34,52,46,2048
Mvaa 68,200,64
s_waitcnt lgkmcnt(8)
DD 35,52,46,3072
Mvaa 72,208,64
Ta 200,9,49152
Mvaa 72,212,68
Ta 202,9,53248
La 12,4,56,45,1024
Mvaa 88,212,84
Ta 204,9,57344
Mvaa 88,208,80
Ta 206,9,61440
Mvaa 104,208,96
Mvaa 104,212,100
s_waitcnt lgkmcnt(8)
Mvaa 108,220,100
s_mov_b32 m0, 0x9000
s_add_u32 s46, s44, 0x8000
Ta 208,10,49152
Mvaa 108,216,96
Ta 210,10,53248
La 24,5,56,45,0
Mvaa 92,216,80
Ta 212,10,57344
DD 32,52,46,0
Mvaa 92,220,84
Ta 214,10,61440
DD 33,52,46,1024
Mvaa 76,220,68
DD 34,52,46,2048
Mvaa 76,216,64
s_waitcnt vmcnt(63) lgkmcnt(8)
DD 35,52,46,3072
Maaa 128,192,72
s_waitcnt vmcnt(63)
Ta 216,11,49152
Maaa 128,196,76
s_waitcnt vmcnt(63)
Ta 218,11,53248
Maaa 144,196,92
Ta 220,11,57344
Maaa 144,192,88
s_waitcnt vmcnt(63)
Ta 222,11,61440
Maaa 160,192,104
Maaa 160,196,108
s_waitcnt lgkmcnt(8)
Maaa 164,204,108
s_mov_b32 m0, 0xa000
s_add_u32 s46, s44, 0x10000
Ta 192,12,49152
Maaa 164,200,104
Ta 194,12,53248
La 28,5,56,45,1024
Maaa 148,200,88
Ta 196,12,57344
DD 32,52,46,0
Maaa 148,204,92
Ta 198,12,61440
DD 33,52,46,1024
Maaa 132,204,76
DD 34,52,46,2048
Maaa 132,200,72
s_waitcnt lgkmcnt(8)
DD 35,52,46,3072
Maaa 136,208,72
Ta 200,13,49152
Maaa 136,212,76
Ta 202,13,53248
La 40,6,56,45,0
Maaa 152,212,92
Ta 204,13,57344
Maaa 152,208,88
Ta 206,13,61440
Maaa 168,208,104
Maaa 168,212,108
s_waitcnt lgkmcnt(8)
Maaa 172,220,108
s_mov_b32 m0, 0xb000
s_add_u32 s46, s44, 0x18000
Ta 208,14,49152
Maaa 172,216,104
Ta 210,14,53248
La 44,6,56,45,1024
Maaa 156,216,88
Ta 212,14,57344
DD 32,52,46,0
Maaa 156,220,92
Ta 214,14,61440
DD 33,52,46,1024
Maaa 140,220,76
DD 34,52,46,2048
Maaa 140,216,72
s_waitcnt lgkmcnt(8)
DD 35,52,46,3072
Mvaa 64,192,72
Ta 216,15,49152
Mvaa 64,196,76
Ta 218,15,53248
Mvaa 80,196,92
Ta 220,15,57344
Mvaa 80,192,88
Ta 222,15,61440
Mvaa 96,192,104
Mvaa 96,196,108
s_barrier
s_waitcnt lgkmcnt(8)
Mvaa 100,204,108
s_cmp_le_u32 s72, 4
s_addc_u32 s44, 4, 0
s_lshl_b32 s44, s44, 19
s_add_u32 s44, s44, 0x60000
s_mov_b32 m0, 0x18000
s_add_u32 s46, s44, 0x0
s_cmp_le_u32 s72, 3
s_addc_u32 s45, 3, 0
s_lshl_b32 s45, s45, 13
s_add_u32 s45, s45, 0x1000
s_add_u32 s45, s45, s48
Ta 192,24,0
Mvaa 100,200,104
Ta 194,24,4096
Lv 128,4,56,45,0
Mvaa 84,200,88
Ta 196,24,8192
DD 32,52,46,0
Mvaa 84,204,92
Ta 198,24,12288
DD 33,52,46,1024
Mvaa 68,204,76
DD 34,52,46,2048
Mvaa 68,200,72
s_waitcnt lgkmcnt(8)
DD 35,52,46,3072
Mvaa 72,208,72
Ta 200,25,0
Mvaa 72,212,76
Ta 202,25,4096
Lv 132,4,56,45,1024
Mvaa 88,212,92
Ta 204,25,8192
Mvaa 88,208,88
Ta 206,25,12288
Mvaa 104,208,104
Mvaa 104,212,108
s_waitcnt lgkmcnt(8)
Mvaa 108,220,108
s_mov_b32 m0, 0x19000
s_add_u32 s46, s44, 0x8000
Ta 208,26,0
Mvaa 108,216,104
Ta 210,26,4096
Lv 160,5,56,45,0
Mvaa 92,216,88
Ta 212,26,8192
DD 32,52,46,0
Mvaa 92,220,92
Ta 214,26,12288
DD 33,52,46,1024
Mvaa 76,220,76
DD 34,52,46,2048
Mvaa 76,216,72
s_waitcnt vmcnt(63) lgkmcnt(8)
DD 35,52,46,3072
Maav 128,192,144
s_waitcnt vmcnt(63)
Ta 216,27,0
Maav 128,196,148
s_waitcnt vmcnt(63)
Ta 218,27,4096
Maav 144,196,180
Ta 220,27,8192
Maav 144,192,176
s_waitcnt vmcnt(63)
Ta 222,27,12288
Maav 160,192,208
Maav 160,196,212
s_waitcnt lgkmcnt(8)
Maav 164,204,212
s_mov_b32 m0, 0x1a000
s_add_u32 s46, s44, 0x10000
Ta 192,28,0
Maav 164,200,208
Ta 194,28,4096
Lv 164,5,56,45,1024
Maav 148,200,176
Ta 196,28,8192
DD 32,52,46,0
Maav 148,204,180
Ta 198,28,12288
DD 33,52,46,1024
Maav 132,204,148
DD 34,52,46,2048
Maav 132,200,144
s_waitcnt lgkmcnt(8)
DD 35,52,46,3072
Maav 136,208,144
Ta 200,29,0
Maav 136,212,148
Ta 202,29,4096
Lv 192,6,56,45,0
Maav 152,212,180
Ta 204,29,8192
Maav 152,208,176
Ta 206,29,12288
Maav 168,208,208
Maav 168,212,212
s_waitcnt lgkmcnt(8)
Maav 172,220,212
s_mov_b32 m0, 0x1b000
s_add_u32 s46, s44, 0x18000
Ta 208,30,0
Maav 172,216,208
Ta 210,30,4096
Lv 196,6,56,45,1024
Maav 156,216,176
Ta 212,30,8192
DD 32,52,46,0
Maav 156,220,180
Ta 214,30,12288
DD 33,52,46,1024
Maav 140,220,148
DD 34,52,46,2048
Maav 140,216,144
s_waitcnt lgkmcnt(8)
DD 35,52,46,3072
Mvav 64,192,144
Ta 216,31,0
Mvav 64,196,148
Ta 218,31,4096
Mvav 80,196,180
Ta 220,31,8192
Mvav 80,192,176
Ta 222,31,12288
Mvav 96,192,208
Mvav 96,196,212
s_waitcnt lgkmcnt(8)
Mvav 100,204,212
s_cmp_le_u32 s72, 5
s_addc_u32 s44, 5, 0
s_lshl_b32 s44, s44, 19
s_add_u32 s44, s44, 0x40000
s_mov_b32 m0, 0xc000
s_add_u32 s46, s44, 0x0
s_cmp_le_u32 s72, 3
s_addc_u32 s45, 3, 0
s_lshl_b32 s45, s45, 13
s_add_u32 s45, s45, 0x1800
s_add_u32 s45, s45, s48
Ta 192,24,16384
Mvav 100,200,208
Ta 194,24,20480
Lv 136,4,56,45,0
Mvav 84,200,176
Ta 196,24,24576
DD 32,52,46,0
Mvav 84,204,180
Ta 198,24,28672
DD 33,52,46,1024
Mvav 68,204,148
DD 34,52,46,2048
Mvav 68,200,144
s_waitcnt lgkmcnt(8)
DD 35,52,46,3072
Lv 140,4,56,45,1024
Mvav 72,208,144
Ta 200,25,16384
Mvav 72,212,148
Ta 202,25,20480
Lv 168,5,56,45,0
Mvav 88,212,180
Ta 204,25,24576
Mvav 88,208,176
Ta 206,25,28672
Mvav 104,208,208
Mvav 104,212,212
s_waitcnt lgkmcnt(8)
Mvav 108,220,212
s_mov_b32 m0, 0xd000
s_add_u32 s46, s44, 0x8000
Ta 208,26,16384
Mvav 108,216,208
Ta 210,26,20480
Lv 172,5,56,45,1024
Mvav 92,216,176
Ta 212,26,24576
DD 32,52,46,0
Mvav 92,220,180
Ta 214,26,28672
DD 33,52,46,1024
Mvav 76,220,148
DD 34,52,46,2048
Mvav 76,216,144
s_waitcnt vmcnt(63) lgkmcnt(8)
DD 35,52,46,3072
Lv 200,6,56,45,0
Maav 128,192,152
s_waitcnt vmcnt(63)
Ta 216,27,16384
Maav 128,196,156
s_waitcnt vmcnt(63)
Ta 218,27,20480
Lv 204,6,56,45,1024
Maav 144,196,188
Ta 220,27,24576
Maav 144,192,184
s_waitcnt vmcnt(63)
Ta 222,27,28672
Maav 160,192,216
Maav 160,196,220
s_waitcnt lgkmcnt(8)
Maav 164,204,220
s_mov_b32 m0, 0xe000
s_add_u32 s46, s44, 0x10000
s_cmp_le_u32 s72, 4
s_addc_u32 s45, 4, 0
s_lshl_b32 s45, s45, 13
s_add_u32 s45, s45, 0x1000
s_add_u32 s45, s45, s48
Ta 192,28,16384
Maav 164,200,216
Ta 194,28,20480
La 64,4,56,45,0
Maav 148,200,184
Ta 196,28,24576
DD 32,52,46,0
Maav 148,204,188
Ta 198,28,28672
DD 33,52,46,1024
Maav 132,204,156
DD 34,52,46,2048
Maav 132,200,152
s_waitcnt lgkmcnt(8)
DD 35,52,46,3072
La 68,4,56,45,1024
Maav 136,208,152
Ta 200,29,16384
Maav 136,212,156
Ta 202,29,20480
La 80,5,56,45,0
Maav 152,212,188
Ta 204,29,24576
Maav 152,208,184
Ta 206,29,28672
Maav 168,208,216
Maav 168,212,220
s_waitcnt lgkmcnt(8)
Maav 172,220,220
s_mov_b32 m0, 0xf000
s_add_u32 s46, s44, 0x18000
Ta 208,30,16384
Maav 172,216,216
Ta 210,30,20480
La 84,5,56,45,1024
Maav 156,216,184
Ta 212,30,24576
DD 32,52,46,0
Maav 156,220,188
Ta 214,30,28672
DD 33,52,46,1024
Maav 140,220,156
DD 34,52,46,2048
Maav 140,216,152
s_waitcnt lgkmcnt(8)
DD 35,52,46,3072
La 96,6,56,45,0
Mvav 64,192,152
Ta 216,31,16384
Mvav 64,196,156
Ta 218,31,20480
La 100,6,56,45,1024
Mvav 80,196,188
Ta 220,31,24576
Mvav 80,192,184
Ta 222,31,28672
Mvav 96,192,216
Mvav 96,196,220
s_barrier
s_waitcnt lgkmcnt(8)
Mvav 100,204,220
s_cmp_le_u32 s72, 5
s_addc_u32 s44, 5, 0
s_lshl_b32 s44, s44, 19
s_add_u32 s44, s44, 0x60000
s_mov_b32 m0, 0x1c000
s_add_u32 s46, s44, 0x0
s_cmp_le_u32 s72, 4
s_addc_u32 s45, 4, 0
s_lshl_b32 s45, s45, 13
s_add_u32 s45, s45, 0x1800
s_add_u32 s45, s45, s48
Ta 192,16,0
Mvav 100,200,216
Ta 194,16,4096
La 72,4,56,45,0
Mvav 84,200,184
Ta 196,16,8192
DD 32,52,46,0
Mvav 84,204,188
Ta 198,16,12288
DD 33,52,46,1024
Mvav 68,204,156
DD 34,52,46,2048
Mvav 68,200,152
s_waitcnt lgkmcnt(8)
DD 35,52,46,3072
La 76,4,56,45,1024
Mvav 72,208,152
Ta 200,17,0
Mvav 72,212,156
Ta 202,17,4096
La 88,5,56,45,0
Mvav 88,212,188
Ta 204,17,8192
Mvav 88,208,184
Ta 206,17,12288
Mvav 104,208,216
Mvav 104,212,220
s_waitcnt lgkmcnt(8)
Mvav 108,220,220
s_mov_b32 m0, 0x1d000
s_add_u32 s46, s44, 0x8000
Ta 208,18,0
Mvav 108,216,216
Ta 210,18,4096
La 92,5,56,45,1024
Mvav 92,216,184
Ta 212,18,8192
DD 32,52,46,0
Mvav 92,220,188
Ta 214,18,12288
DD 33,52,46,1024
Mvav 76,220,156
DD 34,52,46,2048
Mvav 76,216,152
s_waitcnt vmcnt(63) lgkmcnt(8)
DD 35,52,46,3072
La 104,6,56,45,0
Maaa 128,192,0
s_waitcnt vmcnt(63)
Ta 216,19,0
Maaa 128,196,4
s_waitcnt vmcnt(63)
Ta 218,19,4096
La 108,6,56,45,1024
Maaa 144,196,20
Ta 220,19,8192
Maaa 144,192,16
s_waitcnt vmcnt(63)
Ta 222,19,12288
Maaa 160,192,32
Maaa 160,196,36
s_waitcnt lgkmcnt(8)
Maaa 164,204,36
s_mov_b32 m0, 0x1e000
s_add_u32 s46, s44, 0x10000
s_cmp_le_u32 s72, 5
s_addc_u32 s45, 5, 0
s_lshl_b32 s45, s45, 13
s_add_u32 s45, s45, 0x1000
s_add_u32 s45, s45, s48
Ta 192,20,0
Maaa 164,200,32
Ta 194,20,4096
Lv 144,4,56,45,0
Maaa 148,200,16
Ta 196,20,8192
DD 32,52,46,0
Maaa 148,204,20
Ta 198,20,12288
DD 33,52,46,1024
Maaa 132,204,4
DD 34,52,46,2048
Maaa 132,200,0
s_waitcnt lgkmcnt(8)
DD 35,52,46,3072
Lv 148,4,56,45,1024
Maaa 136,208,0
Ta 200,21,0
Maaa 136,212,4
Ta 202,21,4096
Lv 176,5,56,45,0
Maaa 152,212,20
Ta 204,21,8192
Maaa 152,208,16
Ta 206,21,12288
Maaa 168,208,32
Maaa 168,212,36
s_waitcnt lgkmcnt(8)
Maaa 172,220,36
s_mov_b32 m0, 0x1f000
s_add_u32 s46, s44, 0x18000
Ta 208,22,0
Maaa 172,216,32
Ta 210,22,4096
Lv 180,5,56,45,1024
Maaa 156,216,16
Ta 212,22,8192
DD 32,52,46,0
Maaa 156,220,20
Ta 214,22,12288
DD 33,52,46,1024
Maaa 140,220,4
DD 34,52,46,2048
Maaa 140,216,0
s_waitcnt lgkmcnt(8)
DD 35,52,46,3072
Lv 208,6,56,45,0
Mvaa 64,192,0
Ta 216,23,0
Mvaa 64,196,4
Ta 218,23,4096
Lv 212,6,56,45,1024
Mvaa 80,196,20
Ta 220,23,8192
Mvaa 80,192,16
Ta 222,23,12288
Mvaa 96,192,32
Mvaa 96,196,36
s_waitcnt lgkmcnt(8)
Mvaa 100,204,36
s_cmp_le_u32 s72, 6
s_addc_u32 s44, 6, 0
s_lshl_b32 s44, s44, 19
s_add_u32 s44, s44, 0x40000
s_mov_b32 m0, 0x20000
s_add_u32 s46, s44, 0x0
s_cmp_le_u32 s72, 5
s_addc_u32 s45, 5, 0
s_lshl_b32 s45, s45, 13
s_add_u32 s45, s45, 0x1800
s_add_u32 s45, s45, s48
Ta 192,8,0
Mvaa 100,200,32
Ta 194,8,4096
Lv 152,4,56,45,0
Mvaa 84,200,16
Ta 196,8,8192
DD 32,52,46,0
Mvaa 84,204,20
Ta 198,8,12288
DD 33,52,46,1024
Mvaa 68,204,4
DD 34,52,46,2048
Mvaa 68,200,0
s_waitcnt lgkmcnt(8)
DD 35,52,46,3072
Lv 156,4,56,45,1024
Mvaa 72,208,0
Ta 200,9,0
Mvaa 72,212,4
Ta 202,9,4096
Lv 184,5,56,45,0
Mvaa 88,212,20
Ta 204,9,8192
Mvaa 88,208,16
Ta 206,9,12288
Mvaa 104,208,32
Mvaa 104,212,36
s_waitcnt lgkmcnt(8)
Mvaa 108,220,36
s_mov_b32 m0, 0x21000
s_add_u32 s46, s44, 0x8000
Ta 208,10,0
Mvaa 108,216,32
Ta 210,10,4096
Lv 188,5,56,45,1024
Mvaa 92,216,16
Ta 212,10,8192
DD 32,52,46,0
Mvaa 92,220,20
Ta 214,10,12288
DD 33,52,46,1024
Mvaa 76,220,4
DD 34,52,46,2048
Mvaa 76,216,0
s_waitcnt vmcnt(63) lgkmcnt(8)
DD 35,52,46,3072
Lv 216,6,56,45,0
Maaa 128,192,8
s_waitcnt vmcnt(63)
Ta 216,11,0
Maaa 128,196,12
s_waitcnt vmcnt(63)
Ta 218,11,4096
Lv 220,6,56,45,1024
Maaa 144,196,28
Ta 220,11,8192
Maaa 144,192,24
s_waitcnt vmcnt(63)
Ta 222,11,12288
Maaa 160,192,40
Maaa 160,196,44
s_waitcnt lgkmcnt(8)
Maaa 164,204,44
s_mov_b32 m0, 0x22000
s_add_u32 s46, s44, 0x10000
s_cmp_le_u32 s72, 6
s_addc_u32 s45, 6, 0
s_lshl_b32 s45, s45, 13
s_add_u32 s45, s45, 0x1000
s_add_u32 s45, s45, s48
Ta 192,12,0
Maaa 164,200,40
Ta 194,12,4096
La 0,4,56,45,0
Maaa 148,200,24
Ta 196,12,8192
DD 32,52,46,0
Maaa 148,204,28
Ta 198,12,12288
DD 33,52,46,1024
Maaa 132,204,12
DD 34,52,46,2048
Maaa 132,200,8
s_waitcnt lgkmcnt(8)
DD 35,52,46,3072
La 4,4,56,45,1024
Maaa 136,208,8
Ta 200,13,0
Maaa 136,212,12
Ta 202,13,4096
La 16,5,56,45,0
Maaa 152,212,28
Ta 204,13,8192
Maaa 152,208,24
Ta 206,13,12288
Maaa 168,208,40
Maaa 168,212,44
s_waitcnt lgkmcnt(8)
Maaa 172,220,44
s_mov_b32 m0, 0x23000
s_add_u32 s46, s44, 0x18000
Ta 208,14,0
Maaa 172,216,40
Ta 210,14,4096
La 20,5,56,45,1024
Maaa 156,216,24
Ta 212,14,8192
DD 32,52,46,0
Maaa 156,220,28
Ta 214,14,12288
DD 33,52,46,1024
Maaa 140,220,12
DD 34,52,46,2048
Maaa 140,216,8
s_waitcnt lgkmcnt(8)
DD 35,52,46,3072
La 32,6,56,45,0
Mvaa 64,192,8
Ta 216,15,0
Mvaa 64,196,12
Ta 218,15,4096
La 36,6,56,45,1024
Mvaa 80,196,28
Ta 220,15,8192
Mvaa 80,192,24
Ta 222,15,12288
Mvaa 96,192,40
Mvaa 96,196,44
s_waitcnt vmcnt(63)
s_barrier
s_waitcnt lgkmcnt(8)
Mvaa 100,204,44
s_cmp_le_u32 s72, 6
s_addc_u32 s44, 6, 0
s_lshl_b32 s44, s44, 19
s_add_u32 s44, s44, 0x60000
s_mov_b32 m0, 0x24000
s_add_u32 s46, s44, 0x0
Ta 192,16,16384
Mvaa 100,200,40
Ta 194,16,20480
Mvaa 84,200,24
Ta 196,16,24576
DD 32,52,46,0
Mvaa 84,204,28
Ta 198,16,28672
DD 33,52,46,1024
Mvaa 68,204,12
DD 34,52,46,2048
Mvaa 68,200,8
s_waitcnt lgkmcnt(8)
DD 35,52,46,3072
Mvaa 72,208,8
Ta 200,17,16384
Mvaa 72,212,12
Ta 202,17,20480
Mvaa 88,212,28
Ta 204,17,24576
Mvaa 88,208,24
Ta 206,17,28672
Mvaa 104,208,40
Mvaa 104,212,44
s_waitcnt lgkmcnt(8)
Mvaa 108,220,44
s_mov_b32 m0, 0x25000
s_add_u32 s46, s44, 0x8000
Ta 208,18,16384
Mvaa 108,216,40
Ta 210,18,20480
Mvaa 92,216,24
Ta 212,18,24576
DD 32,52,46,0
Mvaa 92,220,28
Ta 214,18,28672
DD 33,52,46,1024
Mvaa 76,220,12
DD 34,52,46,2048
Mvaa 76,216,8
s_waitcnt lgkmcnt(8)
DD 35,52,46,3072
Maav 128,192,128
s_cmp_le_u32 s72, 6
s_addc_u32 s45, 6, 0
s_lshl_b32 s45, s45, 13
s_add_u32 s45, s45, 0x1800
s_add_u32 s45, s45, s48
Ta 216,19,16384
Maav 128,196,132
Ta 218,19,20480
La 8,4,56,45,0
Maav 144,196,164
Ta 220,19,24576
Maav 144,192,160
Ta 222,19,28672
Maav 160,192,192
Maav 160,196,196
s_waitcnt lgkmcnt(8)
La 12,4,56,45,1024
Maav 164,204,196
s_mov_b32 m0, 0x26000
s_add_u32 s46, s44, 0x10000
Ta 192,8,16384
Maav 164,200,192
Ta 194,8,20480
La 24,5,56,45,0
Maav 148,200,160
Ta 196,8,24576
DD 32,52,46,0
Maav 148,204,164
Ta 198,8,28672
DD 33,52,46,1024
Maav 132,204,132
DD 34,52,46,2048
Maav 132,200,128
s_waitcnt lgkmcnt(8)
DD 35,52,46,3072
Maav 136,208,128
Ta 200,9,16384
Maav 136,212,132
Ta 202,9,20480
La 28,5,56,45,1024
Maav 152,212,164
Ta 204,9,24576
Maav 152,208,160
Ta 206,9,28672
Maav 168,208,192
Maav 168,212,196
s_waitcnt lgkmcnt(8)
Maav 172,220,196
s_mov_b32 m0, 0x27000
s_add_u32 s46, s44, 0x18000
Ta 208,10,16384
Maav 172,216,192
Ta 210,10,20480
La 40,6,56,45,0
Maav 156,216,160
Ta 212,10,24576
DD 32,52,46,0
Maav 156,220,164
Ta 214,10,28672
DD 33,52,46,1024
Maav 140,220,132
DD 34,52,46,2048
Maav 140,216,128
s_waitcnt vmcnt(63) lgkmcnt(8)
DD 35,52,46,3072
Maav 128,192,136
s_waitcnt vmcnt(63)
Ta 216,11,16384
Maav 128,196,140
Ta 218,11,20480
La 44,6,56,45,1024
Maav 144,196,172
Ta 220,11,24576
Maav 144,192,168
s_waitcnt vmcnt(63)
Ta 222,11,28672
Maav 160,192,200
Maav 160,196,204
s_waitcnt lgkmcnt(8)
Maav 164,204,204
Ta 192,16,32768
Maav 164,200,200
Ta 194,16,36864
Maav 148,200,168
Ta 196,16,40960
Maav 148,204,172
Ta 198,16,45056
Maav 132,204,140
Maav 132,200,136
s_waitcnt lgkmcnt(8)
Maav 136,208,136
Ta 200,17,32768
Maav 136,212,140
Ta 202,17,36864
Maav 152,212,172
Ta 204,17,40960
Maav 152,208,168
Ta 206,17,45056
Maav 168,208,200
Maav 168,212,204
s_waitcnt lgkmcnt(8)
Maav 172,220,204
Ta 208,18,32768
Maav 172,216,200
Ta 210,18,36864
Maav 156,216,168
Ta 212,18,40960
Maav 156,220,172
Ta 214,18,45056
Maav 140,220,140
Maav 140,216,136
s_waitcnt vmcnt(63) lgkmcnt(8)
Maaa 128,192,64
s_waitcnt vmcnt(63)
Ta 216,19,32768
Maaa 128,196,68
Ta 218,19,36864
Maaa 144,196,84
Ta 220,19,40960
Maaa 144,192,80
s_waitcnt vmcnt(63)
Ta 222,19,45056
Maaa 160,192,96
Maaa 160,196,100
s_waitcnt lgkmcnt(8)
Maaa 164,204,100
Ta 192,8,32768
Maaa 164,200,96
Ta 194,8,36864
Maaa 148,200,80
Ta 196,8,40960
Maaa 148,204,84
Ta 198,8,45056
Maaa 132,204,68
Maaa 132,200,64
s_waitcnt lgkmcnt(8)
Maaa 136,208,64
Ta 200,9,32768
Maaa 136,212,68
Ta 202,9,36864
Maaa 152,212,84
Ta 204,9,40960
Maaa 152,208,80
Ta 206,9,45056
Maaa 168,208,96
Maaa 168,212,100
s_waitcnt lgkmcnt(8)
Maaa 172,220,100
Ta 208,10,32768
Maaa 172,216,96
Ta 210,10,36864
Maaa 156,216,80
Ta 212,10,40960
Maaa 156,220,84
Ta 214,10,45056
Maaa 140,220,68
Maaa 140,216,64
s_waitcnt vmcnt(63) lgkmcnt(8)
Maaa 128,192,72
s_waitcnt vmcnt(63)
Ta 216,11,32768
Maaa 128,196,76
Ta 218,11,36864
Maaa 144,196,92
Ta 220,11,40960
Maaa 144,192,88
s_waitcnt vmcnt(63)
Ta 222,11,45056
Maaa 160,192,104
Maaa 160,196,108
s_waitcnt vmcnt(1)
s_barrier
s_waitcnt lgkmcnt(8)
Maaa 164,204,108
Ta 192,16,49152
Maaa 164,200,104
Ta 194,16,53248
Maaa 148,200,88
Ta 196,16,57344
Maaa 148,204,92
Ta 198,16,61440
Maaa 132,204,76
Maaa 132,200,72
s_waitcnt lgkmcnt(8)
Maaa 136,208,72
Ta 200,17,49152
Maaa 136,212,76
Ta 202,17,53248
Maaa 152,212,92
Ta 204,17,57344
Maaa 152,208,88
Ta 206,17,61440
Maaa 168,208,104
Maaa 168,212,108
s_waitcnt lgkmcnt(8)
Maaa 172,220,108
Ta 208,18,49152
Maaa 172,216,104
Ta 210,18,53248
Maaa 156,216,88
Ta 212,18,57344
Maaa 156,220,92
Ta 214,18,61440
Maaa 140,220,76
Maaa 140,216,72
s_waitcnt lgkmcnt(8)
Maav 128,192,144
Ta 216,19,49152
Maav 128,196,148
Ta 218,19,53248
Maav 144,196,180
Ta 220,19,57344
Maav 144,192,176
Ta 222,19,61440
Maav 160,192,208
Maav 160,196,212
s_waitcnt lgkmcnt(8)
Maav 164,204,212
Ta 192,8,49152
Maav 164,200,208
Ta 194,8,53248
Maav 148,200,176
Ta 196,8,57344
Maav 148,204,180
Ta 198,8,61440
Maav 132,204,148
Maav 132,200,144
s_waitcnt lgkmcnt(8)
Maav 136,208,144
Ta 200,9,49152
Maav 136,212,148
Ta 202,9,53248
Maav 152,212,180
Ta 204,9,57344
Maav 152,208,176
Ta 206,9,61440
Maav 168,208,208
Maav 168,212,212
s_waitcnt lgkmcnt(8)
Maav 172,220,212
Ta 208,10,49152
Maav 172,216,208
Ta 210,10,53248
Maav 156,216,176
Ta 212,10,57344
Maav 156,220,180
Ta 214,10,61440
Maav 140,220,148
Maav 140,216,144
s_waitcnt lgkmcnt(8)
Maav 128,192,152
Ta 216,11,49152
Maav 128,196,156
Ta 218,11,53248
Maav 144,196,188
Ta 220,11,57344
Maav 144,192,184
Ta 222,11,61440
Maav 160,192,216
Maav 160,196,220
s_waitcnt lgkmcnt(8)
Maav 164,204,220
Ta 192,24,0
Maav 164,200,216
Ta 194,24,4096
Maav 148,200,184
Ta 196,24,8192
Maav 148,204,188
Ta 198,24,12288
Maav 132,204,156
Maav 132,200,152
s_waitcnt lgkmcnt(8)
Maav 136,208,152
Ta 200,25,0
Maav 136,212,156
Ta 202,25,4096
Maav 152,212,188
Ta 204,25,8192
Maav 152,208,184
Ta 206,25,12288
Maav 168,208,216
Maav 168,212,220
s_waitcnt lgkmcnt(8)
Maav 172,220,220
Ta 208,26,0
Maav 172,216,216
Ta 210,26,4096
Maav 156,216,184
Ta 212,26,8192
Maav 156,220,188
Ta 214,26,12288
Maav 140,220,156
Maav 140,216,152
s_waitcnt lgkmcnt(8)
Maaa 128,192,0
Ta 216,27,0
Maaa 128,196,4
Ta 218,27,4096
Maaa 144,196,20
Ta 220,27,8192
Maaa 144,192,16
Ta 222,27,12288
Maaa 160,192,32
Maaa 160,196,36
s_waitcnt lgkmcnt(8)
Maaa 164,204,36
Ta 192,24,16384
Maaa 164,200,32
Ta 194,24,20480
Maaa 148,200,16
Ta 196,24,24576
Maaa 148,204,20
Ta 198,24,28672
Maaa 132,204,4
Maaa 132,200,0
s_waitcnt lgkmcnt(8)
Maaa 136,208,0
Ta 200,25,16384
Maaa 136,212,4
Ta 202,25,20480
Maaa 152,212,20
Ta 204,25,24576
Maaa 152,208,16
Ta 206,25,28672
Maaa 168,208,32
Maaa 168,212,36
s_waitcnt lgkmcnt(8)
Maaa 172,220,36
Ta 208,26,16384
Maaa 172,216,32
Ta 210,26,20480
Maaa 156,216,16
Ta 212,26,24576
Maaa 156,220,20
Ta 214,26,28672
Maaa 140,220,4
Maaa 140,216,0
s_waitcnt lgkmcnt(8)
Maaa 128,192,8
s_add_u32 s37, s51, 4096
Ta 216,27,16384
Maaa 128,196,12
Ta 218,27,20480
Maaa 144,196,28
Ta 220,27,24576
Maaa 144,192,24
Ta 222,27,28672
Maaa 160,192,40
s_waitcnt vmcnt(0)
Maaa 160,196,44
s_waitcnt lgkmcnt(8)
Maaa 164,204,44
Ta 192,20,16384
Maaa 164,200,40
Ta 194,20,20480
Maaa 148,200,24
Ta 196,20,24576
Maaa 148,204,28
Ta 198,20,28672
Maaa 132,204,12
Maaa 132,200,8
s_waitcnt lgkmcnt(8)
Maaa 136,208,8
Ta 200,21,16384
Maaa 136,212,12
Ta 202,21,20480
Maaa 152,212,28
Ta 204,21,24576
Maaa 152,208,24
Ta 206,21,28672
Maaa 168,208,40
Maaa 168,212,44
s_waitcnt lgkmcnt(8)
Maaa 172,220,44
Ta 208,22,16384
Maaa 172,216,40
Ta 210,22,20480
Maaa 156,216,24
Ta 212,22,24576
AR 40,128
AR 41,129
Maaa 156,220,28
Ta 214,22,28672
AR 42,130
AR 43,131
Maaa 140,220,12
AR 44,132
AR 45,133
Maaa 140,216,8
s_waitcnt lgkmcnt(8)
AR 46,134
AR 47,135
Mvav 64,192,128
Ta 216,23,16384
CV 48,40
CV 49,42
Mvav 64,196,132
Ta 218,23,20480
CV 50,44
CV 51,46
Mvav 80,196,164
Ta 220,23,24576
v_min_u32 v48, -2, v48
v_min_u32 v49, -2, v49
Mvav 80,192,160
Ta 222,23,28672
v_min_u32 v50, -2, v50
v_min_u32 v51, -2, v51
Mvav 96,192,192
buffer_store_dwordx4 v[48:51], v1, s[60:63], s51 offen sc1
Mvav 96,196,196
s_waitcnt lgkmcnt(8)
AR 40,144
AR 41,145
Mvav 100,204,196
Ta 192,12,16384
AR 42,146
AR 43,147
Mvav 100,200,192
Ta 194,12,20480
AR 44,148
AR 45,149
Mvav 84,200,160
Ta 196,12,24576
AR 46,150
AR 47,151
Mvav 84,204,164
Ta 198,12,28672
CV 52,40
CV 53,42
Mvav 68,204,132
CV 54,44
CV 55,46
Mvav 68,200,128
s_waitcnt lgkmcnt(8)
v_min_u32 v52, -2, v52
v_min_u32 v53, -2, v53
Mvav 72,208,128
Ta 200,13,16384
v_min_u32 v54, -2, v54
v_min_u32 v55, -2, v55
Mvav 72,212,132
Ta 202,13,20480
buffer_store_dwordx4 v[52:55], v1, s[60:63], s51 offen offset:2048 sc1
Mvav 88,212,164
Ta 204,13,24576
AR 40,160
AR 41,161
Mvav 88,208,160
Ta 206,13,28672
AR 42,162
AR 43,163
Mvav 104,208,192
AR 44,164
AR 45,165
Mvav 104,212,196
s_waitcnt lgkmcnt(8)
AR 46,166
AR 47,167
Mvav 108,220,196
Ta 208,14,16384
CV 48,40
CV 49,42
Mvav 108,216,192
Ta 210,14,20480
CV 50,44
CV 51,46
Mvav 92,216,160
Ta 212,14,24576
v_min_u32 v48, -2, v48
v_min_u32 v49, -2, v49
Mvav 92,220,164
Ta 214,14,28672
v_min_u32 v50, -2, v50
v_min_u32 v51, -2, v51
Mvav 76,220,132
buffer_store_dwordx4 v[48:51], v1, s[60:63], s37 offen sc1
Mvav 76,216,128
s_waitcnt lgkmcnt(8)
AR 40,136
AR 41,137
Mvav 64,192,136
s_add_u32 s36, s75, 4096
Ta 216,15,16384
AR 42,138
AR 43,139
Mvav 64,196,140
Ta 218,15,20480
AR 44,140
AR 45,141
Mvav 80,196,172
Ta 220,15,24576
AR 46,142
AR 47,143
Mvav 80,192,168
Ta 222,15,28672
CV 52,40
CV 53,42
Mvav 96,192,200
CV 54,44
CV 55,46
Mvav 96,196,204
s_waitcnt lgkmcnt(8)
v_min_u32 v52, -2, v52
v_min_u32 v53, -2, v53
Mvav 100,204,204
Ta 192,20,32768
v_min_u32 v54, -2, v54
v_min_u32 v55, -2, v55
Mvav 100,200,200
Ta 194,20,36864
buffer_store_dwordx4 v[52:55], v1, s[60:63], s51 offen offset:1024 sc1
Mvav 84,200,168
Ta 196,20,40960
AR 40,152
AR 41,153
Mvav 84,204,172
Ta 198,20,45056
AR 42,154
AR 43,155
Mvav 68,204,140
AR 44,156
AR 45,157
Mvav 68,200,136
s_waitcnt lgkmcnt(8)
AR 46,158
AR 47,159
Mvav 72,208,136
Ta 200,21,32768
CV 48,40
CV 49,42
Mvav 72,212,140
Ta 202,21,36864
CV 50,44
CV 51,46
Mvav 88,212,172
Ta 204,21,40960
v_min_u32 v48, -2, v48
v_min_u32 v49, -2, v49
Mvav 88,208,168
Ta 206,21,45056
v_min_u32 v50, -2, v50
v_min_u32 v51, -2, v51
Mvav 104,208,200
buffer_store_dwordx4 v[48:51], v1, s[60:63], s51 offen offset:3072 sc1
Mvav 104,212,204
s_waitcnt lgkmcnt(8)
AR 40,168
AR 41,169
Mvav 108,220,204
Ta 208,22,32768
AR 42,170
AR 43,171
Mvav 108,216,200
Ta 210,22,36864
AR 44,172
AR 45,173
Mvav 92,216,168
Ta 212,22,40960
AR 46,174
AR 47,175
Mvav 92,220,172
Ta 214,22,45056
CV 52,40
CV 53,42
Mvav 76,220,140
CV 54,44
CV 55,46
Mvav 76,216,136
s_waitcnt lgkmcnt(8)
v_min_u32 v52, -2, v52
v_min_u32 v53, -2, v53
Mvaa 64,192,64
Ta 216,23,32768
v_min_u32 v54, -2, v54
v_min_u32 v55, -2, v55
Mvaa 64,196,68
Ta 218,23,36864
buffer_store_dwordx4 v[52:55], v1, s[60:63], s37 offen offset:1024 sc1
Mvaa 80,196,84
Ta 220,23,40960
Mvaa 80,192,80
Ta 222,23,45056
Mvaa 96,192,96
Mvaa 96,196,100
s_waitcnt lgkmcnt(8)
Mvaa 100,204,100
Ta 192,12,32768
Mvaa 100,200,96
Ta 194,12,36864
Mvaa 84,200,80
Ta 196,12,40960
Mvaa 84,204,84
Ta 198,12,45056
Mvaa 68,204,68
Mvaa 68,200,64
s_waitcnt lgkmcnt(8)
Mvaa 72,208,64
Ta 200,13,32768
Mvaa 72,212,68
Ta 202,13,36864
Mvaa 88,212,84
Ta 204,13,40960
Mvaa 88,208,80
Ta 206,13,45056
Mvaa 104,208,96
Mvaa 104,212,100
s_waitcnt lgkmcnt(8)
Mvaa 108,220,100
Ta 208,14,32768
Mvaa 108,216,96
Ta 210,14,36864
Mvaa 92,216,80
Ta 212,14,40960
Mvaa 92,220,84
Ta 214,14,45056
Mvaa 76,220,68
Mvaa 76,216,64
s_waitcnt lgkmcnt(8)
Mvaa 64,192,72
Ta 216,15,32768
Mvaa 64,196,76
Ta 218,15,36864
Mvaa 80,196,92
Ta 220,15,40960
Mvaa 80,192,88
Ta 222,15,45056
Mvaa 96,192,104
Mvaa 96,196,108
s_waitcnt lgkmcnt(8)
Mvaa 100,204,108
Ta 192,20,49152
Mvaa 100,200,104
Ta 194,20,53248
Mvaa 84,200,88
Ta 196,20,57344
Mvaa 84,204,92
Ta 198,20,61440
Mvaa 68,204,76
Mvaa 68,200,72
s_waitcnt lgkmcnt(8)
Mvaa 72,208,72
Ta 200,21,49152
Mvaa 72,212,76
Ta 202,21,53248
Mvaa 88,212,92
Ta 204,21,57344
Mvaa 88,208,88
Ta 206,21,61440
Mvaa 104,208,104
Mvaa 104,212,108
s_waitcnt lgkmcnt(8)
Mvaa 108,220,108
Ta 208,22,49152
Mvaa 108,216,104
Ta 210,22,53248
Mvaa 92,216,88
Ta 212,22,57344
Mvaa 92,220,92
Ta 214,22,61440
Mvaa 76,220,76
Mvaa 76,216,72
s_waitcnt lgkmcnt(8)
Mvav 64,192,144
Ta 216,23,49152
Mvav 64,196,148
Ta 218,23,53248
Mvav 80,196,180
Ta 220,23,57344
Mvav 80,192,176
Ta 222,23,61440
Mvav 96,192,208
Mvav 96,196,212
s_waitcnt lgkmcnt(8)
Mvav 100,204,212
Ta 192,12,49152
Mvav 100,200,208
Ta 194,12,53248
Mvav 84,200,176
Ta 196,12,57344
Mvav 84,204,180
Ta 198,12,61440
Mvav 68,204,148
Mvav 68,200,144
s_waitcnt lgkmcnt(8)
Mvav 72,208,144
Ta 200,13,49152
Mvav 72,212,148
Ta 202,13,53248
Mvav 88,212,180
Ta 204,13,57344
Mvav 88,208,176
Ta 206,13,61440
Mvav 104,208,208
Mvav 104,212,212
s_waitcnt lgkmcnt(8)
Mvav 108,220,212
Ta 208,14,49152
Mvav 108,216,208
Ta 210,14,53248
Mvav 92,216,176
Ta 212,14,57344
Mvav 92,220,180
Ta 214,14,61440
Mvav 76,220,148
Mvav 76,216,144
s_waitcnt lgkmcnt(8)
Mvav 64,192,152
Ta 216,15,49152
Mvav 64,196,156
Ta 218,15,53248
Mvav 80,196,188
Ta 220,15,57344
Mvav 80,192,184
Ta 222,15,61440
Mvav 96,192,216
Mvav 96,196,220
s_waitcnt lgkmcnt(8)
Mvav 100,204,220
Ta 192,28,0
Lv 128,1,60,75,0
Mvav 100,200,216
Ta 194,28,4096
Mvav 84,200,184
Ta 196,28,8192
Lv 132,1,60,75,1024
Mvav 84,204,188
Ta 198,28,12288
Mvav 68,204,156
Lv 160,1,60,75,2048
Mvav 68,200,152
s_waitcnt lgkmcnt(8)
Mvav 72,208,152
Ta 200,29,0
Lv 164,1,60,75,3072
Mvav 72,212,156
Ta 202,29,4096
Mvav 88,212,188
Ta 204,29,8192
Lv 192,1,60,36,0
Mvav 88,208,184
Ta 206,29,12288
Mvav 104,208,216
Lv 196,1,60,36,1024
Mvav 104,212,220
s_waitcnt lgkmcnt(8)
Mvav 108,220,220
Ta 208,30,0
Mvav 108,216,216
Ta 210,30,4096
Mvav 92,216,184
Ta 212,30,8192
Mvav 92,220,188
Ta 214,30,12288
Mvav 76,220,156
Mvav 76,216,152
s_waitcnt lgkmcnt(8)
Mvaa 64,192,0
Ta 216,31,0
Mvaa 64,196,4
Ta 218,31,4096
Mvaa 80,196,20
Ta 220,31,8192
Mvaa 80,192,16
Ta 222,31,12288
Mvaa 96,192,32
Mvaa 96,196,36
s_waitcnt lgkmcnt(8)
Mvaa 100,204,36
Ta 192,28,16384
Mvaa 100,200,32
Ta 194,28,20480
Mvaa 84,200,16
Ta 196,28,24576
Mvaa 84,204,20
Ta 198,28,28672
Mvaa 68,204,4
Mvaa 68,200,0
s_waitcnt lgkmcnt(8)
Mvaa 72,208,0
Ta 200,29,16384
Mvaa 72,212,4
Ta 202,29,20480
Mvaa 88,212,20
Ta 204,29,24576
Mvaa 88,208,16
Ta 206,29,28672
Mvaa 104,208,32
Mvaa 104,212,36
s_waitcnt lgkmcnt(8)
Mvaa 108,220,36
Ta 208,30,16384
Mvaa 108,216,32
Ta 210,30,20480
Mvaa 92,216,16
Ta 212,30,24576
Mvaa 92,220,20
Ta 214,30,28672
Mvaa 76,220,4
Mvaa 76,216,0
s_waitcnt lgkmcnt(8)
Mvaa 64,192,8
Ta 216,31,16384
Mvaa 64,196,12
Ta 218,31,20480
Mvaa 80,196,28
Ta 220,31,24576
Mvaa 80,192,24
Ta 222,31,28672
Mvaa 96,192,40
Mvaa 96,196,44
s_waitcnt lgkmcnt(8)
Mvaa 100,204,44
Mvaa 100,200,40
Mvaa 84,200,24
Mvaa 84,204,28
Mvaa 68,204,12
Mvaa 68,200,8
s_waitcnt lgkmcnt(4)
Mvaa 72,208,8
Mvaa 72,212,12
Mvaa 88,212,28
Mvaa 88,208,24
Mvaa 104,208,40
Mvaa 104,212,44
s_waitcnt lgkmcnt(0)
Mvaa 108,220,44
Mvaa 108,216,40
Mvaa 92,216,24
Mvaa 92,220,28
Mvaa 76,220,12
Mvaa 76,216,8
s_waitcnt vmcnt(0)
s_waitcnt vmcnt(1)
s_waitcnt vmcnt(2)
s_waitcnt vmcnt(3)
s_waitcnt vmcnt(4)
s_waitcnt vmcnt(5)
v_max3_u32 v40, v128, v129, v130
v_max3_u32 v40, v40, v131, v132
v_max3_u32 v40, v40, v133, v134
v_max3_u32 v40, v40, v135, v160
v_max3_u32 v40, v40, v161, v162
v_max3_u32 v40, v40, v163, v164
v_max3_u32 v40, v40, v165, v166
v_max3_u32 v40, v40, v167, v192
v_max3_u32 v40, v40, v193, v194
v_max3_u32 v40, v40, v195, v196
v_max3_u32 v40, v40, v197, v198
v_max_u32 v40, v40, v199
v_cmp_eq_u32 vcc, -1, v40
s_nop 1
s_cbranch_vccnz L1b_rspin
L1b_rspin_back:
Mvvv 64,58,128
Mvvv 68,56,128
Mvvv 72,58,132
Mvvv 76,56,132
Mvvv 80,58,160
Mvvv 84,56,160
Mvvv 88,58,164
Mvvv 92,56,164
Mvvv 96,58,192
Mvvv 100,56,192
Mvvv 104,58,196
Mvvv 108,56,196
s_lshl_b32 s38, s28, 18
s_nop 3
CV 40,64
CV 41,66
CV 42,68
CV 43,70
s_nop 0
v_permlane32_swap_b32 v40, v42
v_permlane32_swap_b32 v41, v43
s_nop 0
v_permlane16_swap_b32 v40, v42
v_permlane16_swap_b32 v41, v43
buffer_store_dwordx4 v[40:43], v36, s[64:67], s38 offen sc1
CV 44,72
CV 45,74
CV 46,76
CV 47,78
s_nop 0
v_permlane32_swap_b32 v44, v46
v_permlane32_swap_b32 v45, v47
s_nop 0
v_permlane16_swap_b32 v44, v46
v_permlane16_swap_b32 v45, v47
buffer_store_dwordx4 v[44:47], v36, s[64:67], s38 offen offset:64 sc1
s_add_u32 s38, s38, 0x10000
CV 48,80
CV 49,82
CV 50,84
CV 51,86
s_nop 0
v_permlane32_swap_b32 v48, v50
v_permlane32_swap_b32 v49, v51
s_nop 0
v_permlane16_swap_b32 v48, v50
v_permlane16_swap_b32 v49, v51
buffer_store_dwordx4 v[48:51], v36, s[64:67], s38 offen sc1
CV 52,88
CV 53,90
CV 54,92
CV 55,94
s_nop 0
v_permlane32_swap_b32 v52, v54
v_permlane32_swap_b32 v53, v55
s_nop 0
v_permlane16_swap_b32 v52, v54
v_permlane16_swap_b32 v53, v55
buffer_store_dwordx4 v[52:55], v36, s[64:67], s38 offen offset:64 sc1
s_add_u32 s38, s38, 0x10000
CV 40,96
CV 41,98
CV 42,100
CV 43,102
s_nop 0
v_permlane32_swap_b32 v40, v42
v_permlane32_swap_b32 v41, v43
s_nop 0
v_permlane16_swap_b32 v40, v42
v_permlane16_swap_b32 v41, v43
buffer_store_dwordx4 v[40:43], v36, s[64:67], s38 offen sc1
CV 44,104
CV 45,106
CV 46,108
CV 47,110
s_nop 0
v_permlane32_swap_b32 v44, v46
v_permlane32_swap_b32 v45, v47
s_nop 0
v_permlane16_swap_b32 v44, v46
v_permlane16_swap_b32 v45, v47
buffer_store_dwordx4 v[44:47], v36, s[64:67], s38 offen offset:64 sc1

s_endpgm
L1b_flush0:
v_mov_b32 v40, v112
s_nop 1
v_permlane32_swap_b32 v112, v40
AD 112,40
v_mov_b32 v40, v112
s_nop 1
v_permlane16_swap_b32 v112, v40
AD 112,40
v_subrev_u32 v40, 0x30800000, v112
v_cmp_lt_u32 vcc, 0x1b000000, v40
s_nop 1
s_cbranch_vccnz L1b_flush0_slow
L1b_flush0_rcp:
v_rcp_f32 v112, v112
s_add_u32 s50, s48, 0
v_pk_mul_f32 v[40:41], v[128:129], v[112:113] op_sel_hi:[1,0]
v_pk_mul_f32 v[42:43], v[130:131], v[112:113] op_sel_hi:[1,0]
v_pk_mul_f32 v[44:45], v[132:133], v[112:113] op_sel_hi:[1,0]
v_pk_mul_f32 v[46:47], v[134:135], v[112:113] op_sel_hi:[1,0]
CV 48,40
CV 49,42
CV 50,44
CV 51,46
buffer_store_dwordx4 v[48:51], v1, s[24:27], s50 offen sc1
v_pk_mul_f32 v[40:41], v[136:137], v[112:113] op_sel_hi:[1,0]
v_pk_mul_f32 v[42:43], v[138:139], v[112:113] op_sel_hi:[1,0]
v_pk_mul_f32 v[44:45], v[140:141], v[112:113] op_sel_hi:[1,0]
v_pk_mul_f32 v[46:47], v[142:143], v[112:113] op_sel_hi:[1,0]
CV 52,40
CV 53,42
CV 54,44
CV 55,46
buffer_store_dwordx4 v[52:55], v1, s[24:27], s50 offen offset:1024 sc1
v_pk_mul_f32 v[40:41], v[144:145], v[112:113] op_sel_hi:[1,0]
v_pk_mul_f32 v[42:43], v[146:147], v[112:113] op_sel_hi:[1,0]
v_pk_mul_f32 v[44:45], v[148:149], v[112:113] op_sel_hi:[1,0]
v_pk_mul_f32 v[46:47], v[150:151], v[112:113] op_sel_hi:[1,0]
CV 56,40
CV 57,42
CV 58,44
CV 59,46
buffer_store_dwordx4 v[56:59], v1, s[24:27], s50 offen offset:2048 sc1
v_pk_mul_f32 v[40:41], v[152:153], v[112:113] op_sel_hi:[1,0]
v_pk_mul_f32 v[42:43], v[154:155], v[112:113] op_sel_hi:[1,0]
v_pk_mul_f32 v[44:45], v[156:157], v[112:113] op_sel_hi:[1,0]
v_pk_mul_f32 v[46:47], v[158:159], v[112:113] op_sel_hi:[1,0]
CV 60,40
CV 61,42
CV 62,44
CV 63,46
buffer_store_dwordx4 v[60:63], v1, s[24:27], s50 offen offset:3072 sc1
L1b_flush0_done:
v_mov_b64 v[40:41], 0
v_mov_b64 v[42:43], 0
AM 0,64
AM 1,65
AM 2,66
AM 3,67
AM 4,68
AM 5,69
AM 6,70
AM 7,71
AM 8,72
AM 9,73
AM 10,74
AM 11,75
AM 12,76
AM 13,77
AM 14,78
AM 15,79
v_mfma_f32_32x32x16_bf16 v[128:143], v[40:43], v[40:43], 0
v_mfma_f32_32x32x16_bf16 v[144:159], v[40:43], v[40:43], 0
v_mov_b32 v112, 0
AW 64,48
AW 65,49
AW 66,50
AW 67,51
AW 68,52
AW 69,53
AW 70,54
AW 71,55
AW 72,56
AW 73,57
AW 74,58
AW 75,59
AW 76,60
AW 77,61
AW 78,62
AW 79,63
s_nop 1
s_branch L1b_flush0_back
L1b_flush1:
v_mov_b32 v40, v113
s_nop 1
v_permlane32_swap_b32 v113, v40
AD 113,40
v_mov_b32 v40, v113
s_nop 1
v_permlane16_swap_b32 v113, v40
AD 113,40
v_subrev_u32 v40, 0x30800000, v113
v_cmp_lt_u32 vcc, 0x1b000000, v40
s_nop 1
s_cbranch_vccnz L1b_flush1_slow
L1b_flush1_rcp:
v_rcp_f32 v113, v113
s_add_u32 s50, s48, 131072
v_pk_mul_f32 v[40:41], v[160:161], v[112:113] op_sel:[0,1] op_sel_hi:[1,1]
v_pk_mul_f32 v[42:43], v[162:163], v[112:113] op_sel:[0,1] op_sel_hi:[1,1]
v_pk_mul_f32 v[44:45], v[164:165], v[112:113] op_sel:[0,1] op_sel_hi:[1,1]
v_pk_mul_f32 v[46:47], v[166:167], v[112:113] op_sel:[0,1] op_sel_hi:[1,1]
CV 48,40
CV 49,42
CV 50,44
CV 51,46
buffer_store_dwordx4 v[48:51], v1, s[24:27], s50 offen sc1
v_pk_mul_f32 v[40:41], v[168:169], v[112:113] op_sel:[0,1] op_sel_hi:[1,1]
v_pk_mul_f32 v[42:43], v[170:171], v[112:113] op_sel:[0,1] op_sel_hi:[1,1]
v_pk_mul_f32 v[44:45], v[172:173], v[112:113] op_sel:[0,1] op_sel_hi:[1,1]
v_pk_mul_f32 v[46:47], v[174:175], v[112:113] op_sel:[0,1] op_sel_hi:[1,1]
CV 52,40
CV 53,42
CV 54,44
CV 55,46
buffer_store_dwordx4 v[52:55], v1, s[24:27], s50 offen offset:1024 sc1
v_pk_mul_f32 v[40:41], v[176:177], v[112:113] op_sel:[0,1] op_sel_hi:[1,1]
v_pk_mul_f32 v[42:43], v[178:179], v[112:113] op_sel:[0,1] op_sel_hi:[1,1]
v_pk_mul_f32 v[44:45], v[180:181], v[112:113] op_sel:[0,1] op_sel_hi:[1,1]
v_pk_mul_f32 v[46:47], v[182:183], v[112:113] op_sel:[0,1] op_sel_hi:[1,1]
CV 56,40
CV 57,42
CV 58,44
CV 59,46
buffer_store_dwordx4 v[56:59], v1, s[24:27], s50 offen offset:2048 sc1
v_pk_mul_f32 v[40:41], v[184:185], v[112:113] op_sel:[0,1] op_sel_hi:[1,1]
v_pk_mul_f32 v[42:43], v[186:187], v[112:113] op_sel:[0,1] op_sel_hi:[1,1]
v_pk_mul_f32 v[44:45], v[188:189], v[112:113] op_sel:[0,1] op_sel_hi:[1,1]
v_pk_mul_f32 v[46:47], v[190:191], v[112:113] op_sel:[0,1] op_sel_hi:[1,1]
CV 60,40
CV 61,42
CV 62,44
CV 63,46
buffer_store_dwordx4 v[60:63], v1, s[24:27], s50 offen offset:3072 sc1
L1b_flush1_done:
v_mov_b64 v[40:41], 0
v_mov_b64 v[42:43], 0
AM 16,80
AM 17,81
AM 18,82
AM 19,83
AM 20,84
AM 21,85
AM 22,86
AM 23,87
AM 24,88
AM 25,89
AM 26,90
AM 27,91
AM 28,92
AM 29,93
AM 30,94
AM 31,95
v_mfma_f32_32x32x16_bf16 v[160:175], v[40:43], v[40:43], 0
v_mfma_f32_32x32x16_bf16 v[176:191], v[40:43], v[40:43], 0
v_mov_b32 v113, 0
AW 80,48
AW 81,49
AW 82,50
AW 83,51
AW 84,52
AW 85,53
AW 86,54
AW 87,55
AW 88,56
AW 89,57
AW 90,58
AW 91,59
AW 92,60
AW 93,61
AW 94,62
AW 95,63
s_nop 1
s_branch L1b_flush1_back
L1b_flush2:
v_mov_b32 v40, v114
s_nop 1
v_permlane32_swap_b32 v114, v40
AD 114,40
v_mov_b32 v40, v114
s_nop 1
v_permlane16_swap_b32 v114, v40
AD 114,40
v_subrev_u32 v40, 0x30800000, v114
v_cmp_lt_u32 vcc, 0x1b000000, v40
s_nop 1
s_cbranch_vccnz L1b_flush2_slow
L1b_flush2_rcp:
v_rcp_f32 v114, v114
s_add_u32 s50, s48, 262144
v_pk_mul_f32 v[40:41], v[192:193], v[114:115] op_sel_hi:[1,0]
v_pk_mul_f32 v[42:43], v[194:195], v[114:115] op_sel_hi:[1,0]
v_pk_mul_f32 v[44:45], v[196:197], v[114:115] op_sel_hi:[1,0]
v_pk_mul_f32 v[46:47], v[198:199], v[114:115] op_sel_hi:[1,0]
CV 48,40
CV 49,42
CV 50,44
CV 51,46
buffer_store_dwordx4 v[48:51], v1, s[24:27], s50 offen sc1
v_pk_mul_f32 v[40:41], v[200:201], v[114:115] op_sel_hi:[1,0]
v_pk_mul_f32 v[42:43], v[202:203], v[114:115] op_sel_hi:[1,0]
v_pk_mul_f32 v[44:45], v[204:205], v[114:115] op_sel_hi:[1,0]
v_pk_mul_f32 v[46:47], v[206:207], v[114:115] op_sel_hi:[1,0]
CV 52,40
CV 53,42
CV 54,44
CV 55,46
buffer_store_dwordx4 v[52:55], v1, s[24:27], s50 offen offset:1024 sc1
v_pk_mul_f32 v[40:41], v[208:209], v[114:115] op_sel_hi:[1,0]
v_pk_mul_f32 v[42:43], v[210:211], v[114:115] op_sel_hi:[1,0]
v_pk_mul_f32 v[44:45], v[212:213], v[114:115] op_sel_hi:[1,0]
v_pk_mul_f32 v[46:47], v[214:215], v[114:115] op_sel_hi:[1,0]
CV 56,40
CV 57,42
CV 58,44
CV 59,46
buffer_store_dwordx4 v[56:59], v1, s[24:27], s50 offen offset:2048 sc1
v_pk_mul_f32 v[40:41], v[216:217], v[114:115] op_sel_hi:[1,0]
v_pk_mul_f32 v[42:43], v[218:219], v[114:115] op_sel_hi:[1,0]
v_pk_mul_f32 v[44:45], v[220:221], v[114:115] op_sel_hi:[1,0]
v_pk_mul_f32 v[46:47], v[222:223], v[114:115] op_sel_hi:[1,0]
CV 60,40
CV 61,42
CV 62,44
CV 63,46
buffer_store_dwordx4 v[60:63], v1, s[24:27], s50 offen offset:3072 sc1
L1b_flush2_done:
v_mov_b64 v[40:41], 0
v_mov_b64 v[42:43], 0
AM 32,96
AM 33,97
AM 34,98
AM 35,99
AM 36,100
AM 37,101
AM 38,102
AM 39,103
AM 40,104
AM 41,105
AM 42,106
AM 43,107
AM 44,108
AM 45,109
AM 46,110
AM 47,111
v_mfma_f32_32x32x16_bf16 v[192:207], v[40:43], v[40:43], 0
v_mfma_f32_32x32x16_bf16 v[208:223], v[40:43], v[40:43], 0
v_mov_b32 v114, 0
AW 96,48
AW 97,49
AW 98,50
AW 99,51
AW 100,52
AW 101,53
AW 102,54
AW 103,55
AW 104,56
AW 105,57
AW 106,58
AW 107,59
AW 108,60
AW 109,61
AW 110,62
AW 111,63
s_nop 1
s_branch L1b_flush2_back
L1b_rspin:
s_mov_b32 s34, 400000
L1b_rspin_loop:
Lv 128,1,60,75,0
Lv 132,1,60,75,1024
Lv 160,1,60,75,2048
Lv 164,1,60,75,3072
Lv 192,1,60,36,0
Lv 196,1,60,36,1024
s_waitcnt vmcnt(0)
v_max3_u32 v40, v128, v129, v130
v_max3_u32 v40, v40, v131, v132
v_max3_u32 v40, v40, v133, v134
v_max3_u32 v40, v40, v135, v160
v_max3_u32 v40, v40, v161, v162
v_max3_u32 v40, v40, v163, v164
v_max3_u32 v40, v40, v165, v166
v_max3_u32 v40, v40, v167, v192
v_max3_u32 v40, v40, v193, v194
v_max3_u32 v40, v40, v195, v196
v_max3_u32 v40, v40, v197, v198
v_max_u32 v40, v40, v199
v_cmp_eq_u32 vcc, -1, v40
s_nop 1
s_cbranch_vccz L1b_rspin_back
s_sub_u32 s34, s34, 1
s_cmp_lg_u32 s34, 0
s_cbranch_scc1 L1b_rspin_loop
s_branch L1b_rspin_back
L1_sig0:
s_mov_b64 exec, 1
v_mov_b32 v2, 0x1
buffer_atomic_add v2, off, s[68:71], s73 sc1
s_mov_b64 exec, -1
s_branch L1_sig0_back
L1_spin0:
s_mov_b32 s34, 400000
L1_spin0_loop:
buffer_load_dwordx2 v[2:3], off, s[68:71], s74 sc1
s_waitcnt vmcnt(0)
v_readfirstlane_b32 s35, v2
v_readfirstlane_b32 s36, v3
s_nop 1
s_and_b32 s35, s35, s36
s_bitcmp1_b32 s35, 3
s_cbranch_scc1 L1_spin0_back
s_sub_u32 s34, s34, 1
s_cmp_lg_u32 s34, 0
s_cbranch_scc1 L1_spin0_loop
s_branch L1_spin0_back
L1_spin1:
s_mov_b32 s34, 400000
L1_spin1_loop:
buffer_load_dword v2, off, s[68:71], s73 sc1
s_waitcnt vmcnt(0)
v_readfirstlane_b32 s35, v2
s_nop 1
s_bitcmp1_b32 s35, 11
s_cbranch_scc1 L1_spin1_back
s_sub_u32 s34, s34, 1
s_cmp_lg_u32 s34, 0
s_cbranch_scc1 L1_spin1_loop
s_branch L1_spin1_back
L1_codeend:
L1a_flush0_slow:
s_nop 7
v_lshrrev_b32 v42, 4, v1
v_and_b32 v43, 15, v42
v_lshrrev_b32 v42, 4, v42
v_lshlrev_b32 v40, 4, v42
v_lshl_add_u32 v40, v43, 8, v40
v_lshlrev_b32 v41, 1, v43
v_lshl_add_u32 v41, v42, 10, v41
v_mov_b32 v42, 0xff800000
s_mov_b32 s3, 0x0
s_mov_b32 s5, 0x40000
L1a_flush0_s1:
Pv 128,40,16,3,0
Pv 132,40,16,3,64
Pv 136,40,16,3,128
Pv 140,40,16,3,192
s_waitcnt vmcnt(0)
Zvva 44,128,0
Mvva 44,132,4
Mvva 44,136,8
Mvva 44,140,12
s_nop 7
s_nop 1
v_max3_f32 v42, v42, v44, v45
v_max3_f32 v42, v42, v46, v47
s_add_u32 s3, s3, 4096
s_cmp_lg_u32 s3, s5
s_cbranch_scc1 L1a_flush0_s1
v_mov_b32 v43, v42
s_nop 1
v_permlane32_swap_b32 v42, v43
s_nop 1
v_max_f32 v42, v42, v43
v_mov_b32 v43, v42
s_nop 1
v_permlane16_swap_b32 v42, v43
s_nop 1
v_max_f32 v42, v42, v43
v_mov_b64 v[128:129], 0
v_mov_b64 v[130:131], 0
v_mov_b64 v[132:133], 0
v_mov_b64 v[134:135], 0
v_mov_b64 v[136:137], 0
v_mov_b64 v[138:139], 0
v_mov_b64 v[140:141], 0
v_mov_b64 v[142:143], 0
v_mov_b64 v[144:145], 0
v_mov_b64 v[146:147], 0
v_mov_b64 v[148:149], 0
v_mov_b64 v[150:151], 0
v_mov_b64 v[152:153], 0
v_mov_b64 v[154:155], 0
v_mov_b64 v[156:157], 0
v_mov_b64 v[158:159], 0
v_mov_b32 v112, 0
s_mov_b32 s3, 0x0
L1a_flush0_s2:
s_add_u32 s4, s3, 4096
Pv 56,40,16,3,0
Pv 60,40,16,3,64
s_waitcnt vmcnt(0)
Zvva 44,56,0
Mvva 44,60,4
s_nop 3
Pv 56,40,16,3,128
Pv 60,40,16,3,192
s_waitcnt vmcnt(0)
Mvva 44,56,8
Mvva 44,60,12
s_nop 3
Pv 56,40,16,4,0
Pv 60,40,16,4,64
s_waitcnt vmcnt(0)
Zvva 48,56,0
Mvva 48,60,4
s_nop 3
Pv 56,40,16,4,128
Pv 60,40,16,4,192
s_waitcnt vmcnt(0)
Mvva 48,56,8
Mvva 48,60,12
s_nop 3
s_nop 7
s_nop 1
v_sub_f32 v44, v44, v42
v_sub_f32 v45, v45, v42
v_sub_f32 v46, v46, v42
v_sub_f32 v47, v47, v42
v_sub_f32 v48, v48, v42
v_sub_f32 v49, v49, v42
v_sub_f32 v50, v50, v42
v_sub_f32 v51, v51, v42
EX 44
EX 45
EX 46
EX 47
EX 48
EX 49
EX 50
EX 51
s_nop 1
AD 112,44
AD 112,45
AD 112,46
AD 112,47
AD 112,48
AD 112,49
AD 112,50
AD 112,51
CV 52,44
CV 53,46
CV 54,48
CV 55,50
buffer_load_ushort v44, v41, s[20:23], s3 offen offset:0
buffer_load_ushort v45, v41, s[20:23], s3 offen offset:256
buffer_load_ushort v46, v41, s[20:23], s3 offen offset:512
buffer_load_ushort v47, v41, s[20:23], s3 offen offset:768
buffer_load_ushort v48, v41, s[20:23], s4 offen offset:0
buffer_load_ushort v49, v41, s[20:23], s4 offen offset:256
buffer_load_ushort v50, v41, s[20:23], s4 offen offset:512
buffer_load_ushort v51, v41, s[20:23], s4 offen offset:768
s_waitcnt vmcnt(0)
v_lshl_or_b32 v56, v45, 16, v44
v_lshl_or_b32 v57, v47, 16, v46
v_lshl_or_b32 v58, v49, 16, v48
v_lshl_or_b32 v59, v51, 16, v50
s_nop 1
Mvvv 128,56,52
s_nop 3
buffer_load_ushort v44, v41, s[20:23], s3 offen offset:32
buffer_load_ushort v45, v41, s[20:23], s3 offen offset:288
buffer_load_ushort v46, v41, s[20:23], s3 offen offset:544
buffer_load_ushort v47, v41, s[20:23], s3 offen offset:800
buffer_load_ushort v48, v41, s[20:23], s4 offen offset:32
buffer_load_ushort v49, v41, s[20:23], s4 offen offset:288
buffer_load_ushort v50, v41, s[20:23], s4 offen offset:544
buffer_load_ushort v51, v41, s[20:23], s4 offen offset:800
s_waitcnt vmcnt(0)
v_lshl_or_b32 v56, v45, 16, v44
v_lshl_or_b32 v57, v47, 16, v46
v_lshl_or_b32 v58, v49, 16, v48
v_lshl_or_b32 v59, v51, 16, v50
s_nop 1
Mvvv 132,56,52
s_nop 3
buffer_load_ushort v44, v41, s[20:23], s3 offen offset:64
buffer_load_ushort v45, v41, s[20:23], s3 offen offset:320
buffer_load_ushort v46, v41, s[20:23], s3 offen offset:576
buffer_load_ushort v47, v41, s[20:23], s3 offen offset:832
buffer_load_ushort v48, v41, s[20:23], s4 offen offset:64
buffer_load_ushort v49, v41, s[20:23], s4 offen offset:320
buffer_load_ushort v50, v41, s[20:23], s4 offen offset:576
buffer_load_ushort v51, v41, s[20:23], s4 offen offset:832
s_waitcnt vmcnt(0)
v_lshl_or_b32 v56, v45, 16, v44
v_lshl_or_b32 v57, v47, 16, v46
v_lshl_or_b32 v58, v49, 16, v48
v_lshl_or_b32 v59, v51, 16, v50
s_nop 1
Mvvv 136,56,52
s_nop 3
buffer_load_ushort v44, v41, s[20:23], s3 offen offset:96
buffer_load_ushort v45, v41, s[20:23], s3 offen offset:352
buffer_load_ushort v46, v41, s[20:23], s3 offen offset:608
buffer_load_ushort v47, v41, s[20:23], s3 offen offset:864
buffer_load_ushort v48, v41, s[20:23], s4 offen offset:96
buffer_load_ushort v49, v41, s[20:23], s4 offen offset:352
buffer_load_ushort v50, v41, s[20:23], s4 offen offset:608
buffer_load_ushort v51, v41, s[20:23], s4 offen offset:864
s_waitcnt vmcnt(0)
v_lshl_or_b32 v56, v45, 16, v44
v_lshl_or_b32 v57, v47, 16, v46
v_lshl_or_b32 v58, v49, 16, v48
v_lshl_or_b32 v59, v51, 16, v50
s_nop 1
Mvvv 140,56,52
s_nop 3
buffer_load_ushort v44, v41, s[20:23], s3 offen offset:128
buffer_load_ushort v45, v41, s[20:23], s3 offen offset:384
buffer_load_ushort v46, v41, s[20:23], s3 offen offset:640
buffer_load_ushort v47, v41, s[20:23], s3 offen offset:896
buffer_load_ushort v48, v41, s[20:23], s4 offen offset:128
buffer_load_ushort v49, v41, s[20:23], s4 offen offset:384
buffer_load_ushort v50, v41, s[20:23], s4 offen offset:640
buffer_load_ushort v51, v41, s[20:23], s4 offen offset:896
s_waitcnt vmcnt(0)
v_lshl_or_b32 v56, v45, 16, v44
v_lshl_or_b32 v57, v47, 16, v46
v_lshl_or_b32 v58, v49, 16, v48
v_lshl_or_b32 v59, v51, 16, v50
s_nop 1
Mvvv 144,56,52
s_nop 3
buffer_load_ushort v44, v41, s[20:23], s3 offen offset:160
buffer_load_ushort v45, v41, s[20:23], s3 offen offset:416
buffer_load_ushort v46, v41, s[20:23], s3 offen offset:672
buffer_load_ushort v47, v41, s[20:23], s3 offen offset:928
buffer_load_ushort v48, v41, s[20:23], s4 offen offset:160
buffer_load_ushort v49, v41, s[20:23], s4 offen offset:416
buffer_load_ushort v50, v41, s[20:23], s4 offen offset:672
buffer_load_ushort v51, v41, s[20:23], s4 offen offset:928
s_waitcnt vmcnt(0)
v_lshl_or_b32 v56, v45, 16, v44
v_lshl_or_b32 v57, v47, 16, v46
v_lshl_or_b32 v58, v49, 16, v48
v_lshl_or_b32 v59, v51, 16, v50
s_nop 1
Mvvv 148,56,52
s_nop 3
buffer_load_ushort v44, v41, s[20:23], s3 offen offset:192
buffer_load_ushort v45, v41, s[20:23], s3 offen offset:448
buffer_load_ushort v46, v41, s[20:23], s3 offen offset:704
buffer_load_ushort v47, v41, s[20:23], s3 offen offset:960
buffer_load_ushort v48, v41, s[20:23], s4 offen offset:192
buffer_load_ushort v49, v41, s[20:23], s4 offen offset:448
buffer_load_ushort v50, v41, s[20:23], s4 offen offset:704
buffer_load_ushort v51, v41, s[20:23], s4 offen offset:960
s_waitcnt vmcnt(0)
v_lshl_or_b32 v56, v45, 16, v44
v_lshl_or_b32 v57, v47, 16, v46
v_lshl_or_b32 v58, v49, 16, v48
v_lshl_or_b32 v59, v51, 16, v50
s_nop 1
Mvvv 152,56,52
s_nop 3
buffer_load_ushort v44, v41, s[20:23], s3 offen offset:224
buffer_load_ushort v45, v41, s[20:23], s3 offen offset:480
buffer_load_ushort v46, v41, s[20:23], s3 offen offset:736
buffer_load_ushort v47, v41, s[20:23], s3 offen offset:992
buffer_load_ushort v48, v41, s[20:23], s4 offen offset:224
buffer_load_ushort v49, v41, s[20:23], s4 offen offset:480
buffer_load_ushort v50, v41, s[20:23], s4 offen offset:736
buffer_load_ushort v51, v41, s[20:23], s4 offen offset:992
s_waitcnt vmcnt(0)
v_lshl_or_b32 v56, v45, 16, v44
v_lshl_or_b32 v57, v47, 16, v46
v_lshl_or_b32 v58, v49, 16, v48
v_lshl_or_b32 v59, v51, 16, v50
s_nop 1
Mvvv 156,56,52
s_nop 3
s_add_u32 s3, s3, 8192
s_cmp_lg_u32 s3, s5
s_cbranch_scc1 L1a_flush0_s2
s_nop 7
s_nop 7
v_mov_b32 v43, v112
s_nop 1
v_permlane32_swap_b32 v112, v43
s_nop 1
v_add_f32 v112, v112, v43
v_mov_b32 v43, v112
s_nop 1
v_permlane16_swap_b32 v112, v43
s_nop 1
v_add_f32 v112, v112, v43
s_nop 1
s_branch L1a_flush0_rcp
L1a_ffin0_slow:
s_nop 7
v_lshrrev_b32 v42, 4, v1
v_and_b32 v43, 15, v42
v_lshrrev_b32 v42, 4, v42
v_lshlrev_b32 v40, 4, v42
v_lshl_add_u32 v40, v43, 8, v40
v_lshlrev_b32 v41, 1, v43
v_lshl_add_u32 v41, v42, 10, v41
v_mov_b32 v42, 0xff800000
s_mov_b32 s3, 0x40000
s_mov_b32 s5, 0x80000
L1a_ffin0_s1:
Pv 128,40,16,3,0
Pv 132,40,16,3,64
Pv 136,40,16,3,128
Pv 140,40,16,3,192
s_waitcnt vmcnt(0)
Zvva 44,128,0
Mvva 44,132,4
Mvva 44,136,8
Mvva 44,140,12
s_nop 7
s_nop 1
v_max3_f32 v42, v42, v44, v45
v_max3_f32 v42, v42, v46, v47
s_add_u32 s3, s3, 4096
s_cmp_lg_u32 s3, s5
s_cbranch_scc1 L1a_ffin0_s1
v_mov_b32 v43, v42
s_nop 1
v_permlane32_swap_b32 v42, v43
s_nop 1
v_max_f32 v42, v42, v43
v_mov_b32 v43, v42
s_nop 1
v_permlane16_swap_b32 v42, v43
s_nop 1
v_max_f32 v42, v42, v43
v_mov_b64 v[128:129], 0
v_mov_b64 v[130:131], 0
v_mov_b64 v[132:133], 0
v_mov_b64 v[134:135], 0
v_mov_b64 v[136:137], 0
v_mov_b64 v[138:139], 0
v_mov_b64 v[140:141], 0
v_mov_b64 v[142:143], 0
v_mov_b64 v[144:145], 0
v_mov_b64 v[146:147], 0
v_mov_b64 v[148:149], 0
v_mov_b64 v[150:151], 0
v_mov_b64 v[152:153], 0
v_mov_b64 v[154:155], 0
v_mov_b64 v[156:157], 0
v_mov_b64 v[158:159], 0
v_mov_b32 v112, 0
s_mov_b32 s3, 0x40000
L1a_ffin0_s2:
s_add_u32 s4, s3, 4096
Pv 56,40,16,3,0
Pv 60,40,16,3,64
s_waitcnt vmcnt(0)
Zvva 44,56,0
Mvva 44,60,4
s_nop 3
Pv 56,40,16,3,128
Pv 60,40,16,3,192
s_waitcnt vmcnt(0)
Mvva 44,56,8
Mvva 44,60,12
s_nop 3
Pv 56,40,16,4,0
Pv 60,40,16,4,64
s_waitcnt vmcnt(0)
Zvva 48,56,0
Mvva 48,60,4
s_nop 3
Pv 56,40,16,4,128
Pv 60,40,16,4,192
s_waitcnt vmcnt(0)
Mvva 48,56,8
Mvva 48,60,12
s_nop 3
s_nop 7
s_nop 1
v_sub_f32 v44, v44, v42
v_sub_f32 v45, v45, v42
v_sub_f32 v46, v46, v42
v_sub_f32 v47, v47, v42
v_sub_f32 v48, v48, v42
v_sub_f32 v49, v49, v42
v_sub_f32 v50, v50, v42
v_sub_f32 v51, v51, v42
EX 44
EX 45
EX 46
EX 47
EX 48
EX 49
EX 50
EX 51
s_nop 1
AD 112,44
AD 112,45
AD 112,46
AD 112,47
AD 112,48
AD 112,49
AD 112,50
AD 112,51
CV 52,44
CV 53,46
CV 54,48
CV 55,50
buffer_load_ushort v44, v41, s[20:23], s3 offen offset:0
buffer_load_ushort v45, v41, s[20:23], s3 offen offset:256
buffer_load_ushort v46, v41, s[20:23], s3 offen offset:512
buffer_load_ushort v47, v41, s[20:23], s3 offen offset:768
buffer_load_ushort v48, v41, s[20:23], s4 offen offset:0
buffer_load_ushort v49, v41, s[20:23], s4 offen offset:256
buffer_load_ushort v50, v41, s[20:23], s4 offen offset:512
buffer_load_ushort v51, v41, s[20:23], s4 offen offset:768
s_waitcnt vmcnt(0)
v_lshl_or_b32 v56, v45, 16, v44
v_lshl_or_b32 v57, v47, 16, v46
v_lshl_or_b32 v58, v49, 16, v48
v_lshl_or_b32 v59, v51, 16, v50
s_nop 1
Mvvv 128,56,52
s_nop 3
buffer_load_ushort v44, v41, s[20:23], s3 offen offset:32
buffer_load_ushort v45, v41, s[20:23], s3 offen offset:288
buffer_load_ushort v46, v41, s[20:23], s3 offen offset:544
buffer_load_ushort v47, v41, s[20:23], s3 offen offset:800
buffer_load_ushort v48, v41, s[20:23], s4 offen offset:32
buffer_load_ushort v49, v41, s[20:23], s4 offen offset:288
buffer_load_ushort v50, v41, s[20:23], s4 offen offset:544
buffer_load_ushort v51, v41, s[20:23], s4 offen offset:800
s_waitcnt vmcnt(0)
v_lshl_or_b32 v56, v45, 16, v44
v_lshl_or_b32 v57, v47, 16, v46
v_lshl_or_b32 v58, v49, 16, v48
v_lshl_or_b32 v59, v51, 16, v50
s_nop 1
Mvvv 132,56,52
s_nop 3
buffer_load_ushort v44, v41, s[20:23], s3 offen offset:64
buffer_load_ushort v45, v41, s[20:23], s3 offen offset:320
buffer_load_ushort v46, v41, s[20:23], s3 offen offset:576
buffer_load_ushort v47, v41, s[20:23], s3 offen offset:832
buffer_load_ushort v48, v41, s[20:23], s4 offen offset:64
buffer_load_ushort v49, v41, s[20:23], s4 offen offset:320
buffer_load_ushort v50, v41, s[20:23], s4 offen offset:576
buffer_load_ushort v51, v41, s[20:23], s4 offen offset:832
s_waitcnt vmcnt(0)
v_lshl_or_b32 v56, v45, 16, v44
v_lshl_or_b32 v57, v47, 16, v46
v_lshl_or_b32 v58, v49, 16, v48
v_lshl_or_b32 v59, v51, 16, v50
s_nop 1
Mvvv 136,56,52
s_nop 3
buffer_load_ushort v44, v41, s[20:23], s3 offen offset:96
buffer_load_ushort v45, v41, s[20:23], s3 offen offset:352
buffer_load_ushort v46, v41, s[20:23], s3 offen offset:608
buffer_load_ushort v47, v41, s[20:23], s3 offen offset:864
buffer_load_ushort v48, v41, s[20:23], s4 offen offset:96
buffer_load_ushort v49, v41, s[20:23], s4 offen offset:352
buffer_load_ushort v50, v41, s[20:23], s4 offen offset:608
buffer_load_ushort v51, v41, s[20:23], s4 offen offset:864
s_waitcnt vmcnt(0)
v_lshl_or_b32 v56, v45, 16, v44
v_lshl_or_b32 v57, v47, 16, v46
v_lshl_or_b32 v58, v49, 16, v48
v_lshl_or_b32 v59, v51, 16, v50
s_nop 1
Mvvv 140,56,52
s_nop 3
buffer_load_ushort v44, v41, s[20:23], s3 offen offset:128
buffer_load_ushort v45, v41, s[20:23], s3 offen offset:384
buffer_load_ushort v46, v41, s[20:23], s3 offen offset:640
buffer_load_ushort v47, v41, s[20:23], s3 offen offset:896
buffer_load_ushort v48, v41, s[20:23], s4 offen offset:128
buffer_load_ushort v49, v41, s[20:23], s4 offen offset:384
buffer_load_ushort v50, v41, s[20:23], s4 offen offset:640
buffer_load_ushort v51, v41, s[20:23], s4 offen offset:896
s_waitcnt vmcnt(0)
v_lshl_or_b32 v56, v45, 16, v44
v_lshl_or_b32 v57, v47, 16, v46
v_lshl_or_b32 v58, v49, 16, v48
v_lshl_or_b32 v59, v51, 16, v50
s_nop 1
Mvvv 144,56,52
s_nop 3
buffer_load_ushort v44, v41, s[20:23], s3 offen offset:160
buffer_load_ushort v45, v41, s[20:23], s3 offen offset:416
buffer_load_ushort v46, v41, s[20:23], s3 offen offset:672
buffer_load_ushort v47, v41, s[20:23], s3 offen offset:928
buffer_load_ushort v48, v41, s[20:23], s4 offen offset:160
buffer_load_ushort v49, v41, s[20:23], s4 offen offset:416
buffer_load_ushort v50, v41, s[20:23], s4 offen offset:672
buffer_load_ushort v51, v41, s[20:23], s4 offen offset:928
s_waitcnt vmcnt(0)
v_lshl_or_b32 v56, v45, 16, v44
v_lshl_or_b32 v57, v47, 16, v46
v_lshl_or_b32 v58, v49, 16, v48
v_lshl_or_b32 v59, v51, 16, v50
s_nop 1
Mvvv 148,56,52
s_nop 3
buffer_load_ushort v44, v41, s[20:23], s3 offen offset:192
buffer_load_ushort v45, v41, s[20:23], s3 offen offset:448
buffer_load_ushort v46, v41, s[20:23], s3 offen offset:704
buffer_load_ushort v47, v41, s[20:23], s3 offen offset:960
buffer_load_ushort v48, v41, s[20:23], s4 offen offset:192
buffer_load_ushort v49, v41, s[20:23], s4 offen offset:448
buffer_load_ushort v50, v41, s[20:23], s4 offen offset:704
buffer_load_ushort v51, v41, s[20:23], s4 offen offset:960
s_waitcnt vmcnt(0)
v_lshl_or_b32 v56, v45, 16, v44
v_lshl_or_b32 v57, v47, 16, v46
v_lshl_or_b32 v58, v49, 16, v48
v_lshl_or_b32 v59, v51, 16, v50
s_nop 1
Mvvv 152,56,52
s_nop 3
buffer_load_ushort v44, v41, s[20:23], s3 offen offset:224
buffer_load_ushort v45, v41, s[20:23], s3 offen offset:480
buffer_load_ushort v46, v41, s[20:23], s3 offen offset:736
buffer_load_ushort v47, v41, s[20:23], s3 offen offset:992
buffer_load_ushort v48, v41, s[20:23], s4 offen offset:224
buffer_load_ushort v49, v41, s[20:23], s4 offen offset:480
buffer_load_ushort v50, v41, s[20:23], s4 offen offset:736
buffer_load_ushort v51, v41, s[20:23], s4 offen offset:992
s_waitcnt vmcnt(0)
v_lshl_or_b32 v56, v45, 16, v44
v_lshl_or_b32 v57, v47, 16, v46
v_lshl_or_b32 v58, v49, 16, v48
v_lshl_or_b32 v59, v51, 16, v50
s_nop 1
Mvvv 156,56,52
s_nop 3
s_add_u32 s3, s3, 8192
s_cmp_lg_u32 s3, s5
s_cbranch_scc1 L1a_ffin0_s2
s_nop 7
s_nop 7
v_mov_b32 v43, v112
s_nop 1
v_permlane32_swap_b32 v112, v43
s_nop 1
v_add_f32 v112, v112, v43
v_mov_b32 v43, v112
s_nop 1
v_permlane16_swap_b32 v112, v43
s_nop 1
v_add_f32 v112, v112, v43
s_nop 1
s_branch L1a_ffin0_rcp
L1a_flush1_slow:
s_nop 7
v_lshrrev_b32 v42, 4, v1
v_and_b32 v43, 15, v42
v_lshrrev_b32 v42, 4, v42
v_lshlrev_b32 v40, 4, v42
v_lshl_add_u32 v40, v43, 8, v40
v_lshlrev_b32 v41, 1, v43
v_lshl_add_u32 v41, v42, 10, v41
v_mov_b32 v42, 0xff800000
s_mov_b32 s3, 0x0
s_mov_b32 s5, 0x40000
L1a_flush1_s1:
Pv 160,40,16,3,0
Pv 164,40,16,3,64
Pv 168,40,16,3,128
Pv 172,40,16,3,192
s_waitcnt vmcnt(0)
Zvva 44,160,16
Mvva 44,164,20
Mvva 44,168,24
Mvva 44,172,28
s_nop 7
s_nop 1
v_max3_f32 v42, v42, v44, v45
v_max3_f32 v42, v42, v46, v47
s_add_u32 s3, s3, 4096
s_cmp_lg_u32 s3, s5
s_cbranch_scc1 L1a_flush1_s1
v_mov_b32 v43, v42
s_nop 1
v_permlane32_swap_b32 v42, v43
s_nop 1
v_max_f32 v42, v42, v43
v_mov_b32 v43, v42
s_nop 1
v_permlane16_swap_b32 v42, v43
s_nop 1
v_max_f32 v42, v42, v43
v_mov_b64 v[160:161], 0
v_mov_b64 v[162:163], 0
v_mov_b64 v[164:165], 0
v_mov_b64 v[166:167], 0
v_mov_b64 v[168:169], 0
v_mov_b64 v[170:171], 0
v_mov_b64 v[172:173], 0
v_mov_b64 v[174:175], 0
v_mov_b64 v[176:177], 0
v_mov_b64 v[178:179], 0
v_mov_b64 v[180:181], 0
v_mov_b64 v[182:183], 0
v_mov_b64 v[184:185], 0
v_mov_b64 v[186:187], 0
v_mov_b64 v[188:189], 0
v_mov_b64 v[190:191], 0
v_mov_b32 v113, 0
s_mov_b32 s3, 0x0
L1a_flush1_s2:
s_add_u32 s4, s3, 4096
Pv 56,40,16,3,0
Pv 60,40,16,3,64
s_waitcnt vmcnt(0)
Zvva 44,56,16
Mvva 44,60,20
s_nop 3
Pv 56,40,16,3,128
Pv 60,40,16,3,192
s_waitcnt vmcnt(0)
Mvva 44,56,24
Mvva 44,60,28
s_nop 3
Pv 56,40,16,4,0
Pv 60,40,16,4,64
s_waitcnt vmcnt(0)
Zvva 48,56,16
Mvva 48,60,20
s_nop 3
Pv 56,40,16,4,128
Pv 60,40,16,4,192
s_waitcnt vmcnt(0)
Mvva 48,56,24
Mvva 48,60,28
s_nop 3
s_nop 7
s_nop 1
v_sub_f32 v44, v44, v42
v_sub_f32 v45, v45, v42
v_sub_f32 v46, v46, v42
v_sub_f32 v47, v47, v42
v_sub_f32 v48, v48, v42
v_sub_f32 v49, v49, v42
v_sub_f32 v50, v50, v42
v_sub_f32 v51, v51, v42
EX 44
EX 45
EX 46
EX 47
EX 48
EX 49
EX 50
EX 51
s_nop 1
AD 113,44
AD 113,45
AD 113,46
AD 113,47
AD 113,48
AD 113,49
AD 113,50
AD 113,51
CV 52,44
CV 53,46
CV 54,48
CV 55,50
buffer_load_ushort v44, v41, s[20:23], s3 offen offset:0
buffer_load_ushort v45, v41, s[20:23], s3 offen offset:256
buffer_load_ushort v46, v41, s[20:23], s3 offen offset:512
buffer_load_ushort v47, v41, s[20:23], s3 offen offset:768
buffer_load_ushort v48, v41, s[20:23], s4 offen offset:0
buffer_load_ushort v49, v41, s[20:23], s4 offen offset:256
buffer_load_ushort v50, v41, s[20:23], s4 offen offset:512
buffer_load_ushort v51, v41, s[20:23], s4 offen offset:768
s_waitcnt vmcnt(0)
v_lshl_or_b32 v56, v45, 16, v44
v_lshl_or_b32 v57, v47, 16, v46
v_lshl_or_b32 v58, v49, 16, v48
v_lshl_or_b32 v59, v51, 16, v50
s_nop 1
Mvvv 160,56,52
s_nop 3
buffer_load_ushort v44, v41, s[20:23], s3 offen offset:32
buffer_load_ushort v45, v41, s[20:23], s3 offen offset:288
buffer_load_ushort v46, v41, s[20:23], s3 offen offset:544
buffer_load_ushort v47, v41, s[20:23], s3 offen offset:800
buffer_load_ushort v48, v41, s[20:23], s4 offen offset:32
buffer_load_ushort v49, v41, s[20:23], s4 offen offset:288
buffer_load_ushort v50, v41, s[20:23], s4 offen offset:544
buffer_load_ushort v51, v41, s[20:23], s4 offen offset:800
s_waitcnt vmcnt(0)
v_lshl_or_b32 v56, v45, 16, v44
v_lshl_or_b32 v57, v47, 16, v46
v_lshl_or_b32 v58, v49, 16, v48
v_lshl_or_b32 v59, v51, 16, v50
s_nop 1
Mvvv 164,56,52
s_nop 3
buffer_load_ushort v44, v41, s[20:23], s3 offen offset:64
buffer_load_ushort v45, v41, s[20:23], s3 offen offset:320
buffer_load_ushort v46, v41, s[20:23], s3 offen offset:576
buffer_load_ushort v47, v41, s[20:23], s3 offen offset:832
buffer_load_ushort v48, v41, s[20:23], s4 offen offset:64
buffer_load_ushort v49, v41, s[20:23], s4 offen offset:320
buffer_load_ushort v50, v41, s[20:23], s4 offen offset:576
buffer_load_ushort v51, v41, s[20:23], s4 offen offset:832
s_waitcnt vmcnt(0)
v_lshl_or_b32 v56, v45, 16, v44
v_lshl_or_b32 v57, v47, 16, v46
v_lshl_or_b32 v58, v49, 16, v48
v_lshl_or_b32 v59, v51, 16, v50
s_nop 1
Mvvv 168,56,52
s_nop 3
buffer_load_ushort v44, v41, s[20:23], s3 offen offset:96
buffer_load_ushort v45, v41, s[20:23], s3 offen offset:352
buffer_load_ushort v46, v41, s[20:23], s3 offen offset:608
buffer_load_ushort v47, v41, s[20:23], s3 offen offset:864
buffer_load_ushort v48, v41, s[20:23], s4 offen offset:96
buffer_load_ushort v49, v41, s[20:23], s4 offen offset:352
buffer_load_ushort v50, v41, s[20:23], s4 offen offset:608
buffer_load_ushort v51, v41, s[20:23], s4 offen offset:864
s_waitcnt vmcnt(0)
v_lshl_or_b32 v56, v45, 16, v44
v_lshl_or_b32 v57, v47, 16, v46
v_lshl_or_b32 v58, v49, 16, v48
v_lshl_or_b32 v59, v51, 16, v50
s_nop 1
Mvvv 172,56,52
s_nop 3
buffer_load_ushort v44, v41, s[20:23], s3 offen offset:128
buffer_load_ushort v45, v41, s[20:23], s3 offen offset:384
buffer_load_ushort v46, v41, s[20:23], s3 offen offset:640
buffer_load_ushort v47, v41, s[20:23], s3 offen offset:896
buffer_load_ushort v48, v41, s[20:23], s4 offen offset:128
buffer_load_ushort v49, v41, s[20:23], s4 offen offset:384
buffer_load_ushort v50, v41, s[20:23], s4 offen offset:640
buffer_load_ushort v51, v41, s[20:23], s4 offen offset:896
s_waitcnt vmcnt(0)
v_lshl_or_b32 v56, v45, 16, v44
v_lshl_or_b32 v57, v47, 16, v46
v_lshl_or_b32 v58, v49, 16, v48
v_lshl_or_b32 v59, v51, 16, v50
s_nop 1
Mvvv 176,56,52
s_nop 3
buffer_load_ushort v44, v41, s[20:23], s3 offen offset:160
buffer_load_ushort v45, v41, s[20:23], s3 offen offset:416
buffer_load_ushort v46, v41, s[20:23], s3 offen offset:672
buffer_load_ushort v47, v41, s[20:23], s3 offen offset:928
buffer_load_ushort v48, v41, s[20:23], s4 offen offset:160
buffer_load_ushort v49, v41, s[20:23], s4 offen offset:416
buffer_load_ushort v50, v41, s[20:23], s4 offen offset:672
buffer_load_ushort v51, v41, s[20:23], s4 offen offset:928
s_waitcnt vmcnt(0)
v_lshl_or_b32 v56, v45, 16, v44
v_lshl_or_b32 v57, v47, 16, v46
v_lshl_or_b32 v58, v49, 16, v48
v_lshl_or_b32 v59, v51, 16, v50
s_nop 1
Mvvv 180,56,52
s_nop 3
buffer_load_ushort v44, v41, s[20:23], s3 offen offset:192
buffer_load_ushort v45, v41, s[20:23], s3 offen offset:448
buffer_load_ushort v46, v41, s[20:23], s3 offen offset:704
buffer_load_ushort v47, v41, s[20:23], s3 offen offset:960
buffer_load_ushort v48, v41, s[20:23], s4 offen offset:192
buffer_load_ushort v49, v41, s[20:23], s4 offen offset:448
buffer_load_ushort v50, v41, s[20:23], s4 offen offset:704
buffer_load_ushort v51, v41, s[20:23], s4 offen offset:960
s_waitcnt vmcnt(0)
v_lshl_or_b32 v56, v45, 16, v44
v_lshl_or_b32 v57, v47, 16, v46
v_lshl_or_b32 v58, v49, 16, v48
v_lshl_or_b32 v59, v51, 16, v50
s_nop 1
Mvvv 184,56,52
s_nop 3
buffer_load_ushort v44, v41, s[20:23], s3 offen offset:224
buffer_load_ushort v45, v41, s[20:23], s3 offen offset:480
buffer_load_ushort v46, v41, s[20:23], s3 offen offset:736
buffer_load_ushort v47, v41, s[20:23], s3 offen offset:992
buffer_load_ushort v48, v41, s[20:23], s4 offen offset:224
buffer_load_ushort v49, v41, s[20:23], s4 offen offset:480
buffer_load_ushort v50, v41, s[20:23], s4 offen offset:736
buffer_load_ushort v51, v41, s[20:23], s4 offen offset:992
s_waitcnt vmcnt(0)
v_lshl_or_b32 v56, v45, 16, v44
v_lshl_or_b32 v57, v47, 16, v46
v_lshl_or_b32 v58, v49, 16, v48
v_lshl_or_b32 v59, v51, 16, v50
s_nop 1
Mvvv 188,56,52
s_nop 3
s_add_u32 s3, s3, 8192
s_cmp_lg_u32 s3, s5
s_cbranch_scc1 L1a_flush1_s2
s_nop 7
s_nop 7
v_mov_b32 v43, v113
s_nop 1
v_permlane32_swap_b32 v113, v43
s_nop 1
v_add_f32 v113, v113, v43
v_mov_b32 v43, v113
s_nop 1
v_permlane16_swap_b32 v113, v43
s_nop 1
v_add_f32 v113, v113, v43
s_nop 1
s_branch L1a_flush1_rcp
L1a_ffin1_slow:
s_nop 7
v_lshrrev_b32 v42, 4, v1
v_and_b32 v43, 15, v42
v_lshrrev_b32 v42, 4, v42
v_lshlrev_b32 v40, 4, v42
v_lshl_add_u32 v40, v43, 8, v40
v_lshlrev_b32 v41, 1, v43
v_lshl_add_u32 v41, v42, 10, v41
v_mov_b32 v42, 0xff800000
s_mov_b32 s3, 0x40000
s_mov_b32 s5, 0x80000
L1a_ffin1_s1:
Pv 160,40,16,3,0
Pv 164,40,16,3,64
Pv 168,40,16,3,128
Pv 172,40,16,3,192
s_waitcnt vmcnt(0)
Zvva 44,160,16
Mvva 44,164,20
Mvva 44,168,24
Mvva 44,172,28
s_nop 7
s_nop 1
v_max3_f32 v42, v42, v44, v45
v_max3_f32 v42, v42, v46, v47
s_add_u32 s3, s3, 4096
s_cmp_lg_u32 s3, s5
s_cbranch_scc1 L1a_ffin1_s1
v_mov_b32 v43, v42
s_nop 1
v_permlane32_swap_b32 v42, v43
s_nop 1
v_max_f32 v42, v42, v43
v_mov_b32 v43, v42
s_nop 1
v_permlane16_swap_b32 v42, v43
s_nop 1
v_max_f32 v42, v42, v43
v_mov_b64 v[160:161], 0
v_mov_b64 v[162:163], 0
v_mov_b64 v[164:165], 0
v_mov_b64 v[166:167], 0
v_mov_b64 v[168:169], 0
v_mov_b64 v[170:171], 0
v_mov_b64 v[172:173], 0
v_mov_b64 v[174:175], 0
v_mov_b64 v[176:177], 0
v_mov_b64 v[178:179], 0
v_mov_b64 v[180:181], 0
v_mov_b64 v[182:183], 0
v_mov_b64 v[184:185], 0
v_mov_b64 v[186:187], 0
v_mov_b64 v[188:189], 0
v_mov_b64 v[190:191], 0
v_mov_b32 v113, 0
s_mov_b32 s3, 0x40000
L1a_ffin1_s2:
s_add_u32 s4, s3, 4096
Pv 56,40,16,3,0
Pv 60,40,16,3,64
s_waitcnt vmcnt(0)
Zvva 44,56,16
Mvva 44,60,20
s_nop 3
Pv 56,40,16,3,128
Pv 60,40,16,3,192
s_waitcnt vmcnt(0)
Mvva 44,56,24
Mvva 44,60,28
s_nop 3
Pv 56,40,16,4,0
Pv 60,40,16,4,64
s_waitcnt vmcnt(0)
Zvva 48,56,16
Mvva 48,60,20
s_nop 3
Pv 56,40,16,4,128
Pv 60,40,16,4,192
s_waitcnt vmcnt(0)
Mvva 48,56,24
Mvva 48,60,28
s_nop 3
s_nop 7
s_nop 1
v_sub_f32 v44, v44, v42
v_sub_f32 v45, v45, v42
v_sub_f32 v46, v46, v42
v_sub_f32 v47, v47, v42
v_sub_f32 v48, v48, v42
v_sub_f32 v49, v49, v42
v_sub_f32 v50, v50, v42
v_sub_f32 v51, v51, v42
EX 44
EX 45
EX 46
EX 47
EX 48
EX 49
EX 50
EX 51
s_nop 1
AD 113,44
AD 113,45
AD 113,46
AD 113,47
AD 113,48
AD 113,49
AD 113,50
AD 113,51
CV 52,44
CV 53,46
CV 54,48
CV 55,50
buffer_load_ushort v44, v41, s[20:23], s3 offen offset:0
buffer_load_ushort v45, v41, s[20:23], s3 offen offset:256
buffer_load_ushort v46, v41, s[20:23], s3 offen offset:512
buffer_load_ushort v47, v41, s[20:23], s3 offen offset:768
buffer_load_ushort v48, v41, s[20:23], s4 offen offset:0
buffer_load_ushort v49, v41, s[20:23], s4 offen offset:256
buffer_load_ushort v50, v41, s[20:23], s4 offen offset:512
buffer_load_ushort v51, v41, s[20:23], s4 offen offset:768
s_waitcnt vmcnt(0)
v_lshl_or_b32 v56, v45, 16, v44
v_lshl_or_b32 v57, v47, 16, v46
v_lshl_or_b32 v58, v49, 16, v48
v_lshl_or_b32 v59, v51, 16, v50
s_nop 1
Mvvv 160,56,52
s_nop 3
buffer_load_ushort v44, v41, s[20:23], s3 offen offset:32
buffer_load_ushort v45, v41, s[20:23], s3 offen offset:288
buffer_load_ushort v46, v41, s[20:23], s3 offen offset:544
buffer_load_ushort v47, v41, s[20:23], s3 offen offset:800
buffer_load_ushort v48, v41, s[20:23], s4 offen offset:32
buffer_load_ushort v49, v41, s[20:23], s4 offen offset:288
buffer_load_ushort v50, v41, s[20:23], s4 offen offset:544
buffer_load_ushort v51, v41, s[20:23], s4 offen offset:800
s_waitcnt vmcnt(0)
v_lshl_or_b32 v56, v45, 16, v44
v_lshl_or_b32 v57, v47, 16, v46
v_lshl_or_b32 v58, v49, 16, v48
v_lshl_or_b32 v59, v51, 16, v50
s_nop 1
Mvvv 164,56,52
s_nop 3
buffer_load_ushort v44, v41, s[20:23], s3 offen offset:64
buffer_load_ushort v45, v41, s[20:23], s3 offen offset:320
buffer_load_ushort v46, v41, s[20:23], s3 offen offset:576
buffer_load_ushort v47, v41, s[20:23], s3 offen offset:832
buffer_load_ushort v48, v41, s[20:23], s4 offen offset:64
buffer_load_ushort v49, v41, s[20:23], s4 offen offset:320
buffer_load_ushort v50, v41, s[20:23], s4 offen offset:576
buffer_load_ushort v51, v41, s[20:23], s4 offen offset:832
s_waitcnt vmcnt(0)
v_lshl_or_b32 v56, v45, 16, v44
v_lshl_or_b32 v57, v47, 16, v46
v_lshl_or_b32 v58, v49, 16, v48
v_lshl_or_b32 v59, v51, 16, v50
s_nop 1
Mvvv 168,56,52
s_nop 3
buffer_load_ushort v44, v41, s[20:23], s3 offen offset:96
buffer_load_ushort v45, v41, s[20:23], s3 offen offset:352
buffer_load_ushort v46, v41, s[20:23], s3 offen offset:608
buffer_load_ushort v47, v41, s[20:23], s3 offen offset:864
buffer_load_ushort v48, v41, s[20:23], s4 offen offset:96
buffer_load_ushort v49, v41, s[20:23], s4 offen offset:352
buffer_load_ushort v50, v41, s[20:23], s4 offen offset:608
buffer_load_ushort v51, v41, s[20:23], s4 offen offset:864
s_waitcnt vmcnt(0)
v_lshl_or_b32 v56, v45, 16, v44
v_lshl_or_b32 v57, v47, 16, v46
v_lshl_or_b32 v58, v49, 16, v48
v_lshl_or_b32 v59, v51, 16, v50
s_nop 1
Mvvv 172,56,52
s_nop 3
buffer_load_ushort v44, v41, s[20:23], s3 offen offset:128
buffer_load_ushort v45, v41, s[20:23], s3 offen offset:384
buffer_load_ushort v46, v41, s[20:23], s3 offen offset:640
buffer_load_ushort v47, v41, s[20:23], s3 offen offset:896
buffer_load_ushort v48, v41, s[20:23], s4 offen offset:128
buffer_load_ushort v49, v41, s[20:23], s4 offen offset:384
buffer_load_ushort v50, v41, s[20:23], s4 offen offset:640
buffer_load_ushort v51, v41, s[20:23], s4 offen offset:896
s_waitcnt vmcnt(0)
v_lshl_or_b32 v56, v45, 16, v44
v_lshl_or_b32 v57, v47, 16, v46
v_lshl_or_b32 v58, v49, 16, v48
v_lshl_or_b32 v59, v51, 16, v50
s_nop 1
Mvvv 176,56,52
s_nop 3
buffer_load_ushort v44, v41, s[20:23], s3 offen offset:160
buffer_load_ushort v45, v41, s[20:23], s3 offen offset:416
buffer_load_ushort v46, v41, s[20:23], s3 offen offset:672
buffer_load_ushort v47, v41, s[20:23], s3 offen offset:928
buffer_load_ushort v48, v41, s[20:23], s4 offen offset:160
buffer_load_ushort v49, v41, s[20:23], s4 offen offset:416
buffer_load_ushort v50, v41, s[20:23], s4 offen offset:672
buffer_load_ushort v51, v41, s[20:23], s4 offen offset:928
s_waitcnt vmcnt(0)
v_lshl_or_b32 v56, v45, 16, v44
v_lshl_or_b32 v57, v47, 16, v46
v_lshl_or_b32 v58, v49, 16, v48
v_lshl_or_b32 v59, v51, 16, v50
s_nop 1
Mvvv 180,56,52
s_nop 3
buffer_load_ushort v44, v41, s[20:23], s3 offen offset:192
buffer_load_ushort v45, v41, s[20:23], s3 offen offset:448
buffer_load_ushort v46, v41, s[20:23], s3 offen offset:704
buffer_load_ushort v47, v41, s[20:23], s3 offen offset:960
buffer_load_ushort v48, v41, s[20:23], s4 offen offset:192
buffer_load_ushort v49, v41, s[20:23], s4 offen offset:448
buffer_load_ushort v50, v41, s[20:23], s4 offen offset:704
buffer_load_ushort v51, v41, s[20:23], s4 offen offset:960
s_waitcnt vmcnt(0)
v_lshl_or_b32 v56, v45, 16, v44
v_lshl_or_b32 v57, v47, 16, v46
v_lshl_or_b32 v58, v49, 16, v48
v_lshl_or_b32 v59, v51, 16, v50
s_nop 1
Mvvv 184,56,52
s_nop 3
buffer_load_ushort v44, v41, s[20:23], s3 offen offset:224
buffer_load_ushort v45, v41, s[20:23], s3 offen offset:480
buffer_load_ushort v46, v41, s[20:23], s3 offen offset:736
buffer_load_ushort v47, v41, s[20:23], s3 offen offset:992
buffer_load_ushort v48, v41, s[20:23], s4 offen offset:224
buffer_load_ushort v49, v41, s[20:23], s4 offen offset:480
buffer_load_ushort v50, v41, s[20:23], s4 offen offset:736
buffer_load_ushort v51, v41, s[20:23], s4 offen offset:992
s_waitcnt vmcnt(0)
v_lshl_or_b32 v56, v45, 16, v44
v_lshl_or_b32 v57, v47, 16, v46
v_lshl_or_b32 v58, v49, 16, v48
v_lshl_or_b32 v59, v51, 16, v50
s_nop 1
Mvvv 188,56,52
s_nop 3
s_add_u32 s3, s3, 8192
s_cmp_lg_u32 s3, s5
s_cbranch_scc1 L1a_ffin1_s2
s_nop 7
s_nop 7
v_mov_b32 v43, v113
s_nop 1
v_permlane32_swap_b32 v113, v43
s_nop 1
v_add_f32 v113, v113, v43
v_mov_b32 v43, v113
s_nop 1
v_permlane16_swap_b32 v113, v43
s_nop 1
v_add_f32 v113, v113, v43
s_nop 1
s_branch L1a_ffin1_rcp
L1a_flush2_slow:
s_nop 7
v_lshrrev_b32 v42, 4, v1
v_and_b32 v43, 15, v42
v_lshrrev_b32 v42, 4, v42
v_lshlrev_b32 v40, 4, v42
v_lshl_add_u32 v40, v43, 8, v40
v_lshlrev_b32 v41, 1, v43
v_lshl_add_u32 v41, v42, 10, v41
v_mov_b32 v42, 0xff800000
s_mov_b32 s3, 0x0
s_mov_b32 s5, 0x40000
L1a_flush2_s1:
Pv 192,40,16,3,0
Pv 196,40,16,3,64
Pv 200,40,16,3,128
Pv 204,40,16,3,192
s_waitcnt vmcnt(0)
Zvva 44,192,32
Mvva 44,196,36
Mvva 44,200,40
Mvva 44,204,44
s_nop 7
s_nop 1
v_max3_f32 v42, v42, v44, v45
v_max3_f32 v42, v42, v46, v47
s_add_u32 s3, s3, 4096
s_cmp_lg_u32 s3, s5
s_cbranch_scc1 L1a_flush2_s1
v_mov_b32 v43, v42
s_nop 1
v_permlane32_swap_b32 v42, v43
s_nop 1
v_max_f32 v42, v42, v43
v_mov_b32 v43, v42
s_nop 1
v_permlane16_swap_b32 v42, v43
s_nop 1
v_max_f32 v42, v42, v43
v_mov_b64 v[192:193], 0
v_mov_b64 v[194:195], 0
v_mov_b64 v[196:197], 0
v_mov_b64 v[198:199], 0
v_mov_b64 v[200:201], 0
v_mov_b64 v[202:203], 0
v_mov_b64 v[204:205], 0
v_mov_b64 v[206:207], 0
v_mov_b64 v[208:209], 0
v_mov_b64 v[210:211], 0
v_mov_b64 v[212:213], 0
v_mov_b64 v[214:215], 0
v_mov_b64 v[216:217], 0
v_mov_b64 v[218:219], 0
v_mov_b64 v[220:221], 0
v_mov_b64 v[222:223], 0
v_mov_b32 v114, 0
s_mov_b32 s3, 0x0
L1a_flush2_s2:
s_add_u32 s4, s3, 4096
Pv 56,40,16,3,0
Pv 60,40,16,3,64
s_waitcnt vmcnt(0)
Zvva 44,56,32
Mvva 44,60,36
s_nop 3
Pv 56,40,16,3,128
Pv 60,40,16,3,192
s_waitcnt vmcnt(0)
Mvva 44,56,40
Mvva 44,60,44
s_nop 3
Pv 56,40,16,4,0
Pv 60,40,16,4,64
s_waitcnt vmcnt(0)
Zvva 48,56,32
Mvva 48,60,36
s_nop 3
Pv 56,40,16,4,128
Pv 60,40,16,4,192
s_waitcnt vmcnt(0)
Mvva 48,56,40
Mvva 48,60,44
s_nop 3
s_nop 7
s_nop 1
v_sub_f32 v44, v44, v42
v_sub_f32 v45, v45, v42
v_sub_f32 v46, v46, v42
v_sub_f32 v47, v47, v42
v_sub_f32 v48, v48, v42
v_sub_f32 v49, v49, v42
v_sub_f32 v50, v50, v42
v_sub_f32 v51, v51, v42
EX 44
EX 45
EX 46
EX 47
EX 48
EX 49
EX 50
EX 51
s_nop 1
AD 114,44
AD 114,45
AD 114,46
AD 114,47
AD 114,48
AD 114,49
AD 114,50
AD 114,51
CV 52,44
CV 53,46
CV 54,48
CV 55,50
buffer_load_ushort v44, v41, s[20:23], s3 offen offset:0
buffer_load_ushort v45, v41, s[20:23], s3 offen offset:256
buffer_load_ushort v46, v41, s[20:23], s3 offen offset:512
buffer_load_ushort v47, v41, s[20:23], s3 offen offset:768
buffer_load_ushort v48, v41, s[20:23], s4 offen offset:0
buffer_load_ushort v49, v41, s[20:23], s4 offen offset:256
buffer_load_ushort v50, v41, s[20:23], s4 offen offset:512
buffer_load_ushort v51, v41, s[20:23], s4 offen offset:768
s_waitcnt vmcnt(0)
v_lshl_or_b32 v56, v45, 16, v44
v_lshl_or_b32 v57, v47, 16, v46
v_lshl_or_b32 v58, v49, 16, v48
v_lshl_or_b32 v59, v51, 16, v50
s_nop 1
Mvvv 192,56,52
s_nop 3
buffer_load_ushort v44, v41, s[20:23], s3 offen offset:32
buffer_load_ushort v45, v41, s[20:23], s3 offen offset:288
buffer_load_ushort v46, v41, s[20:23], s3 offen offset:544
buffer_load_ushort v47, v41, s[20:23], s3 offen offset:800
buffer_load_ushort v48, v41, s[20:23], s4 offen offset:32
buffer_load_ushort v49, v41, s[20:23], s4 offen offset:288
buffer_load_ushort v50, v41, s[20:23], s4 offen offset:544
buffer_load_ushort v51, v41, s[20:23], s4 offen offset:800
s_waitcnt vmcnt(0)
v_lshl_or_b32 v56, v45, 16, v44
v_lshl_or_b32 v57, v47, 16, v46
v_lshl_or_b32 v58, v49, 16, v48
v_lshl_or_b32 v59, v51, 16, v50
s_nop 1
Mvvv 196,56,52
s_nop 3
buffer_load_ushort v44, v41, s[20:23], s3 offen offset:64
buffer_load_ushort v45, v41, s[20:23], s3 offen offset:320
buffer_load_ushort v46, v41, s[20:23], s3 offen offset:576
buffer_load_ushort v47, v41, s[20:23], s3 offen offset:832
buffer_load_ushort v48, v41, s[20:23], s4 offen offset:64
buffer_load_ushort v49, v41, s[20:23], s4 offen offset:320
buffer_load_ushort v50, v41, s[20:23], s4 offen offset:576
buffer_load_ushort v51, v41, s[20:23], s4 offen offset:832
s_waitcnt vmcnt(0)
v_lshl_or_b32 v56, v45, 16, v44
v_lshl_or_b32 v57, v47, 16, v46
v_lshl_or_b32 v58, v49, 16, v48
v_lshl_or_b32 v59, v51, 16, v50
s_nop 1
Mvvv 200,56,52
s_nop 3
buffer_load_ushort v44, v41, s[20:23], s3 offen offset:96
buffer_load_ushort v45, v41, s[20:23], s3 offen offset:352
buffer_load_ushort v46, v41, s[20:23], s3 offen offset:608
buffer_load_ushort v47, v41, s[20:23], s3 offen offset:864
buffer_load_ushort v48, v41, s[20:23], s4 offen offset:96
buffer_load_ushort v49, v41, s[20:23], s4 offen offset:352
buffer_load_ushort v50, v41, s[20:23], s4 offen offset:608
buffer_load_ushort v51, v41, s[20:23], s4 offen offset:864
s_waitcnt vmcnt(0)
v_lshl_or_b32 v56, v45, 16, v44
v_lshl_or_b32 v57, v47, 16, v46
v_lshl_or_b32 v58, v49, 16, v48
v_lshl_or_b32 v59, v51, 16, v50
s_nop 1
Mvvv 204,56,52
s_nop 3
buffer_load_ushort v44, v41, s[20:23], s3 offen offset:128
buffer_load_ushort v45, v41, s[20:23], s3 offen offset:384
buffer_load_ushort v46, v41, s[20:23], s3 offen offset:640
buffer_load_ushort v47, v41, s[20:23], s3 offen offset:896
buffer_load_ushort v48, v41, s[20:23], s4 offen offset:128
buffer_load_ushort v49, v41, s[20:23], s4 offen offset:384
buffer_load_ushort v50, v41, s[20:23], s4 offen offset:640
buffer_load_ushort v51, v41, s[20:23], s4 offen offset:896
s_waitcnt vmcnt(0)
v_lshl_or_b32 v56, v45, 16, v44
v_lshl_or_b32 v57, v47, 16, v46
v_lshl_or_b32 v58, v49, 16, v48
v_lshl_or_b32 v59, v51, 16, v50
s_nop 1
Mvvv 208,56,52
s_nop 3
buffer_load_ushort v44, v41, s[20:23], s3 offen offset:160
buffer_load_ushort v45, v41, s[20:23], s3 offen offset:416
buffer_load_ushort v46, v41, s[20:23], s3 offen offset:672
buffer_load_ushort v47, v41, s[20:23], s3 offen offset:928
buffer_load_ushort v48, v41, s[20:23], s4 offen offset:160
buffer_load_ushort v49, v41, s[20:23], s4 offen offset:416
buffer_load_ushort v50, v41, s[20:23], s4 offen offset:672
buffer_load_ushort v51, v41, s[20:23], s4 offen offset:928
s_waitcnt vmcnt(0)
v_lshl_or_b32 v56, v45, 16, v44
v_lshl_or_b32 v57, v47, 16, v46
v_lshl_or_b32 v58, v49, 16, v48
v_lshl_or_b32 v59, v51, 16, v50
s_nop 1
Mvvv 212,56,52
s_nop 3
buffer_load_ushort v44, v41, s[20:23], s3 offen offset:192
buffer_load_ushort v45, v41, s[20:23], s3 offen offset:448
buffer_load_ushort v46, v41, s[20:23], s3 offen offset:704
buffer_load_ushort v47, v41, s[20:23], s3 offen offset:960
buffer_load_ushort v48, v41, s[20:23], s4 offen offset:192
buffer_load_ushort v49, v41, s[20:23], s4 offen offset:448
buffer_load_ushort v50, v41, s[20:23], s4 offen offset:704
buffer_load_ushort v51, v41, s[20:23], s4 offen offset:960
s_waitcnt vmcnt(0)
v_lshl_or_b32 v56, v45, 16, v44
v_lshl_or_b32 v57, v47, 16, v46
v_lshl_or_b32 v58, v49, 16, v48
v_lshl_or_b32 v59, v51, 16, v50
s_nop 1
Mvvv 216,56,52
s_nop 3
buffer_load_ushort v44, v41, s[20:23], s3 offen offset:224
buffer_load_ushort v45, v41, s[20:23], s3 offen offset:480
buffer_load_ushort v46, v41, s[20:23], s3 offen offset:736
buffer_load_ushort v47, v41, s[20:23], s3 offen offset:992
buffer_load_ushort v48, v41, s[20:23], s4 offen offset:224
buffer_load_ushort v49, v41, s[20:23], s4 offen offset:480
buffer_load_ushort v50, v41, s[20:23], s4 offen offset:736
buffer_load_ushort v51, v41, s[20:23], s4 offen offset:992
s_waitcnt vmcnt(0)
v_lshl_or_b32 v56, v45, 16, v44
v_lshl_or_b32 v57, v47, 16, v46
v_lshl_or_b32 v58, v49, 16, v48
v_lshl_or_b32 v59, v51, 16, v50
s_nop 1
Mvvv 220,56,52
s_nop 3
s_add_u32 s3, s3, 8192
s_cmp_lg_u32 s3, s5
s_cbranch_scc1 L1a_flush2_s2
s_nop 7
s_nop 7
v_mov_b32 v43, v114
s_nop 1
v_permlane32_swap_b32 v114, v43
s_nop 1
v_add_f32 v114, v114, v43
v_mov_b32 v43, v114
s_nop 1
v_permlane16_swap_b32 v114, v43
s_nop 1
v_add_f32 v114, v114, v43
s_nop 1
s_branch L1a_flush2_rcp
L1a_ffin2_slow:
s_nop 7
v_lshrrev_b32 v42, 4, v1
v_and_b32 v43, 15, v42
v_lshrrev_b32 v42, 4, v42
v_lshlrev_b32 v40, 4, v42
v_lshl_add_u32 v40, v43, 8, v40
v_lshlrev_b32 v41, 1, v43
v_lshl_add_u32 v41, v42, 10, v41
v_mov_b32 v42, 0xff800000
s_mov_b32 s3, 0x40000
s_mov_b32 s5, 0x80000
L1a_ffin2_s1:
Pv 192,40,16,3,0
Pv 196,40,16,3,64
Pv 200,40,16,3,128
Pv 204,40,16,3,192
s_waitcnt vmcnt(0)
Zvva 44,192,32
Mvva 44,196,36
Mvva 44,200,40
Mvva 44,204,44
s_nop 7
s_nop 1
v_max3_f32 v42, v42, v44, v45
v_max3_f32 v42, v42, v46, v47
s_add_u32 s3, s3, 4096
s_cmp_lg_u32 s3, s5
s_cbranch_scc1 L1a_ffin2_s1
v_mov_b32 v43, v42
s_nop 1
v_permlane32_swap_b32 v42, v43
s_nop 1
v_max_f32 v42, v42, v43
v_mov_b32 v43, v42
s_nop 1
v_permlane16_swap_b32 v42, v43
s_nop 1
v_max_f32 v42, v42, v43
v_mov_b64 v[192:193], 0
v_mov_b64 v[194:195], 0
v_mov_b64 v[196:197], 0
v_mov_b64 v[198:199], 0
v_mov_b64 v[200:201], 0
v_mov_b64 v[202:203], 0
v_mov_b64 v[204:205], 0
v_mov_b64 v[206:207], 0
v_mov_b64 v[208:209], 0
v_mov_b64 v[210:211], 0
v_mov_b64 v[212:213], 0
v_mov_b64 v[214:215], 0
v_mov_b64 v[216:217], 0
v_mov_b64 v[218:219], 0
v_mov_b64 v[220:221], 0
v_mov_b64 v[222:223], 0
v_mov_b32 v114, 0
s_mov_b32 s3, 0x40000
L1a_ffin2_s2:
s_add_u32 s4, s3, 4096
Pv 56,40,16,3,0
Pv 60,40,16,3,64
s_waitcnt vmcnt(0)
Zvva 44,56,32
Mvva 44,60,36
s_nop 3
Pv 56,40,16,3,128
Pv 60,40,16,3,192
s_waitcnt vmcnt(0)
Mvva 44,56,40
Mvva 44,60,44
s_nop 3
Pv 56,40,16,4,0
Pv 60,40,16,4,64
s_waitcnt vmcnt(0)
Zvva 48,56,32
Mvva 48,60,36
s_nop 3
Pv 56,40,16,4,128
Pv 60,40,16,4,192
s_waitcnt vmcnt(0)
Mvva 48,56,40
Mvva 48,60,44
s_nop 3
s_nop 7
s_nop 1
v_sub_f32 v44, v44, v42
v_sub_f32 v45, v45, v42
v_sub_f32 v46, v46, v42
v_sub_f32 v47, v47, v42
v_sub_f32 v48, v48, v42
v_sub_f32 v49, v49, v42
v_sub_f32 v50, v50, v42
v_sub_f32 v51, v51, v42
EX 44
EX 45
EX 46
EX 47
EX 48
EX 49
EX 50
EX 51
s_nop 1
AD 114,44
AD 114,45
AD 114,46
AD 114,47
AD 114,48
AD 114,49
AD 114,50
AD 114,51
CV 52,44
CV 53,46
CV 54,48
CV 55,50
buffer_load_ushort v44, v41, s[20:23], s3 offen offset:0
buffer_load_ushort v45, v41, s[20:23], s3 offen offset:256
buffer_load_ushort v46, v41, s[20:23], s3 offen offset:512
buffer_load_ushort v47, v41, s[20:23], s3 offen offset:768
buffer_load_ushort v48, v41, s[20:23], s4 offen offset:0
buffer_load_ushort v49, v41, s[20:23], s4 offen offset:256
buffer_load_ushort v50, v41, s[20:23], s4 offen offset:512
buffer_load_ushort v51, v41, s[20:23], s4 offen offset:768
s_waitcnt vmcnt(0)
v_lshl_or_b32 v56, v45, 16, v44
v_lshl_or_b32 v57, v47, 16, v46
v_lshl_or_b32 v58, v49, 16, v48
v_lshl_or_b32 v59, v51, 16, v50
s_nop 1
Mvvv 192,56,52
s_nop 3
buffer_load_ushort v44, v41, s[20:23], s3 offen offset:32
buffer_load_ushort v45, v41, s[20:23], s3 offen offset:288
buffer_load_ushort v46, v41, s[20:23], s3 offen offset:544
buffer_load_ushort v47, v41, s[20:23], s3 offen offset:800
buffer_load_ushort v48, v41, s[20:23], s4 offen offset:32
buffer_load_ushort v49, v41, s[20:23], s4 offen offset:288
buffer_load_ushort v50, v41, s[20:23], s4 offen offset:544
buffer_load_ushort v51, v41, s[20:23], s4 offen offset:800
s_waitcnt vmcnt(0)
v_lshl_or_b32 v56, v45, 16, v44
v_lshl_or_b32 v57, v47, 16, v46
v_lshl_or_b32 v58, v49, 16, v48
v_lshl_or_b32 v59, v51, 16, v50
s_nop 1
Mvvv 196,56,52
s_nop 3
buffer_load_ushort v44, v41, s[20:23], s3 offen offset:64
buffer_load_ushort v45, v41, s[20:23], s3 offen offset:320
buffer_load_ushort v46, v41, s[20:23], s3 offen offset:576
buffer_load_ushort v47, v41, s[20:23], s3 offen offset:832
buffer_load_ushort v48, v41, s[20:23], s4 offen offset:64
buffer_load_ushort v49, v41, s[20:23], s4 offen offset:320
buffer_load_ushort v50, v41, s[20:23], s4 offen offset:576
buffer_load_ushort v51, v41, s[20:23], s4 offen offset:832
s_waitcnt vmcnt(0)
v_lshl_or_b32 v56, v45, 16, v44
v_lshl_or_b32 v57, v47, 16, v46
v_lshl_or_b32 v58, v49, 16, v48
v_lshl_or_b32 v59, v51, 16, v50
s_nop 1
Mvvv 200,56,52
s_nop 3
buffer_load_ushort v44, v41, s[20:23], s3 offen offset:96
buffer_load_ushort v45, v41, s[20:23], s3 offen offset:352
buffer_load_ushort v46, v41, s[20:23], s3 offen offset:608
buffer_load_ushort v47, v41, s[20:23], s3 offen offset:864
buffer_load_ushort v48, v41, s[20:23], s4 offen offset:96
buffer_load_ushort v49, v41, s[20:23], s4 offen offset:352
buffer_load_ushort v50, v41, s[20:23], s4 offen offset:608
buffer_load_ushort v51, v41, s[20:23], s4 offen offset:864
s_waitcnt vmcnt(0)
v_lshl_or_b32 v56, v45, 16, v44
v_lshl_or_b32 v57, v47, 16, v46
v_lshl_or_b32 v58, v49, 16, v48
v_lshl_or_b32 v59, v51, 16, v50
s_nop 1
Mvvv 204,56,52
s_nop 3
buffer_load_ushort v44, v41, s[20:23], s3 offen offset:128
buffer_load_ushort v45, v41, s[20:23], s3 offen offset:384
buffer_load_ushort v46, v41, s[20:23], s3 offen offset:640
buffer_load_ushort v47, v41, s[20:23], s3 offen offset:896
buffer_load_ushort v48, v41, s[20:23], s4 offen offset:128
buffer_load_ushort v49, v41, s[20:23], s4 offen offset:384
buffer_load_ushort v50, v41, s[20:23], s4 offen offset:640
buffer_load_ushort v51, v41, s[20:23], s4 offen offset:896
s_waitcnt vmcnt(0)
v_lshl_or_b32 v56, v45, 16, v44
v_lshl_or_b32 v57, v47, 16, v46
v_lshl_or_b32 v58, v49, 16, v48
v_lshl_or_b32 v59, v51, 16, v50
s_nop 1
Mvvv 208,56,52
s_nop 3
buffer_load_ushort v44, v41, s[20:23], s3 offen offset:160
buffer_load_ushort v45, v41, s[20:23], s3 offen offset:416
buffer_load_ushort v46, v41, s[20:23], s3 offen offset:672
buffer_load_ushort v47, v41, s[20:23], s3 offen offset:928
buffer_load_ushort v48, v41, s[20:23], s4 offen offset:160
buffer_load_ushort v49, v41, s[20:23], s4 offen offset:416
buffer_load_ushort v50, v41, s[20:23], s4 offen offset:672
buffer_load_ushort v51, v41, s[20:23], s4 offen offset:928
s_waitcnt vmcnt(0)
v_lshl_or_b32 v56, v45, 16, v44
v_lshl_or_b32 v57, v47, 16, v46
v_lshl_or_b32 v58, v49, 16, v48
v_lshl_or_b32 v59, v51, 16, v50
s_nop 1
Mvvv 212,56,52
s_nop 3
buffer_load_ushort v44, v41, s[20:23], s3 offen offset:192
buffer_load_ushort v45, v41, s[20:23], s3 offen offset:448
buffer_load_ushort v46, v41, s[20:23], s3 offen offset:704
buffer_load_ushort v47, v41, s[20:23], s3 offen offset:960
buffer_load_ushort v48, v41, s[20:23], s4 offen offset:192
buffer_load_ushort v49, v41, s[20:23], s4 offen offset:448
buffer_load_ushort v50, v41, s[20:23], s4 offen offset:704
buffer_load_ushort v51, v41, s[20:23], s4 offen offset:960
s_waitcnt vmcnt(0)
v_lshl_or_b32 v56, v45, 16, v44
v_lshl_or_b32 v57, v47, 16, v46
v_lshl_or_b32 v58, v49, 16, v48
v_lshl_or_b32 v59, v51, 16, v50
s_nop 1
Mvvv 216,56,52
s_nop 3
buffer_load_ushort v44, v41, s[20:23], s3 offen offset:224
buffer_load_ushort v45, v41, s[20:23], s3 offen offset:480
buffer_load_ushort v46, v41, s[20:23], s3 offen offset:736
buffer_load_ushort v47, v41, s[20:23], s3 offen offset:992
buffer_load_ushort v48, v41, s[20:23], s4 offen offset:224
buffer_load_ushort v49, v41, s[20:23], s4 offen offset:480
buffer_load_ushort v50, v41, s[20:23], s4 offen offset:736
buffer_load_ushort v51, v41, s[20:23], s4 offen offset:992
s_waitcnt vmcnt(0)
v_lshl_or_b32 v56, v45, 16, v44
v_lshl_or_b32 v57, v47, 16, v46
v_lshl_or_b32 v58, v49, 16, v48
v_lshl_or_b32 v59, v51, 16, v50
s_nop 1
Mvvv 220,56,52
s_nop 3
s_add_u32 s3, s3, 8192
s_cmp_lg_u32 s3, s5
s_cbranch_scc1 L1a_ffin2_s2
s_nop 7
s_nop 7
v_mov_b32 v43, v114
s_nop 1
v_permlane32_swap_b32 v114, v43
s_nop 1
v_add_f32 v114, v114, v43
v_mov_b32 v43, v114
s_nop 1
v_permlane16_swap_b32 v114, v43
s_nop 1
v_add_f32 v114, v114, v43
s_nop 1
s_branch L1a_ffin2_rcp
L1a_flush3_slow:
s_nop 7
v_lshrrev_b32 v42, 4, v1
v_and_b32 v43, 15, v42
v_lshrrev_b32 v42, 4, v42
v_lshlrev_b32 v40, 4, v42
v_lshl_add_u32 v40, v43, 8, v40
v_lshlrev_b32 v41, 1, v43
v_lshl_add_u32 v41, v42, 10, v41
v_mov_b32 v42, 0xff800000
s_mov_b32 s3, 0x0
s_mov_b32 s5, 0x40000
L1a_flush3_s1:
Pv 224,40,16,3,0
Pv 228,40,16,3,64
Pv 232,40,16,3,128
Pv 236,40,16,3,192
s_waitcnt vmcnt(0)
Zvva 44,224,48
Mvva 44,228,52
Mvva 44,232,56
Mvva 44,236,60
s_nop 7
s_nop 1
v_max3_f32 v42, v42, v44, v45
v_max3_f32 v42, v42, v46, v47
s_add_u32 s3, s3, 4096
s_cmp_lg_u32 s3, s5
s_cbranch_scc1 L1a_flush3_s1
v_mov_b32 v43, v42
s_nop 1
v_permlane32_swap_b32 v42, v43
s_nop 1
v_max_f32 v42, v42, v43
v_mov_b32 v43, v42
s_nop 1
v_permlane16_swap_b32 v42, v43
s_nop 1
v_max_f32 v42, v42, v43
v_mov_b64 v[224:225], 0
v_mov_b64 v[226:227], 0
v_mov_b64 v[228:229], 0
v_mov_b64 v[230:231], 0
v_mov_b64 v[232:233], 0
v_mov_b64 v[234:235], 0
v_mov_b64 v[236:237], 0
v_mov_b64 v[238:239], 0
v_mov_b64 v[240:241], 0
v_mov_b64 v[242:243], 0
v_mov_b64 v[244:245], 0
v_mov_b64 v[246:247], 0
v_mov_b64 v[248:249], 0
v_mov_b64 v[250:251], 0
v_mov_b64 v[252:253], 0
v_mov_b64 v[254:255], 0
v_mov_b32 v115, 0
s_mov_b32 s3, 0x0
L1a_flush3_s2:
s_add_u32 s4, s3, 4096
Pv 56,40,16,3,0
Pv 60,40,16,3,64
s_waitcnt vmcnt(0)
Zvva 44,56,48
Mvva 44,60,52
s_nop 3
Pv 56,40,16,3,128
Pv 60,40,16,3,192
s_waitcnt vmcnt(0)
Mvva 44,56,56
Mvva 44,60,60
s_nop 3
Pv 56,40,16,4,0
Pv 60,40,16,4,64
s_waitcnt vmcnt(0)
Zvva 48,56,48
Mvva 48,60,52
s_nop 3
Pv 56,40,16,4,128
Pv 60,40,16,4,192
s_waitcnt vmcnt(0)
Mvva 48,56,56
Mvva 48,60,60
s_nop 3
s_nop 7
s_nop 1
v_sub_f32 v44, v44, v42
v_sub_f32 v45, v45, v42
v_sub_f32 v46, v46, v42
v_sub_f32 v47, v47, v42
v_sub_f32 v48, v48, v42
v_sub_f32 v49, v49, v42
v_sub_f32 v50, v50, v42
v_sub_f32 v51, v51, v42
EX 44
EX 45
EX 46
EX 47
EX 48
EX 49
EX 50
EX 51
s_nop 1
AD 115,44
AD 115,45
AD 115,46
AD 115,47
AD 115,48
AD 115,49
AD 115,50
AD 115,51
CV 52,44
CV 53,46
CV 54,48
CV 55,50
buffer_load_ushort v44, v41, s[20:23], s3 offen offset:0
buffer_load_ushort v45, v41, s[20:23], s3 offen offset:256
buffer_load_ushort v46, v41, s[20:23], s3 offen offset:512
buffer_load_ushort v47, v41, s[20:23], s3 offen offset:768
buffer_load_ushort v48, v41, s[20:23], s4 offen offset:0
buffer_load_ushort v49, v41, s[20:23], s4 offen offset:256
buffer_load_ushort v50, v41, s[20:23], s4 offen offset:512
buffer_load_ushort v51, v41, s[20:23], s4 offen offset:768
s_waitcnt vmcnt(0)
v_lshl_or_b32 v56, v45, 16, v44
v_lshl_or_b32 v57, v47, 16, v46
v_lshl_or_b32 v58, v49, 16, v48
v_lshl_or_b32 v59, v51, 16, v50
s_nop 1
Mvvv 224,56,52
s_nop 3
buffer_load_ushort v44, v41, s[20:23], s3 offen offset:32
buffer_load_ushort v45, v41, s[20:23], s3 offen offset:288
buffer_load_ushort v46, v41, s[20:23], s3 offen offset:544
buffer_load_ushort v47, v41, s[20:23], s3 offen offset:800
buffer_load_ushort v48, v41, s[20:23], s4 offen offset:32
buffer_load_ushort v49, v41, s[20:23], s4 offen offset:288
buffer_load_ushort v50, v41, s[20:23], s4 offen offset:544
buffer_load_ushort v51, v41, s[20:23], s4 offen offset:800
s_waitcnt vmcnt(0)
v_lshl_or_b32 v56, v45, 16, v44
v_lshl_or_b32 v57, v47, 16, v46
v_lshl_or_b32 v58, v49, 16, v48
v_lshl_or_b32 v59, v51, 16, v50
s_nop 1
Mvvv 228,56,52
s_nop 3
buffer_load_ushort v44, v41, s[20:23], s3 offen offset:64
buffer_load_ushort v45, v41, s[20:23], s3 offen offset:320
buffer_load_ushort v46, v41, s[20:23], s3 offen offset:576
buffer_load_ushort v47, v41, s[20:23], s3 offen offset:832
buffer_load_ushort v48, v41, s[20:23], s4 offen offset:64
buffer_load_ushort v49, v41, s[20:23], s4 offen offset:320
buffer_load_ushort v50, v41, s[20:23], s4 offen offset:576
buffer_load_ushort v51, v41, s[20:23], s4 offen offset:832
s_waitcnt vmcnt(0)
v_lshl_or_b32 v56, v45, 16, v44
v_lshl_or_b32 v57, v47, 16, v46
v_lshl_or_b32 v58, v49, 16, v48
v_lshl_or_b32 v59, v51, 16, v50
s_nop 1
Mvvv 232,56,52
s_nop 3
buffer_load_ushort v44, v41, s[20:23], s3 offen offset:96
buffer_load_ushort v45, v41, s[20:23], s3 offen offset:352
buffer_load_ushort v46, v41, s[20:23], s3 offen offset:608
buffer_load_ushort v47, v41, s[20:23], s3 offen offset:864
buffer_load_ushort v48, v41, s[20:23], s4 offen offset:96
buffer_load_ushort v49, v41, s[20:23], s4 offen offset:352
buffer_load_ushort v50, v41, s[20:23], s4 offen offset:608
buffer_load_ushort v51, v41, s[20:23], s4 offen offset:864
s_waitcnt vmcnt(0)
v_lshl_or_b32 v56, v45, 16, v44
v_lshl_or_b32 v57, v47, 16, v46
v_lshl_or_b32 v58, v49, 16, v48
v_lshl_or_b32 v59, v51, 16, v50
s_nop 1
Mvvv 236,56,52
s_nop 3
buffer_load_ushort v44, v41, s[20:23], s3 offen offset:128
buffer_load_ushort v45, v41, s[20:23], s3 offen offset:384
buffer_load_ushort v46, v41, s[20:23], s3 offen offset:640
buffer_load_ushort v47, v41, s[20:23], s3 offen offset:896
buffer_load_ushort v48, v41, s[20:23], s4 offen offset:128
buffer_load_ushort v49, v41, s[20:23], s4 offen offset:384
buffer_load_ushort v50, v41, s[20:23], s4 offen offset:640
buffer_load_ushort v51, v41, s[20:23], s4 offen offset:896
s_waitcnt vmcnt(0)
v_lshl_or_b32 v56, v45, 16, v44
v_lshl_or_b32 v57, v47, 16, v46
v_lshl_or_b32 v58, v49, 16, v48
v_lshl_or_b32 v59, v51, 16, v50
s_nop 1
Mvvv 240,56,52
s_nop 3
buffer_load_ushort v44, v41, s[20:23], s3 offen offset:160
buffer_load_ushort v45, v41, s[20:23], s3 offen offset:416
buffer_load_ushort v46, v41, s[20:23], s3 offen offset:672
buffer_load_ushort v47, v41, s[20:23], s3 offen offset:928
buffer_load_ushort v48, v41, s[20:23], s4 offen offset:160
buffer_load_ushort v49, v41, s[20:23], s4 offen offset:416
buffer_load_ushort v50, v41, s[20:23], s4 offen offset:672
buffer_load_ushort v51, v41, s[20:23], s4 offen offset:928
s_waitcnt vmcnt(0)
v_lshl_or_b32 v56, v45, 16, v44
v_lshl_or_b32 v57, v47, 16, v46
v_lshl_or_b32 v58, v49, 16, v48
v_lshl_or_b32 v59, v51, 16, v50
s_nop 1
Mvvv 244,56,52
s_nop 3
buffer_load_ushort v44, v41, s[20:23], s3 offen offset:192
buffer_load_ushort v45, v41, s[20:23], s3 offen offset:448
buffer_load_ushort v46, v41, s[20:23], s3 offen offset:704
buffer_load_ushort v47, v41, s[20:23], s3 offen offset:960
buffer_load_ushort v48, v41, s[20:23], s4 offen offset:192
buffer_load_ushort v49, v41, s[20:23], s4 offen offset:448
buffer_load_ushort v50, v41, s[20:23], s4 offen offset:704
buffer_load_ushort v51, v41, s[20:23], s4 offen offset:960
s_waitcnt vmcnt(0)
v_lshl_or_b32 v56, v45, 16, v44
v_lshl_or_b32 v57, v47, 16, v46
v_lshl_or_b32 v58, v49, 16, v48
v_lshl_or_b32 v59, v51, 16, v50
s_nop 1
Mvvv 248,56,52
s_nop 3
buffer_load_ushort v44, v41, s[20:23], s3 offen offset:224
buffer_load_ushort v45, v41, s[20:23], s3 offen offset:480
buffer_load_ushort v46, v41, s[20:23], s3 offen offset:736
buffer_load_ushort v47, v41, s[20:23], s3 offen offset:992
buffer_load_ushort v48, v41, s[20:23], s4 offen offset:224
buffer_load_ushort v49, v41, s[20:23], s4 offen offset:480
buffer_load_ushort v50, v41, s[20:23], s4 offen offset:736
buffer_load_ushort v51, v41, s[20:23], s4 offen offset:992
s_waitcnt vmcnt(0)
v_lshl_or_b32 v56, v45, 16, v44
v_lshl_or_b32 v57, v47, 16, v46
v_lshl_or_b32 v58, v49, 16, v48
v_lshl_or_b32 v59, v51, 16, v50
s_nop 1
Mvvv 252,56,52
s_nop 3
s_add_u32 s3, s3, 8192
s_cmp_lg_u32 s3, s5
s_cbranch_scc1 L1a_flush3_s2
s_nop 7
s_nop 7
v_mov_b32 v43, v115
s_nop 1
v_permlane32_swap_b32 v115, v43
s_nop 1
v_add_f32 v115, v115, v43
v_mov_b32 v43, v115
s_nop 1
v_permlane16_swap_b32 v115, v43
s_nop 1
v_add_f32 v115, v115, v43
s_nop 1
s_branch L1a_flush3_rcp
L1a_ffin3_slow:
s_nop 7
v_lshrrev_b32 v42, 4, v1
v_and_b32 v43, 15, v42
v_lshrrev_b32 v42, 4, v42
v_lshlrev_b32 v40, 4, v42
v_lshl_add_u32 v40, v43, 8, v40
v_lshlrev_b32 v41, 1, v43
v_lshl_add_u32 v41, v42, 10, v41
v_mov_b32 v42, 0xff800000
s_mov_b32 s3, 0x40000
s_mov_b32 s5, 0x80000
L1a_ffin3_s1:
Pv 224,40,16,3,0
Pv 228,40,16,3,64
Pv 232,40,16,3,128
Pv 236,40,16,3,192
s_waitcnt vmcnt(0)
Zvva 44,224,48
Mvva 44,228,52
Mvva 44,232,56
Mvva 44,236,60
s_nop 7
s_nop 1
v_max3_f32 v42, v42, v44, v45
v_max3_f32 v42, v42, v46, v47
s_add_u32 s3, s3, 4096
s_cmp_lg_u32 s3, s5
s_cbranch_scc1 L1a_ffin3_s1
v_mov_b32 v43, v42
s_nop 1
v_permlane32_swap_b32 v42, v43
s_nop 1
v_max_f32 v42, v42, v43
v_mov_b32 v43, v42
s_nop 1
v_permlane16_swap_b32 v42, v43
s_nop 1
v_max_f32 v42, v42, v43
v_mov_b64 v[224:225], 0
v_mov_b64 v[226:227], 0
v_mov_b64 v[228:229], 0
v_mov_b64 v[230:231], 0
v_mov_b64 v[232:233], 0
v_mov_b64 v[234:235], 0
v_mov_b64 v[236:237], 0
v_mov_b64 v[238:239], 0
v_mov_b64 v[240:241], 0
v_mov_b64 v[242:243], 0
v_mov_b64 v[244:245], 0
v_mov_b64 v[246:247], 0
v_mov_b64 v[248:249], 0
v_mov_b64 v[250:251], 0
v_mov_b64 v[252:253], 0
v_mov_b64 v[254:255], 0
v_mov_b32 v115, 0
s_mov_b32 s3, 0x40000
L1a_ffin3_s2:
s_add_u32 s4, s3, 4096
Pv 56,40,16,3,0
Pv 60,40,16,3,64
s_waitcnt vmcnt(0)
Zvva 44,56,48
Mvva 44,60,52
s_nop 3
Pv 56,40,16,3,128
Pv 60,40,16,3,192
s_waitcnt vmcnt(0)
Mvva 44,56,56
Mvva 44,60,60
s_nop 3
Pv 56,40,16,4,0
Pv 60,40,16,4,64
s_waitcnt vmcnt(0)
Zvva 48,56,48
Mvva 48,60,52
s_nop 3
Pv 56,40,16,4,128
Pv 60,40,16,4,192
s_waitcnt vmcnt(0)
Mvva 48,56,56
Mvva 48,60,60
s_nop 3
s_nop 7
s_nop 1
v_sub_f32 v44, v44, v42
v_sub_f32 v45, v45, v42
v_sub_f32 v46, v46, v42
v_sub_f32 v47, v47, v42
v_sub_f32 v48, v48, v42
v_sub_f32 v49, v49, v42
v_sub_f32 v50, v50, v42
v_sub_f32 v51, v51, v42
EX 44
EX 45
EX 46
EX 47
EX 48
EX 49
EX 50
EX 51
s_nop 1
AD 115,44
AD 115,45
AD 115,46
AD 115,47
AD 115,48
AD 115,49
AD 115,50
AD 115,51
CV 52,44
CV 53,46
CV 54,48
CV 55,50
buffer_load_ushort v44, v41, s[20:23], s3 offen offset:0
buffer_load_ushort v45, v41, s[20:23], s3 offen offset:256
buffer_load_ushort v46, v41, s[20:23], s3 offen offset:512
buffer_load_ushort v47, v41, s[20:23], s3 offen offset:768
buffer_load_ushort v48, v41, s[20:23], s4 offen offset:0
buffer_load_ushort v49, v41, s[20:23], s4 offen offset:256
buffer_load_ushort v50, v41, s[20:23], s4 offen offset:512
buffer_load_ushort v51, v41, s[20:23], s4 offen offset:768
s_waitcnt vmcnt(0)
v_lshl_or_b32 v56, v45, 16, v44
v_lshl_or_b32 v57, v47, 16, v46
v_lshl_or_b32 v58, v49, 16, v48
v_lshl_or_b32 v59, v51, 16, v50
s_nop 1
Mvvv 224,56,52
s_nop 3
buffer_load_ushort v44, v41, s[20:23], s3 offen offset:32
buffer_load_ushort v45, v41, s[20:23], s3 offen offset:288
buffer_load_ushort v46, v41, s[20:23], s3 offen offset:544
buffer_load_ushort v47, v41, s[20:23], s3 offen offset:800
buffer_load_ushort v48, v41, s[20:23], s4 offen offset:32
buffer_load_ushort v49, v41, s[20:23], s4 offen offset:288
buffer_load_ushort v50, v41, s[20:23], s4 offen offset:544
buffer_load_ushort v51, v41, s[20:23], s4 offen offset:800
s_waitcnt vmcnt(0)
v_lshl_or_b32 v56, v45, 16, v44
v_lshl_or_b32 v57, v47, 16, v46
v_lshl_or_b32 v58, v49, 16, v48
v_lshl_or_b32 v59, v51, 16, v50
s_nop 1
Mvvv 228,56,52
s_nop 3
buffer_load_ushort v44, v41, s[20:23], s3 offen offset:64
buffer_load_ushort v45, v41, s[20:23], s3 offen offset:320
buffer_load_ushort v46, v41, s[20:23], s3 offen offset:576
buffer_load_ushort v47, v41, s[20:23], s3 offen offset:832
buffer_load_ushort v48, v41, s[20:23], s4 offen offset:64
buffer_load_ushort v49, v41, s[20:23], s4 offen offset:320
buffer_load_ushort v50, v41, s[20:23], s4 offen offset:576
buffer_load_ushort v51, v41, s[20:23], s4 offen offset:832
s_waitcnt vmcnt(0)
v_lshl_or_b32 v56, v45, 16, v44
v_lshl_or_b32 v57, v47, 16, v46
v_lshl_or_b32 v58, v49, 16, v48
v_lshl_or_b32 v59, v51, 16, v50
s_nop 1
Mvvv 232,56,52
s_nop 3
buffer_load_ushort v44, v41, s[20:23], s3 offen offset:96
buffer_load_ushort v45, v41, s[20:23], s3 offen offset:352
buffer_load_ushort v46, v41, s[20:23], s3 offen offset:608
buffer_load_ushort v47, v41, s[20:23], s3 offen offset:864
buffer_load_ushort v48, v41, s[20:23], s4 offen offset:96
buffer_load_ushort v49, v41, s[20:23], s4 offen offset:352
buffer_load_ushort v50, v41, s[20:23], s4 offen offset:608
buffer_load_ushort v51, v41, s[20:23], s4 offen offset:864
s_waitcnt vmcnt(0)
v_lshl_or_b32 v56, v45, 16, v44
v_lshl_or_b32 v57, v47, 16, v46
v_lshl_or_b32 v58, v49, 16, v48
v_lshl_or_b32 v59, v51, 16, v50
s_nop 1
Mvvv 236,56,52
s_nop 3
buffer_load_ushort v44, v41, s[20:23], s3 offen offset:128
buffer_load_ushort v45, v41, s[20:23], s3 offen offset:384
buffer_load_ushort v46, v41, s[20:23], s3 offen offset:640
buffer_load_ushort v47, v41, s[20:23], s3 offen offset:896
buffer_load_ushort v48, v41, s[20:23], s4 offen offset:128
buffer_load_ushort v49, v41, s[20:23], s4 offen offset:384
buffer_load_ushort v50, v41, s[20:23], s4 offen offset:640
buffer_load_ushort v51, v41, s[20:23], s4 offen offset:896
s_waitcnt vmcnt(0)
v_lshl_or_b32 v56, v45, 16, v44
v_lshl_or_b32 v57, v47, 16, v46
v_lshl_or_b32 v58, v49, 16, v48
v_lshl_or_b32 v59, v51, 16, v50
s_nop 1
Mvvv 240,56,52
s_nop 3
buffer_load_ushort v44, v41, s[20:23], s3 offen offset:160
buffer_load_ushort v45, v41, s[20:23], s3 offen offset:416
buffer_load_ushort v46, v41, s[20:23], s3 offen offset:672
buffer_load_ushort v47, v41, s[20:23], s3 offen offset:928
buffer_load_ushort v48, v41, s[20:23], s4 offen offset:160
buffer_load_ushort v49, v41, s[20:23], s4 offen offset:416
buffer_load_ushort v50, v41, s[20:23], s4 offen offset:672
buffer_load_ushort v51, v41, s[20:23], s4 offen offset:928
s_waitcnt vmcnt(0)
v_lshl_or_b32 v56, v45, 16, v44
v_lshl_or_b32 v57, v47, 16, v46
v_lshl_or_b32 v58, v49, 16, v48
v_lshl_or_b32 v59, v51, 16, v50
s_nop 1
Mvvv 244,56,52
s_nop 3
buffer_load_ushort v44, v41, s[20:23], s3 offen offset:192
buffer_load_ushort v45, v41, s[20:23], s3 offen offset:448
buffer_load_ushort v46, v41, s[20:23], s3 offen offset:704
buffer_load_ushort v47, v41, s[20:23], s3 offen offset:960
buffer_load_ushort v48, v41, s[20:23], s4 offen offset:192
buffer_load_ushort v49, v41, s[20:23], s4 offen offset:448
buffer_load_ushort v50, v41, s[20:23], s4 offen offset:704
buffer_load_ushort v51, v41, s[20:23], s4 offen offset:960
s_waitcnt vmcnt(0)
v_lshl_or_b32 v56, v45, 16, v44
v_lshl_or_b32 v57, v47, 16, v46
v_lshl_or_b32 v58, v49, 16, v48
v_lshl_or_b32 v59, v51, 16, v50
s_nop 1
Mvvv 248,56,52
s_nop 3
buffer_load_ushort v44, v41, s[20:23], s3 offen offset:224
buffer_load_ushort v45, v41, s[20:23], s3 offen offset:480
buffer_load_ushort v46, v41, s[20:23], s3 offen offset:736
buffer_load_ushort v47, v41, s[20:23], s3 offen offset:992
buffer_load_ushort v48, v41, s[20:23], s4 offen offset:224
buffer_load_ushort v49, v41, s[20:23], s4 offen offset:480
buffer_load_ushort v50, v41, s[20:23], s4 offen offset:736
buffer_load_ushort v51, v41, s[20:23], s4 offen offset:992
s_waitcnt vmcnt(0)
v_lshl_or_b32 v56, v45, 16, v44
v_lshl_or_b32 v57, v47, 16, v46
v_lshl_or_b32 v58, v49, 16, v48
v_lshl_or_b32 v59, v51, 16, v50
s_nop 1
Mvvv 252,56,52
s_nop 3
s_add_u32 s3, s3, 8192
s_cmp_lg_u32 s3, s5
s_cbranch_scc1 L1a_ffin3_s2
s_nop 7
s_nop 7
v_mov_b32 v43, v115
s_nop 1
v_permlane32_swap_b32 v115, v43
s_nop 1
v_add_f32 v115, v115, v43
v_mov_b32 v43, v115
s_nop 1
v_permlane16_swap_b32 v115, v43
s_nop 1
v_add_f32 v115, v115, v43
s_nop 1
s_branch L1a_ffin3_rcp
L1b_flush0_slow:
s_nop 7
v_lshrrev_b32 v42, 4, v1
v_and_b32 v43, 15, v42
v_lshrrev_b32 v42, 4, v42
v_lshlrev_b32 v40, 4, v42
v_lshl_add_u32 v40, v43, 8, v40
v_lshlrev_b32 v41, 1, v43
v_lshl_add_u32 v41, v42, 10, v41
v_mov_b32 v42, 0xff800000
s_mov_b32 s3, 0x0
s_mov_b32 s5, 0x40000
L1b_flush0_s1:
Pv 128,40,16,3,0
Pv 132,40,16,3,64
Pv 136,40,16,3,128
Pv 140,40,16,3,192
s_waitcnt vmcnt(0)
Zvva 44,128,0
Mvva 44,132,4
Mvva 44,136,8
Mvva 44,140,12
s_nop 7
s_nop 1
v_max3_f32 v42, v42, v44, v45
v_max3_f32 v42, v42, v46, v47
s_add_u32 s3, s3, 4096
s_cmp_lg_u32 s3, s5
s_cbranch_scc1 L1b_flush0_s1
v_mov_b32 v43, v42
s_nop 1
v_permlane32_swap_b32 v42, v43
s_nop 1
v_max_f32 v42, v42, v43
v_mov_b32 v43, v42
s_nop 1
v_permlane16_swap_b32 v42, v43
s_nop 1
v_max_f32 v42, v42, v43
v_mov_b64 v[128:129], 0
v_mov_b64 v[130:131], 0
v_mov_b64 v[132:133], 0
v_mov_b64 v[134:135], 0
v_mov_b64 v[136:137], 0
v_mov_b64 v[138:139], 0
v_mov_b64 v[140:141], 0
v_mov_b64 v[142:143], 0
v_mov_b64 v[144:145], 0
v_mov_b64 v[146:147], 0
v_mov_b64 v[148:149], 0
v_mov_b64 v[150:151], 0
v_mov_b64 v[152:153], 0
v_mov_b64 v[154:155], 0
v_mov_b64 v[156:157], 0
v_mov_b64 v[158:159], 0
v_mov_b32 v112, 0
s_mov_b32 s3, 0x0
L1b_flush0_s2:
s_add_u32 s4, s3, 4096
Pv 56,40,16,3,0
Pv 60,40,16,3,64
s_waitcnt vmcnt(0)
Zvva 44,56,0
Mvva 44,60,4
s_nop 3
Pv 56,40,16,3,128
Pv 60,40,16,3,192
s_waitcnt vmcnt(0)
Mvva 44,56,8
Mvva 44,60,12
s_nop 3
Pv 56,40,16,4,0
Pv 60,40,16,4,64
s_waitcnt vmcnt(0)
Zvva 48,56,0
Mvva 48,60,4
s_nop 3
Pv 56,40,16,4,128
Pv 60,40,16,4,192
s_waitcnt vmcnt(0)
Mvva 48,56,8
Mvva 48,60,12
s_nop 3
s_nop 7
s_nop 1
v_sub_f32 v44, v44, v42
v_sub_f32 v45, v45, v42
v_sub_f32 v46, v46, v42
v_sub_f32 v47, v47, v42
v_sub_f32 v48, v48, v42
v_sub_f32 v49, v49, v42
v_sub_f32 v50, v50, v42
v_sub_f32 v51, v51, v42
EX 44
EX 45
EX 46
EX 47
EX 48
EX 49
EX 50
EX 51
s_nop 1
AD 112,44
AD 112,45
AD 112,46
AD 112,47
AD 112,48
AD 112,49
AD 112,50
AD 112,51
CV 52,44
CV 53,46
CV 54,48
CV 55,50
buffer_load_ushort v44, v41, s[20:23], s3 offen offset:0
buffer_load_ushort v45, v41, s[20:23], s3 offen offset:256
buffer_load_ushort v46, v41, s[20:23], s3 offen offset:512
buffer_load_ushort v47, v41, s[20:23], s3 offen offset:768
buffer_load_ushort v48, v41, s[20:23], s4 offen offset:0
buffer_load_ushort v49, v41, s[20:23], s4 offen offset:256
buffer_load_ushort v50, v41, s[20:23], s4 offen offset:512
buffer_load_ushort v51, v41, s[20:23], s4 offen offset:768
s_waitcnt vmcnt(0)
v_lshl_or_b32 v56, v45, 16, v44
v_lshl_or_b32 v57, v47, 16, v46
v_lshl_or_b32 v58, v49, 16, v48
v_lshl_or_b32 v59, v51, 16, v50
s_nop 1
Mvvv 128,56,52
s_nop 3
buffer_load_ushort v44, v41, s[20:23], s3 offen offset:32
buffer_load_ushort v45, v41, s[20:23], s3 offen offset:288
buffer_load_ushort v46, v41, s[20:23], s3 offen offset:544
buffer_load_ushort v47, v41, s[20:23], s3 offen offset:800
buffer_load_ushort v48, v41, s[20:23], s4 offen offset:32
buffer_load_ushort v49, v41, s[20:23], s4 offen offset:288
buffer_load_ushort v50, v41, s[20:23], s4 offen offset:544
buffer_load_ushort v51, v41, s[20:23], s4 offen offset:800
s_waitcnt vmcnt(0)
v_lshl_or_b32 v56, v45, 16, v44
v_lshl_or_b32 v57, v47, 16, v46
v_lshl_or_b32 v58, v49, 16, v48
v_lshl_or_b32 v59, v51, 16, v50
s_nop 1
Mvvv 132,56,52
s_nop 3
buffer_load_ushort v44, v41, s[20:23], s3 offen offset:64
buffer_load_ushort v45, v41, s[20:23], s3 offen offset:320
buffer_load_ushort v46, v41, s[20:23], s3 offen offset:576
buffer_load_ushort v47, v41, s[20:23], s3 offen offset:832
buffer_load_ushort v48, v41, s[20:23], s4 offen offset:64
buffer_load_ushort v49, v41, s[20:23], s4 offen offset:320
buffer_load_ushort v50, v41, s[20:23], s4 offen offset:576
buffer_load_ushort v51, v41, s[20:23], s4 offen offset:832
s_waitcnt vmcnt(0)
v_lshl_or_b32 v56, v45, 16, v44
v_lshl_or_b32 v57, v47, 16, v46
v_lshl_or_b32 v58, v49, 16, v48
v_lshl_or_b32 v59, v51, 16, v50
s_nop 1
Mvvv 136,56,52
s_nop 3
buffer_load_ushort v44, v41, s[20:23], s3 offen offset:96
buffer_load_ushort v45, v41, s[20:23], s3 offen offset:352
buffer_load_ushort v46, v41, s[20:23], s3 offen offset:608
buffer_load_ushort v47, v41, s[20:23], s3 offen offset:864
buffer_load_ushort v48, v41, s[20:23], s4 offen offset:96
buffer_load_ushort v49, v41, s[20:23], s4 offen offset:352
buffer_load_ushort v50, v41, s[20:23], s4 offen offset:608
buffer_load_ushort v51, v41, s[20:23], s4 offen offset:864
s_waitcnt vmcnt(0)
v_lshl_or_b32 v56, v45, 16, v44
v_lshl_or_b32 v57, v47, 16, v46
v_lshl_or_b32 v58, v49, 16, v48
v_lshl_or_b32 v59, v51, 16, v50
s_nop 1
Mvvv 140,56,52
s_nop 3
buffer_load_ushort v44, v41, s[20:23], s3 offen offset:128
buffer_load_ushort v45, v41, s[20:23], s3 offen offset:384
buffer_load_ushort v46, v41, s[20:23], s3 offen offset:640
buffer_load_ushort v47, v41, s[20:23], s3 offen offset:896
buffer_load_ushort v48, v41, s[20:23], s4 offen offset:128
buffer_load_ushort v49, v41, s[20:23], s4 offen offset:384
buffer_load_ushort v50, v41, s[20:23], s4 offen offset:640
buffer_load_ushort v51, v41, s[20:23], s4 offen offset:896
s_waitcnt vmcnt(0)
v_lshl_or_b32 v56, v45, 16, v44
v_lshl_or_b32 v57, v47, 16, v46
v_lshl_or_b32 v58, v49, 16, v48
v_lshl_or_b32 v59, v51, 16, v50
s_nop 1
Mvvv 144,56,52
s_nop 3
buffer_load_ushort v44, v41, s[20:23], s3 offen offset:160
buffer_load_ushort v45, v41, s[20:23], s3 offen offset:416
buffer_load_ushort v46, v41, s[20:23], s3 offen offset:672
buffer_load_ushort v47, v41, s[20:23], s3 offen offset:928
buffer_load_ushort v48, v41, s[20:23], s4 offen offset:160
buffer_load_ushort v49, v41, s[20:23], s4 offen offset:416
buffer_load_ushort v50, v41, s[20:23], s4 offen offset:672
buffer_load_ushort v51, v41, s[20:23], s4 offen offset:928
s_waitcnt vmcnt(0)
v_lshl_or_b32 v56, v45, 16, v44
v_lshl_or_b32 v57, v47, 16, v46
v_lshl_or_b32 v58, v49, 16, v48
v_lshl_or_b32 v59, v51, 16, v50
s_nop 1
Mvvv 148,56,52
s_nop 3
buffer_load_ushort v44, v41, s[20:23], s3 offen offset:192
buffer_load_ushort v45, v41, s[20:23], s3 offen offset:448
buffer_load_ushort v46, v41, s[20:23], s3 offen offset:704
buffer_load_ushort v47, v41, s[20:23], s3 offen offset:960
buffer_load_ushort v48, v41, s[20:23], s4 offen offset:192
buffer_load_ushort v49, v41, s[20:23], s4 offen offset:448
buffer_load_ushort v50, v41, s[20:23], s4 offen offset:704
buffer_load_ushort v51, v41, s[20:23], s4 offen offset:960
s_waitcnt vmcnt(0)
v_lshl_or_b32 v56, v45, 16, v44
v_lshl_or_b32 v57, v47, 16, v46
v_lshl_or_b32 v58, v49, 16, v48
v_lshl_or_b32 v59, v51, 16, v50
s_nop 1
Mvvv 152,56,52
s_nop 3
buffer_load_ushort v44, v41, s[20:23], s3 offen offset:224
buffer_load_ushort v45, v41, s[20:23], s3 offen offset:480
buffer_load_ushort v46, v41, s[20:23], s3 offen offset:736
buffer_load_ushort v47, v41, s[20:23], s3 offen offset:992
buffer_load_ushort v48, v41, s[20:23], s4 offen offset:224
buffer_load_ushort v49, v41, s[20:23], s4 offen offset:480
buffer_load_ushort v50, v41, s[20:23], s4 offen offset:736
buffer_load_ushort v51, v41, s[20:23], s4 offen offset:992
s_waitcnt vmcnt(0)
v_lshl_or_b32 v56, v45, 16, v44
v_lshl_or_b32 v57, v47, 16, v46
v_lshl_or_b32 v58, v49, 16, v48
v_lshl_or_b32 v59, v51, 16, v50
s_nop 1
Mvvv 156,56,52
s_nop 3
s_add_u32 s3, s3, 8192
s_cmp_lg_u32 s3, s5
s_cbranch_scc1 L1b_flush0_s2
s_nop 7
s_nop 7
v_mov_b32 v43, v112
s_nop 1
v_permlane32_swap_b32 v112, v43
s_nop 1
v_add_f32 v112, v112, v43
v_mov_b32 v43, v112
s_nop 1
v_permlane16_swap_b32 v112, v43
s_nop 1
v_add_f32 v112, v112, v43
s_nop 1
s_branch L1b_flush0_rcp
L1b_ffin0_slow:
s_nop 7
v_lshrrev_b32 v42, 4, v1
v_and_b32 v43, 15, v42
v_lshrrev_b32 v42, 4, v42
v_lshlrev_b32 v40, 4, v42
v_lshl_add_u32 v40, v43, 8, v40
v_lshlrev_b32 v41, 1, v43
v_lshl_add_u32 v41, v42, 10, v41
v_mov_b32 v42, 0xff800000
s_mov_b32 s3, 0x40000
s_mov_b32 s5, 0x80000
L1b_ffin0_s1:
Pv 128,40,16,3,0
Pv 132,40,16,3,64
Pv 136,40,16,3,128
Pv 140,40,16,3,192
s_waitcnt vmcnt(0)
Zvva 44,128,0
Mvva 44,132,4
Mvva 44,136,8
Mvva 44,140,12
s_nop 7
s_nop 1
v_max3_f32 v42, v42, v44, v45
v_max3_f32 v42, v42, v46, v47
s_add_u32 s3, s3, 4096
s_cmp_lg_u32 s3, s5
s_cbranch_scc1 L1b_ffin0_s1
v_mov_b32 v43, v42
s_nop 1
v_permlane32_swap_b32 v42, v43
s_nop 1
v_max_f32 v42, v42, v43
v_mov_b32 v43, v42
s_nop 1
v_permlane16_swap_b32 v42, v43
s_nop 1
v_max_f32 v42, v42, v43
v_mov_b64 v[128:129], 0
v_mov_b64 v[130:131], 0
v_mov_b64 v[132:133], 0
v_mov_b64 v[134:135], 0
v_mov_b64 v[136:137], 0
v_mov_b64 v[138:139], 0
v_mov_b64 v[140:141], 0
v_mov_b64 v[142:143], 0
v_mov_b64 v[144:145], 0
v_mov_b64 v[146:147], 0
v_mov_b64 v[148:149], 0
v_mov_b64 v[150:151], 0
v_mov_b64 v[152:153], 0
v_mov_b64 v[154:155], 0
v_mov_b64 v[156:157], 0
v_mov_b64 v[158:159], 0
v_mov_b32 v112, 0
s_mov_b32 s3, 0x40000
L1b_ffin0_s2:
s_add_u32 s4, s3, 4096
Pv 56,40,16,3,0
Pv 60,40,16,3,64
s_waitcnt vmcnt(0)
Zvva 44,56,0
Mvva 44,60,4
s_nop 3
Pv 56,40,16,3,128
Pv 60,40,16,3,192
s_waitcnt vmcnt(0)
Mvva 44,56,8
Mvva 44,60,12
s_nop 3
Pv 56,40,16,4,0
Pv 60,40,16,4,64
s_waitcnt vmcnt(0)
Zvva 48,56,0
Mvva 48,60,4
s_nop 3
Pv 56,40,16,4,128
Pv 60,40,16,4,192
s_waitcnt vmcnt(0)
Mvva 48,56,8
Mvva 48,60,12
s_nop 3
s_nop 7
s_nop 1
v_sub_f32 v44, v44, v42
v_sub_f32 v45, v45, v42
v_sub_f32 v46, v46, v42
v_sub_f32 v47, v47, v42
v_sub_f32 v48, v48, v42
v_sub_f32 v49, v49, v42
v_sub_f32 v50, v50, v42
v_sub_f32 v51, v51, v42
EX 44
EX 45
EX 46
EX 47
EX 48
EX 49
EX 50
EX 51
s_nop 1
AD 112,44
AD 112,45
AD 112,46
AD 112,47
AD 112,48
AD 112,49
AD 112,50
AD 112,51
CV 52,44
CV 53,46
CV 54,48
CV 55,50
buffer_load_ushort v44, v41, s[20:23], s3 offen offset:0
buffer_load_ushort v45, v41, s[20:23], s3 offen offset:256
buffer_load_ushort v46, v41, s[20:23], s3 offen offset:512
buffer_load_ushort v47, v41, s[20:23], s3 offen offset:768
buffer_load_ushort v48, v41, s[20:23], s4 offen offset:0
buffer_load_ushort v49, v41, s[20:23], s4 offen offset:256
buffer_load_ushort v50, v41, s[20:23], s4 offen offset:512
buffer_load_ushort v51, v41, s[20:23], s4 offen offset:768
s_waitcnt vmcnt(0)
v_lshl_or_b32 v56, v45, 16, v44
v_lshl_or_b32 v57, v47, 16, v46
v_lshl_or_b32 v58, v49, 16, v48
v_lshl_or_b32 v59, v51, 16, v50
s_nop 1
Mvvv 128,56,52
s_nop 3
buffer_load_ushort v44, v41, s[20:23], s3 offen offset:32
buffer_load_ushort v45, v41, s[20:23], s3 offen offset:288
buffer_load_ushort v46, v41, s[20:23], s3 offen offset:544
buffer_load_ushort v47, v41, s[20:23], s3 offen offset:800
buffer_load_ushort v48, v41, s[20:23], s4 offen offset:32
buffer_load_ushort v49, v41, s[20:23], s4 offen offset:288
buffer_load_ushort v50, v41, s[20:23], s4 offen offset:544
buffer_load_ushort v51, v41, s[20:23], s4 offen offset:800
s_waitcnt vmcnt(0)
v_lshl_or_b32 v56, v45, 16, v44
v_lshl_or_b32 v57, v47, 16, v46
v_lshl_or_b32 v58, v49, 16, v48
v_lshl_or_b32 v59, v51, 16, v50
s_nop 1
Mvvv 132,56,52
s_nop 3
buffer_load_ushort v44, v41, s[20:23], s3 offen offset:64
buffer_load_ushort v45, v41, s[20:23], s3 offen offset:320
buffer_load_ushort v46, v41, s[20:23], s3 offen offset:576
buffer_load_ushort v47, v41, s[20:23], s3 offen offset:832
buffer_load_ushort v48, v41, s[20:23], s4 offen offset:64
buffer_load_ushort v49, v41, s[20:23], s4 offen offset:320
buffer_load_ushort v50, v41, s[20:23], s4 offen offset:576
buffer_load_ushort v51, v41, s[20:23], s4 offen offset:832
s_waitcnt vmcnt(0)
v_lshl_or_b32 v56, v45, 16, v44
v_lshl_or_b32 v57, v47, 16, v46
v_lshl_or_b32 v58, v49, 16, v48
v_lshl_or_b32 v59, v51, 16, v50
s_nop 1
Mvvv 136,56,52
s_nop 3
buffer_load_ushort v44, v41, s[20:23], s3 offen offset:96
buffer_load_ushort v45, v41, s[20:23], s3 offen offset:352
buffer_load_ushort v46, v41, s[20:23], s3 offen offset:608
buffer_load_ushort v47, v41, s[20:23], s3 offen offset:864
buffer_load_ushort v48, v41, s[20:23], s4 offen offset:96
buffer_load_ushort v49, v41, s[20:23], s4 offen offset:352
buffer_load_ushort v50, v41, s[20:23], s4 offen offset:608
buffer_load_ushort v51, v41, s[20:23], s4 offen offset:864
s_waitcnt vmcnt(0)
v_lshl_or_b32 v56, v45, 16, v44
v_lshl_or_b32 v57, v47, 16, v46
v_lshl_or_b32 v58, v49, 16, v48
v_lshl_or_b32 v59, v51, 16, v50
s_nop 1
Mvvv 140,56,52
s_nop 3
buffer_load_ushort v44, v41, s[20:23], s3 offen offset:128
buffer_load_ushort v45, v41, s[20:23], s3 offen offset:384
buffer_load_ushort v46, v41, s[20:23], s3 offen offset:640
buffer_load_ushort v47, v41, s[20:23], s3 offen offset:896
buffer_load_ushort v48, v41, s[20:23], s4 offen offset:128
buffer_load_ushort v49, v41, s[20:23], s4 offen offset:384
buffer_load_ushort v50, v41, s[20:23], s4 offen offset:640
buffer_load_ushort v51, v41, s[20:23], s4 offen offset:896
s_waitcnt vmcnt(0)
v_lshl_or_b32 v56, v45, 16, v44
v_lshl_or_b32 v57, v47, 16, v46
v_lshl_or_b32 v58, v49, 16, v48
v_lshl_or_b32 v59, v51, 16, v50
s_nop 1
Mvvv 144,56,52
s_nop 3
buffer_load_ushort v44, v41, s[20:23], s3 offen offset:160
buffer_load_ushort v45, v41, s[20:23], s3 offen offset:416
buffer_load_ushort v46, v41, s[20:23], s3 offen offset:672
buffer_load_ushort v47, v41, s[20:23], s3 offen offset:928
buffer_load_ushort v48, v41, s[20:23], s4 offen offset:160
buffer_load_ushort v49, v41, s[20:23], s4 offen offset:416
buffer_load_ushort v50, v41, s[20:23], s4 offen offset:672
buffer_load_ushort v51, v41, s[20:23], s4 offen offset:928
s_waitcnt vmcnt(0)
v_lshl_or_b32 v56, v45, 16, v44
v_lshl_or_b32 v57, v47, 16, v46
v_lshl_or_b32 v58, v49, 16, v48
v_lshl_or_b32 v59, v51, 16, v50
s_nop 1
Mvvv 148,56,52
s_nop 3
buffer_load_ushort v44, v41, s[20:23], s3 offen offset:192
buffer_load_ushort v45, v41, s[20:23], s3 offen offset:448
buffer_load_ushort v46, v41, s[20:23], s3 offen offset:704
buffer_load_ushort v47, v41, s[20:23], s3 offen offset:960
buffer_load_ushort v48, v41, s[20:23], s4 offen offset:192
buffer_load_ushort v49, v41, s[20:23], s4 offen offset:448
buffer_load_ushort v50, v41, s[20:23], s4 offen offset:704
buffer_load_ushort v51, v41, s[20:23], s4 offen offset:960
s_waitcnt vmcnt(0)
v_lshl_or_b32 v56, v45, 16, v44
v_lshl_or_b32 v57, v47, 16, v46
v_lshl_or_b32 v58, v49, 16, v48
v_lshl_or_b32 v59, v51, 16, v50
s_nop 1
Mvvv 152,56,52
s_nop 3
buffer_load_ushort v44, v41, s[20:23], s3 offen offset:224
buffer_load_ushort v45, v41, s[20:23], s3 offen offset:480
buffer_load_ushort v46, v41, s[20:23], s3 offen offset:736
buffer_load_ushort v47, v41, s[20:23], s3 offen offset:992
buffer_load_ushort v48, v41, s[20:23], s4 offen offset:224
buffer_load_ushort v49, v41, s[20:23], s4 offen offset:480
buffer_load_ushort v50, v41, s[20:23], s4 offen offset:736
buffer_load_ushort v51, v41, s[20:23], s4 offen offset:992
s_waitcnt vmcnt(0)
v_lshl_or_b32 v56, v45, 16, v44
v_lshl_or_b32 v57, v47, 16, v46
v_lshl_or_b32 v58, v49, 16, v48
v_lshl_or_b32 v59, v51, 16, v50
s_nop 1
Mvvv 156,56,52
s_nop 3
s_add_u32 s3, s3, 8192
s_cmp_lg_u32 s3, s5
s_cbranch_scc1 L1b_ffin0_s2
s_nop 7
s_nop 7
v_mov_b32 v43, v112
s_nop 1
v_permlane32_swap_b32 v112, v43
s_nop 1
v_add_f32 v112, v112, v43
v_mov_b32 v43, v112
s_nop 1
v_permlane16_swap_b32 v112, v43
s_nop 1
v_add_f32 v112, v112, v43
s_nop 1
s_branch L1b_ffin0_rcp
L1b_flush1_slow:
s_nop 7
v_lshrrev_b32 v42, 4, v1
v_and_b32 v43, 15, v42
v_lshrrev_b32 v42, 4, v42
v_lshlrev_b32 v40, 4, v42
v_lshl_add_u32 v40, v43, 8, v40
v_lshlrev_b32 v41, 1, v43
v_lshl_add_u32 v41, v42, 10, v41
v_mov_b32 v42, 0xff800000
s_mov_b32 s3, 0x0
s_mov_b32 s5, 0x40000
L1b_flush1_s1:
Pv 160,40,16,3,0
Pv 164,40,16,3,64
Pv 168,40,16,3,128
Pv 172,40,16,3,192
s_waitcnt vmcnt(0)
Zvva 44,160,16
Mvva 44,164,20
Mvva 44,168,24
Mvva 44,172,28
s_nop 7
s_nop 1
v_max3_f32 v42, v42, v44, v45
v_max3_f32 v42, v42, v46, v47
s_add_u32 s3, s3, 4096
s_cmp_lg_u32 s3, s5
s_cbranch_scc1 L1b_flush1_s1
v_mov_b32 v43, v42
s_nop 1
v_permlane32_swap_b32 v42, v43
s_nop 1
v_max_f32 v42, v42, v43
v_mov_b32 v43, v42
s_nop 1
v_permlane16_swap_b32 v42, v43
s_nop 1
v_max_f32 v42, v42, v43
v_mov_b64 v[160:161], 0
v_mov_b64 v[162:163], 0
v_mov_b64 v[164:165], 0
v_mov_b64 v[166:167], 0
v_mov_b64 v[168:169], 0
v_mov_b64 v[170:171], 0
v_mov_b64 v[172:173], 0
v_mov_b64 v[174:175], 0
v_mov_b64 v[176:177], 0
v_mov_b64 v[178:179], 0
v_mov_b64 v[180:181], 0
v_mov_b64 v[182:183], 0
v_mov_b64 v[184:185], 0
v_mov_b64 v[186:187], 0
v_mov_b64 v[188:189], 0
v_mov_b64 v[190:191], 0
v_mov_b32 v113, 0
s_mov_b32 s3, 0x0
L1b_flush1_s2:
s_add_u32 s4, s3, 4096
Pv 56,40,16,3,0
Pv 60,40,16,3,64
s_waitcnt vmcnt(0)
Zvva 44,56,16
Mvva 44,60,20
s_nop 3
Pv 56,40,16,3,128
Pv 60,40,16,3,192
s_waitcnt vmcnt(0)
Mvva 44,56,24
Mvva 44,60,28
s_nop 3
Pv 56,40,16,4,0
Pv 60,40,16,4,64
s_waitcnt vmcnt(0)
Zvva 48,56,16
Mvva 48,60,20
s_nop 3
Pv 56,40,16,4,128
Pv 60,40,16,4,192
s_waitcnt vmcnt(0)
Mvva 48,56,24
Mvva 48,60,28
s_nop 3
s_nop 7
s_nop 1
v_sub_f32 v44, v44, v42
v_sub_f32 v45, v45, v42
v_sub_f32 v46, v46, v42
v_sub_f32 v47, v47, v42
v_sub_f32 v48, v48, v42
v_sub_f32 v49, v49, v42
v_sub_f32 v50, v50, v42
v_sub_f32 v51, v51, v42
EX 44
EX 45
EX 46
EX 47
EX 48
EX 49
EX 50
EX 51
s_nop 1
AD 113,44
AD 113,45
AD 113,46
AD 113,47
AD 113,48
AD 113,49
AD 113,50
AD 113,51
CV 52,44
CV 53,46
CV 54,48
CV 55,50
buffer_load_ushort v44, v41, s[20:23], s3 offen offset:0
buffer_load_ushort v45, v41, s[20:23], s3 offen offset:256
buffer_load_ushort v46, v41, s[20:23], s3 offen offset:512
buffer_load_ushort v47, v41, s[20:23], s3 offen offset:768
buffer_load_ushort v48, v41, s[20:23], s4 offen offset:0
buffer_load_ushort v49, v41, s[20:23], s4 offen offset:256
buffer_load_ushort v50, v41, s[20:23], s4 offen offset:512
buffer_load_ushort v51, v41, s[20:23], s4 offen offset:768
s_waitcnt vmcnt(0)
v_lshl_or_b32 v56, v45, 16, v44
v_lshl_or_b32 v57, v47, 16, v46
v_lshl_or_b32 v58, v49, 16, v48
v_lshl_or_b32 v59, v51, 16, v50
s_nop 1
Mvvv 160,56,52
s_nop 3
buffer_load_ushort v44, v41, s[20:23], s3 offen offset:32
buffer_load_ushort v45, v41, s[20:23], s3 offen offset:288
buffer_load_ushort v46, v41, s[20:23], s3 offen offset:544
buffer_load_ushort v47, v41, s[20:23], s3 offen offset:800
buffer_load_ushort v48, v41, s[20:23], s4 offen offset:32
buffer_load_ushort v49, v41, s[20:23], s4 offen offset:288
buffer_load_ushort v50, v41, s[20:23], s4 offen offset:544
buffer_load_ushort v51, v41, s[20:23], s4 offen offset:800
s_waitcnt vmcnt(0)
v_lshl_or_b32 v56, v45, 16, v44
v_lshl_or_b32 v57, v47, 16, v46
v_lshl_or_b32 v58, v49, 16, v48
v_lshl_or_b32 v59, v51, 16, v50
s_nop 1
Mvvv 164,56,52
s_nop 3
buffer_load_ushort v44, v41, s[20:23], s3 offen offset:64
buffer_load_ushort v45, v41, s[20:23], s3 offen offset:320
buffer_load_ushort v46, v41, s[20:23], s3 offen offset:576
buffer_load_ushort v47, v41, s[20:23], s3 offen offset:832
buffer_load_ushort v48, v41, s[20:23], s4 offen offset:64
buffer_load_ushort v49, v41, s[20:23], s4 offen offset:320
buffer_load_ushort v50, v41, s[20:23], s4 offen offset:576
buffer_load_ushort v51, v41, s[20:23], s4 offen offset:832
s_waitcnt vmcnt(0)
v_lshl_or_b32 v56, v45, 16, v44
v_lshl_or_b32 v57, v47, 16, v46
v_lshl_or_b32 v58, v49, 16, v48
v_lshl_or_b32 v59, v51, 16, v50
s_nop 1
Mvvv 168,56,52
s_nop 3
buffer_load_ushort v44, v41, s[20:23], s3 offen offset:96
buffer_load_ushort v45, v41, s[20:23], s3 offen offset:352
buffer_load_ushort v46, v41, s[20:23], s3 offen offset:608
buffer_load_ushort v47, v41, s[20:23], s3 offen offset:864
buffer_load_ushort v48, v41, s[20:23], s4 offen offset:96
buffer_load_ushort v49, v41, s[20:23], s4 offen offset:352
buffer_load_ushort v50, v41, s[20:23], s4 offen offset:608
buffer_load_ushort v51, v41, s[20:23], s4 offen offset:864
s_waitcnt vmcnt(0)
v_lshl_or_b32 v56, v45, 16, v44
v_lshl_or_b32 v57, v47, 16, v46
v_lshl_or_b32 v58, v49, 16, v48
v_lshl_or_b32 v59, v51, 16, v50
s_nop 1
Mvvv 172,56,52
s_nop 3
buffer_load_ushort v44, v41, s[20:23], s3 offen offset:128
buffer_load_ushort v45, v41, s[20:23], s3 offen offset:384
buffer_load_ushort v46, v41, s[20:23], s3 offen offset:640
buffer_load_ushort v47, v41, s[20:23], s3 offen offset:896
buffer_load_ushort v48, v41, s[20:23], s4 offen offset:128
buffer_load_ushort v49, v41, s[20:23], s4 offen offset:384
buffer_load_ushort v50, v41, s[20:23], s4 offen offset:640
buffer_load_ushort v51, v41, s[20:23], s4 offen offset:896
s_waitcnt vmcnt(0)
v_lshl_or_b32 v56, v45, 16, v44
v_lshl_or_b32 v57, v47, 16, v46
v_lshl_or_b32 v58, v49, 16, v48
v_lshl_or_b32 v59, v51, 16, v50
s_nop 1
Mvvv 176,56,52
s_nop 3
buffer_load_ushort v44, v41, s[20:23], s3 offen offset:160
buffer_load_ushort v45, v41, s[20:23], s3 offen offset:416
buffer_load_ushort v46, v41, s[20:23], s3 offen offset:672
buffer_load_ushort v47, v41, s[20:23], s3 offen offset:928
buffer_load_ushort v48, v41, s[20:23], s4 offen offset:160
buffer_load_ushort v49, v41, s[20:23], s4 offen offset:416
buffer_load_ushort v50, v41, s[20:23], s4 offen offset:672
buffer_load_ushort v51, v41, s[20:23], s4 offen offset:928
s_waitcnt vmcnt(0)
v_lshl_or_b32 v56, v45, 16, v44
v_lshl_or_b32 v57, v47, 16, v46
v_lshl_or_b32 v58, v49, 16, v48
v_lshl_or_b32 v59, v51, 16, v50
s_nop 1
Mvvv 180,56,52
s_nop 3
buffer_load_ushort v44, v41, s[20:23], s3 offen offset:192
buffer_load_ushort v45, v41, s[20:23], s3 offen offset:448
buffer_load_ushort v46, v41, s[20:23], s3 offen offset:704
buffer_load_ushort v47, v41, s[20:23], s3 offen offset:960
buffer_load_ushort v48, v41, s[20:23], s4 offen offset:192
buffer_load_ushort v49, v41, s[20:23], s4 offen offset:448
buffer_load_ushort v50, v41, s[20:23], s4 offen offset:704
buffer_load_ushort v51, v41, s[20:23], s4 offen offset:960
s_waitcnt vmcnt(0)
v_lshl_or_b32 v56, v45, 16, v44
v_lshl_or_b32 v57, v47, 16, v46
v_lshl_or_b32 v58, v49, 16, v48
v_lshl_or_b32 v59, v51, 16, v50
s_nop 1
Mvvv 184,56,52
s_nop 3
buffer_load_ushort v44, v41, s[20:23], s3 offen offset:224
buffer_load_ushort v45, v41, s[20:23], s3 offen offset:480
buffer_load_ushort v46, v41, s[20:23], s3 offen offset:736
buffer_load_ushort v47, v41, s[20:23], s3 offen offset:992
buffer_load_ushort v48, v41, s[20:23], s4 offen offset:224
buffer_load_ushort v49, v41, s[20:23], s4 offen offset:480
buffer_load_ushort v50, v41, s[20:23], s4 offen offset:736
buffer_load_ushort v51, v41, s[20:23], s4 offen offset:992
s_waitcnt vmcnt(0)
v_lshl_or_b32 v56, v45, 16, v44
v_lshl_or_b32 v57, v47, 16, v46
v_lshl_or_b32 v58, v49, 16, v48
v_lshl_or_b32 v59, v51, 16, v50
s_nop 1
Mvvv 188,56,52
s_nop 3
s_add_u32 s3, s3, 8192
s_cmp_lg_u32 s3, s5
s_cbranch_scc1 L1b_flush1_s2
s_nop 7
s_nop 7
v_mov_b32 v43, v113
s_nop 1
v_permlane32_swap_b32 v113, v43
s_nop 1
v_add_f32 v113, v113, v43
v_mov_b32 v43, v113
s_nop 1
v_permlane16_swap_b32 v113, v43
s_nop 1
v_add_f32 v113, v113, v43
s_nop 1
s_branch L1b_flush1_rcp
L1b_ffin1_slow:
s_nop 7
v_lshrrev_b32 v42, 4, v1
v_and_b32 v43, 15, v42
v_lshrrev_b32 v42, 4, v42
v_lshlrev_b32 v40, 4, v42
v_lshl_add_u32 v40, v43, 8, v40
v_lshlrev_b32 v41, 1, v43
v_lshl_add_u32 v41, v42, 10, v41
v_mov_b32 v42, 0xff800000
s_mov_b32 s3, 0x40000
s_mov_b32 s5, 0x80000
L1b_ffin1_s1:
Pv 160,40,16,3,0
Pv 164,40,16,3,64
Pv 168,40,16,3,128
Pv 172,40,16,3,192
s_waitcnt vmcnt(0)
Zvva 44,160,16
Mvva 44,164,20
Mvva 44,168,24
Mvva 44,172,28
s_nop 7
s_nop 1
v_max3_f32 v42, v42, v44, v45
v_max3_f32 v42, v42, v46, v47
s_add_u32 s3, s3, 4096
s_cmp_lg_u32 s3, s5
s_cbranch_scc1 L1b_ffin1_s1
v_mov_b32 v43, v42
s_nop 1
v_permlane32_swap_b32 v42, v43
s_nop 1
v_max_f32 v42, v42, v43
v_mov_b32 v43, v42
s_nop 1
v_permlane16_swap_b32 v42, v43
s_nop 1
v_max_f32 v42, v42, v43
v_mov_b64 v[160:161], 0
v_mov_b64 v[162:163], 0
v_mov_b64 v[164:165], 0
v_mov_b64 v[166:167], 0
v_mov_b64 v[168:169], 0
v_mov_b64 v[170:171], 0
v_mov_b64 v[172:173], 0
v_mov_b64 v[174:175], 0
v_mov_b64 v[176:177], 0
v_mov_b64 v[178:179], 0
v_mov_b64 v[180:181], 0
v_mov_b64 v[182:183], 0
v_mov_b64 v[184:185], 0
v_mov_b64 v[186:187], 0
v_mov_b64 v[188:189], 0
v_mov_b64 v[190:191], 0
v_mov_b32 v113, 0
s_mov_b32 s3, 0x40000
L1b_ffin1_s2:
s_add_u32 s4, s3, 4096
Pv 56,40,16,3,0
Pv 60,40,16,3,64
s_waitcnt vmcnt(0)
Zvva 44,56,16
Mvva 44,60,20
s_nop 3
Pv 56,40,16,3,128
Pv 60,40,16,3,192
s_waitcnt vmcnt(0)
Mvva 44,56,24
Mvva 44,60,28
s_nop 3
Pv 56,40,16,4,0
Pv 60,40,16,4,64
s_waitcnt vmcnt(0)
Zvva 48,56,16
Mvva 48,60,20
s_nop 3
Pv 56,40,16,4,128
Pv 60,40,16,4,192
s_waitcnt vmcnt(0)
Mvva 48,56,24
Mvva 48,60,28
s_nop 3
s_nop 7
s_nop 1
v_sub_f32 v44, v44, v42
v_sub_f32 v45, v45, v42
v_sub_f32 v46, v46, v42
v_sub_f32 v47, v47, v42
v_sub_f32 v48, v48, v42
v_sub_f32 v49, v49, v42
v_sub_f32 v50, v50, v42
v_sub_f32 v51, v51, v42
EX 44
EX 45
EX 46
EX 47
EX 48
EX 49
EX 50
EX 51
s_nop 1
AD 113,44
AD 113,45
AD 113,46
AD 113,47
AD 113,48
AD 113,49
AD 113,50
AD 113,51
CV 52,44
CV 53,46
CV 54,48
CV 55,50
buffer_load_ushort v44, v41, s[20:23], s3 offen offset:0
buffer_load_ushort v45, v41, s[20:23], s3 offen offset:256
buffer_load_ushort v46, v41, s[20:23], s3 offen offset:512
buffer_load_ushort v47, v41, s[20:23], s3 offen offset:768
buffer_load_ushort v48, v41, s[20:23], s4 offen offset:0
buffer_load_ushort v49, v41, s[20:23], s4 offen offset:256
buffer_load_ushort v50, v41, s[20:23], s4 offen offset:512
buffer_load_ushort v51, v41, s[20:23], s4 offen offset:768
s_waitcnt vmcnt(0)
v_lshl_or_b32 v56, v45, 16, v44
v_lshl_or_b32 v57, v47, 16, v46
v_lshl_or_b32 v58, v49, 16, v48
v_lshl_or_b32 v59, v51, 16, v50
s_nop 1
Mvvv 160,56,52
s_nop 3
buffer_load_ushort v44, v41, s[20:23], s3 offen offset:32
buffer_load_ushort v45, v41, s[20:23], s3 offen offset:288
buffer_load_ushort v46, v41, s[20:23], s3 offen offset:544
buffer_load_ushort v47, v41, s[20:23], s3 offen offset:800
buffer_load_ushort v48, v41, s[20:23], s4 offen offset:32
buffer_load_ushort v49, v41, s[20:23], s4 offen offset:288
buffer_load_ushort v50, v41, s[20:23], s4 offen offset:544
buffer_load_ushort v51, v41, s[20:23], s4 offen offset:800
s_waitcnt vmcnt(0)
v_lshl_or_b32 v56, v45, 16, v44
v_lshl_or_b32 v57, v47, 16, v46
v_lshl_or_b32 v58, v49, 16, v48
v_lshl_or_b32 v59, v51, 16, v50
s_nop 1
Mvvv 164,56,52
s_nop 3
buffer_load_ushort v44, v41, s[20:23], s3 offen offset:64
buffer_load_ushort v45, v41, s[20:23], s3 offen offset:320
buffer_load_ushort v46, v41, s[20:23], s3 offen offset:576
buffer_load_ushort v47, v41, s[20:23], s3 offen offset:832
buffer_load_ushort v48, v41, s[20:23], s4 offen offset:64
buffer_load_ushort v49, v41, s[20:23], s4 offen offset:320
buffer_load_ushort v50, v41, s[20:23], s4 offen offset:576
buffer_load_ushort v51, v41, s[20:23], s4 offen offset:832
s_waitcnt vmcnt(0)
v_lshl_or_b32 v56, v45, 16, v44
v_lshl_or_b32 v57, v47, 16, v46
v_lshl_or_b32 v58, v49, 16, v48
v_lshl_or_b32 v59, v51, 16, v50
s_nop 1
Mvvv 168,56,52
s_nop 3
buffer_load_ushort v44, v41, s[20:23], s3 offen offset:96
buffer_load_ushort v45, v41, s[20:23], s3 offen offset:352
buffer_load_ushort v46, v41, s[20:23], s3 offen offset:608
buffer_load_ushort v47, v41, s[20:23], s3 offen offset:864
buffer_load_ushort v48, v41, s[20:23], s4 offen offset:96
buffer_load_ushort v49, v41, s[20:23], s4 offen offset:352
buffer_load_ushort v50, v41, s[20:23], s4 offen offset:608
buffer_load_ushort v51, v41, s[20:23], s4 offen offset:864
s_waitcnt vmcnt(0)
v_lshl_or_b32 v56, v45, 16, v44
v_lshl_or_b32 v57, v47, 16, v46
v_lshl_or_b32 v58, v49, 16, v48
v_lshl_or_b32 v59, v51, 16, v50
s_nop 1
Mvvv 172,56,52
s_nop 3
buffer_load_ushort v44, v41, s[20:23], s3 offen offset:128
buffer_load_ushort v45, v41, s[20:23], s3 offen offset:384
buffer_load_ushort v46, v41, s[20:23], s3 offen offset:640
buffer_load_ushort v47, v41, s[20:23], s3 offen offset:896
buffer_load_ushort v48, v41, s[20:23], s4 offen offset:128
buffer_load_ushort v49, v41, s[20:23], s4 offen offset:384
buffer_load_ushort v50, v41, s[20:23], s4 offen offset:640
buffer_load_ushort v51, v41, s[20:23], s4 offen offset:896
s_waitcnt vmcnt(0)
v_lshl_or_b32 v56, v45, 16, v44
v_lshl_or_b32 v57, v47, 16, v46
v_lshl_or_b32 v58, v49, 16, v48
v_lshl_or_b32 v59, v51, 16, v50
s_nop 1
Mvvv 176,56,52
s_nop 3
buffer_load_ushort v44, v41, s[20:23], s3 offen offset:160
buffer_load_ushort v45, v41, s[20:23], s3 offen offset:416
buffer_load_ushort v46, v41, s[20:23], s3 offen offset:672
buffer_load_ushort v47, v41, s[20:23], s3 offen offset:928
buffer_load_ushort v48, v41, s[20:23], s4 offen offset:160
buffer_load_ushort v49, v41, s[20:23], s4 offen offset:416
buffer_load_ushort v50, v41, s[20:23], s4 offen offset:672
buffer_load_ushort v51, v41, s[20:23], s4 offen offset:928
s_waitcnt vmcnt(0)
v_lshl_or_b32 v56, v45, 16, v44
v_lshl_or_b32 v57, v47, 16, v46
v_lshl_or_b32 v58, v49, 16, v48
v_lshl_or_b32 v59, v51, 16, v50
s_nop 1
Mvvv 180,56,52
s_nop 3
buffer_load_ushort v44, v41, s[20:23], s3 offen offset:192
buffer_load_ushort v45, v41, s[20:23], s3 offen offset:448
buffer_load_ushort v46, v41, s[20:23], s3 offen offset:704
buffer_load_ushort v47, v41, s[20:23], s3 offen offset:960
buffer_load_ushort v48, v41, s[20:23], s4 offen offset:192
buffer_load_ushort v49, v41, s[20:23], s4 offen offset:448
buffer_load_ushort v50, v41, s[20:23], s4 offen offset:704
buffer_load_ushort v51, v41, s[20:23], s4 offen offset:960
s_waitcnt vmcnt(0)
v_lshl_or_b32 v56, v45, 16, v44
v_lshl_or_b32 v57, v47, 16, v46
v_lshl_or_b32 v58, v49, 16, v48
v_lshl_or_b32 v59, v51, 16, v50
s_nop 1
Mvvv 184,56,52
s_nop 3
buffer_load_ushort v44, v41, s[20:23], s3 offen offset:224
buffer_load_ushort v45, v41, s[20:23], s3 offen offset:480
buffer_load_ushort v46, v41, s[20:23], s3 offen offset:736
buffer_load_ushort v47, v41, s[20:23], s3 offen offset:992
buffer_load_ushort v48, v41, s[20:23], s4 offen offset:224
buffer_load_ushort v49, v41, s[20:23], s4 offen offset:480
buffer_load_ushort v50, v41, s[20:23], s4 offen offset:736
buffer_load_ushort v51, v41, s[20:23], s4 offen offset:992
s_waitcnt vmcnt(0)
v_lshl_or_b32 v56, v45, 16, v44
v_lshl_or_b32 v57, v47, 16, v46
v_lshl_or_b32 v58, v49, 16, v48
v_lshl_or_b32 v59, v51, 16, v50
s_nop 1
Mvvv 188,56,52
s_nop 3
s_add_u32 s3, s3, 8192
s_cmp_lg_u32 s3, s5
s_cbranch_scc1 L1b_ffin1_s2
s_nop 7
s_nop 7
v_mov_b32 v43, v113
s_nop 1
v_permlane32_swap_b32 v113, v43
s_nop 1
v_add_f32 v113, v113, v43
v_mov_b32 v43, v113
s_nop 1
v_permlane16_swap_b32 v113, v43
s_nop 1
v_add_f32 v113, v113, v43
s_nop 1
s_branch L1b_ffin1_rcp
L1b_flush2_slow:
s_nop 7
v_lshrrev_b32 v42, 4, v1
v_and_b32 v43, 15, v42
v_lshrrev_b32 v42, 4, v42
v_lshlrev_b32 v40, 4, v42
v_lshl_add_u32 v40, v43, 8, v40
v_lshlrev_b32 v41, 1, v43
v_lshl_add_u32 v41, v42, 10, v41
v_mov_b32 v42, 0xff800000
s_mov_b32 s3, 0x0
s_mov_b32 s5, 0x40000
L1b_flush2_s1:
Pv 192,40,16,3,0
Pv 196,40,16,3,64
Pv 200,40,16,3,128
Pv 204,40,16,3,192
s_waitcnt vmcnt(0)
Zvva 44,192,32
Mvva 44,196,36
Mvva 44,200,40
Mvva 44,204,44
s_nop 7
s_nop 1
v_max3_f32 v42, v42, v44, v45
v_max3_f32 v42, v42, v46, v47
s_add_u32 s3, s3, 4096
s_cmp_lg_u32 s3, s5
s_cbranch_scc1 L1b_flush2_s1
v_mov_b32 v43, v42
s_nop 1
v_permlane32_swap_b32 v42, v43
s_nop 1
v_max_f32 v42, v42, v43
v_mov_b32 v43, v42
s_nop 1
v_permlane16_swap_b32 v42, v43
s_nop 1
v_max_f32 v42, v42, v43
v_mov_b64 v[192:193], 0
v_mov_b64 v[194:195], 0
v_mov_b64 v[196:197], 0
v_mov_b64 v[198:199], 0
v_mov_b64 v[200:201], 0
v_mov_b64 v[202:203], 0
v_mov_b64 v[204:205], 0
v_mov_b64 v[206:207], 0
v_mov_b64 v[208:209], 0
v_mov_b64 v[210:211], 0
v_mov_b64 v[212:213], 0
v_mov_b64 v[214:215], 0
v_mov_b64 v[216:217], 0
v_mov_b64 v[218:219], 0
v_mov_b64 v[220:221], 0
v_mov_b64 v[222:223], 0
v_mov_b32 v114, 0
s_mov_b32 s3, 0x0
L1b_flush2_s2:
s_add_u32 s4, s3, 4096
Pv 56,40,16,3,0
Pv 60,40,16,3,64
s_waitcnt vmcnt(0)
Zvva 44,56,32
Mvva 44,60,36
s_nop 3
Pv 56,40,16,3,128
Pv 60,40,16,3,192
s_waitcnt vmcnt(0)
Mvva 44,56,40
Mvva 44,60,44
s_nop 3
Pv 56,40,16,4,0
Pv 60,40,16,4,64
s_waitcnt vmcnt(0)
Zvva 48,56,32
Mvva 48,60,36
s_nop 3
Pv 56,40,16,4,128
Pv 60,40,16,4,192
s_waitcnt vmcnt(0)
Mvva 48,56,40
Mvva 48,60,44
s_nop 3
s_nop 7
s_nop 1
v_sub_f32 v44, v44, v42
v_sub_f32 v45, v45, v42
v_sub_f32 v46, v46, v42
v_sub_f32 v47, v47, v42
v_sub_f32 v48, v48, v42
v_sub_f32 v49, v49, v42
v_sub_f32 v50, v50, v42
v_sub_f32 v51, v51, v42
EX 44
EX 45
EX 46
EX 47
EX 48
EX 49
EX 50
EX 51
s_nop 1
AD 114,44
AD 114,45
AD 114,46
AD 114,47
AD 114,48
AD 114,49
AD 114,50
AD 114,51
CV 52,44
CV 53,46
CV 54,48
CV 55,50
buffer_load_ushort v44, v41, s[20:23], s3 offen offset:0
buffer_load_ushort v45, v41, s[20:23], s3 offen offset:256
buffer_load_ushort v46, v41, s[20:23], s3 offen offset:512
buffer_load_ushort v47, v41, s[20:23], s3 offen offset:768
buffer_load_ushort v48, v41, s[20:23], s4 offen offset:0
buffer_load_ushort v49, v41, s[20:23], s4 offen offset:256
buffer_load_ushort v50, v41, s[20:23], s4 offen offset:512
buffer_load_ushort v51, v41, s[20:23], s4 offen offset:768
s_waitcnt vmcnt(0)
v_lshl_or_b32 v56, v45, 16, v44
v_lshl_or_b32 v57, v47, 16, v46
v_lshl_or_b32 v58, v49, 16, v48
v_lshl_or_b32 v59, v51, 16, v50
s_nop 1
Mvvv 192,56,52
s_nop 3
buffer_load_ushort v44, v41, s[20:23], s3 offen offset:32
buffer_load_ushort v45, v41, s[20:23], s3 offen offset:288
buffer_load_ushort v46, v41, s[20:23], s3 offen offset:544
buffer_load_ushort v47, v41, s[20:23], s3 offen offset:800
buffer_load_ushort v48, v41, s[20:23], s4 offen offset:32
buffer_load_ushort v49, v41, s[20:23], s4 offen offset:288
buffer_load_ushort v50, v41, s[20:23], s4 offen offset:544
buffer_load_ushort v51, v41, s[20:23], s4 offen offset:800
s_waitcnt vmcnt(0)
v_lshl_or_b32 v56, v45, 16, v44
v_lshl_or_b32 v57, v47, 16, v46
v_lshl_or_b32 v58, v49, 16, v48
v_lshl_or_b32 v59, v51, 16, v50
s_nop 1
Mvvv 196,56,52
s_nop 3
buffer_load_ushort v44, v41, s[20:23], s3 offen offset:64
buffer_load_ushort v45, v41, s[20:23], s3 offen offset:320
buffer_load_ushort v46, v41, s[20:23], s3 offen offset:576
buffer_load_ushort v47, v41, s[20:23], s3 offen offset:832
buffer_load_ushort v48, v41, s[20:23], s4 offen offset:64
buffer_load_ushort v49, v41, s[20:23], s4 offen offset:320
buffer_load_ushort v50, v41, s[20:23], s4 offen offset:576
buffer_load_ushort v51, v41, s[20:23], s4 offen offset:832
s_waitcnt vmcnt(0)
v_lshl_or_b32 v56, v45, 16, v44
v_lshl_or_b32 v57, v47, 16, v46
v_lshl_or_b32 v58, v49, 16, v48
v_lshl_or_b32 v59, v51, 16, v50
s_nop 1
Mvvv 200,56,52
s_nop 3
buffer_load_ushort v44, v41, s[20:23], s3 offen offset:96
buffer_load_ushort v45, v41, s[20:23], s3 offen offset:352
buffer_load_ushort v46, v41, s[20:23], s3 offen offset:608
buffer_load_ushort v47, v41, s[20:23], s3 offen offset:864
buffer_load_ushort v48, v41, s[20:23], s4 offen offset:96
buffer_load_ushort v49, v41, s[20:23], s4 offen offset:352
buffer_load_ushort v50, v41, s[20:23], s4 offen offset:608
buffer_load_ushort v51, v41, s[20:23], s4 offen offset:864
s_waitcnt vmcnt(0)
v_lshl_or_b32 v56, v45, 16, v44
v_lshl_or_b32 v57, v47, 16, v46
v_lshl_or_b32 v58, v49, 16, v48
v_lshl_or_b32 v59, v51, 16, v50
s_nop 1
Mvvv 204,56,52
s_nop 3
buffer_load_ushort v44, v41, s[20:23], s3 offen offset:128
buffer_load_ushort v45, v41, s[20:23], s3 offen offset:384
buffer_load_ushort v46, v41, s[20:23], s3 offen offset:640
buffer_load_ushort v47, v41, s[20:23], s3 offen offset:896
buffer_load_ushort v48, v41, s[20:23], s4 offen offset:128
buffer_load_ushort v49, v41, s[20:23], s4 offen offset:384
buffer_load_ushort v50, v41, s[20:23], s4 offen offset:640
buffer_load_ushort v51, v41, s[20:23], s4 offen offset:896
s_waitcnt vmcnt(0)
v_lshl_or_b32 v56, v45, 16, v44
v_lshl_or_b32 v57, v47, 16, v46
v_lshl_or_b32 v58, v49, 16, v48
v_lshl_or_b32 v59, v51, 16, v50
s_nop 1
Mvvv 208,56,52
s_nop 3
buffer_load_ushort v44, v41, s[20:23], s3 offen offset:160
buffer_load_ushort v45, v41, s[20:23], s3 offen offset:416
buffer_load_ushort v46, v41, s[20:23], s3 offen offset:672
buffer_load_ushort v47, v41, s[20:23], s3 offen offset:928
buffer_load_ushort v48, v41, s[20:23], s4 offen offset:160
buffer_load_ushort v49, v41, s[20:23], s4 offen offset:416
buffer_load_ushort v50, v41, s[20:23], s4 offen offset:672
buffer_load_ushort v51, v41, s[20:23], s4 offen offset:928
s_waitcnt vmcnt(0)
v_lshl_or_b32 v56, v45, 16, v44
v_lshl_or_b32 v57, v47, 16, v46
v_lshl_or_b32 v58, v49, 16, v48
v_lshl_or_b32 v59, v51, 16, v50
s_nop 1
Mvvv 212,56,52
s_nop 3
buffer_load_ushort v44, v41, s[20:23], s3 offen offset:192
buffer_load_ushort v45, v41, s[20:23], s3 offen offset:448
buffer_load_ushort v46, v41, s[20:23], s3 offen offset:704
buffer_load_ushort v47, v41, s[20:23], s3 offen offset:960
buffer_load_ushort v48, v41, s[20:23], s4 offen offset:192
buffer_load_ushort v49, v41, s[20:23], s4 offen offset:448
buffer_load_ushort v50, v41, s[20:23], s4 offen offset:704
buffer_load_ushort v51, v41, s[20:23], s4 offen offset:960
s_waitcnt vmcnt(0)
v_lshl_or_b32 v56, v45, 16, v44
v_lshl_or_b32 v57, v47, 16, v46
v_lshl_or_b32 v58, v49, 16, v48
v_lshl_or_b32 v59, v51, 16, v50
s_nop 1
Mvvv 216,56,52
s_nop 3
buffer_load_ushort v44, v41, s[20:23], s3 offen offset:224
buffer_load_ushort v45, v41, s[20:23], s3 offen offset:480
buffer_load_ushort v46, v41, s[20:23], s3 offen offset:736
buffer_load_ushort v47, v41, s[20:23], s3 offen offset:992
buffer_load_ushort v48, v41, s[20:23], s4 offen offset:224
buffer_load_ushort v49, v41, s[20:23], s4 offen offset:480
buffer_load_ushort v50, v41, s[20:23], s4 offen offset:736
buffer_load_ushort v51, v41, s[20:23], s4 offen offset:992
s_waitcnt vmcnt(0)
v_lshl_or_b32 v56, v45, 16, v44
v_lshl_or_b32 v57, v47, 16, v46
v_lshl_or_b32 v58, v49, 16, v48
v_lshl_or_b32 v59, v51, 16, v50
s_nop 1
Mvvv 220,56,52
s_nop 3
s_add_u32 s3, s3, 8192
s_cmp_lg_u32 s3, s5
s_cbranch_scc1 L1b_flush2_s2
s_nop 7
s_nop 7
v_mov_b32 v43, v114
s_nop 1
v_permlane32_swap_b32 v114, v43
s_nop 1
v_add_f32 v114, v114, v43
v_mov_b32 v43, v114
s_nop 1
v_permlane16_swap_b32 v114, v43
s_nop 1
v_add_f32 v114, v114, v43
s_nop 1
s_branch L1b_flush2_rcp
L1b_ffin2_slow:
s_nop 7
v_lshrrev_b32 v42, 4, v1
v_and_b32 v43, 15, v42
v_lshrrev_b32 v42, 4, v42
v_lshlrev_b32 v40, 4, v42
v_lshl_add_u32 v40, v43, 8, v40
v_lshlrev_b32 v41, 1, v43
v_lshl_add_u32 v41, v42, 10, v41
v_mov_b32 v42, 0xff800000
s_mov_b32 s3, 0x40000
s_mov_b32 s5, 0x80000
L1b_ffin2_s1:
Pv 192,40,16,3,0
Pv 196,40,16,3,64
Pv 200,40,16,3,128
Pv 204,40,16,3,192
s_waitcnt vmcnt(0)
Zvva 44,192,32
Mvva 44,196,36
Mvva 44,200,40
Mvva 44,204,44
s_nop 7
s_nop 1
v_max3_f32 v42, v42, v44, v45
v_max3_f32 v42, v42, v46, v47
s_add_u32 s3, s3, 4096
s_cmp_lg_u32 s3, s5
s_cbranch_scc1 L1b_ffin2_s1
v_mov_b32 v43, v42
s_nop 1
v_permlane32_swap_b32 v42, v43
s_nop 1
v_max_f32 v42, v42, v43
v_mov_b32 v43, v42
s_nop 1
v_permlane16_swap_b32 v42, v43
s_nop 1
v_max_f32 v42, v42, v43
v_mov_b64 v[192:193], 0
v_mov_b64 v[194:195], 0
v_mov_b64 v[196:197], 0
v_mov_b64 v[198:199], 0
v_mov_b64 v[200:201], 0
v_mov_b64 v[202:203], 0
v_mov_b64 v[204:205], 0
v_mov_b64 v[206:207], 0
v_mov_b64 v[208:209], 0
v_mov_b64 v[210:211], 0
v_mov_b64 v[212:213], 0
v_mov_b64 v[214:215], 0
v_mov_b64 v[216:217], 0
v_mov_b64 v[218:219], 0
v_mov_b64 v[220:221], 0
v_mov_b64 v[222:223], 0
v_mov_b32 v114, 0
s_mov_b32 s3, 0x40000
L1b_ffin2_s2:
s_add_u32 s4, s3, 4096
Pv 56,40,16,3,0
Pv 60,40,16,3,64
s_waitcnt vmcnt(0)
Zvva 44,56,32
Mvva 44,60,36
s_nop 3
Pv 56,40,16,3,128
Pv 60,40,16,3,192
s_waitcnt vmcnt(0)
Mvva 44,56,40
Mvva 44,60,44
s_nop 3
Pv 56,40,16,4,0
Pv 60,40,16,4,64
s_waitcnt vmcnt(0)
Zvva 48,56,32
Mvva 48,60,36
s_nop 3
Pv 56,40,16,4,128
Pv 60,40,16,4,192
s_waitcnt vmcnt(0)
Mvva 48,56,40
Mvva 48,60,44
s_nop 3
s_nop 7
s_nop 1
v_sub_f32 v44, v44, v42
v_sub_f32 v45, v45, v42
v_sub_f32 v46, v46, v42
v_sub_f32 v47, v47, v42
v_sub_f32 v48, v48, v42
v_sub_f32 v49, v49, v42
v_sub_f32 v50, v50, v42
v_sub_f32 v51, v51, v42
EX 44
EX 45
EX 46
EX 47
EX 48
EX 49
EX 50
EX 51
s_nop 1
AD 114,44
AD 114,45
AD 114,46
AD 114,47
AD 114,48
AD 114,49
AD 114,50
AD 114,51
CV 52,44
CV 53,46
CV 54,48
CV 55,50
buffer_load_ushort v44, v41, s[20:23], s3 offen offset:0
buffer_load_ushort v45, v41, s[20:23], s3 offen offset:256
buffer_load_ushort v46, v41, s[20:23], s3 offen offset:512
buffer_load_ushort v47, v41, s[20:23], s3 offen offset:768
buffer_load_ushort v48, v41, s[20:23], s4 offen offset:0
buffer_load_ushort v49, v41, s[20:23], s4 offen offset:256
buffer_load_ushort v50, v41, s[20:23], s4 offen offset:512
buffer_load_ushort v51, v41, s[20:23], s4 offen offset:768
s_waitcnt vmcnt(0)
v_lshl_or_b32 v56, v45, 16, v44
v_lshl_or_b32 v57, v47, 16, v46
v_lshl_or_b32 v58, v49, 16, v48
v_lshl_or_b32 v59, v51, 16, v50
s_nop 1
Mvvv 192,56,52
s_nop 3
buffer_load_ushort v44, v41, s[20:23], s3 offen offset:32
buffer_load_ushort v45, v41, s[20:23], s3 offen offset:288
buffer_load_ushort v46, v41, s[20:23], s3 offen offset:544
buffer_load_ushort v47, v41, s[20:23], s3 offen offset:800
buffer_load_ushort v48, v41, s[20:23], s4 offen offset:32
buffer_load_ushort v49, v41, s[20:23], s4 offen offset:288
buffer_load_ushort v50, v41, s[20:23], s4 offen offset:544
buffer_load_ushort v51, v41, s[20:23], s4 offen offset:800
s_waitcnt vmcnt(0)
v_lshl_or_b32 v56, v45, 16, v44
v_lshl_or_b32 v57, v47, 16, v46
v_lshl_or_b32 v58, v49, 16, v48
v_lshl_or_b32 v59, v51, 16, v50
s_nop 1
Mvvv 196,56,52
s_nop 3
buffer_load_ushort v44, v41, s[20:23], s3 offen offset:64
buffer_load_ushort v45, v41, s[20:23], s3 offen offset:320
buffer_load_ushort v46, v41, s[20:23], s3 offen offset:576
buffer_load_ushort v47, v41, s[20:23], s3 offen offset:832
buffer_load_ushort v48, v41, s[20:23], s4 offen offset:64
buffer_load_ushort v49, v41, s[20:23], s4 offen offset:320
buffer_load_ushort v50, v41, s[20:23], s4 offen offset:576
buffer_load_ushort v51, v41, s[20:23], s4 offen offset:832
s_waitcnt vmcnt(0)
v_lshl_or_b32 v56, v45, 16, v44
v_lshl_or_b32 v57, v47, 16, v46
v_lshl_or_b32 v58, v49, 16, v48
v_lshl_or_b32 v59, v51, 16, v50
s_nop 1
Mvvv 200,56,52
s_nop 3
buffer_load_ushort v44, v41, s[20:23], s3 offen offset:96
buffer_load_ushort v45, v41, s[20:23], s3 offen offset:352
buffer_load_ushort v46, v41, s[20:23], s3 offen offset:608
buffer_load_ushort v47, v41, s[20:23], s3 offen offset:864
buffer_load_ushort v48, v41, s[20:23], s4 offen offset:96
buffer_load_ushort v49, v41, s[20:23], s4 offen offset:352
buffer_load_ushort v50, v41, s[20:23], s4 offen offset:608
buffer_load_ushort v51, v41, s[20:23], s4 offen offset:864
s_waitcnt vmcnt(0)
v_lshl_or_b32 v56, v45, 16, v44
v_lshl_or_b32 v57, v47, 16, v46
v_lshl_or_b32 v58, v49, 16, v48
v_lshl_or_b32 v59, v51, 16, v50
s_nop 1
Mvvv 204,56,52
s_nop 3
buffer_load_ushort v44, v41, s[20:23], s3 offen offset:128
buffer_load_ushort v45, v41, s[20:23], s3 offen offset:384
buffer_load_ushort v46, v41, s[20:23], s3 offen offset:640
buffer_load_ushort v47, v41, s[20:23], s3 offen offset:896
buffer_load_ushort v48, v41, s[20:23], s4 offen offset:128
buffer_load_ushort v49, v41, s[20:23], s4 offen offset:384
buffer_load_ushort v50, v41, s[20:23], s4 offen offset:640
buffer_load_ushort v51, v41, s[20:23], s4 offen offset:896
s_waitcnt vmcnt(0)
v_lshl_or_b32 v56, v45, 16, v44
v_lshl_or_b32 v57, v47, 16, v46
v_lshl_or_b32 v58, v49, 16, v48
v_lshl_or_b32 v59, v51, 16, v50
s_nop 1
Mvvv 208,56,52
s_nop 3
buffer_load_ushort v44, v41, s[20:23], s3 offen offset:160
buffer_load_ushort v45, v41, s[20:23], s3 offen offset:416
buffer_load_ushort v46, v41, s[20:23], s3 offen offset:672
buffer_load_ushort v47, v41, s[20:23], s3 offen offset:928
buffer_load_ushort v48, v41, s[20:23], s4 offen offset:160
buffer_load_ushort v49, v41, s[20:23], s4 offen offset:416
buffer_load_ushort v50, v41, s[20:23], s4 offen offset:672
buffer_load_ushort v51, v41, s[20:23], s4 offen offset:928
s_waitcnt vmcnt(0)
v_lshl_or_b32 v56, v45, 16, v44
v_lshl_or_b32 v57, v47, 16, v46
v_lshl_or_b32 v58, v49, 16, v48
v_lshl_or_b32 v59, v51, 16, v50
s_nop 1
Mvvv 212,56,52
s_nop 3
buffer_load_ushort v44, v41, s[20:23], s3 offen offset:192
buffer_load_ushort v45, v41, s[20:23], s3 offen offset:448
buffer_load_ushort v46, v41, s[20:23], s3 offen offset:704
buffer_load_ushort v47, v41, s[20:23], s3 offen offset:960
buffer_load_ushort v48, v41, s[20:23], s4 offen offset:192
buffer_load_ushort v49, v41, s[20:23], s4 offen offset:448
buffer_load_ushort v50, v41, s[20:23], s4 offen offset:704
buffer_load_ushort v51, v41, s[20:23], s4 offen offset:960
s_waitcnt vmcnt(0)
v_lshl_or_b32 v56, v45, 16, v44
v_lshl_or_b32 v57, v47, 16, v46
v_lshl_or_b32 v58, v49, 16, v48
v_lshl_or_b32 v59, v51, 16, v50
s_nop 1
Mvvv 216,56,52
s_nop 3
buffer_load_ushort v44, v41, s[20:23], s3 offen offset:224
buffer_load_ushort v45, v41, s[20:23], s3 offen offset:480
buffer_load_ushort v46, v41, s[20:23], s3 offen offset:736
buffer_load_ushort v47, v41, s[20:23], s3 offen offset:992
buffer_load_ushort v48, v41, s[20:23], s4 offen offset:224
buffer_load_ushort v49, v41, s[20:23], s4 offen offset:480
buffer_load_ushort v50, v41, s[20:23], s4 offen offset:736
buffer_load_ushort v51, v41, s[20:23], s4 offen offset:992
s_waitcnt vmcnt(0)
v_lshl_or_b32 v56, v45, 16, v44
v_lshl_or_b32 v57, v47, 16, v46
v_lshl_or_b32 v58, v49, 16, v48
v_lshl_or_b32 v59, v51, 16, v50
s_nop 1
Mvvv 220,56,52
s_nop 3
s_add_u32 s3, s3, 8192
s_cmp_lg_u32 s3, s5
s_cbranch_scc1 L1b_ffin2_s2
s_nop 7
s_nop 7
v_mov_b32 v43, v114
s_nop 1
v_permlane32_swap_b32 v114, v43
s_nop 1
v_add_f32 v114, v114, v43
v_mov_b32 v43, v114
s_nop 1
v_permlane16_swap_b32 v114, v43
s_nop 1
v_add_f32 v114, v114, v43
s_nop 1
s_branch L1b_ffin2_rcp
.section .rodata,"a"
.p2align 6
.amdhsa_kernel concat_heads__mha_block_cached__gqa_block_cached__near_ridge_kernel
  .amdhsa_next_free_vgpr 512
  .amdhsa_next_free_sgpr 100
  .amdhsa_accum_offset 256
  .amdhsa_group_segment_fixed_size 0
  .amdhsa_kernarg_size 104
  .amdhsa_user_sgpr_count 2
  .amdhsa_user_sgpr_kernarg_segment_ptr 1
  .amdhsa_system_sgpr_workgroup_id_x 1
.end_amdhsa_kernel
```
